```python
import torch

def _softmax(x, axis=-1):
    return torch.softmax(x, dim=axis)
def _gelu(x):
    return torch.nn.functional.gelu(x, approximate="tanh")
def _silu(x):
    return torch.nn.functional.silu(x)
def _sigmoid(x):
    return torch.sigmoid(x)
def _layernorm(x, axis=-1, eps=1e-5):
    m = x.mean(dim=axis, keepdim=True)
    v = x.var(dim=axis, keepdim=True, unbiased=False)
    return (x - m) / torch.sqrt(v + eps)
def _scatter_add(tgt, idx, src, axis=0):
    return tgt.clone().index_add_(axis, idx, src)
def _segment_sum(src, seg, n):
    out = torch.zeros((n,) + src.shape[1:], dtype=src.dtype)
    return out.index_add_(0, seg, src)
def _pad(x, pw):
    flat = tuple(v for pair in reversed(pw) for v in pair)
    return torch.nn.functional.pad(x, flat)

kernel_name = 'parallel_sum__softmax_full_mha__mixer_s_mlp__prompt'

def setup_inputs():

    _w = (lambda a: (lambda t: t.to(torch.bfloat16) if t.is_floating_point() else t)(torch.as_tensor(a)))
    def _A_setup():
        B, S, D = 1, 2048, 576
        return {
            "x": _w((lambda *s: torch.randn(*s, dtype=torch.bfloat16) * 0.05)(B, S, D)),
            "wqkv": _w((lambda *s: torch.randn(*s, dtype=torch.bfloat16) * 0.1)(D, 3 * D)),
            "wo": _w((lambda *s: torch.randn(*s, dtype=torch.bfloat16) * 0.05)(D, D)),
        }
    _A_in = _A_setup()

    def _B_setup():
        B, S, D, F = 1, 2048, 576, 4608
        return {
            "x":  _w((lambda *s: torch.randn(*s, dtype=torch.bfloat16) * 0.05)(B, S, D)),
            "w1": _w((lambda *s: torch.randn(*s, dtype=torch.bfloat16) * 3.2)(D, D) * (D ** -0.5)),
            "w2": _w((lambda *s: torch.randn(*s, dtype=torch.bfloat16) * 3.2)(D, D) * (D ** -0.5)),
            "w3": _w((lambda *s: torch.randn(*s, dtype=torch.bfloat16) * 3.2)(D, F) * (D ** -0.5)),
            "w4": _w((lambda *s: torch.randn(*s, dtype=torch.bfloat16) * 3.2)(F, D) * (F ** -0.5)),
        }
    _B_in = _B_setup()

    return {
        "A_x": _A_in["x"],
        "A_wqkv": _A_in["wqkv"],
        "A_wo": _A_in["wo"],
        "B_x": _B_in["x"],
        "B_w1": _B_in["w1"],
        "B_w2": _B_in["w2"],
        "B_w3": _B_in["w3"],
        "B_w4": _B_in["w4"],
    }

def reference(A_x, A_wqkv, A_wo, B_x, B_w1, B_w2, B_w3, B_w4):
    def _A_ref(x, wqkv, wo):
        B, S, D = x.shape
        H = 32; Dh = D // H
        qkv = (lambda x, *d: x.permute(*d))((x @ wqkv).reshape(B, S, 3, H, Dh), 2, 0, 3, 1, 4)
        q, k, v = qkv[0], qkv[1], qkv[2]
        scale = Dh ** -0.5
        scores = torch.einsum("bhqd,bhkd->bhqk", q, k) * scale
        p = _softmax(scores, axis=-1)
        o = torch.einsum("bhqk,bhkd->bhqd", p, v)
        return (lambda x, *d: x.permute(*d))(o, 0, 2, 1, 3).reshape(B, S, D) @ wo

    def _B_ref(x, w1, w2, w3, w4):
        B, S, D = x.shape
        h = _gelu(_layernorm(x, axis=-1) @ w1)
        c = D // 4
        g0 = _pad(h[:, :, 0*c:1*c], ((0, 0), (1, 0), (0, 0)))[:, :S, :]
        g1 = _pad(h[:, :, 1*c:2*c], ((0, 0), (0, 1), (0, 0)))[:, 1:, :]
        g2 = _pad(h[:, :, 2*c:3*c], ((0, 0), (2, 0), (0, 0)))[:, :S, :]
        g3 = _pad(h[:, :, 3*c:   ], ((0, 0), (0, 2), (0, 0)))[:, 2:, :]
        hs = torch.concatenate([g0, g1, g2, g3], axis=-1) @ w2
        x1 = x + hs
        h2 = _gelu(_layernorm(x1, axis=-1) @ w3) @ w4
        return x1 + h2

    x = A_x
    xn = _layernorm(x, axis=-1)
    return x + _A_ref(xn, A_wqkv, A_wo) + _B_ref(xn, B_w1, B_w2, B_w3, B_w4)
```

```asm
; @launch kernel=proj_kernel grid=(256,1,1) block=(512,1,1) lds=158336
; @launch kernel=main_kernel grid=(512,1,1) block=(256,1,1) lds=79872
.amdgcn_target "amdgcn-amd-amdhsa--gfx950"
.text
.p2align 8
code_start:
.text
.globl proj_kernel
.p2align 8
.type proj_kernel,@function
proj_kernel:
  s_cmp_ge_u32 s2, 256
  s_cbranch_scc1 Ldone2_2
  s_load_dwordx4 s[4:7], s[0:1], 0
  s_load_dwordx4 s[16:19], s[0:1], 32
  s_load_dwordx2 s[12:13], s[0:1], 80
  s_load_dwordx2 s[56:57], s[0:1], 16
  v_lshrrev_b32 v1, 6, v0
  v_and_b32 v13, 63, v0
  v_readfirstlane_b32 s20, v1
  s_lshr_b32 s46, s2, 3
  s_and_b32 s31, s2, 1
  s_lshl_b32 s31, s31, 3
  s_and_b32 s23, s46, 7
  s_add_u32 s23, s23, s31
  s_bfe_u32 s31, s2, 0x20001
  s_lshl_b32 s31, s31, 2
  s_lshr_b32 s47, s46, 3
  s_add_u32 s24, s47, s31
  s_and_b32 s21, s20, 3
  s_lshr_b32 s22, s20, 2
  s_getpc_b64 s[42:43]
Lpc_3:
  s_add_u32 s42, s42, code_start-Lpc_3
  s_addc_u32 s43, s43, ((code_start-Lpc_3)>>32)
  s_mul_i32 s44, s46, 8
  s_add_u32 s44, s44, s20
  s_lshl_b32 s44, s44, 9
  v_and_b32 v14, 63, v0
  v_lshlrev_b32 v14, 3, v14
  v_add_u32 v14, s44, v14
  v_min_u32 v14, code_end-code_start-8, v14
  global_load_dword v19, v14, s[42:43]
  v_lshrrev_b32 v14, 2, v13
  s_lshl_b32 s31, s23, 3
  s_add_u32 s31, s31, s20
  s_lshl_b32 s31, s31, 4
  v_add_u32 v15, s31, v14
  v_mul_u32_u24 v15, 1152, v15
  v_lshrrev_b32 v14, 4, v13
  v_and_b32 v14, 2, v14
  v_xor_b32 v14, v14, v13
  v_and_b32 v14, 3, v14
  v_lshl_add_u32 v1, v14, 4, v15
  s_movk_i32 s25, 3456
  s_cmp_ge_u32 s24, 12
  s_cselect_b32 s25, 1152, s25
  s_cselect_b32 s31, s47, s24
  s_mul_i32 s48, s31, 288
  s_lshl_b32 s28, s25, 5
  s_lshl_b32 s29, s20, 10
  s_add_u32 s30, s29, 8192
  v_mul_u32_u24 v15, 3641, v0
  v_lshrrev_b32 v15, 16, v15
  v_mul_u32_u24 v16, 18, v15
  v_sub_u32 v16, v0, v16
  v_lshlrev_b32 v16, 4, v16
  v_add_u32 v16, s48, v16
  v_lshrrev_b32 v2, 1, v15
  v_xor_b32 v2, v2, v15
  v_and_b32 v2, 4, v2
  v_mul_u32_u24 v2, 3, v2
  v_xor_b32 v15, v2, v15
  v_mad_u32_u24 v2, v15, s25, v16
  v_bfe_u32 v14, v0, 2, 6
  v_add_u32 v14, 512, v14
  v_mul_u32_u24 v15, 3641, v14
  v_lshrrev_b32 v15, 16, v15
  v_mul_u32_u24 v16, 18, v15
  v_sub_u32 v16, v14, v16
  v_lshlrev_b32 v16, 4, v16
  v_add_u32 v16, s48, v16
  v_lshrrev_b32 v3, 1, v15
  v_xor_b32 v3, v3, v15
  v_and_b32 v3, 4, v3
  v_mul_u32_u24 v3, 3, v3
  v_xor_b32 v15, v3, v15
  v_mad_u32_u24 v3, v15, s25, v16
  v_and_b32 v14, 3, v0
  v_lshl_add_u32 v3, v14, 2, v3
  s_lshl_b32 s53, s21, 8
  s_add_u32 s53, s53, 16384
  s_and_b32 s49, s46, 7
  s_lshl_b32 s49, s49, 1
  s_mul_i32 s31, s47, 9
  s_lshr_b32 s31, s31, 1
  s_add_u32 s49, s49, s31
  s_lshr_b32 s31, s24, 2
  s_add_u32 s49, s49, s31
  s_sub_u32 s31, s49, 18
  s_cselect_b32 s49, s49, s31
  s_lshl_b32 s26, s49, 6
  s_mul_i32 s27, s49, s28
  s_waitcnt lgkmcnt(0)
  s_cmp_ge_u32 s24, 12
  s_cselect_b32 s8, s16, s6
  s_cselect_b32 s9, s17, s7
  s_mov_b32 s10, 1990656
  s_cselect_b32 s10, 663552, s10
  s_mov_b32 s11, 0x20000
  s_mov_b32 s6, 2359296
  s_mov_b32 s7, 0x20000
  s_mov_b32 s16, s18
  s_mov_b32 s17, s19
  s_mov_b32 s18, 663552
  s_mov_b32 s19, 0x20000
  s_mov_b32 s14, 268435456
  s_mov_b32 s15, 0x20000
  s_nop 0
  s_mul_i32 s31, s23, 12
  s_add_u32 s31, s31, s24
  s_mul_i32 s31, s31, 3
  s_add_u32 s31, s31, s20
  s_mul_i32 s42, s31, 1152
  v_lshlrev_b32 v14, 4, v13
  s_add_u32 m0, s29, 0
  s_nop 0
  buffer_load_dwordx4 v1, s[4:7], s26 offen lds
  s_add_u32 m0, s30, 0
  s_add_u32 s26, s26, 64
  buffer_load_dwordx4 v2, s[8:11], s27 offen lds
  s_add_u32 m0, s53, 0
  s_cmp_eq_u32 s26, 1152
  s_cselect_b32 s26, 0, s26
  buffer_load_dword v3, s[8:11], s27 offen lds
  s_add_u32 s27, s27, s28
  s_cmp_eq_u32 s26, 0
  s_cselect_b32 s27, 0, s27
  s_add_u32 m0, s29, 17408
  s_nop 0
  buffer_load_dwordx4 v1, s[4:7], s26 offen lds
  s_add_u32 m0, s30, 17408
  s_add_u32 s26, s26, 64
  buffer_load_dwordx4 v2, s[8:11], s27 offen lds
  s_add_u32 m0, s53, 17408
  s_cmp_eq_u32 s26, 1152
  s_cselect_b32 s26, 0, s26
  buffer_load_dword v3, s[8:11], s27 offen lds
  s_add_u32 s27, s27, s28
  s_cmp_eq_u32 s26, 0
  s_cselect_b32 s27, 0, s27
  v_cmp_gt_u32 vcc, 8, v13
  v_mov_b32 v16, 0x7fff0000
  s_mov_b32 s52, s42
  v_mov_b32 v17, v14
  v_cndmask_b32 v18, v16, v14, vcc
  s_mov_b32 s44, s31
  v_and_b32 v14, 15, v13
  s_lshl_b32 s31, s21, 5
  v_add_u32 v15, s31, v14
  v_lshlrev_b32 v15, 6, v15
  v_lshrrev_b32 v14, 2, v13
  v_and_b32 v14, 2, v14
  v_lshrrev_b32 v16, 4, v13
  v_xor_b32 v14, v14, v16
  v_lshl_add_u32 v4, v14, 4, v15
  v_lshrrev_b32 v14, 5, v13
  v_lshlrev_b32 v14, 4, v14
  v_bfe_u32 v15, v13, 2, 3
  v_add_u32 v14, v14, v15
  v_mul_u32_u24 v14, 288, v14
  v_and_b32 v15, 3, v13
  v_lshl_add_u32 v14, v15, 3, v14
  s_mul_i32 s31, s22, 160
  s_add_u32 s31, s31, 8192
  v_add_u32 v7, s31, v14
  s_lshl_b32 s31, s21, 5
  v_add_u32 v10, s31, v7
  v_add_u32 v5, 52224, v4
  v_add_u32 v6, 104448, v4
  v_add_u32 v8, 52224, v7
  v_add_u32 v9, 104448, v7
  v_add_u32 v11, 52224, v10
  v_add_u32 v12, 104448, v10
  v_mov_b32 v20, 0x3f803f80
  v_mov_b32 v21, 0x3f803f80
  v_mov_b32 v22, 0x3f803f80
  v_mov_b32 v23, 0x3f803f80
  s_mov_b32 s34, 0x22222222
  s_mov_b32 s35, 0x22222222
  s_mov_b32 s36, 0x44444444
  s_mov_b32 s37, 0x44444444
  s_mov_b32 s38, 0x88888888
  s_mov_b32 s39, 0x88888888
  s_mov_b32 s40, 0x00F0000F
  s_mov_b32 s41, 0xF0000F00
  v_lshrrev_b32 v210, 4, v13
  v_lshlrev_b32 v210, 15, v210
  v_and_b32 v14, 15, v13
  v_lshl_add_u32 v210, v14, 4, v210
  s_lshl_b32 s51, s23, 2
  s_add_u32 s51, s51, s21
  s_lshl_b32 s51, s51, 1
  s_add_u32 s51, s51, s22
  s_lshl_b32 s51, s51, 8
  s_add_u32 s51, s51, 14798848
  s_cmp_ge_u32 s2, 11
  s_cbranch_scc1 Lnz_4
  v_mov_b32 v156, 0
  v_mov_b32 v157, 0
  v_lshlrev_b32 v14, 3, v0
  s_lshl_b32 s31, s2, 12
  s_add_u32 s31, s31, 36032512
  buffer_store_dwordx2 v[156:157], v14, s[12:15], s31 offen
Lnz_4:
  s_lshr_b32 s31, s24, 2
  s_cmp_eq_u32 s31, 2
  s_cbranch_scc1 Lisv_9
  s_cmp_eq_u32 s22, 0
  s_cbranch_scc1 Lk1_01_5
  s_branch Lk1_11_7
Lisv_9:
  s_cmp_eq_u32 s22, 0
  s_cbranch_scc1 Lk1_02_6
  s_branch Lk1_12_8
.p2align 6
Lk1_01_5:
  s_waitcnt vmcnt(3)
  s_barrier
  ds_read_b128 v[32:35], v4 offset:0
  ds_read_b128 v[36:39], v4 offset:1024
  ds_read_b64_tr_b16 v[40:41], v7 offset:0
  ds_read_b64_tr_b16 v[42:43], v7 offset:2304
  ds_read_b64_tr_b16 v[44:45], v7 offset:32
  ds_read_b64_tr_b16 v[46:47], v7 offset:2336
  ds_read_b64_tr_b16 v[48:49], v7 offset:64
  ds_read_b64_tr_b16 v[50:51], v7 offset:2368
  ds_read_b64_tr_b16 v[52:53], v7 offset:96
  ds_read_b64_tr_b16 v[54:55], v7 offset:2400
  ds_read_b64_tr_b16 v[56:57], v7 offset:128
  ds_read_b64_tr_b16 v[58:59], v7 offset:2432
  ds_read_b64_tr_b16 v[60:61], v10 offset:0
  ds_read_b64_tr_b16 v[62:63], v10 offset:2304
  s_add_u32 m0, s29, 34816
  s_nop 0
  buffer_load_dwordx4 v1, s[4:7], s26 offen lds
  s_add_u32 m0, s30, 34816
  s_add_u32 s26, s26, 64
  buffer_load_dwordx4 v2, s[8:11], s27 offen lds
  s_add_u32 m0, s53, 34816
  s_cmp_eq_u32 s26, 1152
  s_cselect_b32 s26, 0, s26
  buffer_load_dword v3, s[8:11], s27 offen lds
  s_add_u32 s27, s27, s28
  s_cmp_eq_u32 s26, 0
  s_cselect_b32 s27, 0, s27
  s_waitcnt lgkmcnt(0)
  s_waitcnt vmcnt(3)
  s_barrier
  v_mfma_f32_16x16x32_bf16 v[96:99], v[40:43], v[32:35], 0
  ds_read_b128 v[64:67], v4 offset:17408
  ds_read_b128 v[68:71], v4 offset:18432
  v_mfma_f32_16x16x32_bf16 v[100:103], v[40:43], v[36:39], 0
  ds_read_b64_tr_b16 v[72:73], v7 offset:17408
  ds_read_b64_tr_b16 v[74:75], v7 offset:19712
  ds_read_b64_tr_b16 v[76:77], v7 offset:17440
  v_mfma_f32_16x16x32_bf16 v[104:107], v[44:47], v[32:35], 0
  ds_read_b64_tr_b16 v[78:79], v7 offset:19744
  ds_read_b64_tr_b16 v[80:81], v7 offset:17472
  ds_read_b64_tr_b16 v[82:83], v7 offset:19776
  v_mfma_f32_16x16x32_bf16 v[108:111], v[44:47], v[36:39], 0
  ds_read_b64_tr_b16 v[84:85], v7 offset:17504
  ds_read_b64_tr_b16 v[86:87], v7 offset:19808
  ds_read_b64_tr_b16 v[88:89], v7 offset:17536
  v_mfma_f32_16x16x32_bf16 v[112:115], v[48:51], v[32:35], 0
  ds_read_b64_tr_b16 v[90:91], v7 offset:19840
  ds_read_b64_tr_b16 v[92:93], v10 offset:17408
  ds_read_b64_tr_b16 v[94:95], v10 offset:19712
  v_mfma_f32_16x16x32_bf16 v[116:119], v[48:51], v[36:39], 0
  s_add_u32 m0, s29, 52224
  s_nop 0
  buffer_load_dwordx4 v1, s[4:7], s26 offen lds
  v_mfma_f32_16x16x32_bf16 v[120:123], v[52:55], v[32:35], 0
  s_add_u32 m0, s30, 52224
  s_add_u32 s26, s26, 64
  v_mfma_f32_16x16x32_bf16 v[124:127], v[52:55], v[36:39], 0
  buffer_load_dwordx4 v2, s[8:11], s27 offen lds
  s_add_u32 m0, s53, 52224
  s_cmp_eq_u32 s26, 1152
  s_cselect_b32 s26, 0, s26
  v_mfma_f32_16x16x32_bf16 v[128:131], v[56:59], v[32:35], 0
  buffer_load_dword v3, s[8:11], s27 offen lds
  s_add_u32 s27, s27, s28
  s_cmp_eq_u32 s26, 0
  s_cselect_b32 s27, 0, s27
  s_add_u32 m0, s29, 69632
  v_mfma_f32_16x16x32_bf16 v[132:135], v[56:59], v[36:39], 0
  s_nop 0
  buffer_load_dwordx4 v1, s[4:7], s26 offen lds
  s_add_u32 m0, s30, 69632
  v_mfma_f32_16x16x32_bf16 v[136:139], v[20:23], v[60:63], 0
  s_add_u32 s26, s26, 64
  buffer_load_dwordx4 v2, s[8:11], s27 offen lds
  s_add_u32 m0, s53, 69632
  v_mfma_f32_16x16x32_bf16 v[140:143], v[20:23], v[56:59], 0
  s_cmp_eq_u32 s26, 1152
  s_cselect_b32 s26, 0, s26
  buffer_load_dword v3, s[8:11], s27 offen lds
  s_add_u32 s27, s27, s28
  s_cmp_eq_u32 s26, 0
  s_cselect_b32 s27, 0, s27
  s_waitcnt lgkmcnt(0)
  s_waitcnt vmcnt(6)
  s_barrier
  v_mfma_f32_16x16x32_bf16 v[96:99], v[72:75], v[64:67], v[96:99]
  ds_read_b128 v[32:35], v4 offset:34816
  ds_read_b128 v[36:39], v4 offset:35840
  v_mfma_f32_16x16x32_bf16 v[100:103], v[72:75], v[68:71], v[100:103]
  ds_read_b64_tr_b16 v[40:41], v7 offset:34816
  ds_read_b64_tr_b16 v[42:43], v7 offset:37120
  ds_read_b64_tr_b16 v[44:45], v7 offset:34848
  v_mfma_f32_16x16x32_bf16 v[104:107], v[76:79], v[64:67], v[104:107]
  ds_read_b64_tr_b16 v[46:47], v7 offset:37152
  ds_read_b64_tr_b16 v[48:49], v7 offset:34880
  ds_read_b64_tr_b16 v[50:51], v7 offset:37184
  v_mfma_f32_16x16x32_bf16 v[108:111], v[76:79], v[68:71], v[108:111]
  ds_read_b64_tr_b16 v[52:53], v7 offset:34912
  ds_read_b64_tr_b16 v[54:55], v7 offset:37216
  ds_read_b64_tr_b16 v[56:57], v7 offset:34944
  v_mfma_f32_16x16x32_bf16 v[112:115], v[80:83], v[64:67], v[112:115]
  ds_read_b64_tr_b16 v[58:59], v7 offset:37248
  ds_read_b64_tr_b16 v[60:61], v10 offset:34816
  ds_read_b64_tr_b16 v[62:63], v10 offset:37120
  v_mfma_f32_16x16x32_bf16 v[116:119], v[80:83], v[68:71], v[116:119]
  s_add_u32 m0, s29, 87040
  s_nop 0
  buffer_load_dwordx4 v1, s[4:7], s26 offen lds
  v_mfma_f32_16x16x32_bf16 v[120:123], v[84:87], v[64:67], v[120:123]
  s_add_u32 m0, s30, 87040
  s_add_u32 s26, s26, 64
  v_mfma_f32_16x16x32_bf16 v[124:127], v[84:87], v[68:71], v[124:127]
  buffer_load_dwordx4 v2, s[8:11], s27 offen lds
  s_add_u32 m0, s53, 87040
  s_cmp_eq_u32 s26, 1152
  s_cselect_b32 s26, 0, s26
  v_mfma_f32_16x16x32_bf16 v[128:131], v[88:91], v[64:67], v[128:131]
  buffer_load_dword v3, s[8:11], s27 offen lds
  s_add_u32 s27, s27, s28
  s_cmp_eq_u32 s26, 0
  s_cselect_b32 s27, 0, s27
  s_add_u32 m0, s29, 104448
  v_mfma_f32_16x16x32_bf16 v[132:135], v[88:91], v[68:71], v[132:135]
  s_nop 0
  buffer_load_dwordx4 v1, s[4:7], s26 offen lds
  s_add_u32 m0, s30, 104448
  v_mfma_f32_16x16x32_bf16 v[136:139], v[20:23], v[92:95], v[136:139]
  s_add_u32 s26, s26, 64
  buffer_load_dwordx4 v2, s[8:11], s27 offen lds
  s_add_u32 m0, s53, 104448
  v_mfma_f32_16x16x32_bf16 v[140:143], v[20:23], v[88:91], v[140:143]
  s_cmp_eq_u32 s26, 1152
  s_cselect_b32 s26, 0, s26
  buffer_load_dword v3, s[8:11], s27 offen lds
  s_add_u32 s27, s27, s28
  s_cmp_eq_u32 s26, 0
  s_cselect_b32 s27, 0, s27
  s_waitcnt lgkmcnt(0)
  s_waitcnt vmcnt(6)
  s_barrier
  v_mfma_f32_16x16x32_bf16 v[96:99], v[40:43], v[32:35], v[96:99]
  ds_read_b128 v[64:67], v5 offset:0
  ds_read_b128 v[68:71], v5 offset:1024
  v_mfma_f32_16x16x32_bf16 v[100:103], v[40:43], v[36:39], v[100:103]
  ds_read_b64_tr_b16 v[72:73], v8 offset:0
  ds_read_b64_tr_b16 v[74:75], v8 offset:2304
  v_mfma_f32_16x16x32_bf16 v[104:107], v[44:47], v[32:35], v[104:107]
  ds_read_b64_tr_b16 v[76:77], v8 offset:32
  ds_read_b64_tr_b16 v[78:79], v8 offset:2336
  v_mfma_f32_16x16x32_bf16 v[108:111], v[44:47], v[36:39], v[108:111]
  ds_read_b64_tr_b16 v[80:81], v8 offset:64
  ds_read_b64_tr_b16 v[82:83], v8 offset:2368
  v_mfma_f32_16x16x32_bf16 v[112:115], v[48:51], v[32:35], v[112:115]
  ds_read_b64_tr_b16 v[84:85], v8 offset:96
  ds_read_b64_tr_b16 v[86:87], v8 offset:2400
  v_mfma_f32_16x16x32_bf16 v[116:119], v[48:51], v[36:39], v[116:119]
  ds_read_b64_tr_b16 v[88:89], v8 offset:128
  ds_read_b64_tr_b16 v[90:91], v8 offset:2432
  v_mfma_f32_16x16x32_bf16 v[120:123], v[52:55], v[32:35], v[120:123]
  ds_read_b64_tr_b16 v[92:93], v11 offset:0
  ds_read_b64_tr_b16 v[94:95], v11 offset:2304
  v_mfma_f32_16x16x32_bf16 v[124:127], v[52:55], v[36:39], v[124:127]
  s_add_u32 m0, s29, 121856
  s_nop 0
  v_mfma_f32_16x16x32_bf16 v[128:131], v[56:59], v[32:35], v[128:131]
  buffer_load_dwordx4 v1, s[4:7], s26 offen lds
  s_add_u32 m0, s30, 121856
  v_mfma_f32_16x16x32_bf16 v[132:135], v[56:59], v[36:39], v[132:135]
  s_add_u32 s26, s26, 64
  buffer_load_dwordx4 v2, s[8:11], s27 offen lds
  v_mfma_f32_16x16x32_bf16 v[136:139], v[20:23], v[60:63], v[136:139]
  s_add_u32 m0, s53, 121856
  s_cmp_eq_u32 s26, 1152
  s_cselect_b32 s26, 0, s26
  v_mfma_f32_16x16x32_bf16 v[140:143], v[20:23], v[56:59], v[140:143]
  buffer_load_dword v3, s[8:11], s27 offen lds
  s_add_u32 s27, s27, s28
  s_cmp_eq_u32 s26, 0
  s_cselect_b32 s27, 0, s27
  s_waitcnt lgkmcnt(0)
  v_mfma_f32_16x16x32_bf16 v[96:99], v[72:75], v[64:67], v[96:99]
  ds_read_b128 v[32:35], v5 offset:17408
  ds_read_b128 v[36:39], v5 offset:18432
  v_mfma_f32_16x16x32_bf16 v[100:103], v[72:75], v[68:71], v[100:103]
  ds_read_b64_tr_b16 v[40:41], v8 offset:17408
  ds_read_b64_tr_b16 v[42:43], v8 offset:19712
  v_mfma_f32_16x16x32_bf16 v[104:107], v[76:79], v[64:67], v[104:107]
  ds_read_b64_tr_b16 v[44:45], v8 offset:17440
  ds_read_b64_tr_b16 v[46:47], v8 offset:19744
  v_mfma_f32_16x16x32_bf16 v[108:111], v[76:79], v[68:71], v[108:111]
  ds_read_b64_tr_b16 v[48:49], v8 offset:17472
  ds_read_b64_tr_b16 v[50:51], v8 offset:19776
  v_mfma_f32_16x16x32_bf16 v[112:115], v[80:83], v[64:67], v[112:115]
  ds_read_b64_tr_b16 v[52:53], v8 offset:17504
  ds_read_b64_tr_b16 v[54:55], v8 offset:19808
  v_mfma_f32_16x16x32_bf16 v[116:119], v[80:83], v[68:71], v[116:119]
  ds_read_b64_tr_b16 v[56:57], v8 offset:17536
  ds_read_b64_tr_b16 v[58:59], v8 offset:19840
  v_mfma_f32_16x16x32_bf16 v[120:123], v[84:87], v[64:67], v[120:123]
  ds_read_b64_tr_b16 v[60:61], v11 offset:17408
  ds_read_b64_tr_b16 v[62:63], v11 offset:19712
  v_mfma_f32_16x16x32_bf16 v[124:127], v[84:87], v[68:71], v[124:127]
  s_add_u32 m0, s29, 139264
  s_nop 0
  v_mfma_f32_16x16x32_bf16 v[128:131], v[88:91], v[64:67], v[128:131]
  buffer_load_dwordx4 v1, s[4:7], s26 offen lds
  s_add_u32 m0, s30, 139264
  v_mfma_f32_16x16x32_bf16 v[132:135], v[88:91], v[68:71], v[132:135]
  s_add_u32 s26, s26, 64
  buffer_load_dwordx4 v2, s[8:11], s27 offen lds
  v_mfma_f32_16x16x32_bf16 v[136:139], v[20:23], v[92:95], v[136:139]
  s_add_u32 m0, s53, 139264
  s_cmp_eq_u32 s26, 1152
  s_cselect_b32 s26, 0, s26
  v_mfma_f32_16x16x32_bf16 v[140:143], v[20:23], v[88:91], v[140:143]
  buffer_load_dword v3, s[8:11], s27 offen lds
  s_add_u32 s27, s27, s28
  s_cmp_eq_u32 s26, 0
  s_cselect_b32 s27, 0, s27
  s_waitcnt lgkmcnt(0)
  s_waitcnt vmcnt(6)
  s_barrier
  v_mfma_f32_16x16x32_bf16 v[96:99], v[40:43], v[32:35], v[96:99]
  ds_read_b128 v[64:67], v5 offset:34816
  ds_read_b128 v[68:71], v5 offset:35840
  v_mfma_f32_16x16x32_bf16 v[100:103], v[40:43], v[36:39], v[100:103]
  ds_read_b64_tr_b16 v[72:73], v8 offset:34816
  ds_read_b64_tr_b16 v[74:75], v8 offset:37120
  v_mfma_f32_16x16x32_bf16 v[104:107], v[44:47], v[32:35], v[104:107]
  ds_read_b64_tr_b16 v[76:77], v8 offset:34848
  ds_read_b64_tr_b16 v[78:79], v8 offset:37152
  v_mfma_f32_16x16x32_bf16 v[108:111], v[44:47], v[36:39], v[108:111]
  ds_read_b64_tr_b16 v[80:81], v8 offset:34880
  ds_read_b64_tr_b16 v[82:83], v8 offset:37184
  v_mfma_f32_16x16x32_bf16 v[112:115], v[48:51], v[32:35], v[112:115]
  ds_read_b64_tr_b16 v[84:85], v8 offset:34912
  ds_read_b64_tr_b16 v[86:87], v8 offset:37216
  v_mfma_f32_16x16x32_bf16 v[116:119], v[48:51], v[36:39], v[116:119]
  ds_read_b64_tr_b16 v[88:89], v8 offset:34944
  ds_read_b64_tr_b16 v[90:91], v8 offset:37248
  v_mfma_f32_16x16x32_bf16 v[120:123], v[52:55], v[32:35], v[120:123]
  ds_read_b64_tr_b16 v[92:93], v11 offset:34816
  ds_read_b64_tr_b16 v[94:95], v11 offset:37120
  v_mfma_f32_16x16x32_bf16 v[124:127], v[52:55], v[36:39], v[124:127]
  s_add_u32 m0, s29, 0
  s_nop 0
  v_mfma_f32_16x16x32_bf16 v[128:131], v[56:59], v[32:35], v[128:131]
  buffer_load_dwordx4 v1, s[4:7], s26 offen lds
  s_add_u32 m0, s30, 0
  v_mfma_f32_16x16x32_bf16 v[132:135], v[56:59], v[36:39], v[132:135]
  s_add_u32 s26, s26, 64
  buffer_load_dwordx4 v2, s[8:11], s27 offen lds
  v_mfma_f32_16x16x32_bf16 v[136:139], v[20:23], v[60:63], v[136:139]
  s_add_u32 m0, s53, 0
  s_cmp_eq_u32 s26, 1152
  s_cselect_b32 s26, 0, s26
  v_mfma_f32_16x16x32_bf16 v[140:143], v[20:23], v[56:59], v[140:143]
  buffer_load_dword v3, s[8:11], s27 offen lds
  s_add_u32 s27, s27, s28
  s_cmp_eq_u32 s26, 0
  s_cselect_b32 s27, 0, s27
  s_waitcnt lgkmcnt(0)
  v_mfma_f32_16x16x32_bf16 v[96:99], v[72:75], v[64:67], v[96:99]
  ds_read_b128 v[32:35], v6 offset:0
  ds_read_b128 v[36:39], v6 offset:1024
  v_mfma_f32_16x16x32_bf16 v[100:103], v[72:75], v[68:71], v[100:103]
  ds_read_b64_tr_b16 v[40:41], v9 offset:0
  ds_read_b64_tr_b16 v[42:43], v9 offset:2304
  v_mfma_f32_16x16x32_bf16 v[104:107], v[76:79], v[64:67], v[104:107]
  ds_read_b64_tr_b16 v[44:45], v9 offset:32
  ds_read_b64_tr_b16 v[46:47], v9 offset:2336
  v_mfma_f32_16x16x32_bf16 v[108:111], v[76:79], v[68:71], v[108:111]
  ds_read_b64_tr_b16 v[48:49], v9 offset:64
  ds_read_b64_tr_b16 v[50:51], v9 offset:2368
  v_mfma_f32_16x16x32_bf16 v[112:115], v[80:83], v[64:67], v[112:115]
  ds_read_b64_tr_b16 v[52:53], v9 offset:96
  ds_read_b64_tr_b16 v[54:55], v9 offset:2400
  v_mfma_f32_16x16x32_bf16 v[116:119], v[80:83], v[68:71], v[116:119]
  ds_read_b64_tr_b16 v[56:57], v9 offset:128
  ds_read_b64_tr_b16 v[58:59], v9 offset:2432
  v_mfma_f32_16x16x32_bf16 v[120:123], v[84:87], v[64:67], v[120:123]
  ds_read_b64_tr_b16 v[60:61], v12 offset:0
  ds_read_b64_tr_b16 v[62:63], v12 offset:2304
  v_mfma_f32_16x16x32_bf16 v[124:127], v[84:87], v[68:71], v[124:127]
  s_add_u32 m0, s29, 17408
  s_nop 0
  v_mfma_f32_16x16x32_bf16 v[128:131], v[88:91], v[64:67], v[128:131]
  buffer_load_dwordx4 v1, s[4:7], s26 offen lds
  s_add_u32 m0, s30, 17408
  v_mfma_f32_16x16x32_bf16 v[132:135], v[88:91], v[68:71], v[132:135]
  s_add_u32 s26, s26, 64
  buffer_load_dwordx4 v2, s[8:11], s27 offen lds
  v_mfma_f32_16x16x32_bf16 v[136:139], v[20:23], v[92:95], v[136:139]
  s_add_u32 m0, s53, 17408
  s_cmp_eq_u32 s26, 1152
  s_cselect_b32 s26, 0, s26
  v_mfma_f32_16x16x32_bf16 v[140:143], v[20:23], v[88:91], v[140:143]
  buffer_load_dword v3, s[8:11], s27 offen lds
  s_add_u32 s27, s27, s28
  s_cmp_eq_u32 s26, 0
  s_cselect_b32 s27, 0, s27
  s_waitcnt lgkmcnt(0)
  s_waitcnt vmcnt(6)
  s_barrier
  v_mfma_f32_16x16x32_bf16 v[96:99], v[40:43], v[32:35], v[96:99]
  ds_read_b128 v[64:67], v6 offset:17408
  ds_read_b128 v[68:71], v6 offset:18432
  v_mfma_f32_16x16x32_bf16 v[100:103], v[40:43], v[36:39], v[100:103]
  ds_read_b64_tr_b16 v[72:73], v9 offset:17408
  ds_read_b64_tr_b16 v[74:75], v9 offset:19712
  v_mfma_f32_16x16x32_bf16 v[104:107], v[44:47], v[32:35], v[104:107]
  ds_read_b64_tr_b16 v[76:77], v9 offset:17440
  ds_read_b64_tr_b16 v[78:79], v9 offset:19744
  v_mfma_f32_16x16x32_bf16 v[108:111], v[44:47], v[36:39], v[108:111]
  ds_read_b64_tr_b16 v[80:81], v9 offset:17472
  ds_read_b64_tr_b16 v[82:83], v9 offset:19776
  v_mfma_f32_16x16x32_bf16 v[112:115], v[48:51], v[32:35], v[112:115]
  ds_read_b64_tr_b16 v[84:85], v9 offset:17504
  ds_read_b64_tr_b16 v[86:87], v9 offset:19808
  v_mfma_f32_16x16x32_bf16 v[116:119], v[48:51], v[36:39], v[116:119]
  ds_read_b64_tr_b16 v[88:89], v9 offset:17536
  ds_read_b64_tr_b16 v[90:91], v9 offset:19840
  v_mfma_f32_16x16x32_bf16 v[120:123], v[52:55], v[32:35], v[120:123]
  ds_read_b64_tr_b16 v[92:93], v12 offset:17408
  ds_read_b64_tr_b16 v[94:95], v12 offset:19712
  v_mfma_f32_16x16x32_bf16 v[124:127], v[52:55], v[36:39], v[124:127]
  s_add_u32 m0, s29, 34816
  s_nop 0
  v_mfma_f32_16x16x32_bf16 v[128:131], v[56:59], v[32:35], v[128:131]
  buffer_load_dwordx4 v1, s[4:7], s26 offen lds
  s_add_u32 m0, s30, 34816
  v_mfma_f32_16x16x32_bf16 v[132:135], v[56:59], v[36:39], v[132:135]
  s_add_u32 s26, s26, 64
  buffer_load_dwordx4 v2, s[8:11], s27 offen lds
  v_mfma_f32_16x16x32_bf16 v[136:139], v[20:23], v[60:63], v[136:139]
  s_add_u32 m0, s53, 34816
  s_cmp_eq_u32 s26, 1152
  s_cselect_b32 s26, 0, s26
  v_mfma_f32_16x16x32_bf16 v[140:143], v[20:23], v[56:59], v[140:143]
  buffer_load_dword v3, s[8:11], s27 offen lds
  s_add_u32 s27, s27, s28
  s_cmp_eq_u32 s26, 0
  s_cselect_b32 s27, 0, s27
  s_waitcnt lgkmcnt(0)
  v_mfma_f32_16x16x32_bf16 v[96:99], v[72:75], v[64:67], v[96:99]
  ds_read_b128 v[32:35], v6 offset:34816
  ds_read_b128 v[36:39], v6 offset:35840
  v_mfma_f32_16x16x32_bf16 v[100:103], v[72:75], v[68:71], v[100:103]
  ds_read_b64_tr_b16 v[40:41], v9 offset:34816
  ds_read_b64_tr_b16 v[42:43], v9 offset:37120
  v_mfma_f32_16x16x32_bf16 v[104:107], v[76:79], v[64:67], v[104:107]
  ds_read_b64_tr_b16 v[44:45], v9 offset:34848
  ds_read_b64_tr_b16 v[46:47], v9 offset:37152
  v_mfma_f32_16x16x32_bf16 v[108:111], v[76:79], v[68:71], v[108:111]
  ds_read_b64_tr_b16 v[48:49], v9 offset:34880
  ds_read_b64_tr_b16 v[50:51], v9 offset:37184
  v_mfma_f32_16x16x32_bf16 v[112:115], v[80:83], v[64:67], v[112:115]
  ds_read_b64_tr_b16 v[52:53], v9 offset:34912
  ds_read_b64_tr_b16 v[54:55], v9 offset:37216
  v_mfma_f32_16x16x32_bf16 v[116:119], v[80:83], v[68:71], v[116:119]
  ds_read_b64_tr_b16 v[56:57], v9 offset:34944
  ds_read_b64_tr_b16 v[58:59], v9 offset:37248
  v_mfma_f32_16x16x32_bf16 v[120:123], v[84:87], v[64:67], v[120:123]
  ds_read_b64_tr_b16 v[60:61], v12 offset:34816
  ds_read_b64_tr_b16 v[62:63], v12 offset:37120
  v_mfma_f32_16x16x32_bf16 v[124:127], v[84:87], v[68:71], v[124:127]
  s_add_u32 m0, s29, 52224
  s_nop 0
  v_mfma_f32_16x16x32_bf16 v[128:131], v[88:91], v[64:67], v[128:131]
  buffer_load_dwordx4 v1, s[4:7], s26 offen lds
  s_add_u32 m0, s30, 52224
  v_mfma_f32_16x16x32_bf16 v[132:135], v[88:91], v[68:71], v[132:135]
  s_add_u32 s26, s26, 64
  buffer_load_dwordx4 v2, s[8:11], s27 offen lds
  v_mfma_f32_16x16x32_bf16 v[136:139], v[20:23], v[92:95], v[136:139]
  s_add_u32 m0, s53, 52224
  s_cmp_eq_u32 s26, 1152
  s_cselect_b32 s26, 0, s26
  v_mfma_f32_16x16x32_bf16 v[140:143], v[20:23], v[88:91], v[140:143]
  buffer_load_dword v3, s[8:11], s27 offen lds
  s_add_u32 s27, s27, s28
  s_cmp_eq_u32 s26, 0
  s_cselect_b32 s27, 0, s27
  s_waitcnt lgkmcnt(0)
  s_waitcnt vmcnt(6)
  s_barrier
  v_mfma_f32_16x16x32_bf16 v[96:99], v[40:43], v[32:35], v[96:99]
  ds_read_b128 v[64:67], v4 offset:0
  ds_read_b128 v[68:71], v4 offset:1024
  v_mfma_f32_16x16x32_bf16 v[100:103], v[40:43], v[36:39], v[100:103]
  ds_read_b64_tr_b16 v[72:73], v7 offset:0
  ds_read_b64_tr_b16 v[74:75], v7 offset:2304
  v_mfma_f32_16x16x32_bf16 v[104:107], v[44:47], v[32:35], v[104:107]
  ds_read_b64_tr_b16 v[76:77], v7 offset:32
  ds_read_b64_tr_b16 v[78:79], v7 offset:2336
  v_mfma_f32_16x16x32_bf16 v[108:111], v[44:47], v[36:39], v[108:111]
  ds_read_b64_tr_b16 v[80:81], v7 offset:64
  ds_read_b64_tr_b16 v[82:83], v7 offset:2368
  v_mfma_f32_16x16x32_bf16 v[112:115], v[48:51], v[32:35], v[112:115]
  ds_read_b64_tr_b16 v[84:85], v7 offset:96
  ds_read_b64_tr_b16 v[86:87], v7 offset:2400
  v_mfma_f32_16x16x32_bf16 v[116:119], v[48:51], v[36:39], v[116:119]
  ds_read_b64_tr_b16 v[88:89], v7 offset:128
  ds_read_b64_tr_b16 v[90:91], v7 offset:2432
  v_mfma_f32_16x16x32_bf16 v[120:123], v[52:55], v[32:35], v[120:123]
  ds_read_b64_tr_b16 v[92:93], v10 offset:0
  ds_read_b64_tr_b16 v[94:95], v10 offset:2304
  v_mfma_f32_16x16x32_bf16 v[124:127], v[52:55], v[36:39], v[124:127]
  s_add_u32 m0, s29, 69632
  s_nop 0
  v_mfma_f32_16x16x32_bf16 v[128:131], v[56:59], v[32:35], v[128:131]
  buffer_load_dwordx4 v1, s[4:7], s26 offen lds
  s_add_u32 m0, s30, 69632
  v_mfma_f32_16x16x32_bf16 v[132:135], v[56:59], v[36:39], v[132:135]
  s_add_u32 s26, s26, 64
  buffer_load_dwordx4 v2, s[8:11], s27 offen lds
  v_mfma_f32_16x16x32_bf16 v[136:139], v[20:23], v[60:63], v[136:139]
  s_add_u32 m0, s53, 69632
  s_cmp_eq_u32 s26, 1152
  s_cselect_b32 s26, 0, s26
  v_mfma_f32_16x16x32_bf16 v[140:143], v[20:23], v[56:59], v[140:143]
  buffer_load_dword v3, s[8:11], s27 offen lds
  s_add_u32 s27, s27, s28
  s_cmp_eq_u32 s26, 0
  s_cselect_b32 s27, 0, s27
  s_waitcnt lgkmcnt(0)
  v_mfma_f32_16x16x32_bf16 v[96:99], v[72:75], v[64:67], v[96:99]
  ds_read_b128 v[32:35], v4 offset:17408
  ds_read_b128 v[36:39], v4 offset:18432
  v_mfma_f32_16x16x32_bf16 v[100:103], v[72:75], v[68:71], v[100:103]
  ds_read_b64_tr_b16 v[40:41], v7 offset:17408
  ds_read_b64_tr_b16 v[42:43], v7 offset:19712
  v_mfma_f32_16x16x32_bf16 v[104:107], v[76:79], v[64:67], v[104:107]
  ds_read_b64_tr_b16 v[44:45], v7 offset:17440
  ds_read_b64_tr_b16 v[46:47], v7 offset:19744
  v_mfma_f32_16x16x32_bf16 v[108:111], v[76:79], v[68:71], v[108:111]
  ds_read_b64_tr_b16 v[48:49], v7 offset:17472
  ds_read_b64_tr_b16 v[50:51], v7 offset:19776
  v_mfma_f32_16x16x32_bf16 v[112:115], v[80:83], v[64:67], v[112:115]
  ds_read_b64_tr_b16 v[52:53], v7 offset:17504
  ds_read_b64_tr_b16 v[54:55], v7 offset:19808
  v_mfma_f32_16x16x32_bf16 v[116:119], v[80:83], v[68:71], v[116:119]
  ds_read_b64_tr_b16 v[56:57], v7 offset:17536
  ds_read_b64_tr_b16 v[58:59], v7 offset:19840
  v_mfma_f32_16x16x32_bf16 v[120:123], v[84:87], v[64:67], v[120:123]
  ds_read_b64_tr_b16 v[60:61], v10 offset:17408
  ds_read_b64_tr_b16 v[62:63], v10 offset:19712
  v_mfma_f32_16x16x32_bf16 v[124:127], v[84:87], v[68:71], v[124:127]
  s_add_u32 m0, s29, 87040
  s_nop 0
  v_mfma_f32_16x16x32_bf16 v[128:131], v[88:91], v[64:67], v[128:131]
  buffer_load_dwordx4 v1, s[4:7], s26 offen lds
  s_add_u32 m0, s30, 87040
  v_mfma_f32_16x16x32_bf16 v[132:135], v[88:91], v[68:71], v[132:135]
  s_add_u32 s26, s26, 64
  buffer_load_dwordx4 v2, s[8:11], s27 offen lds
  v_mfma_f32_16x16x32_bf16 v[136:139], v[20:23], v[92:95], v[136:139]
  s_add_u32 m0, s53, 87040
  s_cmp_eq_u32 s26, 1152
  s_cselect_b32 s26, 0, s26
  v_mfma_f32_16x16x32_bf16 v[140:143], v[20:23], v[88:91], v[140:143]
  buffer_load_dword v3, s[8:11], s27 offen lds
  s_add_u32 s27, s27, s28
  s_cmp_eq_u32 s26, 0
  s_cselect_b32 s27, 0, s27
  s_waitcnt lgkmcnt(0)
  s_waitcnt vmcnt(6)
  s_barrier
  v_mfma_f32_16x16x32_bf16 v[96:99], v[40:43], v[32:35], v[96:99]
  ds_read_b128 v[64:67], v4 offset:34816
  ds_read_b128 v[68:71], v4 offset:35840
  v_mfma_f32_16x16x32_bf16 v[100:103], v[40:43], v[36:39], v[100:103]
  ds_read_b64_tr_b16 v[72:73], v7 offset:34816
  ds_read_b64_tr_b16 v[74:75], v7 offset:37120
  v_mfma_f32_16x16x32_bf16 v[104:107], v[44:47], v[32:35], v[104:107]
  ds_read_b64_tr_b16 v[76:77], v7 offset:34848
  ds_read_b64_tr_b16 v[78:79], v7 offset:37152
  v_mfma_f32_16x16x32_bf16 v[108:111], v[44:47], v[36:39], v[108:111]
  ds_read_b64_tr_b16 v[80:81], v7 offset:34880
  ds_read_b64_tr_b16 v[82:83], v7 offset:37184
  v_mfma_f32_16x16x32_bf16 v[112:115], v[48:51], v[32:35], v[112:115]
  ds_read_b64_tr_b16 v[84:85], v7 offset:34912
  ds_read_b64_tr_b16 v[86:87], v7 offset:37216
  v_mfma_f32_16x16x32_bf16 v[116:119], v[48:51], v[36:39], v[116:119]
  ds_read_b64_tr_b16 v[88:89], v7 offset:34944
  ds_read_b64_tr_b16 v[90:91], v7 offset:37248
  v_mfma_f32_16x16x32_bf16 v[120:123], v[52:55], v[32:35], v[120:123]
  ds_read_b64_tr_b16 v[92:93], v10 offset:34816
  ds_read_b64_tr_b16 v[94:95], v10 offset:37120
  v_mfma_f32_16x16x32_bf16 v[124:127], v[52:55], v[36:39], v[124:127]
  s_add_u32 m0, s29, 104448
  s_nop 0
  v_mfma_f32_16x16x32_bf16 v[128:131], v[56:59], v[32:35], v[128:131]
  buffer_load_dwordx4 v1, s[4:7], s26 offen lds
  s_add_u32 m0, s30, 104448
  v_mfma_f32_16x16x32_bf16 v[132:135], v[56:59], v[36:39], v[132:135]
  s_add_u32 s26, s26, 64
  buffer_load_dwordx4 v2, s[8:11], s27 offen lds
  v_mfma_f32_16x16x32_bf16 v[136:139], v[20:23], v[60:63], v[136:139]
  s_add_u32 m0, s53, 104448
  s_cmp_eq_u32 s26, 1152
  s_cselect_b32 s26, 0, s26
  v_mfma_f32_16x16x32_bf16 v[140:143], v[20:23], v[56:59], v[140:143]
  buffer_load_dword v3, s[8:11], s27 offen lds
  s_add_u32 s27, s27, s28
  s_cmp_eq_u32 s26, 0
  s_cselect_b32 s27, 0, s27
  s_waitcnt lgkmcnt(0)
  v_mfma_f32_16x16x32_bf16 v[96:99], v[72:75], v[64:67], v[96:99]
  ds_read_b128 v[32:35], v5 offset:0
  ds_read_b128 v[36:39], v5 offset:1024
  v_mfma_f32_16x16x32_bf16 v[100:103], v[72:75], v[68:71], v[100:103]
  ds_read_b64_tr_b16 v[40:41], v8 offset:0
  ds_read_b64_tr_b16 v[42:43], v8 offset:2304
  v_mfma_f32_16x16x32_bf16 v[104:107], v[76:79], v[64:67], v[104:107]
  ds_read_b64_tr_b16 v[44:45], v8 offset:32
  ds_read_b64_tr_b16 v[46:47], v8 offset:2336
  v_mfma_f32_16x16x32_bf16 v[108:111], v[76:79], v[68:71], v[108:111]
  ds_read_b64_tr_b16 v[48:49], v8 offset:64
  ds_read_b64_tr_b16 v[50:51], v8 offset:2368
  v_mfma_f32_16x16x32_bf16 v[112:115], v[80:83], v[64:67], v[112:115]
  ds_read_b64_tr_b16 v[52:53], v8 offset:96
  ds_read_b64_tr_b16 v[54:55], v8 offset:2400
  v_mfma_f32_16x16x32_bf16 v[116:119], v[80:83], v[68:71], v[116:119]
  ds_read_b64_tr_b16 v[56:57], v8 offset:128
  ds_read_b64_tr_b16 v[58:59], v8 offset:2432
  v_mfma_f32_16x16x32_bf16 v[120:123], v[84:87], v[64:67], v[120:123]
  ds_read_b64_tr_b16 v[60:61], v11 offset:0
  ds_read_b64_tr_b16 v[62:63], v11 offset:2304
  v_mfma_f32_16x16x32_bf16 v[124:127], v[84:87], v[68:71], v[124:127]
  s_add_u32 m0, s29, 121856
  s_nop 0
  v_mfma_f32_16x16x32_bf16 v[128:131], v[88:91], v[64:67], v[128:131]
  buffer_load_dwordx4 v1, s[4:7], s26 offen lds
  s_add_u32 m0, s30, 121856
  v_mfma_f32_16x16x32_bf16 v[132:135], v[88:91], v[68:71], v[132:135]
  s_add_u32 s26, s26, 64
  buffer_load_dwordx4 v2, s[8:11], s27 offen lds
  v_mfma_f32_16x16x32_bf16 v[136:139], v[20:23], v[92:95], v[136:139]
  s_add_u32 m0, s53, 121856
  s_cmp_eq_u32 s26, 1152
  s_cselect_b32 s26, 0, s26
  v_mfma_f32_16x16x32_bf16 v[140:143], v[20:23], v[88:91], v[140:143]
  buffer_load_dword v3, s[8:11], s27 offen lds
  s_add_u32 s27, s27, s28
  s_cmp_eq_u32 s26, 0
  s_cselect_b32 s27, 0, s27
  s_waitcnt lgkmcnt(0)
  s_waitcnt vmcnt(6)
  s_barrier
  v_mfma_f32_16x16x32_bf16 v[96:99], v[40:43], v[32:35], v[96:99]
  ds_read_b128 v[64:67], v5 offset:17408
  ds_read_b128 v[68:71], v5 offset:18432
  v_mfma_f32_16x16x32_bf16 v[100:103], v[40:43], v[36:39], v[100:103]
  ds_read_b64_tr_b16 v[72:73], v8 offset:17408
  ds_read_b64_tr_b16 v[74:75], v8 offset:19712
  v_mfma_f32_16x16x32_bf16 v[104:107], v[44:47], v[32:35], v[104:107]
  ds_read_b64_tr_b16 v[76:77], v8 offset:17440
  ds_read_b64_tr_b16 v[78:79], v8 offset:19744
  v_mfma_f32_16x16x32_bf16 v[108:111], v[44:47], v[36:39], v[108:111]
  ds_read_b64_tr_b16 v[80:81], v8 offset:17472
  ds_read_b64_tr_b16 v[82:83], v8 offset:19776
  v_mfma_f32_16x16x32_bf16 v[112:115], v[48:51], v[32:35], v[112:115]
  ds_read_b64_tr_b16 v[84:85], v8 offset:17504
  ds_read_b64_tr_b16 v[86:87], v8 offset:19808
  v_mfma_f32_16x16x32_bf16 v[116:119], v[48:51], v[36:39], v[116:119]
  ds_read_b64_tr_b16 v[88:89], v8 offset:17536
  ds_read_b64_tr_b16 v[90:91], v8 offset:19840
  v_mfma_f32_16x16x32_bf16 v[120:123], v[52:55], v[32:35], v[120:123]
  ds_read_b64_tr_b16 v[92:93], v11 offset:17408
  ds_read_b64_tr_b16 v[94:95], v11 offset:19712
  v_mfma_f32_16x16x32_bf16 v[124:127], v[52:55], v[36:39], v[124:127]
  s_add_u32 m0, s29, 139264
  s_nop 0
  v_mfma_f32_16x16x32_bf16 v[128:131], v[56:59], v[32:35], v[128:131]
  buffer_load_dwordx4 v1, s[4:7], s26 offen lds
  s_add_u32 m0, s30, 139264
  v_mfma_f32_16x16x32_bf16 v[132:135], v[56:59], v[36:39], v[132:135]
  s_add_u32 s26, s26, 64
  buffer_load_dwordx4 v2, s[8:11], s27 offen lds
  v_mfma_f32_16x16x32_bf16 v[136:139], v[20:23], v[60:63], v[136:139]
  s_add_u32 m0, s53, 139264
  s_cmp_eq_u32 s26, 1152
  s_cselect_b32 s26, 0, s26
  v_mfma_f32_16x16x32_bf16 v[140:143], v[20:23], v[56:59], v[140:143]
  buffer_load_dword v3, s[8:11], s27 offen lds
  s_add_u32 s27, s27, s28
  s_cmp_eq_u32 s26, 0
  s_cselect_b32 s27, 0, s27
  s_waitcnt lgkmcnt(0)
  v_mfma_f32_16x16x32_bf16 v[96:99], v[72:75], v[64:67], v[96:99]
  ds_read_b128 v[32:35], v5 offset:34816
  v_mfma_f32_16x16x32_bf16 v[100:103], v[72:75], v[68:71], v[100:103]
  ds_read_b128 v[36:39], v5 offset:35840
  v_mfma_f32_16x16x32_bf16 v[104:107], v[76:79], v[64:67], v[104:107]
  ds_read_b64_tr_b16 v[40:41], v8 offset:34816
  v_mfma_f32_16x16x32_bf16 v[108:111], v[76:79], v[68:71], v[108:111]
  ds_read_b64_tr_b16 v[42:43], v8 offset:37120
  v_mfma_f32_16x16x32_bf16 v[112:115], v[80:83], v[64:67], v[112:115]
  ds_read_b64_tr_b16 v[44:45], v8 offset:34848
  v_mfma_f32_16x16x32_bf16 v[116:119], v[80:83], v[68:71], v[116:119]
  ds_read_b64_tr_b16 v[46:47], v8 offset:37152
  ds_read_b64_tr_b16 v[48:49], v8 offset:34880
  v_mfma_f32_16x16x32_bf16 v[120:123], v[84:87], v[64:67], v[120:123]
  ds_read_b64_tr_b16 v[50:51], v8 offset:37184
  v_mfma_f32_16x16x32_bf16 v[124:127], v[84:87], v[68:71], v[124:127]
  ds_read_b64_tr_b16 v[52:53], v8 offset:34912
  v_mfma_f32_16x16x32_bf16 v[128:131], v[88:91], v[64:67], v[128:131]
  ds_read_b64_tr_b16 v[54:55], v8 offset:37216
  v_mfma_f32_16x16x32_bf16 v[132:135], v[88:91], v[68:71], v[132:135]
  ds_read_b64_tr_b16 v[56:57], v8 offset:34944
  v_mfma_f32_16x16x32_bf16 v[136:139], v[20:23], v[92:95], v[136:139]
  ds_read_b64_tr_b16 v[58:59], v8 offset:37248
  v_mfma_f32_16x16x32_bf16 v[140:143], v[20:23], v[88:91], v[140:143]
  ds_read_b64_tr_b16 v[60:61], v11 offset:34816
  ds_read_b64_tr_b16 v[62:63], v11 offset:37120
  s_waitcnt lgkmcnt(0)
  s_waitcnt vmcnt(3)
  s_barrier
  v_mfma_f32_16x16x32_bf16 v[96:99], v[40:43], v[32:35], v[96:99]
  ds_read_b128 v[64:67], v6 offset:0
  v_mfma_f32_16x16x32_bf16 v[100:103], v[40:43], v[36:39], v[100:103]
  ds_read_b128 v[68:71], v6 offset:1024
  v_mfma_f32_16x16x32_bf16 v[104:107], v[44:47], v[32:35], v[104:107]
  ds_read_b64_tr_b16 v[72:73], v9 offset:0
  v_mfma_f32_16x16x32_bf16 v[108:111], v[44:47], v[36:39], v[108:111]
  ds_read_b64_tr_b16 v[74:75], v9 offset:2304
  v_mfma_f32_16x16x32_bf16 v[112:115], v[48:51], v[32:35], v[112:115]
  ds_read_b64_tr_b16 v[76:77], v9 offset:32
  v_mfma_f32_16x16x32_bf16 v[116:119], v[48:51], v[36:39], v[116:119]
  ds_read_b64_tr_b16 v[78:79], v9 offset:2336
  ds_read_b64_tr_b16 v[80:81], v9 offset:64
  v_mfma_f32_16x16x32_bf16 v[120:123], v[52:55], v[32:35], v[120:123]
  ds_read_b64_tr_b16 v[82:83], v9 offset:2368
  v_mfma_f32_16x16x32_bf16 v[124:127], v[52:55], v[36:39], v[124:127]
  ds_read_b64_tr_b16 v[84:85], v9 offset:96
  v_mfma_f32_16x16x32_bf16 v[128:131], v[56:59], v[32:35], v[128:131]
  ds_read_b64_tr_b16 v[86:87], v9 offset:2400
  v_mfma_f32_16x16x32_bf16 v[132:135], v[56:59], v[36:39], v[132:135]
  ds_read_b64_tr_b16 v[88:89], v9 offset:128
  v_mfma_f32_16x16x32_bf16 v[136:139], v[20:23], v[60:63], v[136:139]
  ds_read_b64_tr_b16 v[90:91], v9 offset:2432
  v_mfma_f32_16x16x32_bf16 v[140:143], v[20:23], v[56:59], v[140:143]
  ds_read_b64_tr_b16 v[92:93], v12 offset:0
  ds_read_b64_tr_b16 v[94:95], v12 offset:2304
  s_waitcnt lgkmcnt(0)
  v_mfma_f32_16x16x32_bf16 v[96:99], v[72:75], v[64:67], v[96:99]
  ds_read_b128 v[32:35], v6 offset:17408
  v_mfma_f32_16x16x32_bf16 v[100:103], v[72:75], v[68:71], v[100:103]
  ds_read_b128 v[36:39], v6 offset:18432
  v_mfma_f32_16x16x32_bf16 v[104:107], v[76:79], v[64:67], v[104:107]
  ds_read_b64_tr_b16 v[40:41], v9 offset:17408
  v_mfma_f32_16x16x32_bf16 v[108:111], v[76:79], v[68:71], v[108:111]
  ds_read_b64_tr_b16 v[42:43], v9 offset:19712
  v_mfma_f32_16x16x32_bf16 v[112:115], v[80:83], v[64:67], v[112:115]
  ds_read_b64_tr_b16 v[44:45], v9 offset:17440
  v_mfma_f32_16x16x32_bf16 v[116:119], v[80:83], v[68:71], v[116:119]
  ds_read_b64_tr_b16 v[46:47], v9 offset:19744
  ds_read_b64_tr_b16 v[48:49], v9 offset:17472
  v_mfma_f32_16x16x32_bf16 v[120:123], v[84:87], v[64:67], v[120:123]
  ds_read_b64_tr_b16 v[50:51], v9 offset:19776
  v_mfma_f32_16x16x32_bf16 v[124:127], v[84:87], v[68:71], v[124:127]
  ds_read_b64_tr_b16 v[52:53], v9 offset:17504
  v_mfma_f32_16x16x32_bf16 v[128:131], v[88:91], v[64:67], v[128:131]
  ds_read_b64_tr_b16 v[54:55], v9 offset:19808
  v_mfma_f32_16x16x32_bf16 v[132:135], v[88:91], v[68:71], v[132:135]
  ds_read_b64_tr_b16 v[56:57], v9 offset:17536
  v_mfma_f32_16x16x32_bf16 v[136:139], v[20:23], v[92:95], v[136:139]
  ds_read_b64_tr_b16 v[58:59], v9 offset:19840
  v_mfma_f32_16x16x32_bf16 v[140:143], v[20:23], v[88:91], v[140:143]
  ds_read_b64_tr_b16 v[60:61], v12 offset:17408
  ds_read_b64_tr_b16 v[62:63], v12 offset:19712
  s_waitcnt lgkmcnt(0)
  s_waitcnt vmcnt(0)
  s_barrier
  v_mfma_f32_16x16x32_bf16 v[96:99], v[40:43], v[32:35], v[96:99]
  ds_read_b128 v[64:67], v6 offset:34816
  v_mfma_f32_16x16x32_bf16 v[100:103], v[40:43], v[36:39], v[100:103]
  ds_read_b128 v[68:71], v6 offset:35840
  ds_read_b64_tr_b16 v[72:73], v9 offset:34816
  v_mfma_f32_16x16x32_bf16 v[104:107], v[44:47], v[32:35], v[104:107]
  ds_read_b64_tr_b16 v[74:75], v9 offset:37120
  ds_read_b64_tr_b16 v[76:77], v9 offset:34848
  v_mfma_f32_16x16x32_bf16 v[108:111], v[44:47], v[36:39], v[108:111]
  ds_read_b64_tr_b16 v[78:79], v9 offset:37152
  ds_read_b64_tr_b16 v[80:81], v9 offset:34880
  v_mfma_f32_16x16x32_bf16 v[112:115], v[48:51], v[32:35], v[112:115]
  ds_read_b64_tr_b16 v[82:83], v9 offset:37184
  ds_read_b64_tr_b16 v[84:85], v9 offset:34912
  v_mfma_f32_16x16x32_bf16 v[116:119], v[48:51], v[36:39], v[116:119]
  ds_read_b64_tr_b16 v[86:87], v9 offset:37216
  ds_read_b64_tr_b16 v[88:89], v9 offset:34944
  v_mfma_f32_16x16x32_bf16 v[120:123], v[52:55], v[32:35], v[120:123]
  ds_read_b64_tr_b16 v[90:91], v9 offset:37248
  ds_read_b64_tr_b16 v[92:93], v12 offset:34816
  v_mfma_f32_16x16x32_bf16 v[124:127], v[52:55], v[36:39], v[124:127]
  ds_read_b64_tr_b16 v[94:95], v12 offset:37120
  buffer_load_dwordx4 v[24:27], v17, s[16:19], s52 offen
  v_mfma_f32_16x16x32_bf16 v[128:131], v[56:59], v[32:35], v[128:131]
  buffer_load_dwordx4 v[28:31], v18, s[16:19], s52 offen offset:1024
  s_mov_b32 s58, 663552
  s_mov_b32 s59, 0x20000
  s_sub_u32 s42, s52, 3456
  v_mfma_f32_16x16x32_bf16 v[132:135], v[56:59], v[36:39], v[132:135]
  buffer_load_dwordx4 v[216:219], v18, s[56:59], s42 offen offset:1024
  s_mul_i32 s42, s46, 20736
  v_mfma_f32_16x16x32_bf16 v[136:139], v[20:23], v[60:63], v[136:139]
  v_lshlrev_b32 v211, 4, v0
  buffer_load_dwordx4 v[212:215], v211, s[16:19], s42 offen
  s_add_u32 s42, s42, 8192
  v_mfma_f32_16x16x32_bf16 v[140:143], v[20:23], v[56:59], v[140:143]
  buffer_load_dwordx4 v[212:215], v211, s[16:19], s42 offen
  s_add_u32 s42, s42, 8192
  buffer_load_dwordx4 v[212:215], v211, s[16:19], s42 offen
  s_add_u32 s42, s42, 8192
  s_waitcnt lgkmcnt(0)
  v_mfma_f32_16x16x32_bf16 v[96:99], v[72:75], v[64:67], v[96:99]
  v_mfma_f32_16x16x32_bf16 v[100:103], v[72:75], v[68:71], v[100:103]
  v_mfma_f32_16x16x32_bf16 v[104:107], v[76:79], v[64:67], v[104:107]
  v_mfma_f32_16x16x32_bf16 v[108:111], v[76:79], v[68:71], v[108:111]
  v_mfma_f32_16x16x32_bf16 v[112:115], v[80:83], v[64:67], v[112:115]
  v_mfma_f32_16x16x32_bf16 v[116:119], v[80:83], v[68:71], v[116:119]
  v_mfma_f32_16x16x32_bf16 v[120:123], v[84:87], v[64:67], v[120:123]
  v_mfma_f32_16x16x32_bf16 v[124:127], v[84:87], v[68:71], v[124:127]
  v_mfma_f32_16x16x32_bf16 v[128:131], v[88:91], v[64:67], v[128:131]
  v_mfma_f32_16x16x32_bf16 v[132:135], v[88:91], v[68:71], v[132:135]
  v_mfma_f32_16x16x32_bf16 v[136:139], v[20:23], v[92:95], v[136:139]
  v_mfma_f32_16x16x32_bf16 v[140:143], v[20:23], v[88:91], v[140:143]
  s_add_u32 s31, s49, 17
  s_sub_u32 s50, s31, 18
  s_cselect_b32 s31, s31, s50
  s_lshl_b32 s31, s31, 17
  s_add_u32 s31, s31, s51
  buffer_store_dwordx4 v[64:67], v210, s[12:15], s31 offen sc1
  s_and_b32 s31, s24, 13
  s_cmp_lg_u32 s31, 0
  s_cbranch_scc1 Lnx_11
  s_add_u32 s31, s49, 16
  s_sub_u32 s50, s31, 18
  s_cselect_b32 s31, s31, s50
  s_lshl_b32 s31, s31, 17
  s_add_u32 s31, s31, s51
  buffer_store_dwordx4 v[32:35], v210, s[12:15], s31 offen sc1
Lnx_11:
  v_and_b32 v14, 15, v13
  s_mul_i32 s31, s22, 5
  s_add_u32 s31, s31, s21
  s_lshl_b32 s31, s31, 4
  v_add_u32 v15, s31, v14
  v_lshlrev_b32 v15, 2, v15
  v_lshlrev_b32 v16, 2, v14
  v_add_u32 v15, 157696, v15
  v_add_u32 v16, 157952, v16
  s_lshl_b32 s31, s21, 5
  v_add_u32 v156, s31, v14
  v_lshlrev_b32 v156, 2, v156
  v_add_u32 v157, 156672, v156
  s_nop 1
  ds_write_b32 v15, v136
  ds_write_b32 v16, v140
  s_waitcnt lgkmcnt(0)
  s_barrier
  v_lshrrev_b32 v14, 4, v13
  v_lshlrev_b32 v14, 4, v14
  v_add_u32 v14, 157696, v14
  ds_read_b32 v158, v157 offset:0
  ds_read_b32 v160, v157 offset:512
  ds_read_b32 v159, v157 offset:64
  ds_read_b32 v161, v157 offset:576
  ds_read_b128 v[164:167], v14 offset:0
  ds_read_b128 v[168:171], v14 offset:64
  ds_read_b128 v[172:175], v14 offset:128
  ds_read_b128 v[176:179], v14 offset:192
  ds_read_b128 v[180:183], v14 offset:256
  v_lshrrev_b32 v15, 5, v13
  v_lshlrev_b32 v15, 15, v15
  v_and_b32 v16, 31, v13
  v_lshl_add_u32 v15, v16, 4, v15
  s_lshr_b32 s31, s24, 2
  s_min_u32 s31, s31, 2
  s_mul_i32 s31, s31, 2359296
  s_mul_i32 s42, s47, 589824
  s_add_u32 s31, s31, s42
  s_lshl_b32 s42, s23, 2
  s_add_u32 s42, s42, s21
  s_lshl_b32 s42, s42, 9
  s_add_u32 s31, s31, s42
  s_add_u32 s31, s31, 0
  s_waitcnt lgkmcnt(0)
  v_fma_f32 v96, -v158, v164, v96
  v_fma_f32 v97, -v158, v165, v97
  v_fma_f32 v98, -v158, v166, v98
  v_fma_f32 v99, -v158, v167, v99
  v_fma_f32 v100, -v159, v164, v100
  v_fma_f32 v101, -v159, v165, v101
  v_fma_f32 v102, -v159, v166, v102
  v_fma_f32 v103, -v159, v167, v103
  v_fma_f32 v104, -v158, v168, v104
  v_fma_f32 v105, -v158, v169, v105
  v_fma_f32 v106, -v158, v170, v106
  v_fma_f32 v107, -v158, v171, v107
  v_fma_f32 v108, -v159, v168, v108
  v_fma_f32 v109, -v159, v169, v109
  v_fma_f32 v110, -v159, v170, v110
  v_fma_f32 v111, -v159, v171, v111
  v_fma_f32 v112, -v158, v172, v112
  v_fma_f32 v113, -v158, v173, v113
  v_fma_f32 v114, -v158, v174, v114
  v_fma_f32 v115, -v158, v175, v115
  v_fma_f32 v116, -v159, v172, v116
  v_fma_f32 v117, -v159, v173, v117
  v_fma_f32 v118, -v159, v174, v118
  v_fma_f32 v119, -v159, v175, v119
  v_fma_f32 v120, -v158, v176, v120
  v_fma_f32 v121, -v158, v177, v121
  v_fma_f32 v122, -v158, v178, v122
  v_fma_f32 v123, -v158, v179, v123
  v_fma_f32 v124, -v159, v176, v124
  v_fma_f32 v125, -v159, v177, v125
  v_fma_f32 v126, -v159, v178, v126
  v_fma_f32 v127, -v159, v179, v127
  v_fma_f32 v128, -v158, v180, v128
  v_fma_f32 v129, -v158, v181, v129
  v_fma_f32 v130, -v158, v182, v130
  v_fma_f32 v131, -v158, v183, v131
  v_fma_f32 v132, -v159, v180, v132
  v_fma_f32 v133, -v159, v181, v133
  v_fma_f32 v134, -v159, v182, v134
  v_fma_f32 v135, -v159, v183, v135
  s_cmp_ge_u32 s24, 12
  s_cbranch_scc1 Lish_12
  v_mul_f32 v96, v160, v96
  v_mul_f32 v97, v160, v97
  v_mul_f32 v98, v160, v98
  v_mul_f32 v99, v160, v99
  v_mul_f32 v100, v161, v100
  v_mul_f32 v101, v161, v101
  v_mul_f32 v102, v161, v102
  v_mul_f32 v103, v161, v103
  v_cvt_pk_bf16_f32 v188, v96, v97
  v_cvt_pk_bf16_f32 v189, v98, v99
  v_cvt_pk_bf16_f32 v190, v100, v101
  v_cvt_pk_bf16_f32 v191, v102, v103
  s_nop 1
  v_permlane16_swap_b32 v188, v190
  v_permlane16_swap_b32 v189, v191
  buffer_store_dwordx4 v[188:191], v15, s[12:15], s31 offen sc1
  s_add_u32 s31, s31, 65536
  v_mul_f32 v104, v160, v104
  v_mul_f32 v105, v160, v105
  v_mul_f32 v106, v160, v106
  v_mul_f32 v107, v160, v107
  v_mul_f32 v108, v161, v108
  v_mul_f32 v109, v161, v109
  v_mul_f32 v110, v161, v110
  v_mul_f32 v111, v161, v111
  v_cvt_pk_bf16_f32 v192, v104, v105
  v_cvt_pk_bf16_f32 v193, v106, v107
  v_cvt_pk_bf16_f32 v194, v108, v109
  v_cvt_pk_bf16_f32 v195, v110, v111
  s_nop 1
  v_permlane16_swap_b32 v192, v194
  v_permlane16_swap_b32 v193, v195
  buffer_store_dwordx4 v[192:195], v15, s[12:15], s31 offen sc1
  s_add_u32 s31, s31, 65536
  v_mul_f32 v112, v160, v112
  v_mul_f32 v113, v160, v113
  v_mul_f32 v114, v160, v114
  v_mul_f32 v115, v160, v115
  v_mul_f32 v116, v161, v116
  v_mul_f32 v117, v161, v117
  v_mul_f32 v118, v161, v118
  v_mul_f32 v119, v161, v119
  v_cvt_pk_bf16_f32 v188, v112, v113
  v_cvt_pk_bf16_f32 v189, v114, v115
  v_cvt_pk_bf16_f32 v190, v116, v117
  v_cvt_pk_bf16_f32 v191, v118, v119
  s_nop 1
  v_permlane16_swap_b32 v188, v190
  v_permlane16_swap_b32 v189, v191
  buffer_store_dwordx4 v[188:191], v15, s[12:15], s31 offen sc1
  s_add_u32 s31, s31, 65536
  v_mul_f32 v120, v160, v120
  v_mul_f32 v121, v160, v121
  v_mul_f32 v122, v160, v122
  v_mul_f32 v123, v160, v123
  v_mul_f32 v124, v161, v124
  v_mul_f32 v125, v161, v125
  v_mul_f32 v126, v161, v126
  v_mul_f32 v127, v161, v127
  v_cvt_pk_bf16_f32 v192, v120, v121
  v_cvt_pk_bf16_f32 v193, v122, v123
  v_cvt_pk_bf16_f32 v194, v124, v125
  v_cvt_pk_bf16_f32 v195, v126, v127
  s_nop 1
  v_permlane16_swap_b32 v192, v194
  v_permlane16_swap_b32 v193, v195
  buffer_store_dwordx4 v[192:195], v15, s[12:15], s31 offen sc1
  s_add_u32 s31, s31, 65536
  v_mul_f32 v128, v160, v128
  v_mul_f32 v129, v160, v129
  v_mul_f32 v130, v160, v130
  v_mul_f32 v131, v160, v131
  v_mul_f32 v132, v161, v132
  v_mul_f32 v133, v161, v133
  v_mul_f32 v134, v161, v134
  v_mul_f32 v135, v161, v135
  v_cvt_pk_bf16_f32 v188, v128, v129
  v_cvt_pk_bf16_f32 v189, v130, v131
  v_cvt_pk_bf16_f32 v190, v132, v133
  v_cvt_pk_bf16_f32 v191, v134, v135
  s_nop 1
  v_permlane16_swap_b32 v188, v190
  v_permlane16_swap_b32 v189, v191
  buffer_store_dwordx4 v[188:191], v15, s[12:15], s31 offen sc1
  s_add_u32 s31, s31, 65536
  s_branch Lbarjob_10
Lish_12:
  v_mul_f32 v204, 0xc0135761, v160
  v_mul_f32 v205, v160, v160
  v_mul_f32 v205, v205, v160
  v_mul_f32 v205, 0xbdd2d3e8, v205
  v_rcp_f32 v206, v160
  v_mul_f32 v208, 0xc0135761, v161
  v_mul_f32 v209, v161, v161
  v_mul_f32 v209, v209, v161
  v_mul_f32 v209, 0xbdd2d3e8, v209
  v_rcp_f32 v210, v161
  v_mul_f32 v196, v96, v96
  v_mul_f32 v197, v97, v97
  v_mul_f32 v198, v98, v98
  v_mul_f32 v199, v99, v99
  v_fma_f32 v196, v196, v205, v204
  v_fma_f32 v197, v197, v205, v204
  v_fma_f32 v198, v198, v205, v204
  v_fma_f32 v199, v199, v205, v204
  v_mul_f32 v196, v196, v96
  v_mul_f32 v197, v197, v97
  v_mul_f32 v198, v198, v98
  v_mul_f32 v199, v199, v99
  v_exp_f32 v196, v196
  v_exp_f32 v197, v197
  v_exp_f32 v198, v198
  v_exp_f32 v199, v199
  v_fma_f32 v196, v196, v206, v206
  v_fma_f32 v197, v197, v206, v206
  v_fma_f32 v198, v198, v206, v206
  v_fma_f32 v199, v199, v206, v206
  v_rcp_f32 v196, v196
  v_rcp_f32 v197, v197
  v_rcp_f32 v198, v198
  v_rcp_f32 v199, v199
  v_mul_f32 v96, v96, v196
  v_mul_f32 v97, v97, v197
  v_mul_f32 v98, v98, v198
  v_mul_f32 v99, v99, v199
  v_mul_f32 v196, v100, v100
  v_mul_f32 v197, v101, v101
  v_mul_f32 v198, v102, v102
  v_mul_f32 v199, v103, v103
  v_fma_f32 v196, v196, v209, v208
  v_fma_f32 v197, v197, v209, v208
  v_fma_f32 v198, v198, v209, v208
  v_fma_f32 v199, v199, v209, v208
  v_mul_f32 v196, v196, v100
  v_mul_f32 v197, v197, v101
  v_mul_f32 v198, v198, v102
  v_mul_f32 v199, v199, v103
  v_exp_f32 v196, v196
  v_exp_f32 v197, v197
  v_exp_f32 v198, v198
  v_exp_f32 v199, v199
  v_fma_f32 v196, v196, v210, v210
  v_fma_f32 v197, v197, v210, v210
  v_fma_f32 v198, v198, v210, v210
  v_fma_f32 v199, v199, v210, v210
  v_rcp_f32 v196, v196
  v_rcp_f32 v197, v197
  v_rcp_f32 v198, v198
  v_rcp_f32 v199, v199
  v_mul_f32 v100, v100, v196
  v_mul_f32 v101, v101, v197
  v_mul_f32 v102, v102, v198
  v_mul_f32 v103, v103, v199
  v_cvt_pk_bf16_f32 v188, v96, v97
  v_cvt_pk_bf16_f32 v189, v98, v99
  v_cvt_pk_bf16_f32 v190, v100, v101
  v_cvt_pk_bf16_f32 v191, v102, v103
  s_nop 1
  v_permlane16_swap_b32 v188, v190
  v_permlane16_swap_b32 v189, v191
  buffer_store_dwordx4 v[188:191], v15, s[12:15], s31 offen sc1
  s_add_u32 s31, s31, 65536
  v_mul_f32 v196, v104, v104
  v_mul_f32 v197, v105, v105
  v_mul_f32 v198, v106, v106
  v_mul_f32 v199, v107, v107
  v_fma_f32 v196, v196, v205, v204
  v_fma_f32 v197, v197, v205, v204
  v_fma_f32 v198, v198, v205, v204
  v_fma_f32 v199, v199, v205, v204
  v_mul_f32 v196, v196, v104
  v_mul_f32 v197, v197, v105
  v_mul_f32 v198, v198, v106
  v_mul_f32 v199, v199, v107
  v_exp_f32 v196, v196
  v_exp_f32 v197, v197
  v_exp_f32 v198, v198
  v_exp_f32 v199, v199
  v_fma_f32 v196, v196, v206, v206
  v_fma_f32 v197, v197, v206, v206
  v_fma_f32 v198, v198, v206, v206
  v_fma_f32 v199, v199, v206, v206
  v_rcp_f32 v196, v196
  v_rcp_f32 v197, v197
  v_rcp_f32 v198, v198
  v_rcp_f32 v199, v199
  v_mul_f32 v104, v104, v196
  v_mul_f32 v105, v105, v197
  v_mul_f32 v106, v106, v198
  v_mul_f32 v107, v107, v199
  v_mul_f32 v196, v108, v108
  v_mul_f32 v197, v109, v109
  v_mul_f32 v198, v110, v110
  v_mul_f32 v199, v111, v111
  v_fma_f32 v196, v196, v209, v208
  v_fma_f32 v197, v197, v209, v208
  v_fma_f32 v198, v198, v209, v208
  v_fma_f32 v199, v199, v209, v208
  v_mul_f32 v196, v196, v108
  v_mul_f32 v197, v197, v109
  v_mul_f32 v198, v198, v110
  v_mul_f32 v199, v199, v111
  v_exp_f32 v196, v196
  v_exp_f32 v197, v197
  v_exp_f32 v198, v198
  v_exp_f32 v199, v199
  v_fma_f32 v196, v196, v210, v210
  v_fma_f32 v197, v197, v210, v210
  v_fma_f32 v198, v198, v210, v210
  v_fma_f32 v199, v199, v210, v210
  v_rcp_f32 v196, v196
  v_rcp_f32 v197, v197
  v_rcp_f32 v198, v198
  v_rcp_f32 v199, v199
  v_mul_f32 v108, v108, v196
  v_mul_f32 v109, v109, v197
  v_mul_f32 v110, v110, v198
  v_mul_f32 v111, v111, v199
  v_cvt_pk_bf16_f32 v192, v104, v105
  v_cvt_pk_bf16_f32 v193, v106, v107
  v_cvt_pk_bf16_f32 v194, v108, v109
  v_cvt_pk_bf16_f32 v195, v110, v111
  s_nop 1
  v_permlane16_swap_b32 v192, v194
  v_permlane16_swap_b32 v193, v195
  buffer_store_dwordx4 v[192:195], v15, s[12:15], s31 offen sc1
  s_add_u32 s31, s31, 65536
  v_mul_f32 v196, v112, v112
  v_mul_f32 v197, v113, v113
  v_mul_f32 v198, v114, v114
  v_mul_f32 v199, v115, v115
  v_fma_f32 v196, v196, v205, v204
  v_fma_f32 v197, v197, v205, v204
  v_fma_f32 v198, v198, v205, v204
  v_fma_f32 v199, v199, v205, v204
  v_mul_f32 v196, v196, v112
  v_mul_f32 v197, v197, v113
  v_mul_f32 v198, v198, v114
  v_mul_f32 v199, v199, v115
  v_exp_f32 v196, v196
  v_exp_f32 v197, v197
  v_exp_f32 v198, v198
  v_exp_f32 v199, v199
  v_fma_f32 v196, v196, v206, v206
  v_fma_f32 v197, v197, v206, v206
  v_fma_f32 v198, v198, v206, v206
  v_fma_f32 v199, v199, v206, v206
  v_rcp_f32 v196, v196
  v_rcp_f32 v197, v197
  v_rcp_f32 v198, v198
  v_rcp_f32 v199, v199
  v_mul_f32 v112, v112, v196
  v_mul_f32 v113, v113, v197
  v_mul_f32 v114, v114, v198
  v_mul_f32 v115, v115, v199
  v_mul_f32 v196, v116, v116
  v_mul_f32 v197, v117, v117
  v_mul_f32 v198, v118, v118
  v_mul_f32 v199, v119, v119
  v_fma_f32 v196, v196, v209, v208
  v_fma_f32 v197, v197, v209, v208
  v_fma_f32 v198, v198, v209, v208
  v_fma_f32 v199, v199, v209, v208
  v_mul_f32 v196, v196, v116
  v_mul_f32 v197, v197, v117
  v_mul_f32 v198, v198, v118
  v_mul_f32 v199, v199, v119
  v_exp_f32 v196, v196
  v_exp_f32 v197, v197
  v_exp_f32 v198, v198
  v_exp_f32 v199, v199
  v_fma_f32 v196, v196, v210, v210
  v_fma_f32 v197, v197, v210, v210
  v_fma_f32 v198, v198, v210, v210
  v_fma_f32 v199, v199, v210, v210
  v_rcp_f32 v196, v196
  v_rcp_f32 v197, v197
  v_rcp_f32 v198, v198
  v_rcp_f32 v199, v199
  v_mul_f32 v116, v116, v196
  v_mul_f32 v117, v117, v197
  v_mul_f32 v118, v118, v198
  v_mul_f32 v119, v119, v199
  v_cvt_pk_bf16_f32 v188, v112, v113
  v_cvt_pk_bf16_f32 v189, v114, v115
  v_cvt_pk_bf16_f32 v190, v116, v117
  v_cvt_pk_bf16_f32 v191, v118, v119
  s_nop 1
  v_permlane16_swap_b32 v188, v190
  v_permlane16_swap_b32 v189, v191
  buffer_store_dwordx4 v[188:191], v15, s[12:15], s31 offen sc1
  s_add_u32 s31, s31, 65536
  v_mul_f32 v196, v120, v120
  v_mul_f32 v197, v121, v121
  v_mul_f32 v198, v122, v122
  v_mul_f32 v199, v123, v123
  v_fma_f32 v196, v196, v205, v204
  v_fma_f32 v197, v197, v205, v204
  v_fma_f32 v198, v198, v205, v204
  v_fma_f32 v199, v199, v205, v204
  v_mul_f32 v196, v196, v120
  v_mul_f32 v197, v197, v121
  v_mul_f32 v198, v198, v122
  v_mul_f32 v199, v199, v123
  v_exp_f32 v196, v196
  v_exp_f32 v197, v197
  v_exp_f32 v198, v198
  v_exp_f32 v199, v199
  v_fma_f32 v196, v196, v206, v206
  v_fma_f32 v197, v197, v206, v206
  v_fma_f32 v198, v198, v206, v206
  v_fma_f32 v199, v199, v206, v206
  v_rcp_f32 v196, v196
  v_rcp_f32 v197, v197
  v_rcp_f32 v198, v198
  v_rcp_f32 v199, v199
  v_mul_f32 v120, v120, v196
  v_mul_f32 v121, v121, v197
  v_mul_f32 v122, v122, v198
  v_mul_f32 v123, v123, v199
  v_mul_f32 v196, v124, v124
  v_mul_f32 v197, v125, v125
  v_mul_f32 v198, v126, v126
  v_mul_f32 v199, v127, v127
  v_fma_f32 v196, v196, v209, v208
  v_fma_f32 v197, v197, v209, v208
  v_fma_f32 v198, v198, v209, v208
  v_fma_f32 v199, v199, v209, v208
  v_mul_f32 v196, v196, v124
  v_mul_f32 v197, v197, v125
  v_mul_f32 v198, v198, v126
  v_mul_f32 v199, v199, v127
  v_exp_f32 v196, v196
  v_exp_f32 v197, v197
  v_exp_f32 v198, v198
  v_exp_f32 v199, v199
  v_fma_f32 v196, v196, v210, v210
  v_fma_f32 v197, v197, v210, v210
  v_fma_f32 v198, v198, v210, v210
  v_fma_f32 v199, v199, v210, v210
  v_rcp_f32 v196, v196
  v_rcp_f32 v197, v197
  v_rcp_f32 v198, v198
  v_rcp_f32 v199, v199
  v_mul_f32 v124, v124, v196
  v_mul_f32 v125, v125, v197
  v_mul_f32 v126, v126, v198
  v_mul_f32 v127, v127, v199
  v_cvt_pk_bf16_f32 v192, v120, v121
  v_cvt_pk_bf16_f32 v193, v122, v123
  v_cvt_pk_bf16_f32 v194, v124, v125
  v_cvt_pk_bf16_f32 v195, v126, v127
  s_nop 1
  v_permlane16_swap_b32 v192, v194
  v_permlane16_swap_b32 v193, v195
  buffer_store_dwordx4 v[192:195], v15, s[12:15], s31 offen sc1
  s_add_u32 s31, s31, 65536
  v_mul_f32 v196, v128, v128
  v_mul_f32 v197, v129, v129
  v_mul_f32 v198, v130, v130
  v_mul_f32 v199, v131, v131
  v_fma_f32 v196, v196, v205, v204
  v_fma_f32 v197, v197, v205, v204
  v_fma_f32 v198, v198, v205, v204
  v_fma_f32 v199, v199, v205, v204
  v_mul_f32 v196, v196, v128
  v_mul_f32 v197, v197, v129
  v_mul_f32 v198, v198, v130
  v_mul_f32 v199, v199, v131
  v_exp_f32 v196, v196
  v_exp_f32 v197, v197
  v_exp_f32 v198, v198
  v_exp_f32 v199, v199
  v_fma_f32 v196, v196, v206, v206
  v_fma_f32 v197, v197, v206, v206
  v_fma_f32 v198, v198, v206, v206
  v_fma_f32 v199, v199, v206, v206
  v_rcp_f32 v196, v196
  v_rcp_f32 v197, v197
  v_rcp_f32 v198, v198
  v_rcp_f32 v199, v199
  v_mul_f32 v128, v128, v196
  v_mul_f32 v129, v129, v197
  v_mul_f32 v130, v130, v198
  v_mul_f32 v131, v131, v199
  v_mul_f32 v196, v132, v132
  v_mul_f32 v197, v133, v133
  v_mul_f32 v198, v134, v134
  v_mul_f32 v199, v135, v135
  v_fma_f32 v196, v196, v209, v208
  v_fma_f32 v197, v197, v209, v208
  v_fma_f32 v198, v198, v209, v208
  v_fma_f32 v199, v199, v209, v208
  v_mul_f32 v196, v196, v132
  v_mul_f32 v197, v197, v133
  v_mul_f32 v198, v198, v134
  v_mul_f32 v199, v199, v135
  v_exp_f32 v196, v196
  v_exp_f32 v197, v197
  v_exp_f32 v198, v198
  v_exp_f32 v199, v199
  v_fma_f32 v196, v196, v210, v210
  v_fma_f32 v197, v197, v210, v210
  v_fma_f32 v198, v198, v210, v210
  v_fma_f32 v199, v199, v210, v210
  v_rcp_f32 v196, v196
  v_rcp_f32 v197, v197
  v_rcp_f32 v198, v198
  v_rcp_f32 v199, v199
  v_mul_f32 v132, v132, v196
  v_mul_f32 v133, v133, v197
  v_mul_f32 v134, v134, v198
  v_mul_f32 v135, v135, v199
  v_cvt_pk_bf16_f32 v188, v128, v129
  v_cvt_pk_bf16_f32 v189, v130, v131
  v_cvt_pk_bf16_f32 v190, v132, v133
  v_cvt_pk_bf16_f32 v191, v134, v135
  s_nop 1
  v_permlane16_swap_b32 v188, v190
  v_permlane16_swap_b32 v189, v191
  buffer_store_dwordx4 v[188:191], v15, s[12:15], s31 offen sc1
  s_add_u32 s31, s31, 65536
  s_branch Ldone_1
.p2align 6
Lk1_02_6:
  s_waitcnt vmcnt(3)
  s_barrier
  ds_read_b128 v[32:35], v4 offset:0
  ds_read_b128 v[36:39], v4 offset:1024
  ds_read_b64_tr_b16 v[40:41], v7 offset:0
  ds_read_b64_tr_b16 v[42:43], v7 offset:2304
  ds_read_b64_tr_b16 v[44:45], v7 offset:32
  ds_read_b64_tr_b16 v[46:47], v7 offset:2336
  ds_read_b64_tr_b16 v[48:49], v7 offset:64
  ds_read_b64_tr_b16 v[50:51], v7 offset:2368
  ds_read_b64_tr_b16 v[52:53], v7 offset:96
  ds_read_b64_tr_b16 v[54:55], v7 offset:2400
  ds_read_b64_tr_b16 v[56:57], v7 offset:128
  ds_read_b64_tr_b16 v[58:59], v7 offset:2432
  ds_read_b64_tr_b16 v[60:61], v10 offset:0
  ds_read_b64_tr_b16 v[62:63], v10 offset:2304
  s_add_u32 m0, s29, 34816
  s_nop 0
  buffer_load_dwordx4 v1, s[4:7], s26 offen lds
  s_add_u32 m0, s30, 34816
  s_add_u32 s26, s26, 64
  buffer_load_dwordx4 v2, s[8:11], s27 offen lds
  s_add_u32 m0, s53, 34816
  s_cmp_eq_u32 s26, 1152
  s_cselect_b32 s26, 0, s26
  buffer_load_dword v3, s[8:11], s27 offen lds
  s_add_u32 s27, s27, s28
  s_cmp_eq_u32 s26, 0
  s_cselect_b32 s27, 0, s27
  s_waitcnt lgkmcnt(0)
  s_waitcnt vmcnt(3)
  s_barrier
  v_mfma_f32_16x16x32_bf16 v[96:99], v[32:35], v[40:43], 0
  ds_read_b128 v[64:67], v4 offset:17408
  ds_read_b128 v[68:71], v4 offset:18432
  v_mfma_f32_16x16x32_bf16 v[100:103], v[36:39], v[40:43], 0
  ds_read_b64_tr_b16 v[72:73], v7 offset:17408
  ds_read_b64_tr_b16 v[74:75], v7 offset:19712
  ds_read_b64_tr_b16 v[76:77], v7 offset:17440
  v_mfma_f32_16x16x32_bf16 v[104:107], v[32:35], v[44:47], 0
  ds_read_b64_tr_b16 v[78:79], v7 offset:19744
  ds_read_b64_tr_b16 v[80:81], v7 offset:17472
  ds_read_b64_tr_b16 v[82:83], v7 offset:19776
  v_mfma_f32_16x16x32_bf16 v[108:111], v[36:39], v[44:47], 0
  ds_read_b64_tr_b16 v[84:85], v7 offset:17504
  ds_read_b64_tr_b16 v[86:87], v7 offset:19808
  ds_read_b64_tr_b16 v[88:89], v7 offset:17536
  v_mfma_f32_16x16x32_bf16 v[112:115], v[32:35], v[48:51], 0
  ds_read_b64_tr_b16 v[90:91], v7 offset:19840
  ds_read_b64_tr_b16 v[92:93], v10 offset:17408
  ds_read_b64_tr_b16 v[94:95], v10 offset:19712
  v_mfma_f32_16x16x32_bf16 v[116:119], v[36:39], v[48:51], 0
  s_add_u32 m0, s29, 52224
  s_nop 0
  buffer_load_dwordx4 v1, s[4:7], s26 offen lds
  v_mfma_f32_16x16x32_bf16 v[120:123], v[32:35], v[52:55], 0
  s_add_u32 m0, s30, 52224
  s_add_u32 s26, s26, 64
  v_mfma_f32_16x16x32_bf16 v[124:127], v[36:39], v[52:55], 0
  buffer_load_dwordx4 v2, s[8:11], s27 offen lds
  s_add_u32 m0, s53, 52224
  s_cmp_eq_u32 s26, 1152
  s_cselect_b32 s26, 0, s26
  v_mfma_f32_16x16x32_bf16 v[128:131], v[32:35], v[56:59], 0
  buffer_load_dword v3, s[8:11], s27 offen lds
  s_add_u32 s27, s27, s28
  s_cmp_eq_u32 s26, 0
  s_cselect_b32 s27, 0, s27
  s_add_u32 m0, s29, 69632
  v_mfma_f32_16x16x32_bf16 v[132:135], v[36:39], v[56:59], 0
  s_nop 0
  buffer_load_dwordx4 v1, s[4:7], s26 offen lds
  s_add_u32 m0, s30, 69632
  v_mfma_f32_16x16x32_bf16 v[136:139], v[20:23], v[60:63], 0
  s_add_u32 s26, s26, 64
  buffer_load_dwordx4 v2, s[8:11], s27 offen lds
  s_add_u32 m0, s53, 69632
  v_mfma_f32_16x16x32_bf16 v[140:143], v[20:23], v[56:59], 0
  s_cmp_eq_u32 s26, 1152
  s_cselect_b32 s26, 0, s26
  buffer_load_dword v3, s[8:11], s27 offen lds
  s_add_u32 s27, s27, s28
  s_cmp_eq_u32 s26, 0
  s_cselect_b32 s27, 0, s27
  s_waitcnt lgkmcnt(0)
  s_waitcnt vmcnt(6)
  s_barrier
  v_mfma_f32_16x16x32_bf16 v[96:99], v[64:67], v[72:75], v[96:99]
  ds_read_b128 v[32:35], v4 offset:34816
  ds_read_b128 v[36:39], v4 offset:35840
  v_mfma_f32_16x16x32_bf16 v[100:103], v[68:71], v[72:75], v[100:103]
  ds_read_b64_tr_b16 v[40:41], v7 offset:34816
  ds_read_b64_tr_b16 v[42:43], v7 offset:37120
  ds_read_b64_tr_b16 v[44:45], v7 offset:34848
  v_mfma_f32_16x16x32_bf16 v[104:107], v[64:67], v[76:79], v[104:107]
  ds_read_b64_tr_b16 v[46:47], v7 offset:37152
  ds_read_b64_tr_b16 v[48:49], v7 offset:34880
  ds_read_b64_tr_b16 v[50:51], v7 offset:37184
  v_mfma_f32_16x16x32_bf16 v[108:111], v[68:71], v[76:79], v[108:111]
  ds_read_b64_tr_b16 v[52:53], v7 offset:34912
  ds_read_b64_tr_b16 v[54:55], v7 offset:37216
  ds_read_b64_tr_b16 v[56:57], v7 offset:34944
  v_mfma_f32_16x16x32_bf16 v[112:115], v[64:67], v[80:83], v[112:115]
  ds_read_b64_tr_b16 v[58:59], v7 offset:37248
  ds_read_b64_tr_b16 v[60:61], v10 offset:34816
  ds_read_b64_tr_b16 v[62:63], v10 offset:37120
  v_mfma_f32_16x16x32_bf16 v[116:119], v[68:71], v[80:83], v[116:119]
  s_add_u32 m0, s29, 87040
  s_nop 0
  buffer_load_dwordx4 v1, s[4:7], s26 offen lds
  v_mfma_f32_16x16x32_bf16 v[120:123], v[64:67], v[84:87], v[120:123]
  s_add_u32 m0, s30, 87040
  s_add_u32 s26, s26, 64
  v_mfma_f32_16x16x32_bf16 v[124:127], v[68:71], v[84:87], v[124:127]
  buffer_load_dwordx4 v2, s[8:11], s27 offen lds
  s_add_u32 m0, s53, 87040
  s_cmp_eq_u32 s26, 1152
  s_cselect_b32 s26, 0, s26
  v_mfma_f32_16x16x32_bf16 v[128:131], v[64:67], v[88:91], v[128:131]
  buffer_load_dword v3, s[8:11], s27 offen lds
  s_add_u32 s27, s27, s28
  s_cmp_eq_u32 s26, 0
  s_cselect_b32 s27, 0, s27
  s_add_u32 m0, s29, 104448
  v_mfma_f32_16x16x32_bf16 v[132:135], v[68:71], v[88:91], v[132:135]
  s_nop 0
  buffer_load_dwordx4 v1, s[4:7], s26 offen lds
  s_add_u32 m0, s30, 104448
  v_mfma_f32_16x16x32_bf16 v[136:139], v[20:23], v[92:95], v[136:139]
  s_add_u32 s26, s26, 64
  buffer_load_dwordx4 v2, s[8:11], s27 offen lds
  s_add_u32 m0, s53, 104448
  v_mfma_f32_16x16x32_bf16 v[140:143], v[20:23], v[88:91], v[140:143]
  s_cmp_eq_u32 s26, 1152
  s_cselect_b32 s26, 0, s26
  buffer_load_dword v3, s[8:11], s27 offen lds
  s_add_u32 s27, s27, s28
  s_cmp_eq_u32 s26, 0
  s_cselect_b32 s27, 0, s27
  s_waitcnt lgkmcnt(0)
  s_waitcnt vmcnt(6)
  s_barrier
  v_mfma_f32_16x16x32_bf16 v[96:99], v[32:35], v[40:43], v[96:99]
  ds_read_b128 v[64:67], v5 offset:0
  ds_read_b128 v[68:71], v5 offset:1024
  v_mfma_f32_16x16x32_bf16 v[100:103], v[36:39], v[40:43], v[100:103]
  ds_read_b64_tr_b16 v[72:73], v8 offset:0
  ds_read_b64_tr_b16 v[74:75], v8 offset:2304
  v_mfma_f32_16x16x32_bf16 v[104:107], v[32:35], v[44:47], v[104:107]
  ds_read_b64_tr_b16 v[76:77], v8 offset:32
  ds_read_b64_tr_b16 v[78:79], v8 offset:2336
  v_mfma_f32_16x16x32_bf16 v[108:111], v[36:39], v[44:47], v[108:111]
  ds_read_b64_tr_b16 v[80:81], v8 offset:64
  ds_read_b64_tr_b16 v[82:83], v8 offset:2368
  v_mfma_f32_16x16x32_bf16 v[112:115], v[32:35], v[48:51], v[112:115]
  ds_read_b64_tr_b16 v[84:85], v8 offset:96
  ds_read_b64_tr_b16 v[86:87], v8 offset:2400
  v_mfma_f32_16x16x32_bf16 v[116:119], v[36:39], v[48:51], v[116:119]
  ds_read_b64_tr_b16 v[88:89], v8 offset:128
  ds_read_b64_tr_b16 v[90:91], v8 offset:2432
  v_mfma_f32_16x16x32_bf16 v[120:123], v[32:35], v[52:55], v[120:123]
  ds_read_b64_tr_b16 v[92:93], v11 offset:0
  ds_read_b64_tr_b16 v[94:95], v11 offset:2304
  v_mfma_f32_16x16x32_bf16 v[124:127], v[36:39], v[52:55], v[124:127]
  s_add_u32 m0, s29, 121856
  s_nop 0
  v_mfma_f32_16x16x32_bf16 v[128:131], v[32:35], v[56:59], v[128:131]
  buffer_load_dwordx4 v1, s[4:7], s26 offen lds
  s_add_u32 m0, s30, 121856
  v_mfma_f32_16x16x32_bf16 v[132:135], v[36:39], v[56:59], v[132:135]
  s_add_u32 s26, s26, 64
  buffer_load_dwordx4 v2, s[8:11], s27 offen lds
  v_mfma_f32_16x16x32_bf16 v[136:139], v[20:23], v[60:63], v[136:139]
  s_add_u32 m0, s53, 121856
  s_cmp_eq_u32 s26, 1152
  s_cselect_b32 s26, 0, s26
  v_mfma_f32_16x16x32_bf16 v[140:143], v[20:23], v[56:59], v[140:143]
  buffer_load_dword v3, s[8:11], s27 offen lds
  s_add_u32 s27, s27, s28
  s_cmp_eq_u32 s26, 0
  s_cselect_b32 s27, 0, s27
  s_waitcnt lgkmcnt(0)
  v_mfma_f32_16x16x32_bf16 v[96:99], v[64:67], v[72:75], v[96:99]
  ds_read_b128 v[32:35], v5 offset:17408
  ds_read_b128 v[36:39], v5 offset:18432
  v_mfma_f32_16x16x32_bf16 v[100:103], v[68:71], v[72:75], v[100:103]
  ds_read_b64_tr_b16 v[40:41], v8 offset:17408
  ds_read_b64_tr_b16 v[42:43], v8 offset:19712
  v_mfma_f32_16x16x32_bf16 v[104:107], v[64:67], v[76:79], v[104:107]
  ds_read_b64_tr_b16 v[44:45], v8 offset:17440
  ds_read_b64_tr_b16 v[46:47], v8 offset:19744
  v_mfma_f32_16x16x32_bf16 v[108:111], v[68:71], v[76:79], v[108:111]
  ds_read_b64_tr_b16 v[48:49], v8 offset:17472
  ds_read_b64_tr_b16 v[50:51], v8 offset:19776
  v_mfma_f32_16x16x32_bf16 v[112:115], v[64:67], v[80:83], v[112:115]
  ds_read_b64_tr_b16 v[52:53], v8 offset:17504
  ds_read_b64_tr_b16 v[54:55], v8 offset:19808
  v_mfma_f32_16x16x32_bf16 v[116:119], v[68:71], v[80:83], v[116:119]
  ds_read_b64_tr_b16 v[56:57], v8 offset:17536
  ds_read_b64_tr_b16 v[58:59], v8 offset:19840
  v_mfma_f32_16x16x32_bf16 v[120:123], v[64:67], v[84:87], v[120:123]
  ds_read_b64_tr_b16 v[60:61], v11 offset:17408
  ds_read_b64_tr_b16 v[62:63], v11 offset:19712
  v_mfma_f32_16x16x32_bf16 v[124:127], v[68:71], v[84:87], v[124:127]
  s_add_u32 m0, s29, 139264
  s_nop 0
  v_mfma_f32_16x16x32_bf16 v[128:131], v[64:67], v[88:91], v[128:131]
  buffer_load_dwordx4 v1, s[4:7], s26 offen lds
  s_add_u32 m0, s30, 139264
  v_mfma_f32_16x16x32_bf16 v[132:135], v[68:71], v[88:91], v[132:135]
  s_add_u32 s26, s26, 64
  buffer_load_dwordx4 v2, s[8:11], s27 offen lds
  v_mfma_f32_16x16x32_bf16 v[136:139], v[20:23], v[92:95], v[136:139]
  s_add_u32 m0, s53, 139264
  s_cmp_eq_u32 s26, 1152
  s_cselect_b32 s26, 0, s26
  v_mfma_f32_16x16x32_bf16 v[140:143], v[20:23], v[88:91], v[140:143]
  buffer_load_dword v3, s[8:11], s27 offen lds
  s_add_u32 s27, s27, s28
  s_cmp_eq_u32 s26, 0
  s_cselect_b32 s27, 0, s27
  s_waitcnt lgkmcnt(0)
  s_waitcnt vmcnt(6)
  s_barrier
  v_mfma_f32_16x16x32_bf16 v[96:99], v[32:35], v[40:43], v[96:99]
  ds_read_b128 v[64:67], v5 offset:34816
  ds_read_b128 v[68:71], v5 offset:35840
  v_mfma_f32_16x16x32_bf16 v[100:103], v[36:39], v[40:43], v[100:103]
  ds_read_b64_tr_b16 v[72:73], v8 offset:34816
  ds_read_b64_tr_b16 v[74:75], v8 offset:37120
  v_mfma_f32_16x16x32_bf16 v[104:107], v[32:35], v[44:47], v[104:107]
  ds_read_b64_tr_b16 v[76:77], v8 offset:34848
  ds_read_b64_tr_b16 v[78:79], v8 offset:37152
  v_mfma_f32_16x16x32_bf16 v[108:111], v[36:39], v[44:47], v[108:111]
  ds_read_b64_tr_b16 v[80:81], v8 offset:34880
  ds_read_b64_tr_b16 v[82:83], v8 offset:37184
  v_mfma_f32_16x16x32_bf16 v[112:115], v[32:35], v[48:51], v[112:115]
  ds_read_b64_tr_b16 v[84:85], v8 offset:34912
  ds_read_b64_tr_b16 v[86:87], v8 offset:37216
  v_mfma_f32_16x16x32_bf16 v[116:119], v[36:39], v[48:51], v[116:119]
  ds_read_b64_tr_b16 v[88:89], v8 offset:34944
  ds_read_b64_tr_b16 v[90:91], v8 offset:37248
  v_mfma_f32_16x16x32_bf16 v[120:123], v[32:35], v[52:55], v[120:123]
  ds_read_b64_tr_b16 v[92:93], v11 offset:34816
  ds_read_b64_tr_b16 v[94:95], v11 offset:37120
  v_mfma_f32_16x16x32_bf16 v[124:127], v[36:39], v[52:55], v[124:127]
  s_add_u32 m0, s29, 0
  s_nop 0
  v_mfma_f32_16x16x32_bf16 v[128:131], v[32:35], v[56:59], v[128:131]
  buffer_load_dwordx4 v1, s[4:7], s26 offen lds
  s_add_u32 m0, s30, 0
  v_mfma_f32_16x16x32_bf16 v[132:135], v[36:39], v[56:59], v[132:135]
  s_add_u32 s26, s26, 64
  buffer_load_dwordx4 v2, s[8:11], s27 offen lds
  v_mfma_f32_16x16x32_bf16 v[136:139], v[20:23], v[60:63], v[136:139]
  s_add_u32 m0, s53, 0
  s_cmp_eq_u32 s26, 1152
  s_cselect_b32 s26, 0, s26
  v_mfma_f32_16x16x32_bf16 v[140:143], v[20:23], v[56:59], v[140:143]
  buffer_load_dword v3, s[8:11], s27 offen lds
  s_add_u32 s27, s27, s28
  s_cmp_eq_u32 s26, 0
  s_cselect_b32 s27, 0, s27
  s_waitcnt lgkmcnt(0)
  v_mfma_f32_16x16x32_bf16 v[96:99], v[64:67], v[72:75], v[96:99]
  ds_read_b128 v[32:35], v6 offset:0
  ds_read_b128 v[36:39], v6 offset:1024
  v_mfma_f32_16x16x32_bf16 v[100:103], v[68:71], v[72:75], v[100:103]
  ds_read_b64_tr_b16 v[40:41], v9 offset:0
  ds_read_b64_tr_b16 v[42:43], v9 offset:2304
  v_mfma_f32_16x16x32_bf16 v[104:107], v[64:67], v[76:79], v[104:107]
  ds_read_b64_tr_b16 v[44:45], v9 offset:32
  ds_read_b64_tr_b16 v[46:47], v9 offset:2336
  v_mfma_f32_16x16x32_bf16 v[108:111], v[68:71], v[76:79], v[108:111]
  ds_read_b64_tr_b16 v[48:49], v9 offset:64
  ds_read_b64_tr_b16 v[50:51], v9 offset:2368
  v_mfma_f32_16x16x32_bf16 v[112:115], v[64:67], v[80:83], v[112:115]
  ds_read_b64_tr_b16 v[52:53], v9 offset:96
  ds_read_b64_tr_b16 v[54:55], v9 offset:2400
  v_mfma_f32_16x16x32_bf16 v[116:119], v[68:71], v[80:83], v[116:119]
  ds_read_b64_tr_b16 v[56:57], v9 offset:128
  ds_read_b64_tr_b16 v[58:59], v9 offset:2432
  v_mfma_f32_16x16x32_bf16 v[120:123], v[64:67], v[84:87], v[120:123]
  ds_read_b64_tr_b16 v[60:61], v12 offset:0
  ds_read_b64_tr_b16 v[62:63], v12 offset:2304
  v_mfma_f32_16x16x32_bf16 v[124:127], v[68:71], v[84:87], v[124:127]
  s_add_u32 m0, s29, 17408
  s_nop 0
  v_mfma_f32_16x16x32_bf16 v[128:131], v[64:67], v[88:91], v[128:131]
  buffer_load_dwordx4 v1, s[4:7], s26 offen lds
  s_add_u32 m0, s30, 17408
  v_mfma_f32_16x16x32_bf16 v[132:135], v[68:71], v[88:91], v[132:135]
  s_add_u32 s26, s26, 64
  buffer_load_dwordx4 v2, s[8:11], s27 offen lds
  v_mfma_f32_16x16x32_bf16 v[136:139], v[20:23], v[92:95], v[136:139]
  s_add_u32 m0, s53, 17408
  s_cmp_eq_u32 s26, 1152
  s_cselect_b32 s26, 0, s26
  v_mfma_f32_16x16x32_bf16 v[140:143], v[20:23], v[88:91], v[140:143]
  buffer_load_dword v3, s[8:11], s27 offen lds
  s_add_u32 s27, s27, s28
  s_cmp_eq_u32 s26, 0
  s_cselect_b32 s27, 0, s27
  s_waitcnt lgkmcnt(0)
  s_waitcnt vmcnt(6)
  s_barrier
  v_mfma_f32_16x16x32_bf16 v[96:99], v[32:35], v[40:43], v[96:99]
  ds_read_b128 v[64:67], v6 offset:17408
  ds_read_b128 v[68:71], v6 offset:18432
  v_mfma_f32_16x16x32_bf16 v[100:103], v[36:39], v[40:43], v[100:103]
  ds_read_b64_tr_b16 v[72:73], v9 offset:17408
  ds_read_b64_tr_b16 v[74:75], v9 offset:19712
  v_mfma_f32_16x16x32_bf16 v[104:107], v[32:35], v[44:47], v[104:107]
  ds_read_b64_tr_b16 v[76:77], v9 offset:17440
  ds_read_b64_tr_b16 v[78:79], v9 offset:19744
  v_mfma_f32_16x16x32_bf16 v[108:111], v[36:39], v[44:47], v[108:111]
  ds_read_b64_tr_b16 v[80:81], v9 offset:17472
  ds_read_b64_tr_b16 v[82:83], v9 offset:19776
  v_mfma_f32_16x16x32_bf16 v[112:115], v[32:35], v[48:51], v[112:115]
  ds_read_b64_tr_b16 v[84:85], v9 offset:17504
  ds_read_b64_tr_b16 v[86:87], v9 offset:19808
  v_mfma_f32_16x16x32_bf16 v[116:119], v[36:39], v[48:51], v[116:119]
  ds_read_b64_tr_b16 v[88:89], v9 offset:17536
  ds_read_b64_tr_b16 v[90:91], v9 offset:19840
  v_mfma_f32_16x16x32_bf16 v[120:123], v[32:35], v[52:55], v[120:123]
  ds_read_b64_tr_b16 v[92:93], v12 offset:17408
  ds_read_b64_tr_b16 v[94:95], v12 offset:19712
  v_mfma_f32_16x16x32_bf16 v[124:127], v[36:39], v[52:55], v[124:127]
  s_add_u32 m0, s29, 34816
  s_nop 0
  v_mfma_f32_16x16x32_bf16 v[128:131], v[32:35], v[56:59], v[128:131]
  buffer_load_dwordx4 v1, s[4:7], s26 offen lds
  s_add_u32 m0, s30, 34816
  v_mfma_f32_16x16x32_bf16 v[132:135], v[36:39], v[56:59], v[132:135]
  s_add_u32 s26, s26, 64
  buffer_load_dwordx4 v2, s[8:11], s27 offen lds
  v_mfma_f32_16x16x32_bf16 v[136:139], v[20:23], v[60:63], v[136:139]
  s_add_u32 m0, s53, 34816
  s_cmp_eq_u32 s26, 1152
  s_cselect_b32 s26, 0, s26
  v_mfma_f32_16x16x32_bf16 v[140:143], v[20:23], v[56:59], v[140:143]
  buffer_load_dword v3, s[8:11], s27 offen lds
  s_add_u32 s27, s27, s28
  s_cmp_eq_u32 s26, 0
  s_cselect_b32 s27, 0, s27
  s_waitcnt lgkmcnt(0)
  v_mfma_f32_16x16x32_bf16 v[96:99], v[64:67], v[72:75], v[96:99]
  ds_read_b128 v[32:35], v6 offset:34816
  ds_read_b128 v[36:39], v6 offset:35840
  v_mfma_f32_16x16x32_bf16 v[100:103], v[68:71], v[72:75], v[100:103]
  ds_read_b64_tr_b16 v[40:41], v9 offset:34816
  ds_read_b64_tr_b16 v[42:43], v9 offset:37120
  v_mfma_f32_16x16x32_bf16 v[104:107], v[64:67], v[76:79], v[104:107]
  ds_read_b64_tr_b16 v[44:45], v9 offset:34848
  ds_read_b64_tr_b16 v[46:47], v9 offset:37152
  v_mfma_f32_16x16x32_bf16 v[108:111], v[68:71], v[76:79], v[108:111]
  ds_read_b64_tr_b16 v[48:49], v9 offset:34880
  ds_read_b64_tr_b16 v[50:51], v9 offset:37184
  v_mfma_f32_16x16x32_bf16 v[112:115], v[64:67], v[80:83], v[112:115]
  ds_read_b64_tr_b16 v[52:53], v9 offset:34912
  ds_read_b64_tr_b16 v[54:55], v9 offset:37216
  v_mfma_f32_16x16x32_bf16 v[116:119], v[68:71], v[80:83], v[116:119]
  ds_read_b64_tr_b16 v[56:57], v9 offset:34944
  ds_read_b64_tr_b16 v[58:59], v9 offset:37248
  v_mfma_f32_16x16x32_bf16 v[120:123], v[64:67], v[84:87], v[120:123]
  ds_read_b64_tr_b16 v[60:61], v12 offset:34816
  ds_read_b64_tr_b16 v[62:63], v12 offset:37120
  v_mfma_f32_16x16x32_bf16 v[124:127], v[68:71], v[84:87], v[124:127]
  s_add_u32 m0, s29, 52224
  s_nop 0
  v_mfma_f32_16x16x32_bf16 v[128:131], v[64:67], v[88:91], v[128:131]
  buffer_load_dwordx4 v1, s[4:7], s26 offen lds
  s_add_u32 m0, s30, 52224
  v_mfma_f32_16x16x32_bf16 v[132:135], v[68:71], v[88:91], v[132:135]
  s_add_u32 s26, s26, 64
  buffer_load_dwordx4 v2, s[8:11], s27 offen lds
  v_mfma_f32_16x16x32_bf16 v[136:139], v[20:23], v[92:95], v[136:139]
  s_add_u32 m0, s53, 52224
  s_cmp_eq_u32 s26, 1152
  s_cselect_b32 s26, 0, s26
  v_mfma_f32_16x16x32_bf16 v[140:143], v[20:23], v[88:91], v[140:143]
  buffer_load_dword v3, s[8:11], s27 offen lds
  s_add_u32 s27, s27, s28
  s_cmp_eq_u32 s26, 0
  s_cselect_b32 s27, 0, s27
  s_waitcnt lgkmcnt(0)
  s_waitcnt vmcnt(6)
  s_barrier
  v_mfma_f32_16x16x32_bf16 v[96:99], v[32:35], v[40:43], v[96:99]
  ds_read_b128 v[64:67], v4 offset:0
  ds_read_b128 v[68:71], v4 offset:1024
  v_mfma_f32_16x16x32_bf16 v[100:103], v[36:39], v[40:43], v[100:103]
  ds_read_b64_tr_b16 v[72:73], v7 offset:0
  ds_read_b64_tr_b16 v[74:75], v7 offset:2304
  v_mfma_f32_16x16x32_bf16 v[104:107], v[32:35], v[44:47], v[104:107]
  ds_read_b64_tr_b16 v[76:77], v7 offset:32
  ds_read_b64_tr_b16 v[78:79], v7 offset:2336
  v_mfma_f32_16x16x32_bf16 v[108:111], v[36:39], v[44:47], v[108:111]
  ds_read_b64_tr_b16 v[80:81], v7 offset:64
  ds_read_b64_tr_b16 v[82:83], v7 offset:2368
  v_mfma_f32_16x16x32_bf16 v[112:115], v[32:35], v[48:51], v[112:115]
  ds_read_b64_tr_b16 v[84:85], v7 offset:96
  ds_read_b64_tr_b16 v[86:87], v7 offset:2400
  v_mfma_f32_16x16x32_bf16 v[116:119], v[36:39], v[48:51], v[116:119]
  ds_read_b64_tr_b16 v[88:89], v7 offset:128
  ds_read_b64_tr_b16 v[90:91], v7 offset:2432
  v_mfma_f32_16x16x32_bf16 v[120:123], v[32:35], v[52:55], v[120:123]
  ds_read_b64_tr_b16 v[92:93], v10 offset:0
  ds_read_b64_tr_b16 v[94:95], v10 offset:2304
  v_mfma_f32_16x16x32_bf16 v[124:127], v[36:39], v[52:55], v[124:127]
  s_add_u32 m0, s29, 69632
  s_nop 0
  v_mfma_f32_16x16x32_bf16 v[128:131], v[32:35], v[56:59], v[128:131]
  buffer_load_dwordx4 v1, s[4:7], s26 offen lds
  s_add_u32 m0, s30, 69632
  v_mfma_f32_16x16x32_bf16 v[132:135], v[36:39], v[56:59], v[132:135]
  s_add_u32 s26, s26, 64
  buffer_load_dwordx4 v2, s[8:11], s27 offen lds
  v_mfma_f32_16x16x32_bf16 v[136:139], v[20:23], v[60:63], v[136:139]
  s_add_u32 m0, s53, 69632
  s_cmp_eq_u32 s26, 1152
  s_cselect_b32 s26, 0, s26
  v_mfma_f32_16x16x32_bf16 v[140:143], v[20:23], v[56:59], v[140:143]
  buffer_load_dword v3, s[8:11], s27 offen lds
  s_add_u32 s27, s27, s28
  s_cmp_eq_u32 s26, 0
  s_cselect_b32 s27, 0, s27
  s_waitcnt lgkmcnt(0)
  v_mfma_f32_16x16x32_bf16 v[96:99], v[64:67], v[72:75], v[96:99]
  ds_read_b128 v[32:35], v4 offset:17408
  ds_read_b128 v[36:39], v4 offset:18432
  v_mfma_f32_16x16x32_bf16 v[100:103], v[68:71], v[72:75], v[100:103]
  ds_read_b64_tr_b16 v[40:41], v7 offset:17408
  ds_read_b64_tr_b16 v[42:43], v7 offset:19712
  v_mfma_f32_16x16x32_bf16 v[104:107], v[64:67], v[76:79], v[104:107]
  ds_read_b64_tr_b16 v[44:45], v7 offset:17440
  ds_read_b64_tr_b16 v[46:47], v7 offset:19744
  v_mfma_f32_16x16x32_bf16 v[108:111], v[68:71], v[76:79], v[108:111]
  ds_read_b64_tr_b16 v[48:49], v7 offset:17472
  ds_read_b64_tr_b16 v[50:51], v7 offset:19776
  v_mfma_f32_16x16x32_bf16 v[112:115], v[64:67], v[80:83], v[112:115]
  ds_read_b64_tr_b16 v[52:53], v7 offset:17504
  ds_read_b64_tr_b16 v[54:55], v7 offset:19808
  v_mfma_f32_16x16x32_bf16 v[116:119], v[68:71], v[80:83], v[116:119]
  ds_read_b64_tr_b16 v[56:57], v7 offset:17536
  ds_read_b64_tr_b16 v[58:59], v7 offset:19840
  v_mfma_f32_16x16x32_bf16 v[120:123], v[64:67], v[84:87], v[120:123]
  ds_read_b64_tr_b16 v[60:61], v10 offset:17408
  ds_read_b64_tr_b16 v[62:63], v10 offset:19712
  v_mfma_f32_16x16x32_bf16 v[124:127], v[68:71], v[84:87], v[124:127]
  s_add_u32 m0, s29, 87040
  s_nop 0
  v_mfma_f32_16x16x32_bf16 v[128:131], v[64:67], v[88:91], v[128:131]
  buffer_load_dwordx4 v1, s[4:7], s26 offen lds
  s_add_u32 m0, s30, 87040
  v_mfma_f32_16x16x32_bf16 v[132:135], v[68:71], v[88:91], v[132:135]
  s_add_u32 s26, s26, 64
  buffer_load_dwordx4 v2, s[8:11], s27 offen lds
  v_mfma_f32_16x16x32_bf16 v[136:139], v[20:23], v[92:95], v[136:139]
  s_add_u32 m0, s53, 87040
  s_cmp_eq_u32 s26, 1152
  s_cselect_b32 s26, 0, s26
  v_mfma_f32_16x16x32_bf16 v[140:143], v[20:23], v[88:91], v[140:143]
  buffer_load_dword v3, s[8:11], s27 offen lds
  s_add_u32 s27, s27, s28
  s_cmp_eq_u32 s26, 0
  s_cselect_b32 s27, 0, s27
  s_waitcnt lgkmcnt(0)
  s_waitcnt vmcnt(6)
  s_barrier
  v_mfma_f32_16x16x32_bf16 v[96:99], v[32:35], v[40:43], v[96:99]
  ds_read_b128 v[64:67], v4 offset:34816
  ds_read_b128 v[68:71], v4 offset:35840
  v_mfma_f32_16x16x32_bf16 v[100:103], v[36:39], v[40:43], v[100:103]
  ds_read_b64_tr_b16 v[72:73], v7 offset:34816
  ds_read_b64_tr_b16 v[74:75], v7 offset:37120
  v_mfma_f32_16x16x32_bf16 v[104:107], v[32:35], v[44:47], v[104:107]
  ds_read_b64_tr_b16 v[76:77], v7 offset:34848
  ds_read_b64_tr_b16 v[78:79], v7 offset:37152
  v_mfma_f32_16x16x32_bf16 v[108:111], v[36:39], v[44:47], v[108:111]
  ds_read_b64_tr_b16 v[80:81], v7 offset:34880
  ds_read_b64_tr_b16 v[82:83], v7 offset:37184
  v_mfma_f32_16x16x32_bf16 v[112:115], v[32:35], v[48:51], v[112:115]
  ds_read_b64_tr_b16 v[84:85], v7 offset:34912
  ds_read_b64_tr_b16 v[86:87], v7 offset:37216
  v_mfma_f32_16x16x32_bf16 v[116:119], v[36:39], v[48:51], v[116:119]
  ds_read_b64_tr_b16 v[88:89], v7 offset:34944
  ds_read_b64_tr_b16 v[90:91], v7 offset:37248
  v_mfma_f32_16x16x32_bf16 v[120:123], v[32:35], v[52:55], v[120:123]
  ds_read_b64_tr_b16 v[92:93], v10 offset:34816
  ds_read_b64_tr_b16 v[94:95], v10 offset:37120
  v_mfma_f32_16x16x32_bf16 v[124:127], v[36:39], v[52:55], v[124:127]
  s_add_u32 m0, s29, 104448
  s_nop 0
  v_mfma_f32_16x16x32_bf16 v[128:131], v[32:35], v[56:59], v[128:131]
  buffer_load_dwordx4 v1, s[4:7], s26 offen lds
  s_add_u32 m0, s30, 104448
  v_mfma_f32_16x16x32_bf16 v[132:135], v[36:39], v[56:59], v[132:135]
  s_add_u32 s26, s26, 64
  buffer_load_dwordx4 v2, s[8:11], s27 offen lds
  v_mfma_f32_16x16x32_bf16 v[136:139], v[20:23], v[60:63], v[136:139]
  s_add_u32 m0, s53, 104448
  s_cmp_eq_u32 s26, 1152
  s_cselect_b32 s26, 0, s26
  v_mfma_f32_16x16x32_bf16 v[140:143], v[20:23], v[56:59], v[140:143]
  buffer_load_dword v3, s[8:11], s27 offen lds
  s_add_u32 s27, s27, s28
  s_cmp_eq_u32 s26, 0
  s_cselect_b32 s27, 0, s27
  s_waitcnt lgkmcnt(0)
  v_mfma_f32_16x16x32_bf16 v[96:99], v[64:67], v[72:75], v[96:99]
  ds_read_b128 v[32:35], v5 offset:0
  ds_read_b128 v[36:39], v5 offset:1024
  v_mfma_f32_16x16x32_bf16 v[100:103], v[68:71], v[72:75], v[100:103]
  ds_read_b64_tr_b16 v[40:41], v8 offset:0
  ds_read_b64_tr_b16 v[42:43], v8 offset:2304
  v_mfma_f32_16x16x32_bf16 v[104:107], v[64:67], v[76:79], v[104:107]
  ds_read_b64_tr_b16 v[44:45], v8 offset:32
  ds_read_b64_tr_b16 v[46:47], v8 offset:2336
  v_mfma_f32_16x16x32_bf16 v[108:111], v[68:71], v[76:79], v[108:111]
  ds_read_b64_tr_b16 v[48:49], v8 offset:64
  ds_read_b64_tr_b16 v[50:51], v8 offset:2368
  v_mfma_f32_16x16x32_bf16 v[112:115], v[64:67], v[80:83], v[112:115]
  ds_read_b64_tr_b16 v[52:53], v8 offset:96
  ds_read_b64_tr_b16 v[54:55], v8 offset:2400
  v_mfma_f32_16x16x32_bf16 v[116:119], v[68:71], v[80:83], v[116:119]
  ds_read_b64_tr_b16 v[56:57], v8 offset:128
  ds_read_b64_tr_b16 v[58:59], v8 offset:2432
  v_mfma_f32_16x16x32_bf16 v[120:123], v[64:67], v[84:87], v[120:123]
  ds_read_b64_tr_b16 v[60:61], v11 offset:0
  ds_read_b64_tr_b16 v[62:63], v11 offset:2304
  v_mfma_f32_16x16x32_bf16 v[124:127], v[68:71], v[84:87], v[124:127]
  s_add_u32 m0, s29, 121856
  s_nop 0
  v_mfma_f32_16x16x32_bf16 v[128:131], v[64:67], v[88:91], v[128:131]
  buffer_load_dwordx4 v1, s[4:7], s26 offen lds
  s_add_u32 m0, s30, 121856
  v_mfma_f32_16x16x32_bf16 v[132:135], v[68:71], v[88:91], v[132:135]
  s_add_u32 s26, s26, 64
  buffer_load_dwordx4 v2, s[8:11], s27 offen lds
  v_mfma_f32_16x16x32_bf16 v[136:139], v[20:23], v[92:95], v[136:139]
  s_add_u32 m0, s53, 121856
  s_cmp_eq_u32 s26, 1152
  s_cselect_b32 s26, 0, s26
  v_mfma_f32_16x16x32_bf16 v[140:143], v[20:23], v[88:91], v[140:143]
  buffer_load_dword v3, s[8:11], s27 offen lds
  s_add_u32 s27, s27, s28
  s_cmp_eq_u32 s26, 0
  s_cselect_b32 s27, 0, s27
  s_waitcnt lgkmcnt(0)
  s_waitcnt vmcnt(6)
  s_barrier
  v_mfma_f32_16x16x32_bf16 v[96:99], v[32:35], v[40:43], v[96:99]
  ds_read_b128 v[64:67], v5 offset:17408
  ds_read_b128 v[68:71], v5 offset:18432
  v_mfma_f32_16x16x32_bf16 v[100:103], v[36:39], v[40:43], v[100:103]
  ds_read_b64_tr_b16 v[72:73], v8 offset:17408
  ds_read_b64_tr_b16 v[74:75], v8 offset:19712
  v_mfma_f32_16x16x32_bf16 v[104:107], v[32:35], v[44:47], v[104:107]
  ds_read_b64_tr_b16 v[76:77], v8 offset:17440
  ds_read_b64_tr_b16 v[78:79], v8 offset:19744
  v_mfma_f32_16x16x32_bf16 v[108:111], v[36:39], v[44:47], v[108:111]
  ds_read_b64_tr_b16 v[80:81], v8 offset:17472
  ds_read_b64_tr_b16 v[82:83], v8 offset:19776
  v_mfma_f32_16x16x32_bf16 v[112:115], v[32:35], v[48:51], v[112:115]
  ds_read_b64_tr_b16 v[84:85], v8 offset:17504
  ds_read_b64_tr_b16 v[86:87], v8 offset:19808
  v_mfma_f32_16x16x32_bf16 v[116:119], v[36:39], v[48:51], v[116:119]
  ds_read_b64_tr_b16 v[88:89], v8 offset:17536
  ds_read_b64_tr_b16 v[90:91], v8 offset:19840
  v_mfma_f32_16x16x32_bf16 v[120:123], v[32:35], v[52:55], v[120:123]
  ds_read_b64_tr_b16 v[92:93], v11 offset:17408
  ds_read_b64_tr_b16 v[94:95], v11 offset:19712
  v_mfma_f32_16x16x32_bf16 v[124:127], v[36:39], v[52:55], v[124:127]
  s_add_u32 m0, s29, 139264
  s_nop 0
  v_mfma_f32_16x16x32_bf16 v[128:131], v[32:35], v[56:59], v[128:131]
  buffer_load_dwordx4 v1, s[4:7], s26 offen lds
  s_add_u32 m0, s30, 139264
  v_mfma_f32_16x16x32_bf16 v[132:135], v[36:39], v[56:59], v[132:135]
  s_add_u32 s26, s26, 64
  buffer_load_dwordx4 v2, s[8:11], s27 offen lds
  v_mfma_f32_16x16x32_bf16 v[136:139], v[20:23], v[60:63], v[136:139]
  s_add_u32 m0, s53, 139264
  s_cmp_eq_u32 s26, 1152
  s_cselect_b32 s26, 0, s26
  v_mfma_f32_16x16x32_bf16 v[140:143], v[20:23], v[56:59], v[140:143]
  buffer_load_dword v3, s[8:11], s27 offen lds
  s_add_u32 s27, s27, s28
  s_cmp_eq_u32 s26, 0
  s_cselect_b32 s27, 0, s27
  s_waitcnt lgkmcnt(0)
  v_mfma_f32_16x16x32_bf16 v[96:99], v[64:67], v[72:75], v[96:99]
  ds_read_b128 v[32:35], v5 offset:34816
  v_mfma_f32_16x16x32_bf16 v[100:103], v[68:71], v[72:75], v[100:103]
  ds_read_b128 v[36:39], v5 offset:35840
  v_mfma_f32_16x16x32_bf16 v[104:107], v[64:67], v[76:79], v[104:107]
  ds_read_b64_tr_b16 v[40:41], v8 offset:34816
  v_mfma_f32_16x16x32_bf16 v[108:111], v[68:71], v[76:79], v[108:111]
  ds_read_b64_tr_b16 v[42:43], v8 offset:37120
  v_mfma_f32_16x16x32_bf16 v[112:115], v[64:67], v[80:83], v[112:115]
  ds_read_b64_tr_b16 v[44:45], v8 offset:34848
  v_mfma_f32_16x16x32_bf16 v[116:119], v[68:71], v[80:83], v[116:119]
  ds_read_b64_tr_b16 v[46:47], v8 offset:37152
  ds_read_b64_tr_b16 v[48:49], v8 offset:34880
  v_mfma_f32_16x16x32_bf16 v[120:123], v[64:67], v[84:87], v[120:123]
  ds_read_b64_tr_b16 v[50:51], v8 offset:37184
  v_mfma_f32_16x16x32_bf16 v[124:127], v[68:71], v[84:87], v[124:127]
  ds_read_b64_tr_b16 v[52:53], v8 offset:34912
  v_mfma_f32_16x16x32_bf16 v[128:131], v[64:67], v[88:91], v[128:131]
  ds_read_b64_tr_b16 v[54:55], v8 offset:37216
  v_mfma_f32_16x16x32_bf16 v[132:135], v[68:71], v[88:91], v[132:135]
  ds_read_b64_tr_b16 v[56:57], v8 offset:34944
  v_mfma_f32_16x16x32_bf16 v[136:139], v[20:23], v[92:95], v[136:139]
  ds_read_b64_tr_b16 v[58:59], v8 offset:37248
  v_mfma_f32_16x16x32_bf16 v[140:143], v[20:23], v[88:91], v[140:143]
  ds_read_b64_tr_b16 v[60:61], v11 offset:34816
  ds_read_b64_tr_b16 v[62:63], v11 offset:37120
  s_waitcnt lgkmcnt(0)
  s_waitcnt vmcnt(3)
  s_barrier
  v_mfma_f32_16x16x32_bf16 v[96:99], v[32:35], v[40:43], v[96:99]
  ds_read_b128 v[64:67], v6 offset:0
  v_mfma_f32_16x16x32_bf16 v[100:103], v[36:39], v[40:43], v[100:103]
  ds_read_b128 v[68:71], v6 offset:1024
  v_mfma_f32_16x16x32_bf16 v[104:107], v[32:35], v[44:47], v[104:107]
  ds_read_b64_tr_b16 v[72:73], v9 offset:0
  v_mfma_f32_16x16x32_bf16 v[108:111], v[36:39], v[44:47], v[108:111]
  ds_read_b64_tr_b16 v[74:75], v9 offset:2304
  v_mfma_f32_16x16x32_bf16 v[112:115], v[32:35], v[48:51], v[112:115]
  ds_read_b64_tr_b16 v[76:77], v9 offset:32
  v_mfma_f32_16x16x32_bf16 v[116:119], v[36:39], v[48:51], v[116:119]
  ds_read_b64_tr_b16 v[78:79], v9 offset:2336
  ds_read_b64_tr_b16 v[80:81], v9 offset:64
  v_mfma_f32_16x16x32_bf16 v[120:123], v[32:35], v[52:55], v[120:123]
  ds_read_b64_tr_b16 v[82:83], v9 offset:2368
  v_mfma_f32_16x16x32_bf16 v[124:127], v[36:39], v[52:55], v[124:127]
  ds_read_b64_tr_b16 v[84:85], v9 offset:96
  v_mfma_f32_16x16x32_bf16 v[128:131], v[32:35], v[56:59], v[128:131]
  ds_read_b64_tr_b16 v[86:87], v9 offset:2400
  v_mfma_f32_16x16x32_bf16 v[132:135], v[36:39], v[56:59], v[132:135]
  ds_read_b64_tr_b16 v[88:89], v9 offset:128
  v_mfma_f32_16x16x32_bf16 v[136:139], v[20:23], v[60:63], v[136:139]
  ds_read_b64_tr_b16 v[90:91], v9 offset:2432
  v_mfma_f32_16x16x32_bf16 v[140:143], v[20:23], v[56:59], v[140:143]
  ds_read_b64_tr_b16 v[92:93], v12 offset:0
  ds_read_b64_tr_b16 v[94:95], v12 offset:2304
  s_waitcnt lgkmcnt(0)
  v_mfma_f32_16x16x32_bf16 v[96:99], v[64:67], v[72:75], v[96:99]
  ds_read_b128 v[32:35], v6 offset:17408
  v_mfma_f32_16x16x32_bf16 v[100:103], v[68:71], v[72:75], v[100:103]
  ds_read_b128 v[36:39], v6 offset:18432
  v_mfma_f32_16x16x32_bf16 v[104:107], v[64:67], v[76:79], v[104:107]
  ds_read_b64_tr_b16 v[40:41], v9 offset:17408
  v_mfma_f32_16x16x32_bf16 v[108:111], v[68:71], v[76:79], v[108:111]
  ds_read_b64_tr_b16 v[42:43], v9 offset:19712
  v_mfma_f32_16x16x32_bf16 v[112:115], v[64:67], v[80:83], v[112:115]
  ds_read_b64_tr_b16 v[44:45], v9 offset:17440
  v_mfma_f32_16x16x32_bf16 v[116:119], v[68:71], v[80:83], v[116:119]
  ds_read_b64_tr_b16 v[46:47], v9 offset:19744
  ds_read_b64_tr_b16 v[48:49], v9 offset:17472
  v_mfma_f32_16x16x32_bf16 v[120:123], v[64:67], v[84:87], v[120:123]
  ds_read_b64_tr_b16 v[50:51], v9 offset:19776
  v_mfma_f32_16x16x32_bf16 v[124:127], v[68:71], v[84:87], v[124:127]
  ds_read_b64_tr_b16 v[52:53], v9 offset:17504
  v_mfma_f32_16x16x32_bf16 v[128:131], v[64:67], v[88:91], v[128:131]
  ds_read_b64_tr_b16 v[54:55], v9 offset:19808
  v_mfma_f32_16x16x32_bf16 v[132:135], v[68:71], v[88:91], v[132:135]
  ds_read_b64_tr_b16 v[56:57], v9 offset:17536
  v_mfma_f32_16x16x32_bf16 v[136:139], v[20:23], v[92:95], v[136:139]
  ds_read_b64_tr_b16 v[58:59], v9 offset:19840
  v_mfma_f32_16x16x32_bf16 v[140:143], v[20:23], v[88:91], v[140:143]
  ds_read_b64_tr_b16 v[60:61], v12 offset:17408
  ds_read_b64_tr_b16 v[62:63], v12 offset:19712
  s_waitcnt lgkmcnt(0)
  s_waitcnt vmcnt(0)
  s_barrier
  v_mfma_f32_16x16x32_bf16 v[96:99], v[32:35], v[40:43], v[96:99]
  ds_read_b128 v[64:67], v6 offset:34816
  v_mfma_f32_16x16x32_bf16 v[100:103], v[36:39], v[40:43], v[100:103]
  ds_read_b128 v[68:71], v6 offset:35840
  ds_read_b64_tr_b16 v[72:73], v9 offset:34816
  v_mfma_f32_16x16x32_bf16 v[104:107], v[32:35], v[44:47], v[104:107]
  ds_read_b64_tr_b16 v[74:75], v9 offset:37120
  ds_read_b64_tr_b16 v[76:77], v9 offset:34848
  v_mfma_f32_16x16x32_bf16 v[108:111], v[36:39], v[44:47], v[108:111]
  ds_read_b64_tr_b16 v[78:79], v9 offset:37152
  ds_read_b64_tr_b16 v[80:81], v9 offset:34880
  v_mfma_f32_16x16x32_bf16 v[112:115], v[32:35], v[48:51], v[112:115]
  ds_read_b64_tr_b16 v[82:83], v9 offset:37184
  ds_read_b64_tr_b16 v[84:85], v9 offset:34912
  v_mfma_f32_16x16x32_bf16 v[116:119], v[36:39], v[48:51], v[116:119]
  ds_read_b64_tr_b16 v[86:87], v9 offset:37216
  ds_read_b64_tr_b16 v[88:89], v9 offset:34944
  v_mfma_f32_16x16x32_bf16 v[120:123], v[32:35], v[52:55], v[120:123]
  ds_read_b64_tr_b16 v[90:91], v9 offset:37248
  ds_read_b64_tr_b16 v[92:93], v12 offset:34816
  v_mfma_f32_16x16x32_bf16 v[124:127], v[36:39], v[52:55], v[124:127]
  ds_read_b64_tr_b16 v[94:95], v12 offset:37120
  buffer_load_dwordx4 v[24:27], v17, s[16:19], s52 offen
  v_mfma_f32_16x16x32_bf16 v[128:131], v[32:35], v[56:59], v[128:131]
  buffer_load_dwordx4 v[28:31], v18, s[16:19], s52 offen offset:1024
  s_mov_b32 s58, 663552
  s_mov_b32 s59, 0x20000
  s_sub_u32 s42, s52, 3456
  v_mfma_f32_16x16x32_bf16 v[132:135], v[36:39], v[56:59], v[132:135]
  buffer_load_dwordx4 v[216:219], v18, s[56:59], s42 offen offset:1024
  s_mul_i32 s42, s46, 20736
  v_mfma_f32_16x16x32_bf16 v[136:139], v[20:23], v[60:63], v[136:139]
  v_lshlrev_b32 v211, 4, v0
  buffer_load_dwordx4 v[212:215], v211, s[16:19], s42 offen
  s_add_u32 s42, s42, 8192
  v_mfma_f32_16x16x32_bf16 v[140:143], v[20:23], v[56:59], v[140:143]
  buffer_load_dwordx4 v[212:215], v211, s[16:19], s42 offen
  s_add_u32 s42, s42, 8192
  buffer_load_dwordx4 v[212:215], v211, s[16:19], s42 offen
  s_add_u32 s42, s42, 8192
  s_waitcnt lgkmcnt(0)
  v_mfma_f32_16x16x32_bf16 v[96:99], v[64:67], v[72:75], v[96:99]
  v_mfma_f32_16x16x32_bf16 v[100:103], v[68:71], v[72:75], v[100:103]
  v_mfma_f32_16x16x32_bf16 v[104:107], v[64:67], v[76:79], v[104:107]
  v_mfma_f32_16x16x32_bf16 v[108:111], v[68:71], v[76:79], v[108:111]
  v_mfma_f32_16x16x32_bf16 v[112:115], v[64:67], v[80:83], v[112:115]
  v_mfma_f32_16x16x32_bf16 v[116:119], v[68:71], v[80:83], v[116:119]
  v_mfma_f32_16x16x32_bf16 v[120:123], v[64:67], v[84:87], v[120:123]
  v_mfma_f32_16x16x32_bf16 v[124:127], v[68:71], v[84:87], v[124:127]
  v_mfma_f32_16x16x32_bf16 v[128:131], v[64:67], v[88:91], v[128:131]
  v_mfma_f32_16x16x32_bf16 v[132:135], v[68:71], v[88:91], v[132:135]
  v_mfma_f32_16x16x32_bf16 v[136:139], v[20:23], v[92:95], v[136:139]
  v_mfma_f32_16x16x32_bf16 v[140:143], v[20:23], v[88:91], v[140:143]
  s_add_u32 s31, s49, 17
  s_sub_u32 s50, s31, 18
  s_cselect_b32 s31, s31, s50
  s_lshl_b32 s31, s31, 17
  s_add_u32 s31, s31, s51
  buffer_store_dwordx4 v[64:67], v210, s[12:15], s31 offen sc1
  s_and_b32 s31, s24, 13
  s_cmp_lg_u32 s31, 0
  s_cbranch_scc1 Lnx_13
  s_add_u32 s31, s49, 16
  s_sub_u32 s50, s31, 18
  s_cselect_b32 s31, s31, s50
  s_lshl_b32 s31, s31, 17
  s_add_u32 s31, s31, s51
  buffer_store_dwordx4 v[32:35], v210, s[12:15], s31 offen sc1
Lnx_13:
  v_and_b32 v14, 15, v13
  s_mul_i32 s31, s22, 5
  s_add_u32 s31, s31, s21
  s_lshl_b32 s31, s31, 4
  v_add_u32 v15, s31, v14
  v_lshlrev_b32 v15, 2, v15
  v_lshlrev_b32 v16, 2, v14
  v_add_u32 v15, 157696, v15
  v_add_u32 v16, 157952, v16
  s_lshl_b32 s31, s21, 5
  v_add_u32 v156, s31, v14
  v_lshlrev_b32 v156, 2, v156
  v_add_u32 v157, 156672, v156
  s_nop 1
  ds_write_b32 v15, v136
  ds_write_b32 v16, v140
  s_waitcnt lgkmcnt(0)
  s_barrier
  v_lshrrev_b32 v14, 4, v13
  v_lshlrev_b32 v14, 4, v14
  s_lshl_b32 s31, s21, 7
  s_add_u32 s31, s31, 156672
  v_add_u32 v14, s31, v14
  v_and_b32 v15, 15, v13
  v_lshlrev_b32 v16, 2, v15
  v_add_u32 v16, 157696, v16
  ds_read_b128 v[164:167], v14 offset:0
  ds_read_b128 v[172:175], v14 offset:512
  ds_read_b128 v[168:171], v14 offset:64
  ds_read_b128 v[176:179], v14 offset:576
  ds_read_b32 v180, v16 offset:0
  ds_read_b32 v181, v16 offset:64
  ds_read_b32 v182, v16 offset:128
  ds_read_b32 v183, v16 offset:192
  ds_read_b32 v184, v16 offset:256
  v_lshrrev_b32 v14, 4, v13
  v_mul_u32_u24 v14, 320, v14
  s_lshl_b32 s31, s23, 2
  s_add_u32 s31, s31, s21
  s_mul_i32 s31, s31, 1280
  s_mul_i32 s42, s47, 655360
  s_add_u32 s31, s31, s42
  s_add_u32 s31, s31, 11796480
  s_mov_b32 s42, 81632
  v_add_u32 v196, 0, v15
  v_mul_u32_u24 v16, 3641, v196
  v_lshrrev_b32 v16, 16, v16
  v_lshl_add_u32 v196, v196, 4, v14
  v_mad_u32_u24 v196, v16, s42, v196
  v_add_u32 v197, 16, v15
  v_mul_u32_u24 v16, 3641, v197
  v_lshrrev_b32 v16, 16, v16
  v_lshl_add_u32 v197, v197, 4, v14
  v_mad_u32_u24 v197, v16, s42, v197
  v_add_u32 v198, 32, v15
  v_mul_u32_u24 v16, 3641, v198
  v_lshrrev_b32 v16, 16, v16
  v_lshl_add_u32 v198, v198, 4, v14
  v_mad_u32_u24 v198, v16, s42, v198
  v_add_u32 v199, 48, v15
  v_mul_u32_u24 v16, 3641, v199
  v_lshrrev_b32 v16, 16, v16
  v_lshl_add_u32 v199, v199, 4, v14
  v_mad_u32_u24 v199, v16, s42, v199
  v_add_u32 v200, 64, v15
  v_mul_u32_u24 v16, 3641, v200
  v_lshrrev_b32 v16, 16, v16
  v_lshl_add_u32 v200, v200, 4, v14
  v_mad_u32_u24 v200, v16, s42, v200
  s_waitcnt lgkmcnt(0)
  v_fma_f32 v96, -v164, v180, v96
  v_mul_f32 v96, v172, v96
  v_fma_f32 v97, -v165, v180, v97
  v_mul_f32 v97, v173, v97
  v_fma_f32 v98, -v166, v180, v98
  v_mul_f32 v98, v174, v98
  v_fma_f32 v99, -v167, v180, v99
  v_mul_f32 v99, v175, v99
  v_cvt_pk_bf16_f32 v188, v96, v97
  v_cvt_pk_bf16_f32 v189, v98, v99
  v_fma_f32 v100, -v168, v180, v100
  v_mul_f32 v100, v176, v100
  v_fma_f32 v101, -v169, v180, v101
  v_mul_f32 v101, v177, v101
  v_fma_f32 v102, -v170, v180, v102
  v_mul_f32 v102, v178, v102
  v_fma_f32 v103, -v171, v180, v103
  v_mul_f32 v103, v179, v103
  v_cvt_pk_bf16_f32 v190, v100, v101
  v_cvt_pk_bf16_f32 v191, v102, v103
  s_nop 1
  v_permlane32_swap_b32 v188, v190
  v_permlane32_swap_b32 v189, v191
  buffer_store_dwordx4 v[188:191], v196, s[12:15], s31 offen sc1
  v_fma_f32 v104, -v164, v181, v104
  v_mul_f32 v104, v172, v104
  v_fma_f32 v105, -v165, v181, v105
  v_mul_f32 v105, v173, v105
  v_fma_f32 v106, -v166, v181, v106
  v_mul_f32 v106, v174, v106
  v_fma_f32 v107, -v167, v181, v107
  v_mul_f32 v107, v175, v107
  v_cvt_pk_bf16_f32 v192, v104, v105
  v_cvt_pk_bf16_f32 v193, v106, v107
  v_fma_f32 v108, -v168, v181, v108
  v_mul_f32 v108, v176, v108
  v_fma_f32 v109, -v169, v181, v109
  v_mul_f32 v109, v177, v109
  v_fma_f32 v110, -v170, v181, v110
  v_mul_f32 v110, v178, v110
  v_fma_f32 v111, -v171, v181, v111
  v_mul_f32 v111, v179, v111
  v_cvt_pk_bf16_f32 v194, v108, v109
  v_cvt_pk_bf16_f32 v195, v110, v111
  s_nop 1
  v_permlane32_swap_b32 v192, v194
  v_permlane32_swap_b32 v193, v195
  buffer_store_dwordx4 v[192:195], v197, s[12:15], s31 offen sc1
  v_fma_f32 v112, -v164, v182, v112
  v_mul_f32 v112, v172, v112
  v_fma_f32 v113, -v165, v182, v113
  v_mul_f32 v113, v173, v113
  v_fma_f32 v114, -v166, v182, v114
  v_mul_f32 v114, v174, v114
  v_fma_f32 v115, -v167, v182, v115
  v_mul_f32 v115, v175, v115
  v_cvt_pk_bf16_f32 v188, v112, v113
  v_cvt_pk_bf16_f32 v189, v114, v115
  v_fma_f32 v116, -v168, v182, v116
  v_mul_f32 v116, v176, v116
  v_fma_f32 v117, -v169, v182, v117
  v_mul_f32 v117, v177, v117
  v_fma_f32 v118, -v170, v182, v118
  v_mul_f32 v118, v178, v118
  v_fma_f32 v119, -v171, v182, v119
  v_mul_f32 v119, v179, v119
  v_cvt_pk_bf16_f32 v190, v116, v117
  v_cvt_pk_bf16_f32 v191, v118, v119
  s_nop 1
  v_permlane32_swap_b32 v188, v190
  v_permlane32_swap_b32 v189, v191
  buffer_store_dwordx4 v[188:191], v198, s[12:15], s31 offen sc1
  v_fma_f32 v120, -v164, v183, v120
  v_mul_f32 v120, v172, v120
  v_fma_f32 v121, -v165, v183, v121
  v_mul_f32 v121, v173, v121
  v_fma_f32 v122, -v166, v183, v122
  v_mul_f32 v122, v174, v122
  v_fma_f32 v123, -v167, v183, v123
  v_mul_f32 v123, v175, v123
  v_cvt_pk_bf16_f32 v192, v120, v121
  v_cvt_pk_bf16_f32 v193, v122, v123
  v_fma_f32 v124, -v168, v183, v124
  v_mul_f32 v124, v176, v124
  v_fma_f32 v125, -v169, v183, v125
  v_mul_f32 v125, v177, v125
  v_fma_f32 v126, -v170, v183, v126
  v_mul_f32 v126, v178, v126
  v_fma_f32 v127, -v171, v183, v127
  v_mul_f32 v127, v179, v127
  v_cvt_pk_bf16_f32 v194, v124, v125
  v_cvt_pk_bf16_f32 v195, v126, v127
  s_nop 1
  v_permlane32_swap_b32 v192, v194
  v_permlane32_swap_b32 v193, v195
  buffer_store_dwordx4 v[192:195], v199, s[12:15], s31 offen sc1
  v_fma_f32 v128, -v164, v184, v128
  v_mul_f32 v128, v172, v128
  v_fma_f32 v129, -v165, v184, v129
  v_mul_f32 v129, v173, v129
  v_fma_f32 v130, -v166, v184, v130
  v_mul_f32 v130, v174, v130
  v_fma_f32 v131, -v167, v184, v131
  v_mul_f32 v131, v175, v131
  v_cvt_pk_bf16_f32 v188, v128, v129
  v_cvt_pk_bf16_f32 v189, v130, v131
  v_fma_f32 v132, -v168, v184, v132
  v_mul_f32 v132, v176, v132
  v_fma_f32 v133, -v169, v184, v133
  v_mul_f32 v133, v177, v133
  v_fma_f32 v134, -v170, v184, v134
  v_mul_f32 v134, v178, v134
  v_fma_f32 v135, -v171, v184, v135
  v_mul_f32 v135, v179, v135
  v_cvt_pk_bf16_f32 v190, v132, v133
  v_cvt_pk_bf16_f32 v191, v134, v135
  s_nop 1
  v_permlane32_swap_b32 v188, v190
  v_permlane32_swap_b32 v189, v191
  buffer_store_dwordx4 v[188:191], v200, s[12:15], s31 offen sc1
  s_branch Lbarjob_10
.p2align 6
Lk1_11_7:
  s_waitcnt vmcnt(3)
  s_barrier
  ds_read_b128 v[32:35], v4 offset:0
  ds_read_b128 v[36:39], v4 offset:1024
  ds_read_b64_tr_b16 v[40:41], v7 offset:0
  ds_read_b64_tr_b16 v[42:43], v7 offset:2304
  ds_read_b64_tr_b16 v[44:45], v7 offset:32
  ds_read_b64_tr_b16 v[46:47], v7 offset:2336
  ds_read_b64_tr_b16 v[48:49], v7 offset:64
  ds_read_b64_tr_b16 v[50:51], v7 offset:2368
  ds_read_b64_tr_b16 v[52:53], v7 offset:96
  ds_read_b64_tr_b16 v[54:55], v7 offset:2400
  ds_read_b64_tr_b16 v[60:61], v10 offset:0
  ds_read_b64_tr_b16 v[62:63], v10 offset:2304
  s_add_u32 m0, s29, 34816
  s_nop 0
  buffer_load_dwordx4 v1, s[4:7], s26 offen lds
  s_add_u32 m0, s30, 34816
  s_add_u32 s26, s26, 64
  buffer_load_dwordx4 v2, s[8:11], s27 offen lds
  s_add_u32 m0, s53, 34816
  s_cmp_eq_u32 s26, 1152
  s_cselect_b32 s26, 0, s26
  buffer_load_dword v3, s[8:11], s27 offen lds
  s_add_u32 s27, s27, s28
  s_cmp_eq_u32 s26, 0
  s_cselect_b32 s27, 0, s27
  s_waitcnt lgkmcnt(0)
  s_waitcnt vmcnt(3)
  s_barrier
  v_mfma_f32_16x16x32_bf16 v[96:99], v[40:43], v[32:35], 0
  ds_read_b128 v[64:67], v4 offset:17408
  ds_read_b128 v[68:71], v4 offset:18432
  v_mfma_f32_16x16x32_bf16 v[100:103], v[40:43], v[36:39], 0
  ds_read_b64_tr_b16 v[72:73], v7 offset:17408
  ds_read_b64_tr_b16 v[74:75], v7 offset:19712
  v_mfma_f32_16x16x32_bf16 v[104:107], v[44:47], v[32:35], 0
  ds_read_b64_tr_b16 v[76:77], v7 offset:17440
  ds_read_b64_tr_b16 v[78:79], v7 offset:19744
  ds_read_b64_tr_b16 v[80:81], v7 offset:17472
  v_mfma_f32_16x16x32_bf16 v[108:111], v[44:47], v[36:39], 0
  ds_read_b64_tr_b16 v[82:83], v7 offset:19776
  ds_read_b64_tr_b16 v[84:85], v7 offset:17504
  v_mfma_f32_16x16x32_bf16 v[112:115], v[48:51], v[32:35], 0
  ds_read_b64_tr_b16 v[86:87], v7 offset:19808
  ds_read_b64_tr_b16 v[92:93], v10 offset:17408
  ds_read_b64_tr_b16 v[94:95], v10 offset:19712
  v_mfma_f32_16x16x32_bf16 v[116:119], v[48:51], v[36:39], 0
  s_add_u32 m0, s29, 52224
  s_nop 0
  v_mfma_f32_16x16x32_bf16 v[120:123], v[52:55], v[32:35], 0
  buffer_load_dwordx4 v1, s[4:7], s26 offen lds
  s_add_u32 m0, s30, 52224
  s_add_u32 s26, s26, 64
  v_mfma_f32_16x16x32_bf16 v[124:127], v[52:55], v[36:39], 0
  buffer_load_dwordx4 v2, s[8:11], s27 offen lds
  s_add_u32 m0, s53, 52224
  v_mfma_f32_16x16x32_bf16 v[136:139], v[20:23], v[60:63], 0
  s_cmp_eq_u32 s26, 1152
  s_cselect_b32 s26, 0, s26
  buffer_load_dword v3, s[8:11], s27 offen lds
  s_add_u32 s27, s27, s28
  s_cmp_eq_u32 s26, 0
  s_cselect_b32 s27, 0, s27
  v_mfma_f32_16x16x32_bf16 v[140:143], v[32:35], v[32:35], 0
  s_add_u32 m0, s29, 69632
  s_nop 0
  v_mfma_f32_16x16x32_bf16 v[148:151], v[20:23], v[32:35], 0
  buffer_load_dwordx4 v1, s[4:7], s26 offen lds
  s_add_u32 m0, s30, 69632
  s_add_u32 s26, s26, 64
  v_mfma_f32_16x16x32_bf16 v[144:147], v[36:39], v[36:39], 0
  buffer_load_dwordx4 v2, s[8:11], s27 offen lds
  s_add_u32 m0, s53, 69632
  v_mfma_f32_16x16x32_bf16 v[152:155], v[20:23], v[36:39], 0
  s_cmp_eq_u32 s26, 1152
  s_cselect_b32 s26, 0, s26
  buffer_load_dword v3, s[8:11], s27 offen lds
  s_add_u32 s27, s27, s28
  s_cmp_eq_u32 s26, 0
  s_cselect_b32 s27, 0, s27
  s_waitcnt lgkmcnt(0)
  s_waitcnt vmcnt(6)
  s_barrier
  v_mfma_f32_16x16x32_bf16 v[96:99], v[72:75], v[64:67], v[96:99]
  ds_read_b128 v[32:35], v4 offset:34816
  ds_read_b128 v[36:39], v4 offset:35840
  v_mfma_f32_16x16x32_bf16 v[100:103], v[72:75], v[68:71], v[100:103]
  ds_read_b64_tr_b16 v[40:41], v7 offset:34816
  ds_read_b64_tr_b16 v[42:43], v7 offset:37120
  v_mfma_f32_16x16x32_bf16 v[104:107], v[76:79], v[64:67], v[104:107]
  ds_read_b64_tr_b16 v[44:45], v7 offset:34848
  ds_read_b64_tr_b16 v[46:47], v7 offset:37152
  ds_read_b64_tr_b16 v[48:49], v7 offset:34880
  v_mfma_f32_16x16x32_bf16 v[108:111], v[76:79], v[68:71], v[108:111]
  ds_read_b64_tr_b16 v[50:51], v7 offset:37184
  ds_read_b64_tr_b16 v[52:53], v7 offset:34912
  v_mfma_f32_16x16x32_bf16 v[112:115], v[80:83], v[64:67], v[112:115]
  ds_read_b64_tr_b16 v[54:55], v7 offset:37216
  ds_read_b64_tr_b16 v[60:61], v10 offset:34816
  ds_read_b64_tr_b16 v[62:63], v10 offset:37120
  v_mfma_f32_16x16x32_bf16 v[116:119], v[80:83], v[68:71], v[116:119]
  s_add_u32 m0, s29, 87040
  s_nop 0
  v_mfma_f32_16x16x32_bf16 v[120:123], v[84:87], v[64:67], v[120:123]
  buffer_load_dwordx4 v1, s[4:7], s26 offen lds
  s_add_u32 m0, s30, 87040
  s_add_u32 s26, s26, 64
  v_mfma_f32_16x16x32_bf16 v[124:127], v[84:87], v[68:71], v[124:127]
  buffer_load_dwordx4 v2, s[8:11], s27 offen lds
  s_add_u32 m0, s53, 87040
  v_mfma_f32_16x16x32_bf16 v[136:139], v[20:23], v[92:95], v[136:139]
  s_cmp_eq_u32 s26, 1152
  s_cselect_b32 s26, 0, s26
  buffer_load_dword v3, s[8:11], s27 offen lds
  s_add_u32 s27, s27, s28
  s_cmp_eq_u32 s26, 0
  s_cselect_b32 s27, 0, s27
  v_mfma_f32_16x16x32_bf16 v[140:143], v[64:67], v[64:67], v[140:143]
  s_add_u32 m0, s29, 104448
  s_nop 0
  v_mfma_f32_16x16x32_bf16 v[148:151], v[20:23], v[64:67], v[148:151]
  buffer_load_dwordx4 v1, s[4:7], s26 offen lds
  s_add_u32 m0, s30, 104448
  s_add_u32 s26, s26, 64
  v_mfma_f32_16x16x32_bf16 v[144:147], v[68:71], v[68:71], v[144:147]
  buffer_load_dwordx4 v2, s[8:11], s27 offen lds
  s_add_u32 m0, s53, 104448
  v_mfma_f32_16x16x32_bf16 v[152:155], v[20:23], v[68:71], v[152:155]
  s_cmp_eq_u32 s26, 1152
  s_cselect_b32 s26, 0, s26
  buffer_load_dword v3, s[8:11], s27 offen lds
  s_add_u32 s27, s27, s28
  s_cmp_eq_u32 s26, 0
  s_cselect_b32 s27, 0, s27
  s_waitcnt lgkmcnt(0)
  s_waitcnt vmcnt(6)
  s_barrier
  v_mfma_f32_16x16x32_bf16 v[96:99], v[40:43], v[32:35], v[96:99]
  ds_read_b128 v[64:67], v5 offset:0
  v_mfma_f32_16x16x32_bf16 v[100:103], v[40:43], v[36:39], v[100:103]
  ds_read_b128 v[68:71], v5 offset:1024
  ds_read_b64_tr_b16 v[72:73], v8 offset:0
  v_mfma_f32_16x16x32_bf16 v[104:107], v[44:47], v[32:35], v[104:107]
  ds_read_b64_tr_b16 v[74:75], v8 offset:2304
  ds_read_b64_tr_b16 v[76:77], v8 offset:32
  v_mfma_f32_16x16x32_bf16 v[108:111], v[44:47], v[36:39], v[108:111]
  ds_read_b64_tr_b16 v[78:79], v8 offset:2336
  v_mfma_f32_16x16x32_bf16 v[112:115], v[48:51], v[32:35], v[112:115]
  ds_read_b64_tr_b16 v[80:81], v8 offset:64
  ds_read_b64_tr_b16 v[82:83], v8 offset:2368
  v_mfma_f32_16x16x32_bf16 v[116:119], v[48:51], v[36:39], v[116:119]
  ds_read_b64_tr_b16 v[84:85], v8 offset:96
  ds_read_b64_tr_b16 v[86:87], v8 offset:2400
  v_mfma_f32_16x16x32_bf16 v[120:123], v[52:55], v[32:35], v[120:123]
  ds_read_b64_tr_b16 v[92:93], v11 offset:0
  v_mfma_f32_16x16x32_bf16 v[124:127], v[52:55], v[36:39], v[124:127]
  ds_read_b64_tr_b16 v[94:95], v11 offset:2304
  s_add_u32 m0, s29, 121856
  v_mfma_f32_16x16x32_bf16 v[136:139], v[20:23], v[60:63], v[136:139]
  s_nop 0
  buffer_load_dwordx4 v1, s[4:7], s26 offen lds
  v_mfma_f32_16x16x32_bf16 v[140:143], v[32:35], v[32:35], v[140:143]
  s_add_u32 m0, s30, 121856
  v_mfma_f32_16x16x32_bf16 v[148:151], v[20:23], v[32:35], v[148:151]
  s_add_u32 s26, s26, 64
  buffer_load_dwordx4 v2, s[8:11], s27 offen lds
  v_mfma_f32_16x16x32_bf16 v[144:147], v[36:39], v[36:39], v[144:147]
  s_add_u32 m0, s53, 121856
  s_cmp_eq_u32 s26, 1152
  s_cselect_b32 s26, 0, s26
  v_mfma_f32_16x16x32_bf16 v[152:155], v[20:23], v[36:39], v[152:155]
  buffer_load_dword v3, s[8:11], s27 offen lds
  s_add_u32 s27, s27, s28
  s_cmp_eq_u32 s26, 0
  s_cselect_b32 s27, 0, s27
  s_waitcnt lgkmcnt(0)
  v_mfma_f32_16x16x32_bf16 v[96:99], v[72:75], v[64:67], v[96:99]
  ds_read_b128 v[32:35], v5 offset:17408
  v_mfma_f32_16x16x32_bf16 v[100:103], v[72:75], v[68:71], v[100:103]
  ds_read_b128 v[36:39], v5 offset:18432
  ds_read_b64_tr_b16 v[40:41], v8 offset:17408
  v_mfma_f32_16x16x32_bf16 v[104:107], v[76:79], v[64:67], v[104:107]
  ds_read_b64_tr_b16 v[42:43], v8 offset:19712
  ds_read_b64_tr_b16 v[44:45], v8 offset:17440
  v_mfma_f32_16x16x32_bf16 v[108:111], v[76:79], v[68:71], v[108:111]
  ds_read_b64_tr_b16 v[46:47], v8 offset:19744
  v_mfma_f32_16x16x32_bf16 v[112:115], v[80:83], v[64:67], v[112:115]
  ds_read_b64_tr_b16 v[48:49], v8 offset:17472
  ds_read_b64_tr_b16 v[50:51], v8 offset:19776
  v_mfma_f32_16x16x32_bf16 v[116:119], v[80:83], v[68:71], v[116:119]
  ds_read_b64_tr_b16 v[52:53], v8 offset:17504
  ds_read_b64_tr_b16 v[54:55], v8 offset:19808
  v_mfma_f32_16x16x32_bf16 v[120:123], v[84:87], v[64:67], v[120:123]
  ds_read_b64_tr_b16 v[60:61], v11 offset:17408
  v_mfma_f32_16x16x32_bf16 v[124:127], v[84:87], v[68:71], v[124:127]
  ds_read_b64_tr_b16 v[62:63], v11 offset:19712
  s_add_u32 m0, s29, 139264
  v_mfma_f32_16x16x32_bf16 v[136:139], v[20:23], v[92:95], v[136:139]
  s_nop 0
  buffer_load_dwordx4 v1, s[4:7], s26 offen lds
  v_mfma_f32_16x16x32_bf16 v[140:143], v[64:67], v[64:67], v[140:143]
  s_add_u32 m0, s30, 139264
  v_mfma_f32_16x16x32_bf16 v[148:151], v[20:23], v[64:67], v[148:151]
  s_add_u32 s26, s26, 64
  buffer_load_dwordx4 v2, s[8:11], s27 offen lds
  v_mfma_f32_16x16x32_bf16 v[144:147], v[68:71], v[68:71], v[144:147]
  s_add_u32 m0, s53, 139264
  s_cmp_eq_u32 s26, 1152
  s_cselect_b32 s26, 0, s26
  v_mfma_f32_16x16x32_bf16 v[152:155], v[20:23], v[68:71], v[152:155]
  buffer_load_dword v3, s[8:11], s27 offen lds
  s_add_u32 s27, s27, s28
  s_cmp_eq_u32 s26, 0
  s_cselect_b32 s27, 0, s27
  s_waitcnt lgkmcnt(0)
  s_waitcnt vmcnt(6)
  s_barrier
  v_mfma_f32_16x16x32_bf16 v[96:99], v[40:43], v[32:35], v[96:99]
  ds_read_b128 v[64:67], v5 offset:34816
  v_mfma_f32_16x16x32_bf16 v[100:103], v[40:43], v[36:39], v[100:103]
  ds_read_b128 v[68:71], v5 offset:35840
  ds_read_b64_tr_b16 v[72:73], v8 offset:34816
  v_mfma_f32_16x16x32_bf16 v[104:107], v[44:47], v[32:35], v[104:107]
  ds_read_b64_tr_b16 v[74:75], v8 offset:37120
  ds_read_b64_tr_b16 v[76:77], v8 offset:34848
  v_mfma_f32_16x16x32_bf16 v[108:111], v[44:47], v[36:39], v[108:111]
  ds_read_b64_tr_b16 v[78:79], v8 offset:37152
  v_mfma_f32_16x16x32_bf16 v[112:115], v[48:51], v[32:35], v[112:115]
  ds_read_b64_tr_b16 v[80:81], v8 offset:34880
  ds_read_b64_tr_b16 v[82:83], v8 offset:37184
  v_mfma_f32_16x16x32_bf16 v[116:119], v[48:51], v[36:39], v[116:119]
  ds_read_b64_tr_b16 v[84:85], v8 offset:34912
  ds_read_b64_tr_b16 v[86:87], v8 offset:37216
  v_mfma_f32_16x16x32_bf16 v[120:123], v[52:55], v[32:35], v[120:123]
  ds_read_b64_tr_b16 v[92:93], v11 offset:34816
  v_mfma_f32_16x16x32_bf16 v[124:127], v[52:55], v[36:39], v[124:127]
  ds_read_b64_tr_b16 v[94:95], v11 offset:37120
  s_add_u32 m0, s29, 0
  v_mfma_f32_16x16x32_bf16 v[136:139], v[20:23], v[60:63], v[136:139]
  s_nop 0
  buffer_load_dwordx4 v1, s[4:7], s26 offen lds
  v_mfma_f32_16x16x32_bf16 v[140:143], v[32:35], v[32:35], v[140:143]
  s_add_u32 m0, s30, 0
  v_mfma_f32_16x16x32_bf16 v[148:151], v[20:23], v[32:35], v[148:151]
  s_add_u32 s26, s26, 64
  buffer_load_dwordx4 v2, s[8:11], s27 offen lds
  v_mfma_f32_16x16x32_bf16 v[144:147], v[36:39], v[36:39], v[144:147]
  s_add_u32 m0, s53, 0
  s_cmp_eq_u32 s26, 1152
  s_cselect_b32 s26, 0, s26
  v_mfma_f32_16x16x32_bf16 v[152:155], v[20:23], v[36:39], v[152:155]
  buffer_load_dword v3, s[8:11], s27 offen lds
  s_add_u32 s27, s27, s28
  s_cmp_eq_u32 s26, 0
  s_cselect_b32 s27, 0, s27
  s_waitcnt lgkmcnt(0)
  v_mfma_f32_16x16x32_bf16 v[96:99], v[72:75], v[64:67], v[96:99]
  ds_read_b128 v[32:35], v6 offset:0
  v_mfma_f32_16x16x32_bf16 v[100:103], v[72:75], v[68:71], v[100:103]
  ds_read_b128 v[36:39], v6 offset:1024
  ds_read_b64_tr_b16 v[40:41], v9 offset:0
  v_mfma_f32_16x16x32_bf16 v[104:107], v[76:79], v[64:67], v[104:107]
  ds_read_b64_tr_b16 v[42:43], v9 offset:2304
  ds_read_b64_tr_b16 v[44:45], v9 offset:32
  v_mfma_f32_16x16x32_bf16 v[108:111], v[76:79], v[68:71], v[108:111]
  ds_read_b64_tr_b16 v[46:47], v9 offset:2336
  v_mfma_f32_16x16x32_bf16 v[112:115], v[80:83], v[64:67], v[112:115]
  ds_read_b64_tr_b16 v[48:49], v9 offset:64
  ds_read_b64_tr_b16 v[50:51], v9 offset:2368
  v_mfma_f32_16x16x32_bf16 v[116:119], v[80:83], v[68:71], v[116:119]
  ds_read_b64_tr_b16 v[52:53], v9 offset:96
  ds_read_b64_tr_b16 v[54:55], v9 offset:2400
  v_mfma_f32_16x16x32_bf16 v[120:123], v[84:87], v[64:67], v[120:123]
  ds_read_b64_tr_b16 v[60:61], v12 offset:0
  v_mfma_f32_16x16x32_bf16 v[124:127], v[84:87], v[68:71], v[124:127]
  ds_read_b64_tr_b16 v[62:63], v12 offset:2304
  s_add_u32 m0, s29, 17408
  v_mfma_f32_16x16x32_bf16 v[136:139], v[20:23], v[92:95], v[136:139]
  s_nop 0
  buffer_load_dwordx4 v1, s[4:7], s26 offen lds
  v_mfma_f32_16x16x32_bf16 v[140:143], v[64:67], v[64:67], v[140:143]
  s_add_u32 m0, s30, 17408
  v_mfma_f32_16x16x32_bf16 v[148:151], v[20:23], v[64:67], v[148:151]
  s_add_u32 s26, s26, 64
  buffer_load_dwordx4 v2, s[8:11], s27 offen lds
  v_mfma_f32_16x16x32_bf16 v[144:147], v[68:71], v[68:71], v[144:147]
  s_add_u32 m0, s53, 17408
  s_cmp_eq_u32 s26, 1152
  s_cselect_b32 s26, 0, s26
  v_mfma_f32_16x16x32_bf16 v[152:155], v[20:23], v[68:71], v[152:155]
  buffer_load_dword v3, s[8:11], s27 offen lds
  s_add_u32 s27, s27, s28
  s_cmp_eq_u32 s26, 0
  s_cselect_b32 s27, 0, s27
  s_waitcnt lgkmcnt(0)
  s_waitcnt vmcnt(6)
  s_barrier
  v_mfma_f32_16x16x32_bf16 v[96:99], v[40:43], v[32:35], v[96:99]
  ds_read_b128 v[64:67], v6 offset:17408
  v_mfma_f32_16x16x32_bf16 v[100:103], v[40:43], v[36:39], v[100:103]
  ds_read_b128 v[68:71], v6 offset:18432
  ds_read_b64_tr_b16 v[72:73], v9 offset:17408
  v_mfma_f32_16x16x32_bf16 v[104:107], v[44:47], v[32:35], v[104:107]
  ds_read_b64_tr_b16 v[74:75], v9 offset:19712
  ds_read_b64_tr_b16 v[76:77], v9 offset:17440
  v_mfma_f32_16x16x32_bf16 v[108:111], v[44:47], v[36:39], v[108:111]
  ds_read_b64_tr_b16 v[78:79], v9 offset:19744
  v_mfma_f32_16x16x32_bf16 v[112:115], v[48:51], v[32:35], v[112:115]
  ds_read_b64_tr_b16 v[80:81], v9 offset:17472
  ds_read_b64_tr_b16 v[82:83], v9 offset:19776
  v_mfma_f32_16x16x32_bf16 v[116:119], v[48:51], v[36:39], v[116:119]
  ds_read_b64_tr_b16 v[84:85], v9 offset:17504
  ds_read_b64_tr_b16 v[86:87], v9 offset:19808
  v_mfma_f32_16x16x32_bf16 v[120:123], v[52:55], v[32:35], v[120:123]
  ds_read_b64_tr_b16 v[92:93], v12 offset:17408
  v_mfma_f32_16x16x32_bf16 v[124:127], v[52:55], v[36:39], v[124:127]
  ds_read_b64_tr_b16 v[94:95], v12 offset:19712
  s_add_u32 m0, s29, 34816
  v_mfma_f32_16x16x32_bf16 v[136:139], v[20:23], v[60:63], v[136:139]
  s_nop 0
  buffer_load_dwordx4 v1, s[4:7], s26 offen lds
  v_mfma_f32_16x16x32_bf16 v[140:143], v[32:35], v[32:35], v[140:143]
  s_add_u32 m0, s30, 34816
  v_mfma_f32_16x16x32_bf16 v[148:151], v[20:23], v[32:35], v[148:151]
  s_add_u32 s26, s26, 64
  buffer_load_dwordx4 v2, s[8:11], s27 offen lds
  v_mfma_f32_16x16x32_bf16 v[144:147], v[36:39], v[36:39], v[144:147]
  s_add_u32 m0, s53, 34816
  s_cmp_eq_u32 s26, 1152
  s_cselect_b32 s26, 0, s26
  v_mfma_f32_16x16x32_bf16 v[152:155], v[20:23], v[36:39], v[152:155]
  buffer_load_dword v3, s[8:11], s27 offen lds
  s_add_u32 s27, s27, s28
  s_cmp_eq_u32 s26, 0
  s_cselect_b32 s27, 0, s27
  s_waitcnt lgkmcnt(0)
  v_mfma_f32_16x16x32_bf16 v[96:99], v[72:75], v[64:67], v[96:99]
  ds_read_b128 v[32:35], v6 offset:34816
  v_mfma_f32_16x16x32_bf16 v[100:103], v[72:75], v[68:71], v[100:103]
  ds_read_b128 v[36:39], v6 offset:35840
  ds_read_b64_tr_b16 v[40:41], v9 offset:34816
  v_mfma_f32_16x16x32_bf16 v[104:107], v[76:79], v[64:67], v[104:107]
  ds_read_b64_tr_b16 v[42:43], v9 offset:37120
  ds_read_b64_tr_b16 v[44:45], v9 offset:34848
  v_mfma_f32_16x16x32_bf16 v[108:111], v[76:79], v[68:71], v[108:111]
  ds_read_b64_tr_b16 v[46:47], v9 offset:37152
  v_mfma_f32_16x16x32_bf16 v[112:115], v[80:83], v[64:67], v[112:115]
  ds_read_b64_tr_b16 v[48:49], v9 offset:34880
  ds_read_b64_tr_b16 v[50:51], v9 offset:37184
  v_mfma_f32_16x16x32_bf16 v[116:119], v[80:83], v[68:71], v[116:119]
  ds_read_b64_tr_b16 v[52:53], v9 offset:34912
  ds_read_b64_tr_b16 v[54:55], v9 offset:37216
  v_mfma_f32_16x16x32_bf16 v[120:123], v[84:87], v[64:67], v[120:123]
  ds_read_b64_tr_b16 v[60:61], v12 offset:34816
  v_mfma_f32_16x16x32_bf16 v[124:127], v[84:87], v[68:71], v[124:127]
  ds_read_b64_tr_b16 v[62:63], v12 offset:37120
  s_add_u32 m0, s29, 52224
  v_mfma_f32_16x16x32_bf16 v[136:139], v[20:23], v[92:95], v[136:139]
  s_nop 0
  buffer_load_dwordx4 v1, s[4:7], s26 offen lds
  v_mfma_f32_16x16x32_bf16 v[140:143], v[64:67], v[64:67], v[140:143]
  s_add_u32 m0, s30, 52224
  v_mfma_f32_16x16x32_bf16 v[148:151], v[20:23], v[64:67], v[148:151]
  s_add_u32 s26, s26, 64
  buffer_load_dwordx4 v2, s[8:11], s27 offen lds
  v_mfma_f32_16x16x32_bf16 v[144:147], v[68:71], v[68:71], v[144:147]
  s_add_u32 m0, s53, 52224
  s_cmp_eq_u32 s26, 1152
  s_cselect_b32 s26, 0, s26
  v_mfma_f32_16x16x32_bf16 v[152:155], v[20:23], v[68:71], v[152:155]
  buffer_load_dword v3, s[8:11], s27 offen lds
  s_add_u32 s27, s27, s28
  s_cmp_eq_u32 s26, 0
  s_cselect_b32 s27, 0, s27
  s_waitcnt lgkmcnt(0)
  s_waitcnt vmcnt(6)
  s_barrier
  v_mfma_f32_16x16x32_bf16 v[96:99], v[40:43], v[32:35], v[96:99]
  ds_read_b128 v[64:67], v4 offset:0
  v_mfma_f32_16x16x32_bf16 v[100:103], v[40:43], v[36:39], v[100:103]
  ds_read_b128 v[68:71], v4 offset:1024
  ds_read_b64_tr_b16 v[72:73], v7 offset:0
  v_mfma_f32_16x16x32_bf16 v[104:107], v[44:47], v[32:35], v[104:107]
  ds_read_b64_tr_b16 v[74:75], v7 offset:2304
  ds_read_b64_tr_b16 v[76:77], v7 offset:32
  v_mfma_f32_16x16x32_bf16 v[108:111], v[44:47], v[36:39], v[108:111]
  ds_read_b64_tr_b16 v[78:79], v7 offset:2336
  v_mfma_f32_16x16x32_bf16 v[112:115], v[48:51], v[32:35], v[112:115]
  ds_read_b64_tr_b16 v[80:81], v7 offset:64
  ds_read_b64_tr_b16 v[82:83], v7 offset:2368
  v_mfma_f32_16x16x32_bf16 v[116:119], v[48:51], v[36:39], v[116:119]
  ds_read_b64_tr_b16 v[84:85], v7 offset:96
  ds_read_b64_tr_b16 v[86:87], v7 offset:2400
  v_mfma_f32_16x16x32_bf16 v[120:123], v[52:55], v[32:35], v[120:123]
  ds_read_b64_tr_b16 v[92:93], v10 offset:0
  v_mfma_f32_16x16x32_bf16 v[124:127], v[52:55], v[36:39], v[124:127]
  ds_read_b64_tr_b16 v[94:95], v10 offset:2304
  s_add_u32 m0, s29, 69632
  v_mfma_f32_16x16x32_bf16 v[136:139], v[20:23], v[60:63], v[136:139]
  s_nop 0
  buffer_load_dwordx4 v1, s[4:7], s26 offen lds
  v_mfma_f32_16x16x32_bf16 v[140:143], v[32:35], v[32:35], v[140:143]
  s_add_u32 m0, s30, 69632
  v_mfma_f32_16x16x32_bf16 v[148:151], v[20:23], v[32:35], v[148:151]
  s_add_u32 s26, s26, 64
  buffer_load_dwordx4 v2, s[8:11], s27 offen lds
  v_mfma_f32_16x16x32_bf16 v[144:147], v[36:39], v[36:39], v[144:147]
  s_add_u32 m0, s53, 69632
  s_cmp_eq_u32 s26, 1152
  s_cselect_b32 s26, 0, s26
  v_mfma_f32_16x16x32_bf16 v[152:155], v[20:23], v[36:39], v[152:155]
  buffer_load_dword v3, s[8:11], s27 offen lds
  s_add_u32 s27, s27, s28
  s_cmp_eq_u32 s26, 0
  s_cselect_b32 s27, 0, s27
  s_waitcnt lgkmcnt(0)
  v_mfma_f32_16x16x32_bf16 v[96:99], v[72:75], v[64:67], v[96:99]
  ds_read_b128 v[32:35], v4 offset:17408
  v_mfma_f32_16x16x32_bf16 v[100:103], v[72:75], v[68:71], v[100:103]
  ds_read_b128 v[36:39], v4 offset:18432
  ds_read_b64_tr_b16 v[40:41], v7 offset:17408
  v_mfma_f32_16x16x32_bf16 v[104:107], v[76:79], v[64:67], v[104:107]
  ds_read_b64_tr_b16 v[42:43], v7 offset:19712
  ds_read_b64_tr_b16 v[44:45], v7 offset:17440
  v_mfma_f32_16x16x32_bf16 v[108:111], v[76:79], v[68:71], v[108:111]
  ds_read_b64_tr_b16 v[46:47], v7 offset:19744
  v_mfma_f32_16x16x32_bf16 v[112:115], v[80:83], v[64:67], v[112:115]
  ds_read_b64_tr_b16 v[48:49], v7 offset:17472
  ds_read_b64_tr_b16 v[50:51], v7 offset:19776
  v_mfma_f32_16x16x32_bf16 v[116:119], v[80:83], v[68:71], v[116:119]
  ds_read_b64_tr_b16 v[52:53], v7 offset:17504
  ds_read_b64_tr_b16 v[54:55], v7 offset:19808
  v_mfma_f32_16x16x32_bf16 v[120:123], v[84:87], v[64:67], v[120:123]
  ds_read_b64_tr_b16 v[60:61], v10 offset:17408
  v_mfma_f32_16x16x32_bf16 v[124:127], v[84:87], v[68:71], v[124:127]
  ds_read_b64_tr_b16 v[62:63], v10 offset:19712
  s_add_u32 m0, s29, 87040
  v_mfma_f32_16x16x32_bf16 v[136:139], v[20:23], v[92:95], v[136:139]
  s_nop 0
  buffer_load_dwordx4 v1, s[4:7], s26 offen lds
  v_mfma_f32_16x16x32_bf16 v[140:143], v[64:67], v[64:67], v[140:143]
  s_add_u32 m0, s30, 87040
  v_mfma_f32_16x16x32_bf16 v[148:151], v[20:23], v[64:67], v[148:151]
  s_add_u32 s26, s26, 64
  buffer_load_dwordx4 v2, s[8:11], s27 offen lds
  v_mfma_f32_16x16x32_bf16 v[144:147], v[68:71], v[68:71], v[144:147]
  s_add_u32 m0, s53, 87040
  s_cmp_eq_u32 s26, 1152
  s_cselect_b32 s26, 0, s26
  v_mfma_f32_16x16x32_bf16 v[152:155], v[20:23], v[68:71], v[152:155]
  buffer_load_dword v3, s[8:11], s27 offen lds
  s_add_u32 s27, s27, s28
  s_cmp_eq_u32 s26, 0
  s_cselect_b32 s27, 0, s27
  s_waitcnt lgkmcnt(0)
  s_waitcnt vmcnt(6)
  s_barrier
  v_mfma_f32_16x16x32_bf16 v[96:99], v[40:43], v[32:35], v[96:99]
  ds_read_b128 v[64:67], v4 offset:34816
  v_mfma_f32_16x16x32_bf16 v[100:103], v[40:43], v[36:39], v[100:103]
  ds_read_b128 v[68:71], v4 offset:35840
  ds_read_b64_tr_b16 v[72:73], v7 offset:34816
  v_mfma_f32_16x16x32_bf16 v[104:107], v[44:47], v[32:35], v[104:107]
  ds_read_b64_tr_b16 v[74:75], v7 offset:37120
  ds_read_b64_tr_b16 v[76:77], v7 offset:34848
  v_mfma_f32_16x16x32_bf16 v[108:111], v[44:47], v[36:39], v[108:111]
  ds_read_b64_tr_b16 v[78:79], v7 offset:37152
  v_mfma_f32_16x16x32_bf16 v[112:115], v[48:51], v[32:35], v[112:115]
  ds_read_b64_tr_b16 v[80:81], v7 offset:34880
  ds_read_b64_tr_b16 v[82:83], v7 offset:37184
  v_mfma_f32_16x16x32_bf16 v[116:119], v[48:51], v[36:39], v[116:119]
  ds_read_b64_tr_b16 v[84:85], v7 offset:34912
  ds_read_b64_tr_b16 v[86:87], v7 offset:37216
  v_mfma_f32_16x16x32_bf16 v[120:123], v[52:55], v[32:35], v[120:123]
  ds_read_b64_tr_b16 v[92:93], v10 offset:34816
  v_mfma_f32_16x16x32_bf16 v[124:127], v[52:55], v[36:39], v[124:127]
  ds_read_b64_tr_b16 v[94:95], v10 offset:37120
  s_add_u32 m0, s29, 104448
  v_mfma_f32_16x16x32_bf16 v[136:139], v[20:23], v[60:63], v[136:139]
  s_nop 0
  buffer_load_dwordx4 v1, s[4:7], s26 offen lds
  v_mfma_f32_16x16x32_bf16 v[140:143], v[32:35], v[32:35], v[140:143]
  s_add_u32 m0, s30, 104448
  v_mfma_f32_16x16x32_bf16 v[148:151], v[20:23], v[32:35], v[148:151]
  s_add_u32 s26, s26, 64
  buffer_load_dwordx4 v2, s[8:11], s27 offen lds
  v_mfma_f32_16x16x32_bf16 v[144:147], v[36:39], v[36:39], v[144:147]
  s_add_u32 m0, s53, 104448
  s_cmp_eq_u32 s26, 1152
  s_cselect_b32 s26, 0, s26
  v_mfma_f32_16x16x32_bf16 v[152:155], v[20:23], v[36:39], v[152:155]
  buffer_load_dword v3, s[8:11], s27 offen lds
  s_add_u32 s27, s27, s28
  s_cmp_eq_u32 s26, 0
  s_cselect_b32 s27, 0, s27
  s_waitcnt lgkmcnt(0)
  v_mfma_f32_16x16x32_bf16 v[96:99], v[72:75], v[64:67], v[96:99]
  ds_read_b128 v[32:35], v5 offset:0
  v_mfma_f32_16x16x32_bf16 v[100:103], v[72:75], v[68:71], v[100:103]
  ds_read_b128 v[36:39], v5 offset:1024
  ds_read_b64_tr_b16 v[40:41], v8 offset:0
  v_mfma_f32_16x16x32_bf16 v[104:107], v[76:79], v[64:67], v[104:107]
  ds_read_b64_tr_b16 v[42:43], v8 offset:2304
  ds_read_b64_tr_b16 v[44:45], v8 offset:32
  v_mfma_f32_16x16x32_bf16 v[108:111], v[76:79], v[68:71], v[108:111]
  ds_read_b64_tr_b16 v[46:47], v8 offset:2336
  v_mfma_f32_16x16x32_bf16 v[112:115], v[80:83], v[64:67], v[112:115]
  ds_read_b64_tr_b16 v[48:49], v8 offset:64
  ds_read_b64_tr_b16 v[50:51], v8 offset:2368
  v_mfma_f32_16x16x32_bf16 v[116:119], v[80:83], v[68:71], v[116:119]
  ds_read_b64_tr_b16 v[52:53], v8 offset:96
  ds_read_b64_tr_b16 v[54:55], v8 offset:2400
  v_mfma_f32_16x16x32_bf16 v[120:123], v[84:87], v[64:67], v[120:123]
  ds_read_b64_tr_b16 v[60:61], v11 offset:0
  v_mfma_f32_16x16x32_bf16 v[124:127], v[84:87], v[68:71], v[124:127]
  ds_read_b64_tr_b16 v[62:63], v11 offset:2304
  s_add_u32 m0, s29, 121856
  v_mfma_f32_16x16x32_bf16 v[136:139], v[20:23], v[92:95], v[136:139]
  s_nop 0
  buffer_load_dwordx4 v1, s[4:7], s26 offen lds
  v_mfma_f32_16x16x32_bf16 v[140:143], v[64:67], v[64:67], v[140:143]
  s_add_u32 m0, s30, 121856
  v_mfma_f32_16x16x32_bf16 v[148:151], v[20:23], v[64:67], v[148:151]
  s_add_u32 s26, s26, 64
  buffer_load_dwordx4 v2, s[8:11], s27 offen lds
  v_mfma_f32_16x16x32_bf16 v[144:147], v[68:71], v[68:71], v[144:147]
  s_add_u32 m0, s53, 121856
  s_cmp_eq_u32 s26, 1152
  s_cselect_b32 s26, 0, s26
  v_mfma_f32_16x16x32_bf16 v[152:155], v[20:23], v[68:71], v[152:155]
  buffer_load_dword v3, s[8:11], s27 offen lds
  s_add_u32 s27, s27, s28
  s_cmp_eq_u32 s26, 0
  s_cselect_b32 s27, 0, s27
  s_waitcnt lgkmcnt(0)
  s_waitcnt vmcnt(6)
  s_barrier
  v_mfma_f32_16x16x32_bf16 v[96:99], v[40:43], v[32:35], v[96:99]
  ds_read_b128 v[64:67], v5 offset:17408
  v_mfma_f32_16x16x32_bf16 v[100:103], v[40:43], v[36:39], v[100:103]
  ds_read_b128 v[68:71], v5 offset:18432
  ds_read_b64_tr_b16 v[72:73], v8 offset:17408
  v_mfma_f32_16x16x32_bf16 v[104:107], v[44:47], v[32:35], v[104:107]
  ds_read_b64_tr_b16 v[74:75], v8 offset:19712
  ds_read_b64_tr_b16 v[76:77], v8 offset:17440
  v_mfma_f32_16x16x32_bf16 v[108:111], v[44:47], v[36:39], v[108:111]
  ds_read_b64_tr_b16 v[78:79], v8 offset:19744
  v_mfma_f32_16x16x32_bf16 v[112:115], v[48:51], v[32:35], v[112:115]
  ds_read_b64_tr_b16 v[80:81], v8 offset:17472
  ds_read_b64_tr_b16 v[82:83], v8 offset:19776
  v_mfma_f32_16x16x32_bf16 v[116:119], v[48:51], v[36:39], v[116:119]
  ds_read_b64_tr_b16 v[84:85], v8 offset:17504
  ds_read_b64_tr_b16 v[86:87], v8 offset:19808
  v_mfma_f32_16x16x32_bf16 v[120:123], v[52:55], v[32:35], v[120:123]
  ds_read_b64_tr_b16 v[92:93], v11 offset:17408
  v_mfma_f32_16x16x32_bf16 v[124:127], v[52:55], v[36:39], v[124:127]
  ds_read_b64_tr_b16 v[94:95], v11 offset:19712
  s_add_u32 m0, s29, 139264
  v_mfma_f32_16x16x32_bf16 v[136:139], v[20:23], v[60:63], v[136:139]
  s_nop 0
  buffer_load_dwordx4 v1, s[4:7], s26 offen lds
  v_mfma_f32_16x16x32_bf16 v[140:143], v[32:35], v[32:35], v[140:143]
  s_add_u32 m0, s30, 139264
  v_mfma_f32_16x16x32_bf16 v[148:151], v[20:23], v[32:35], v[148:151]
  s_add_u32 s26, s26, 64
  buffer_load_dwordx4 v2, s[8:11], s27 offen lds
  v_mfma_f32_16x16x32_bf16 v[144:147], v[36:39], v[36:39], v[144:147]
  s_add_u32 m0, s53, 139264
  s_cmp_eq_u32 s26, 1152
  s_cselect_b32 s26, 0, s26
  v_mfma_f32_16x16x32_bf16 v[152:155], v[20:23], v[36:39], v[152:155]
  buffer_load_dword v3, s[8:11], s27 offen lds
  s_add_u32 s27, s27, s28
  s_cmp_eq_u32 s26, 0
  s_cselect_b32 s27, 0, s27
  s_waitcnt lgkmcnt(0)
  v_mfma_f32_16x16x32_bf16 v[96:99], v[72:75], v[64:67], v[96:99]
  v_mfma_f32_16x16x32_bf16 v[100:103], v[72:75], v[68:71], v[100:103]
  ds_read_b128 v[32:35], v5 offset:34816
  v_mfma_f32_16x16x32_bf16 v[104:107], v[76:79], v[64:67], v[104:107]
  ds_read_b128 v[36:39], v5 offset:35840
  v_mfma_f32_16x16x32_bf16 v[108:111], v[76:79], v[68:71], v[108:111]
  ds_read_b64_tr_b16 v[40:41], v8 offset:34816
  v_mfma_f32_16x16x32_bf16 v[112:115], v[80:83], v[64:67], v[112:115]
  ds_read_b64_tr_b16 v[42:43], v8 offset:37120
  v_mfma_f32_16x16x32_bf16 v[116:119], v[80:83], v[68:71], v[116:119]
  ds_read_b64_tr_b16 v[44:45], v8 offset:34848
  v_mfma_f32_16x16x32_bf16 v[120:123], v[84:87], v[64:67], v[120:123]
  ds_read_b64_tr_b16 v[46:47], v8 offset:37152
  v_mfma_f32_16x16x32_bf16 v[124:127], v[84:87], v[68:71], v[124:127]
  ds_read_b64_tr_b16 v[48:49], v8 offset:34880
  v_mfma_f32_16x16x32_bf16 v[136:139], v[20:23], v[92:95], v[136:139]
  ds_read_b64_tr_b16 v[50:51], v8 offset:37184
  v_mfma_f32_16x16x32_bf16 v[140:143], v[64:67], v[64:67], v[140:143]
  ds_read_b64_tr_b16 v[52:53], v8 offset:34912
  v_mfma_f32_16x16x32_bf16 v[148:151], v[20:23], v[64:67], v[148:151]
  ds_read_b64_tr_b16 v[54:55], v8 offset:37216
  v_mfma_f32_16x16x32_bf16 v[144:147], v[68:71], v[68:71], v[144:147]
  ds_read_b64_tr_b16 v[60:61], v11 offset:34816
  v_mfma_f32_16x16x32_bf16 v[152:155], v[20:23], v[68:71], v[152:155]
  ds_read_b64_tr_b16 v[62:63], v11 offset:37120
  s_waitcnt lgkmcnt(0)
  s_waitcnt vmcnt(3)
  s_barrier
  v_mfma_f32_16x16x32_bf16 v[96:99], v[40:43], v[32:35], v[96:99]
  v_mfma_f32_16x16x32_bf16 v[100:103], v[40:43], v[36:39], v[100:103]
  ds_read_b128 v[64:67], v6 offset:0
  v_mfma_f32_16x16x32_bf16 v[104:107], v[44:47], v[32:35], v[104:107]
  ds_read_b128 v[68:71], v6 offset:1024
  v_mfma_f32_16x16x32_bf16 v[108:111], v[44:47], v[36:39], v[108:111]
  ds_read_b64_tr_b16 v[72:73], v9 offset:0
  v_mfma_f32_16x16x32_bf16 v[112:115], v[48:51], v[32:35], v[112:115]
  ds_read_b64_tr_b16 v[74:75], v9 offset:2304
  v_mfma_f32_16x16x32_bf16 v[116:119], v[48:51], v[36:39], v[116:119]
  ds_read_b64_tr_b16 v[76:77], v9 offset:32
  v_mfma_f32_16x16x32_bf16 v[120:123], v[52:55], v[32:35], v[120:123]
  ds_read_b64_tr_b16 v[78:79], v9 offset:2336
  v_mfma_f32_16x16x32_bf16 v[124:127], v[52:55], v[36:39], v[124:127]
  ds_read_b64_tr_b16 v[80:81], v9 offset:64
  v_mfma_f32_16x16x32_bf16 v[136:139], v[20:23], v[60:63], v[136:139]
  ds_read_b64_tr_b16 v[82:83], v9 offset:2368
  v_mfma_f32_16x16x32_bf16 v[140:143], v[32:35], v[32:35], v[140:143]
  ds_read_b64_tr_b16 v[84:85], v9 offset:96
  v_mfma_f32_16x16x32_bf16 v[148:151], v[20:23], v[32:35], v[148:151]
  ds_read_b64_tr_b16 v[86:87], v9 offset:2400
  v_mfma_f32_16x16x32_bf16 v[144:147], v[36:39], v[36:39], v[144:147]
  ds_read_b64_tr_b16 v[92:93], v12 offset:0
  v_mfma_f32_16x16x32_bf16 v[152:155], v[20:23], v[36:39], v[152:155]
  ds_read_b64_tr_b16 v[94:95], v12 offset:2304
  s_waitcnt lgkmcnt(0)
  v_mfma_f32_16x16x32_bf16 v[96:99], v[72:75], v[64:67], v[96:99]
  v_mfma_f32_16x16x32_bf16 v[100:103], v[72:75], v[68:71], v[100:103]
  ds_read_b128 v[32:35], v6 offset:17408
  v_mfma_f32_16x16x32_bf16 v[104:107], v[76:79], v[64:67], v[104:107]
  ds_read_b128 v[36:39], v6 offset:18432
  v_mfma_f32_16x16x32_bf16 v[108:111], v[76:79], v[68:71], v[108:111]
  ds_read_b64_tr_b16 v[40:41], v9 offset:17408
  v_mfma_f32_16x16x32_bf16 v[112:115], v[80:83], v[64:67], v[112:115]
  ds_read_b64_tr_b16 v[42:43], v9 offset:19712
  v_mfma_f32_16x16x32_bf16 v[116:119], v[80:83], v[68:71], v[116:119]
  ds_read_b64_tr_b16 v[44:45], v9 offset:17440
  v_mfma_f32_16x16x32_bf16 v[120:123], v[84:87], v[64:67], v[120:123]
  ds_read_b64_tr_b16 v[46:47], v9 offset:19744
  v_mfma_f32_16x16x32_bf16 v[124:127], v[84:87], v[68:71], v[124:127]
  ds_read_b64_tr_b16 v[48:49], v9 offset:17472
  v_mfma_f32_16x16x32_bf16 v[136:139], v[20:23], v[92:95], v[136:139]
  ds_read_b64_tr_b16 v[50:51], v9 offset:19776
  v_mfma_f32_16x16x32_bf16 v[140:143], v[64:67], v[64:67], v[140:143]
  ds_read_b64_tr_b16 v[52:53], v9 offset:17504
  v_mfma_f32_16x16x32_bf16 v[148:151], v[20:23], v[64:67], v[148:151]
  ds_read_b64_tr_b16 v[54:55], v9 offset:19808
  v_mfma_f32_16x16x32_bf16 v[144:147], v[68:71], v[68:71], v[144:147]
  ds_read_b64_tr_b16 v[60:61], v12 offset:17408
  v_mfma_f32_16x16x32_bf16 v[152:155], v[20:23], v[68:71], v[152:155]
  ds_read_b64_tr_b16 v[62:63], v12 offset:19712
  s_waitcnt lgkmcnt(0)
  s_waitcnt vmcnt(0)
  s_barrier
  v_mfma_f32_16x16x32_bf16 v[96:99], v[40:43], v[32:35], v[96:99]
  ds_read_b128 v[64:67], v6 offset:34816
  v_mfma_f32_16x16x32_bf16 v[100:103], v[40:43], v[36:39], v[100:103]
  ds_read_b128 v[68:71], v6 offset:35840
  ds_read_b64_tr_b16 v[72:73], v9 offset:34816
  v_mfma_f32_16x16x32_bf16 v[104:107], v[44:47], v[32:35], v[104:107]
  ds_read_b64_tr_b16 v[74:75], v9 offset:37120
  v_mfma_f32_16x16x32_bf16 v[108:111], v[44:47], v[36:39], v[108:111]
  ds_read_b64_tr_b16 v[76:77], v9 offset:34848
  ds_read_b64_tr_b16 v[78:79], v9 offset:37152
  v_mfma_f32_16x16x32_bf16 v[112:115], v[48:51], v[32:35], v[112:115]
  ds_read_b64_tr_b16 v[80:81], v9 offset:34880
  ds_read_b64_tr_b16 v[82:83], v9 offset:37184
  v_mfma_f32_16x16x32_bf16 v[116:119], v[48:51], v[36:39], v[116:119]
  ds_read_b64_tr_b16 v[84:85], v9 offset:34912
  v_mfma_f32_16x16x32_bf16 v[120:123], v[52:55], v[32:35], v[120:123]
  ds_read_b64_tr_b16 v[86:87], v9 offset:37216
  ds_read_b64_tr_b16 v[92:93], v12 offset:34816
  v_mfma_f32_16x16x32_bf16 v[124:127], v[52:55], v[36:39], v[124:127]
  ds_read_b64_tr_b16 v[94:95], v12 offset:37120
  v_mfma_f32_16x16x32_bf16 v[136:139], v[20:23], v[60:63], v[136:139]
  buffer_load_dwordx4 v[24:27], v17, s[16:19], s52 offen
  buffer_load_dwordx4 v[28:31], v18, s[16:19], s52 offen offset:1024
  v_mfma_f32_16x16x32_bf16 v[140:143], v[32:35], v[32:35], v[140:143]
  s_mov_b32 s58, 663552
  s_mov_b32 s59, 0x20000
  s_sub_u32 s42, s52, 3456
  buffer_load_dwordx4 v[216:219], v18, s[56:59], s42 offen offset:1024
  v_mfma_f32_16x16x32_bf16 v[148:151], v[20:23], v[32:35], v[148:151]
  s_mul_i32 s42, s46, 20736
  v_mfma_f32_16x16x32_bf16 v[144:147], v[36:39], v[36:39], v[144:147]
  v_lshlrev_b32 v211, 4, v0
  buffer_load_dwordx4 v[212:215], v211, s[16:19], s42 offen
  s_add_u32 s42, s42, 8192
  v_mfma_f32_16x16x32_bf16 v[152:155], v[20:23], v[36:39], v[152:155]
  buffer_load_dwordx4 v[212:215], v211, s[16:19], s42 offen
  s_add_u32 s42, s42, 8192
  buffer_load_dwordx4 v[212:215], v211, s[16:19], s42 offen
  s_add_u32 s42, s42, 8192
  s_waitcnt lgkmcnt(0)
  v_mfma_f32_16x16x32_bf16 v[96:99], v[72:75], v[64:67], v[96:99]
  v_mfma_f32_16x16x32_bf16 v[100:103], v[72:75], v[68:71], v[100:103]
  v_mfma_f32_16x16x32_bf16 v[104:107], v[76:79], v[64:67], v[104:107]
  v_mfma_f32_16x16x32_bf16 v[108:111], v[76:79], v[68:71], v[108:111]
  v_mfma_f32_16x16x32_bf16 v[112:115], v[80:83], v[64:67], v[112:115]
  v_mfma_f32_16x16x32_bf16 v[116:119], v[80:83], v[68:71], v[116:119]
  v_mfma_f32_16x16x32_bf16 v[120:123], v[84:87], v[64:67], v[120:123]
  v_mfma_f32_16x16x32_bf16 v[124:127], v[84:87], v[68:71], v[124:127]
  v_mfma_f32_16x16x32_bf16 v[136:139], v[20:23], v[92:95], v[136:139]
  v_mfma_f32_16x16x32_bf16 v[140:143], v[64:67], v[64:67], v[140:143]
  v_mfma_f32_16x16x32_bf16 v[148:151], v[20:23], v[64:67], v[148:151]
  v_mfma_f32_16x16x32_bf16 v[144:147], v[68:71], v[68:71], v[144:147]
  v_mfma_f32_16x16x32_bf16 v[152:155], v[20:23], v[68:71], v[152:155]
  s_add_u32 s31, s49, 17
  s_sub_u32 s50, s31, 18
  s_cselect_b32 s31, s31, s50
  s_lshl_b32 s31, s31, 17
  s_add_u32 s31, s31, s51
  buffer_store_dwordx4 v[68:71], v210, s[12:15], s31 offen sc1
  s_and_b32 s31, s24, 13
  s_cmp_lg_u32 s31, 0
  s_cbranch_scc1 Lnx_14
  s_add_u32 s31, s49, 16
  s_sub_u32 s50, s31, 18
  s_cselect_b32 s31, s31, s50
  s_lshl_b32 s31, s31, 17
  s_add_u32 s31, s31, s51
  buffer_store_dwordx4 v[36:39], v210, s[12:15], s31 offen sc1
Lnx_14:
  v_and_b32 v14, 15, v13
  s_mul_i32 s31, s22, 5
  s_add_u32 s31, s31, s21
  s_lshl_b32 s31, s31, 4
  v_add_u32 v15, s31, v14
  v_lshlrev_b32 v15, 2, v15
  v_lshlrev_b32 v16, 2, v14
  v_add_u32 v15, 157696, v15
  v_add_u32 v16, 157952, v16
  s_lshl_b32 s31, s21, 5
  v_add_u32 v156, s31, v14
  v_lshlrev_b32 v156, 2, v156
  v_add_u32 v157, 156672, v156
  s_nop 1
  ds_write_b32 v15, v136
  v_cndmask_b32 v140, v140, v141, s[34:35]
  v_cndmask_b32 v140, v140, v142, s[36:37]
  v_cndmask_b32 v140, v140, v143, s[38:39]
  v_mul_f32 v148, 0x3ae38e39, v148
  v_mul_f32 v140, 0x3ae38e39, v140
  v_fma_f32 v140, -v148, v148, v140
  v_max_f32 v140, 0, v140
  v_add_f32 v141, 0x3727c5ac, v140
  v_rsq_f32 v141, v141
  v_cndmask_b32 v144, v144, v145, s[34:35]
  v_cndmask_b32 v144, v144, v146, s[36:37]
  v_cndmask_b32 v144, v144, v147, s[38:39]
  v_mul_f32 v152, 0x3ae38e39, v152
  v_mul_f32 v144, 0x3ae38e39, v144
  v_fma_f32 v144, -v152, v152, v144
  v_max_f32 v144, 0, v144
  v_add_f32 v145, 0x3727c5ac, v144
  v_rsq_f32 v145, v145
  s_cmp_ge_u32 s24, 4
  s_cbranch_scc1 Lnotq_15
  v_mul_f32 v141, 0x3eae1a93, v141
  v_mul_f32 v145, 0x3eae1a93, v145
Lnotq_15:
  s_cmp_lt_u32 s24, 12
  s_cbranch_scc1 Lnoth_16
  v_mul_f32 v142, v141, v141
  v_mov_b32 v143, 0x3727c5ac
  v_fmac_f32 v143, v142, v140
  v_rsq_f32 v143, v143
  s_nop 0
  v_mul_f32 v141, v141, v143
  v_mul_f32 v146, v145, v145
  v_mov_b32 v147, 0x3727c5ac
  v_fmac_f32 v147, v146, v144
  v_rsq_f32 v147, v147
  s_nop 0
  v_mul_f32 v145, v145, v147
Lnoth_16:
  s_nop 0
  s_mov_b64 exec, s[40:41]
  ds_write_b32 v157, v148 offset:0
  ds_write_b32 v157, v141 offset:512
  ds_write_b32 v157, v152 offset:64
  ds_write_b32 v157, v145 offset:576
  s_cmp_lg_u32 s24, 4
  s_cbranch_scc1 Lstd_17
  s_lshl_b32 s31, s23, 9
  s_add_u32 s31, s31, 14422016
  s_add_u32 s42, s31, 8192
  buffer_store_dword v148, v156, s[12:15], s31 offen offset:0
  buffer_store_dword v141, v156, s[12:15], s42 offen offset:0
  buffer_store_dword v152, v156, s[12:15], s31 offen offset:64
  buffer_store_dword v145, v156, s[12:15], s42 offen offset:64
Lstd_17:
  s_mov_b64 exec, -1
  s_waitcnt lgkmcnt(0)
  s_barrier
  v_lshrrev_b32 v14, 4, v13
  v_lshlrev_b32 v14, 4, v14
  v_add_u32 v14, 158016, v14
  ds_read_b32 v158, v157 offset:0
  ds_read_b32 v160, v157 offset:512
  ds_read_b32 v159, v157 offset:64
  ds_read_b32 v161, v157 offset:576
  ds_read_b128 v[164:167], v14 offset:0
  ds_read_b128 v[168:171], v14 offset:64
  ds_read_b128 v[172:175], v14 offset:128
  ds_read_b128 v[176:179], v14 offset:192
  v_lshrrev_b32 v15, 5, v13
  v_lshlrev_b32 v15, 15, v15
  v_and_b32 v16, 31, v13
  v_lshl_add_u32 v15, v16, 4, v15
  s_lshr_b32 s31, s24, 2
  s_min_u32 s31, s31, 2
  s_mul_i32 s31, s31, 2359296
  s_mul_i32 s42, s47, 589824
  s_add_u32 s31, s31, s42
  s_lshl_b32 s42, s23, 2
  s_add_u32 s42, s42, s21
  s_lshl_b32 s42, s42, 9
  s_add_u32 s31, s31, s42
  s_add_u32 s31, s31, 327680
  s_waitcnt lgkmcnt(0)
  v_fma_f32 v96, -v158, v164, v96
  v_fma_f32 v97, -v158, v165, v97
  v_fma_f32 v98, -v158, v166, v98
  v_fma_f32 v99, -v158, v167, v99
  v_fma_f32 v100, -v159, v164, v100
  v_fma_f32 v101, -v159, v165, v101
  v_fma_f32 v102, -v159, v166, v102
  v_fma_f32 v103, -v159, v167, v103
  v_fma_f32 v104, -v158, v168, v104
  v_fma_f32 v105, -v158, v169, v105
  v_fma_f32 v106, -v158, v170, v106
  v_fma_f32 v107, -v158, v171, v107
  v_fma_f32 v108, -v159, v168, v108
  v_fma_f32 v109, -v159, v169, v109
  v_fma_f32 v110, -v159, v170, v110
  v_fma_f32 v111, -v159, v171, v111
  v_fma_f32 v112, -v158, v172, v112
  v_fma_f32 v113, -v158, v173, v113
  v_fma_f32 v114, -v158, v174, v114
  v_fma_f32 v115, -v158, v175, v115
  v_fma_f32 v116, -v159, v172, v116
  v_fma_f32 v117, -v159, v173, v117
  v_fma_f32 v118, -v159, v174, v118
  v_fma_f32 v119, -v159, v175, v119
  v_fma_f32 v120, -v158, v176, v120
  v_fma_f32 v121, -v158, v177, v121
  v_fma_f32 v122, -v158, v178, v122
  v_fma_f32 v123, -v158, v179, v123
  v_fma_f32 v124, -v159, v176, v124
  v_fma_f32 v125, -v159, v177, v125
  v_fma_f32 v126, -v159, v178, v126
  v_fma_f32 v127, -v159, v179, v127
  s_cmp_ge_u32 s24, 12
  s_cbranch_scc1 Lish_18
  v_mul_f32 v96, v160, v96
  v_mul_f32 v97, v160, v97
  v_mul_f32 v98, v160, v98
  v_mul_f32 v99, v160, v99
  v_mul_f32 v100, v161, v100
  v_mul_f32 v101, v161, v101
  v_mul_f32 v102, v161, v102
  v_mul_f32 v103, v161, v103
  v_cvt_pk_bf16_f32 v188, v96, v97
  v_cvt_pk_bf16_f32 v189, v98, v99
  v_cvt_pk_bf16_f32 v190, v100, v101
  v_cvt_pk_bf16_f32 v191, v102, v103
  s_nop 1
  v_permlane16_swap_b32 v188, v190
  v_permlane16_swap_b32 v189, v191
  buffer_store_dwordx4 v[188:191], v15, s[12:15], s31 offen sc1
  s_add_u32 s31, s31, 65536
  v_mul_f32 v104, v160, v104
  v_mul_f32 v105, v160, v105
  v_mul_f32 v106, v160, v106
  v_mul_f32 v107, v160, v107
  v_mul_f32 v108, v161, v108
  v_mul_f32 v109, v161, v109
  v_mul_f32 v110, v161, v110
  v_mul_f32 v111, v161, v111
  v_cvt_pk_bf16_f32 v192, v104, v105
  v_cvt_pk_bf16_f32 v193, v106, v107
  v_cvt_pk_bf16_f32 v194, v108, v109
  v_cvt_pk_bf16_f32 v195, v110, v111
  s_nop 1
  v_permlane16_swap_b32 v192, v194
  v_permlane16_swap_b32 v193, v195
  buffer_store_dwordx4 v[192:195], v15, s[12:15], s31 offen sc1
  s_add_u32 s31, s31, 65536
  v_mul_f32 v112, v160, v112
  v_mul_f32 v113, v160, v113
  v_mul_f32 v114, v160, v114
  v_mul_f32 v115, v160, v115
  v_mul_f32 v116, v161, v116
  v_mul_f32 v117, v161, v117
  v_mul_f32 v118, v161, v118
  v_mul_f32 v119, v161, v119
  v_cvt_pk_bf16_f32 v188, v112, v113
  v_cvt_pk_bf16_f32 v189, v114, v115
  v_cvt_pk_bf16_f32 v190, v116, v117
  v_cvt_pk_bf16_f32 v191, v118, v119
  s_nop 1
  v_permlane16_swap_b32 v188, v190
  v_permlane16_swap_b32 v189, v191
  buffer_store_dwordx4 v[188:191], v15, s[12:15], s31 offen sc1
  s_add_u32 s31, s31, 65536
  v_mul_f32 v120, v160, v120
  v_mul_f32 v121, v160, v121
  v_mul_f32 v122, v160, v122
  v_mul_f32 v123, v160, v123
  v_mul_f32 v124, v161, v124
  v_mul_f32 v125, v161, v125
  v_mul_f32 v126, v161, v126
  v_mul_f32 v127, v161, v127
  v_cvt_pk_bf16_f32 v192, v120, v121
  v_cvt_pk_bf16_f32 v193, v122, v123
  v_cvt_pk_bf16_f32 v194, v124, v125
  v_cvt_pk_bf16_f32 v195, v126, v127
  s_nop 1
  v_permlane16_swap_b32 v192, v194
  v_permlane16_swap_b32 v193, v195
  buffer_store_dwordx4 v[192:195], v15, s[12:15], s31 offen sc1
  s_add_u32 s31, s31, 65536
  s_branch Lbarjob_10
Lish_18:
  v_mul_f32 v204, 0xc0135761, v160
  v_mul_f32 v205, v160, v160
  v_mul_f32 v205, v205, v160
  v_mul_f32 v205, 0xbdd2d3e8, v205
  v_rcp_f32 v206, v160
  v_mul_f32 v208, 0xc0135761, v161
  v_mul_f32 v209, v161, v161
  v_mul_f32 v209, v209, v161
  v_mul_f32 v209, 0xbdd2d3e8, v209
  v_rcp_f32 v210, v161
  v_mul_f32 v196, v96, v96
  v_mul_f32 v197, v97, v97
  v_mul_f32 v198, v98, v98
  v_mul_f32 v199, v99, v99
  v_fma_f32 v196, v196, v205, v204
  v_fma_f32 v197, v197, v205, v204
  v_fma_f32 v198, v198, v205, v204
  v_fma_f32 v199, v199, v205, v204
  v_mul_f32 v196, v196, v96
  v_mul_f32 v197, v197, v97
  v_mul_f32 v198, v198, v98
  v_mul_f32 v199, v199, v99
  v_exp_f32 v196, v196
  v_exp_f32 v197, v197
  v_exp_f32 v198, v198
  v_exp_f32 v199, v199
  v_fma_f32 v196, v196, v206, v206
  v_fma_f32 v197, v197, v206, v206
  v_fma_f32 v198, v198, v206, v206
  v_fma_f32 v199, v199, v206, v206
  v_rcp_f32 v196, v196
  v_rcp_f32 v197, v197
  v_rcp_f32 v198, v198
  v_rcp_f32 v199, v199
  v_mul_f32 v96, v96, v196
  v_mul_f32 v97, v97, v197
  v_mul_f32 v98, v98, v198
  v_mul_f32 v99, v99, v199
  v_mul_f32 v196, v100, v100
  v_mul_f32 v197, v101, v101
  v_mul_f32 v198, v102, v102
  v_mul_f32 v199, v103, v103
  v_fma_f32 v196, v196, v209, v208
  v_fma_f32 v197, v197, v209, v208
  v_fma_f32 v198, v198, v209, v208
  v_fma_f32 v199, v199, v209, v208
  v_mul_f32 v196, v196, v100
  v_mul_f32 v197, v197, v101
  v_mul_f32 v198, v198, v102
  v_mul_f32 v199, v199, v103
  v_exp_f32 v196, v196
  v_exp_f32 v197, v197
  v_exp_f32 v198, v198
  v_exp_f32 v199, v199
  v_fma_f32 v196, v196, v210, v210
  v_fma_f32 v197, v197, v210, v210
  v_fma_f32 v198, v198, v210, v210
  v_fma_f32 v199, v199, v210, v210
  v_rcp_f32 v196, v196
  v_rcp_f32 v197, v197
  v_rcp_f32 v198, v198
  v_rcp_f32 v199, v199
  v_mul_f32 v100, v100, v196
  v_mul_f32 v101, v101, v197
  v_mul_f32 v102, v102, v198
  v_mul_f32 v103, v103, v199
  v_cvt_pk_bf16_f32 v188, v96, v97
  v_cvt_pk_bf16_f32 v189, v98, v99
  v_cvt_pk_bf16_f32 v190, v100, v101
  v_cvt_pk_bf16_f32 v191, v102, v103
  s_nop 1
  v_permlane16_swap_b32 v188, v190
  v_permlane16_swap_b32 v189, v191
  buffer_store_dwordx4 v[188:191], v15, s[12:15], s31 offen sc1
  s_add_u32 s31, s31, 65536
  v_mul_f32 v196, v104, v104
  v_mul_f32 v197, v105, v105
  v_mul_f32 v198, v106, v106
  v_mul_f32 v199, v107, v107
  v_fma_f32 v196, v196, v205, v204
  v_fma_f32 v197, v197, v205, v204
  v_fma_f32 v198, v198, v205, v204
  v_fma_f32 v199, v199, v205, v204
  v_mul_f32 v196, v196, v104
  v_mul_f32 v197, v197, v105
  v_mul_f32 v198, v198, v106
  v_mul_f32 v199, v199, v107
  v_exp_f32 v196, v196
  v_exp_f32 v197, v197
  v_exp_f32 v198, v198
  v_exp_f32 v199, v199
  v_fma_f32 v196, v196, v206, v206
  v_fma_f32 v197, v197, v206, v206
  v_fma_f32 v198, v198, v206, v206
  v_fma_f32 v199, v199, v206, v206
  v_rcp_f32 v196, v196
  v_rcp_f32 v197, v197
  v_rcp_f32 v198, v198
  v_rcp_f32 v199, v199
  v_mul_f32 v104, v104, v196
  v_mul_f32 v105, v105, v197
  v_mul_f32 v106, v106, v198
  v_mul_f32 v107, v107, v199
  v_mul_f32 v196, v108, v108
  v_mul_f32 v197, v109, v109
  v_mul_f32 v198, v110, v110
  v_mul_f32 v199, v111, v111
  v_fma_f32 v196, v196, v209, v208
  v_fma_f32 v197, v197, v209, v208
  v_fma_f32 v198, v198, v209, v208
  v_fma_f32 v199, v199, v209, v208
  v_mul_f32 v196, v196, v108
  v_mul_f32 v197, v197, v109
  v_mul_f32 v198, v198, v110
  v_mul_f32 v199, v199, v111
  v_exp_f32 v196, v196
  v_exp_f32 v197, v197
  v_exp_f32 v198, v198
  v_exp_f32 v199, v199
  v_fma_f32 v196, v196, v210, v210
  v_fma_f32 v197, v197, v210, v210
  v_fma_f32 v198, v198, v210, v210
  v_fma_f32 v199, v199, v210, v210
  v_rcp_f32 v196, v196
  v_rcp_f32 v197, v197
  v_rcp_f32 v198, v198
  v_rcp_f32 v199, v199
  v_mul_f32 v108, v108, v196
  v_mul_f32 v109, v109, v197
  v_mul_f32 v110, v110, v198
  v_mul_f32 v111, v111, v199
  v_cvt_pk_bf16_f32 v192, v104, v105
  v_cvt_pk_bf16_f32 v193, v106, v107
  v_cvt_pk_bf16_f32 v194, v108, v109
  v_cvt_pk_bf16_f32 v195, v110, v111
  s_nop 1
  v_permlane16_swap_b32 v192, v194
  v_permlane16_swap_b32 v193, v195
  buffer_store_dwordx4 v[192:195], v15, s[12:15], s31 offen sc1
  s_add_u32 s31, s31, 65536
  v_mul_f32 v196, v112, v112
  v_mul_f32 v197, v113, v113
  v_mul_f32 v198, v114, v114
  v_mul_f32 v199, v115, v115
  v_fma_f32 v196, v196, v205, v204
  v_fma_f32 v197, v197, v205, v204
  v_fma_f32 v198, v198, v205, v204
  v_fma_f32 v199, v199, v205, v204
  v_mul_f32 v196, v196, v112
  v_mul_f32 v197, v197, v113
  v_mul_f32 v198, v198, v114
  v_mul_f32 v199, v199, v115
  v_exp_f32 v196, v196
  v_exp_f32 v197, v197
  v_exp_f32 v198, v198
  v_exp_f32 v199, v199
  v_fma_f32 v196, v196, v206, v206
  v_fma_f32 v197, v197, v206, v206
  v_fma_f32 v198, v198, v206, v206
  v_fma_f32 v199, v199, v206, v206
  v_rcp_f32 v196, v196
  v_rcp_f32 v197, v197
  v_rcp_f32 v198, v198
  v_rcp_f32 v199, v199
  v_mul_f32 v112, v112, v196
  v_mul_f32 v113, v113, v197
  v_mul_f32 v114, v114, v198
  v_mul_f32 v115, v115, v199
  v_mul_f32 v196, v116, v116
  v_mul_f32 v197, v117, v117
  v_mul_f32 v198, v118, v118
  v_mul_f32 v199, v119, v119
  v_fma_f32 v196, v196, v209, v208
  v_fma_f32 v197, v197, v209, v208
  v_fma_f32 v198, v198, v209, v208
  v_fma_f32 v199, v199, v209, v208
  v_mul_f32 v196, v196, v116
  v_mul_f32 v197, v197, v117
  v_mul_f32 v198, v198, v118
  v_mul_f32 v199, v199, v119
  v_exp_f32 v196, v196
  v_exp_f32 v197, v197
  v_exp_f32 v198, v198
  v_exp_f32 v199, v199
  v_fma_f32 v196, v196, v210, v210
  v_fma_f32 v197, v197, v210, v210
  v_fma_f32 v198, v198, v210, v210
  v_fma_f32 v199, v199, v210, v210
  v_rcp_f32 v196, v196
  v_rcp_f32 v197, v197
  v_rcp_f32 v198, v198
  v_rcp_f32 v199, v199
  v_mul_f32 v116, v116, v196
  v_mul_f32 v117, v117, v197
  v_mul_f32 v118, v118, v198
  v_mul_f32 v119, v119, v199
  v_cvt_pk_bf16_f32 v188, v112, v113
  v_cvt_pk_bf16_f32 v189, v114, v115
  v_cvt_pk_bf16_f32 v190, v116, v117
  v_cvt_pk_bf16_f32 v191, v118, v119
  s_nop 1
  v_permlane16_swap_b32 v188, v190
  v_permlane16_swap_b32 v189, v191
  buffer_store_dwordx4 v[188:191], v15, s[12:15], s31 offen sc1
  s_add_u32 s31, s31, 65536
  v_mul_f32 v196, v120, v120
  v_mul_f32 v197, v121, v121
  v_mul_f32 v198, v122, v122
  v_mul_f32 v199, v123, v123
  v_fma_f32 v196, v196, v205, v204
  v_fma_f32 v197, v197, v205, v204
  v_fma_f32 v198, v198, v205, v204
  v_fma_f32 v199, v199, v205, v204
  v_mul_f32 v196, v196, v120
  v_mul_f32 v197, v197, v121
  v_mul_f32 v198, v198, v122
  v_mul_f32 v199, v199, v123
  v_exp_f32 v196, v196
  v_exp_f32 v197, v197
  v_exp_f32 v198, v198
  v_exp_f32 v199, v199
  v_fma_f32 v196, v196, v206, v206
  v_fma_f32 v197, v197, v206, v206
  v_fma_f32 v198, v198, v206, v206
  v_fma_f32 v199, v199, v206, v206
  v_rcp_f32 v196, v196
  v_rcp_f32 v197, v197
  v_rcp_f32 v198, v198
  v_rcp_f32 v199, v199
  v_mul_f32 v120, v120, v196
  v_mul_f32 v121, v121, v197
  v_mul_f32 v122, v122, v198
  v_mul_f32 v123, v123, v199
  v_mul_f32 v196, v124, v124
  v_mul_f32 v197, v125, v125
  v_mul_f32 v198, v126, v126
  v_mul_f32 v199, v127, v127
  v_fma_f32 v196, v196, v209, v208
  v_fma_f32 v197, v197, v209, v208
  v_fma_f32 v198, v198, v209, v208
  v_fma_f32 v199, v199, v209, v208
  v_mul_f32 v196, v196, v124
  v_mul_f32 v197, v197, v125
  v_mul_f32 v198, v198, v126
  v_mul_f32 v199, v199, v127
  v_exp_f32 v196, v196
  v_exp_f32 v197, v197
  v_exp_f32 v198, v198
  v_exp_f32 v199, v199
  v_fma_f32 v196, v196, v210, v210
  v_fma_f32 v197, v197, v210, v210
  v_fma_f32 v198, v198, v210, v210
  v_fma_f32 v199, v199, v210, v210
  v_rcp_f32 v196, v196
  v_rcp_f32 v197, v197
  v_rcp_f32 v198, v198
  v_rcp_f32 v199, v199
  v_mul_f32 v124, v124, v196
  v_mul_f32 v125, v125, v197
  v_mul_f32 v126, v126, v198
  v_mul_f32 v127, v127, v199
  v_cvt_pk_bf16_f32 v192, v120, v121
  v_cvt_pk_bf16_f32 v193, v122, v123
  v_cvt_pk_bf16_f32 v194, v124, v125
  v_cvt_pk_bf16_f32 v195, v126, v127
  s_nop 1
  v_permlane16_swap_b32 v192, v194
  v_permlane16_swap_b32 v193, v195
  buffer_store_dwordx4 v[192:195], v15, s[12:15], s31 offen sc1
  s_add_u32 s31, s31, 65536
  s_branch Ldone_1
.p2align 6
Lk1_12_8:
  s_waitcnt vmcnt(3)
  s_barrier
  ds_read_b128 v[32:35], v4 offset:0
  ds_read_b128 v[36:39], v4 offset:1024
  ds_read_b64_tr_b16 v[40:41], v7 offset:0
  ds_read_b64_tr_b16 v[42:43], v7 offset:2304
  ds_read_b64_tr_b16 v[44:45], v7 offset:32
  ds_read_b64_tr_b16 v[46:47], v7 offset:2336
  ds_read_b64_tr_b16 v[48:49], v7 offset:64
  ds_read_b64_tr_b16 v[50:51], v7 offset:2368
  ds_read_b64_tr_b16 v[52:53], v7 offset:96
  ds_read_b64_tr_b16 v[54:55], v7 offset:2400
  ds_read_b64_tr_b16 v[60:61], v10 offset:0
  ds_read_b64_tr_b16 v[62:63], v10 offset:2304
  s_add_u32 m0, s29, 34816
  s_nop 0
  buffer_load_dwordx4 v1, s[4:7], s26 offen lds
  s_add_u32 m0, s30, 34816
  s_add_u32 s26, s26, 64
  buffer_load_dwordx4 v2, s[8:11], s27 offen lds
  s_add_u32 m0, s53, 34816
  s_cmp_eq_u32 s26, 1152
  s_cselect_b32 s26, 0, s26
  buffer_load_dword v3, s[8:11], s27 offen lds
  s_add_u32 s27, s27, s28
  s_cmp_eq_u32 s26, 0
  s_cselect_b32 s27, 0, s27
  s_waitcnt lgkmcnt(0)
  s_waitcnt vmcnt(3)
  s_barrier
  v_mfma_f32_16x16x32_bf16 v[96:99], v[32:35], v[40:43], 0
  ds_read_b128 v[64:67], v4 offset:17408
  ds_read_b128 v[68:71], v4 offset:18432
  v_mfma_f32_16x16x32_bf16 v[100:103], v[36:39], v[40:43], 0
  ds_read_b64_tr_b16 v[72:73], v7 offset:17408
  ds_read_b64_tr_b16 v[74:75], v7 offset:19712
  v_mfma_f32_16x16x32_bf16 v[104:107], v[32:35], v[44:47], 0
  ds_read_b64_tr_b16 v[76:77], v7 offset:17440
  ds_read_b64_tr_b16 v[78:79], v7 offset:19744
  ds_read_b64_tr_b16 v[80:81], v7 offset:17472
  v_mfma_f32_16x16x32_bf16 v[108:111], v[36:39], v[44:47], 0
  ds_read_b64_tr_b16 v[82:83], v7 offset:19776
  ds_read_b64_tr_b16 v[84:85], v7 offset:17504
  v_mfma_f32_16x16x32_bf16 v[112:115], v[32:35], v[48:51], 0
  ds_read_b64_tr_b16 v[86:87], v7 offset:19808
  ds_read_b64_tr_b16 v[92:93], v10 offset:17408
  ds_read_b64_tr_b16 v[94:95], v10 offset:19712
  v_mfma_f32_16x16x32_bf16 v[116:119], v[36:39], v[48:51], 0
  s_add_u32 m0, s29, 52224
  s_nop 0
  v_mfma_f32_16x16x32_bf16 v[120:123], v[32:35], v[52:55], 0
  buffer_load_dwordx4 v1, s[4:7], s26 offen lds
  s_add_u32 m0, s30, 52224
  s_add_u32 s26, s26, 64
  v_mfma_f32_16x16x32_bf16 v[124:127], v[36:39], v[52:55], 0
  buffer_load_dwordx4 v2, s[8:11], s27 offen lds
  s_add_u32 m0, s53, 52224
  v_mfma_f32_16x16x32_bf16 v[136:139], v[20:23], v[60:63], 0
  s_cmp_eq_u32 s26, 1152
  s_cselect_b32 s26, 0, s26
  buffer_load_dword v3, s[8:11], s27 offen lds
  s_add_u32 s27, s27, s28
  s_cmp_eq_u32 s26, 0
  s_cselect_b32 s27, 0, s27
  v_mfma_f32_16x16x32_bf16 v[140:143], v[32:35], v[32:35], 0
  s_add_u32 m0, s29, 69632
  s_nop 0
  v_mfma_f32_16x16x32_bf16 v[148:151], v[20:23], v[32:35], 0
  buffer_load_dwordx4 v1, s[4:7], s26 offen lds
  s_add_u32 m0, s30, 69632
  s_add_u32 s26, s26, 64
  v_mfma_f32_16x16x32_bf16 v[144:147], v[36:39], v[36:39], 0
  buffer_load_dwordx4 v2, s[8:11], s27 offen lds
  s_add_u32 m0, s53, 69632
  v_mfma_f32_16x16x32_bf16 v[152:155], v[20:23], v[36:39], 0
  s_cmp_eq_u32 s26, 1152
  s_cselect_b32 s26, 0, s26
  buffer_load_dword v3, s[8:11], s27 offen lds
  s_add_u32 s27, s27, s28
  s_cmp_eq_u32 s26, 0
  s_cselect_b32 s27, 0, s27
  s_waitcnt lgkmcnt(0)
  s_waitcnt vmcnt(6)
  s_barrier
  v_mfma_f32_16x16x32_bf16 v[96:99], v[64:67], v[72:75], v[96:99]
  ds_read_b128 v[32:35], v4 offset:34816
  ds_read_b128 v[36:39], v4 offset:35840
  v_mfma_f32_16x16x32_bf16 v[100:103], v[68:71], v[72:75], v[100:103]
  ds_read_b64_tr_b16 v[40:41], v7 offset:34816
  ds_read_b64_tr_b16 v[42:43], v7 offset:37120
  v_mfma_f32_16x16x32_bf16 v[104:107], v[64:67], v[76:79], v[104:107]
  ds_read_b64_tr_b16 v[44:45], v7 offset:34848
  ds_read_b64_tr_b16 v[46:47], v7 offset:37152
  ds_read_b64_tr_b16 v[48:49], v7 offset:34880
  v_mfma_f32_16x16x32_bf16 v[108:111], v[68:71], v[76:79], v[108:111]
  ds_read_b64_tr_b16 v[50:51], v7 offset:37184
  ds_read_b64_tr_b16 v[52:53], v7 offset:34912
  v_mfma_f32_16x16x32_bf16 v[112:115], v[64:67], v[80:83], v[112:115]
  ds_read_b64_tr_b16 v[54:55], v7 offset:37216
  ds_read_b64_tr_b16 v[60:61], v10 offset:34816
  ds_read_b64_tr_b16 v[62:63], v10 offset:37120
  v_mfma_f32_16x16x32_bf16 v[116:119], v[68:71], v[80:83], v[116:119]
  s_add_u32 m0, s29, 87040
  s_nop 0
  v_mfma_f32_16x16x32_bf16 v[120:123], v[64:67], v[84:87], v[120:123]
  buffer_load_dwordx4 v1, s[4:7], s26 offen lds
  s_add_u32 m0, s30, 87040
  s_add_u32 s26, s26, 64
  v_mfma_f32_16x16x32_bf16 v[124:127], v[68:71], v[84:87], v[124:127]
  buffer_load_dwordx4 v2, s[8:11], s27 offen lds
  s_add_u32 m0, s53, 87040
  v_mfma_f32_16x16x32_bf16 v[136:139], v[20:23], v[92:95], v[136:139]
  s_cmp_eq_u32 s26, 1152
  s_cselect_b32 s26, 0, s26
  buffer_load_dword v3, s[8:11], s27 offen lds
  s_add_u32 s27, s27, s28
  s_cmp_eq_u32 s26, 0
  s_cselect_b32 s27, 0, s27
  v_mfma_f32_16x16x32_bf16 v[140:143], v[64:67], v[64:67], v[140:143]
  s_add_u32 m0, s29, 104448
  s_nop 0
  v_mfma_f32_16x16x32_bf16 v[148:151], v[20:23], v[64:67], v[148:151]
  buffer_load_dwordx4 v1, s[4:7], s26 offen lds
  s_add_u32 m0, s30, 104448
  s_add_u32 s26, s26, 64
  v_mfma_f32_16x16x32_bf16 v[144:147], v[68:71], v[68:71], v[144:147]
  buffer_load_dwordx4 v2, s[8:11], s27 offen lds
  s_add_u32 m0, s53, 104448
  v_mfma_f32_16x16x32_bf16 v[152:155], v[20:23], v[68:71], v[152:155]
  s_cmp_eq_u32 s26, 1152
  s_cselect_b32 s26, 0, s26
  buffer_load_dword v3, s[8:11], s27 offen lds
  s_add_u32 s27, s27, s28
  s_cmp_eq_u32 s26, 0
  s_cselect_b32 s27, 0, s27
  s_waitcnt lgkmcnt(0)
  s_waitcnt vmcnt(6)
  s_barrier
  v_mfma_f32_16x16x32_bf16 v[96:99], v[32:35], v[40:43], v[96:99]
  ds_read_b128 v[64:67], v5 offset:0
  v_mfma_f32_16x16x32_bf16 v[100:103], v[36:39], v[40:43], v[100:103]
  ds_read_b128 v[68:71], v5 offset:1024
  ds_read_b64_tr_b16 v[72:73], v8 offset:0
  v_mfma_f32_16x16x32_bf16 v[104:107], v[32:35], v[44:47], v[104:107]
  ds_read_b64_tr_b16 v[74:75], v8 offset:2304
  ds_read_b64_tr_b16 v[76:77], v8 offset:32
  v_mfma_f32_16x16x32_bf16 v[108:111], v[36:39], v[44:47], v[108:111]
  ds_read_b64_tr_b16 v[78:79], v8 offset:2336
  v_mfma_f32_16x16x32_bf16 v[112:115], v[32:35], v[48:51], v[112:115]
  ds_read_b64_tr_b16 v[80:81], v8 offset:64
  ds_read_b64_tr_b16 v[82:83], v8 offset:2368
  v_mfma_f32_16x16x32_bf16 v[116:119], v[36:39], v[48:51], v[116:119]
  ds_read_b64_tr_b16 v[84:85], v8 offset:96
  ds_read_b64_tr_b16 v[86:87], v8 offset:2400
  v_mfma_f32_16x16x32_bf16 v[120:123], v[32:35], v[52:55], v[120:123]
  ds_read_b64_tr_b16 v[92:93], v11 offset:0
  v_mfma_f32_16x16x32_bf16 v[124:127], v[36:39], v[52:55], v[124:127]
  ds_read_b64_tr_b16 v[94:95], v11 offset:2304
  s_add_u32 m0, s29, 121856
  v_mfma_f32_16x16x32_bf16 v[136:139], v[20:23], v[60:63], v[136:139]
  s_nop 0
  buffer_load_dwordx4 v1, s[4:7], s26 offen lds
  v_mfma_f32_16x16x32_bf16 v[140:143], v[32:35], v[32:35], v[140:143]
  s_add_u32 m0, s30, 121856
  v_mfma_f32_16x16x32_bf16 v[148:151], v[20:23], v[32:35], v[148:151]
  s_add_u32 s26, s26, 64
  buffer_load_dwordx4 v2, s[8:11], s27 offen lds
  v_mfma_f32_16x16x32_bf16 v[144:147], v[36:39], v[36:39], v[144:147]
  s_add_u32 m0, s53, 121856
  s_cmp_eq_u32 s26, 1152
  s_cselect_b32 s26, 0, s26
  v_mfma_f32_16x16x32_bf16 v[152:155], v[20:23], v[36:39], v[152:155]
  buffer_load_dword v3, s[8:11], s27 offen lds
  s_add_u32 s27, s27, s28
  s_cmp_eq_u32 s26, 0
  s_cselect_b32 s27, 0, s27
  s_waitcnt lgkmcnt(0)
  v_mfma_f32_16x16x32_bf16 v[96:99], v[64:67], v[72:75], v[96:99]
  ds_read_b128 v[32:35], v5 offset:17408
  v_mfma_f32_16x16x32_bf16 v[100:103], v[68:71], v[72:75], v[100:103]
  ds_read_b128 v[36:39], v5 offset:18432
  ds_read_b64_tr_b16 v[40:41], v8 offset:17408
  v_mfma_f32_16x16x32_bf16 v[104:107], v[64:67], v[76:79], v[104:107]
  ds_read_b64_tr_b16 v[42:43], v8 offset:19712
  ds_read_b64_tr_b16 v[44:45], v8 offset:17440
  v_mfma_f32_16x16x32_bf16 v[108:111], v[68:71], v[76:79], v[108:111]
  ds_read_b64_tr_b16 v[46:47], v8 offset:19744
  v_mfma_f32_16x16x32_bf16 v[112:115], v[64:67], v[80:83], v[112:115]
  ds_read_b64_tr_b16 v[48:49], v8 offset:17472
  ds_read_b64_tr_b16 v[50:51], v8 offset:19776
  v_mfma_f32_16x16x32_bf16 v[116:119], v[68:71], v[80:83], v[116:119]
  ds_read_b64_tr_b16 v[52:53], v8 offset:17504
  ds_read_b64_tr_b16 v[54:55], v8 offset:19808
  v_mfma_f32_16x16x32_bf16 v[120:123], v[64:67], v[84:87], v[120:123]
  ds_read_b64_tr_b16 v[60:61], v11 offset:17408
  v_mfma_f32_16x16x32_bf16 v[124:127], v[68:71], v[84:87], v[124:127]
  ds_read_b64_tr_b16 v[62:63], v11 offset:19712
  s_add_u32 m0, s29, 139264
  v_mfma_f32_16x16x32_bf16 v[136:139], v[20:23], v[92:95], v[136:139]
  s_nop 0
  buffer_load_dwordx4 v1, s[4:7], s26 offen lds
  v_mfma_f32_16x16x32_bf16 v[140:143], v[64:67], v[64:67], v[140:143]
  s_add_u32 m0, s30, 139264
  v_mfma_f32_16x16x32_bf16 v[148:151], v[20:23], v[64:67], v[148:151]
  s_add_u32 s26, s26, 64
  buffer_load_dwordx4 v2, s[8:11], s27 offen lds
  v_mfma_f32_16x16x32_bf16 v[144:147], v[68:71], v[68:71], v[144:147]
  s_add_u32 m0, s53, 139264
  s_cmp_eq_u32 s26, 1152
  s_cselect_b32 s26, 0, s26
  v_mfma_f32_16x16x32_bf16 v[152:155], v[20:23], v[68:71], v[152:155]
  buffer_load_dword v3, s[8:11], s27 offen lds
  s_add_u32 s27, s27, s28
  s_cmp_eq_u32 s26, 0
  s_cselect_b32 s27, 0, s27
  s_waitcnt lgkmcnt(0)
  s_waitcnt vmcnt(6)
  s_barrier
  v_mfma_f32_16x16x32_bf16 v[96:99], v[32:35], v[40:43], v[96:99]
  ds_read_b128 v[64:67], v5 offset:34816
  v_mfma_f32_16x16x32_bf16 v[100:103], v[36:39], v[40:43], v[100:103]
  ds_read_b128 v[68:71], v5 offset:35840
  ds_read_b64_tr_b16 v[72:73], v8 offset:34816
  v_mfma_f32_16x16x32_bf16 v[104:107], v[32:35], v[44:47], v[104:107]
  ds_read_b64_tr_b16 v[74:75], v8 offset:37120
  ds_read_b64_tr_b16 v[76:77], v8 offset:34848
  v_mfma_f32_16x16x32_bf16 v[108:111], v[36:39], v[44:47], v[108:111]
  ds_read_b64_tr_b16 v[78:79], v8 offset:37152
  v_mfma_f32_16x16x32_bf16 v[112:115], v[32:35], v[48:51], v[112:115]
  ds_read_b64_tr_b16 v[80:81], v8 offset:34880
  ds_read_b64_tr_b16 v[82:83], v8 offset:37184
  v_mfma_f32_16x16x32_bf16 v[116:119], v[36:39], v[48:51], v[116:119]
  ds_read_b64_tr_b16 v[84:85], v8 offset:34912
  ds_read_b64_tr_b16 v[86:87], v8 offset:37216
  v_mfma_f32_16x16x32_bf16 v[120:123], v[32:35], v[52:55], v[120:123]
  ds_read_b64_tr_b16 v[92:93], v11 offset:34816
  v_mfma_f32_16x16x32_bf16 v[124:127], v[36:39], v[52:55], v[124:127]
  ds_read_b64_tr_b16 v[94:95], v11 offset:37120
  s_add_u32 m0, s29, 0
  v_mfma_f32_16x16x32_bf16 v[136:139], v[20:23], v[60:63], v[136:139]
  s_nop 0
  buffer_load_dwordx4 v1, s[4:7], s26 offen lds
  v_mfma_f32_16x16x32_bf16 v[140:143], v[32:35], v[32:35], v[140:143]
  s_add_u32 m0, s30, 0
  v_mfma_f32_16x16x32_bf16 v[148:151], v[20:23], v[32:35], v[148:151]
  s_add_u32 s26, s26, 64
  buffer_load_dwordx4 v2, s[8:11], s27 offen lds
  v_mfma_f32_16x16x32_bf16 v[144:147], v[36:39], v[36:39], v[144:147]
  s_add_u32 m0, s53, 0
  s_cmp_eq_u32 s26, 1152
  s_cselect_b32 s26, 0, s26
  v_mfma_f32_16x16x32_bf16 v[152:155], v[20:23], v[36:39], v[152:155]
  buffer_load_dword v3, s[8:11], s27 offen lds
  s_add_u32 s27, s27, s28
  s_cmp_eq_u32 s26, 0
  s_cselect_b32 s27, 0, s27
  s_waitcnt lgkmcnt(0)
  v_mfma_f32_16x16x32_bf16 v[96:99], v[64:67], v[72:75], v[96:99]
  ds_read_b128 v[32:35], v6 offset:0
  v_mfma_f32_16x16x32_bf16 v[100:103], v[68:71], v[72:75], v[100:103]
  ds_read_b128 v[36:39], v6 offset:1024
  ds_read_b64_tr_b16 v[40:41], v9 offset:0
  v_mfma_f32_16x16x32_bf16 v[104:107], v[64:67], v[76:79], v[104:107]
  ds_read_b64_tr_b16 v[42:43], v9 offset:2304
  ds_read_b64_tr_b16 v[44:45], v9 offset:32
  v_mfma_f32_16x16x32_bf16 v[108:111], v[68:71], v[76:79], v[108:111]
  ds_read_b64_tr_b16 v[46:47], v9 offset:2336
  v_mfma_f32_16x16x32_bf16 v[112:115], v[64:67], v[80:83], v[112:115]
  ds_read_b64_tr_b16 v[48:49], v9 offset:64
  ds_read_b64_tr_b16 v[50:51], v9 offset:2368
  v_mfma_f32_16x16x32_bf16 v[116:119], v[68:71], v[80:83], v[116:119]
  ds_read_b64_tr_b16 v[52:53], v9 offset:96
  ds_read_b64_tr_b16 v[54:55], v9 offset:2400
  v_mfma_f32_16x16x32_bf16 v[120:123], v[64:67], v[84:87], v[120:123]
  ds_read_b64_tr_b16 v[60:61], v12 offset:0
  v_mfma_f32_16x16x32_bf16 v[124:127], v[68:71], v[84:87], v[124:127]
  ds_read_b64_tr_b16 v[62:63], v12 offset:2304
  s_add_u32 m0, s29, 17408
  v_mfma_f32_16x16x32_bf16 v[136:139], v[20:23], v[92:95], v[136:139]
  s_nop 0
  buffer_load_dwordx4 v1, s[4:7], s26 offen lds
  v_mfma_f32_16x16x32_bf16 v[140:143], v[64:67], v[64:67], v[140:143]
  s_add_u32 m0, s30, 17408
  v_mfma_f32_16x16x32_bf16 v[148:151], v[20:23], v[64:67], v[148:151]
  s_add_u32 s26, s26, 64
  buffer_load_dwordx4 v2, s[8:11], s27 offen lds
  v_mfma_f32_16x16x32_bf16 v[144:147], v[68:71], v[68:71], v[144:147]
  s_add_u32 m0, s53, 17408
  s_cmp_eq_u32 s26, 1152
  s_cselect_b32 s26, 0, s26
  v_mfma_f32_16x16x32_bf16 v[152:155], v[20:23], v[68:71], v[152:155]
  buffer_load_dword v3, s[8:11], s27 offen lds
  s_add_u32 s27, s27, s28
  s_cmp_eq_u32 s26, 0
  s_cselect_b32 s27, 0, s27
  s_waitcnt lgkmcnt(0)
  s_waitcnt vmcnt(6)
  s_barrier
  v_mfma_f32_16x16x32_bf16 v[96:99], v[32:35], v[40:43], v[96:99]
  ds_read_b128 v[64:67], v6 offset:17408
  v_mfma_f32_16x16x32_bf16 v[100:103], v[36:39], v[40:43], v[100:103]
  ds_read_b128 v[68:71], v6 offset:18432
  ds_read_b64_tr_b16 v[72:73], v9 offset:17408
  v_mfma_f32_16x16x32_bf16 v[104:107], v[32:35], v[44:47], v[104:107]
  ds_read_b64_tr_b16 v[74:75], v9 offset:19712
  ds_read_b64_tr_b16 v[76:77], v9 offset:17440
  v_mfma_f32_16x16x32_bf16 v[108:111], v[36:39], v[44:47], v[108:111]
  ds_read_b64_tr_b16 v[78:79], v9 offset:19744
  v_mfma_f32_16x16x32_bf16 v[112:115], v[32:35], v[48:51], v[112:115]
  ds_read_b64_tr_b16 v[80:81], v9 offset:17472
  ds_read_b64_tr_b16 v[82:83], v9 offset:19776
  v_mfma_f32_16x16x32_bf16 v[116:119], v[36:39], v[48:51], v[116:119]
  ds_read_b64_tr_b16 v[84:85], v9 offset:17504
  ds_read_b64_tr_b16 v[86:87], v9 offset:19808
  v_mfma_f32_16x16x32_bf16 v[120:123], v[32:35], v[52:55], v[120:123]
  ds_read_b64_tr_b16 v[92:93], v12 offset:17408
  v_mfma_f32_16x16x32_bf16 v[124:127], v[36:39], v[52:55], v[124:127]
  ds_read_b64_tr_b16 v[94:95], v12 offset:19712
  s_add_u32 m0, s29, 34816
  v_mfma_f32_16x16x32_bf16 v[136:139], v[20:23], v[60:63], v[136:139]
  s_nop 0
  buffer_load_dwordx4 v1, s[4:7], s26 offen lds
  v_mfma_f32_16x16x32_bf16 v[140:143], v[32:35], v[32:35], v[140:143]
  s_add_u32 m0, s30, 34816
  v_mfma_f32_16x16x32_bf16 v[148:151], v[20:23], v[32:35], v[148:151]
  s_add_u32 s26, s26, 64
  buffer_load_dwordx4 v2, s[8:11], s27 offen lds
  v_mfma_f32_16x16x32_bf16 v[144:147], v[36:39], v[36:39], v[144:147]
  s_add_u32 m0, s53, 34816
  s_cmp_eq_u32 s26, 1152
  s_cselect_b32 s26, 0, s26
  v_mfma_f32_16x16x32_bf16 v[152:155], v[20:23], v[36:39], v[152:155]
  buffer_load_dword v3, s[8:11], s27 offen lds
  s_add_u32 s27, s27, s28
  s_cmp_eq_u32 s26, 0
  s_cselect_b32 s27, 0, s27
  s_waitcnt lgkmcnt(0)
  v_mfma_f32_16x16x32_bf16 v[96:99], v[64:67], v[72:75], v[96:99]
  ds_read_b128 v[32:35], v6 offset:34816
  v_mfma_f32_16x16x32_bf16 v[100:103], v[68:71], v[72:75], v[100:103]
  ds_read_b128 v[36:39], v6 offset:35840
  ds_read_b64_tr_b16 v[40:41], v9 offset:34816
  v_mfma_f32_16x16x32_bf16 v[104:107], v[64:67], v[76:79], v[104:107]
  ds_read_b64_tr_b16 v[42:43], v9 offset:37120
  ds_read_b64_tr_b16 v[44:45], v9 offset:34848
  v_mfma_f32_16x16x32_bf16 v[108:111], v[68:71], v[76:79], v[108:111]
  ds_read_b64_tr_b16 v[46:47], v9 offset:37152
  v_mfma_f32_16x16x32_bf16 v[112:115], v[64:67], v[80:83], v[112:115]
  ds_read_b64_tr_b16 v[48:49], v9 offset:34880
  ds_read_b64_tr_b16 v[50:51], v9 offset:37184
  v_mfma_f32_16x16x32_bf16 v[116:119], v[68:71], v[80:83], v[116:119]
  ds_read_b64_tr_b16 v[52:53], v9 offset:34912
  ds_read_b64_tr_b16 v[54:55], v9 offset:37216
  v_mfma_f32_16x16x32_bf16 v[120:123], v[64:67], v[84:87], v[120:123]
  ds_read_b64_tr_b16 v[60:61], v12 offset:34816
  v_mfma_f32_16x16x32_bf16 v[124:127], v[68:71], v[84:87], v[124:127]
  ds_read_b64_tr_b16 v[62:63], v12 offset:37120
  s_add_u32 m0, s29, 52224
  v_mfma_f32_16x16x32_bf16 v[136:139], v[20:23], v[92:95], v[136:139]
  s_nop 0
  buffer_load_dwordx4 v1, s[4:7], s26 offen lds
  v_mfma_f32_16x16x32_bf16 v[140:143], v[64:67], v[64:67], v[140:143]
  s_add_u32 m0, s30, 52224
  v_mfma_f32_16x16x32_bf16 v[148:151], v[20:23], v[64:67], v[148:151]
  s_add_u32 s26, s26, 64
  buffer_load_dwordx4 v2, s[8:11], s27 offen lds
  v_mfma_f32_16x16x32_bf16 v[144:147], v[68:71], v[68:71], v[144:147]
  s_add_u32 m0, s53, 52224
  s_cmp_eq_u32 s26, 1152
  s_cselect_b32 s26, 0, s26
  v_mfma_f32_16x16x32_bf16 v[152:155], v[20:23], v[68:71], v[152:155]
  buffer_load_dword v3, s[8:11], s27 offen lds
  s_add_u32 s27, s27, s28
  s_cmp_eq_u32 s26, 0
  s_cselect_b32 s27, 0, s27
  s_waitcnt lgkmcnt(0)
  s_waitcnt vmcnt(6)
  s_barrier
  v_mfma_f32_16x16x32_bf16 v[96:99], v[32:35], v[40:43], v[96:99]
  ds_read_b128 v[64:67], v4 offset:0
  v_mfma_f32_16x16x32_bf16 v[100:103], v[36:39], v[40:43], v[100:103]
  ds_read_b128 v[68:71], v4 offset:1024
  ds_read_b64_tr_b16 v[72:73], v7 offset:0
  v_mfma_f32_16x16x32_bf16 v[104:107], v[32:35], v[44:47], v[104:107]
  ds_read_b64_tr_b16 v[74:75], v7 offset:2304
  ds_read_b64_tr_b16 v[76:77], v7 offset:32
  v_mfma_f32_16x16x32_bf16 v[108:111], v[36:39], v[44:47], v[108:111]
  ds_read_b64_tr_b16 v[78:79], v7 offset:2336
  v_mfma_f32_16x16x32_bf16 v[112:115], v[32:35], v[48:51], v[112:115]
  ds_read_b64_tr_b16 v[80:81], v7 offset:64
  ds_read_b64_tr_b16 v[82:83], v7 offset:2368
  v_mfma_f32_16x16x32_bf16 v[116:119], v[36:39], v[48:51], v[116:119]
  ds_read_b64_tr_b16 v[84:85], v7 offset:96
  ds_read_b64_tr_b16 v[86:87], v7 offset:2400
  v_mfma_f32_16x16x32_bf16 v[120:123], v[32:35], v[52:55], v[120:123]
  ds_read_b64_tr_b16 v[92:93], v10 offset:0
  v_mfma_f32_16x16x32_bf16 v[124:127], v[36:39], v[52:55], v[124:127]
  ds_read_b64_tr_b16 v[94:95], v10 offset:2304
  s_add_u32 m0, s29, 69632
  v_mfma_f32_16x16x32_bf16 v[136:139], v[20:23], v[60:63], v[136:139]
  s_nop 0
  buffer_load_dwordx4 v1, s[4:7], s26 offen lds
  v_mfma_f32_16x16x32_bf16 v[140:143], v[32:35], v[32:35], v[140:143]
  s_add_u32 m0, s30, 69632
  v_mfma_f32_16x16x32_bf16 v[148:151], v[20:23], v[32:35], v[148:151]
  s_add_u32 s26, s26, 64
  buffer_load_dwordx4 v2, s[8:11], s27 offen lds
  v_mfma_f32_16x16x32_bf16 v[144:147], v[36:39], v[36:39], v[144:147]
  s_add_u32 m0, s53, 69632
  s_cmp_eq_u32 s26, 1152
  s_cselect_b32 s26, 0, s26
  v_mfma_f32_16x16x32_bf16 v[152:155], v[20:23], v[36:39], v[152:155]
  buffer_load_dword v3, s[8:11], s27 offen lds
  s_add_u32 s27, s27, s28
  s_cmp_eq_u32 s26, 0
  s_cselect_b32 s27, 0, s27
  s_waitcnt lgkmcnt(0)
  v_mfma_f32_16x16x32_bf16 v[96:99], v[64:67], v[72:75], v[96:99]
  ds_read_b128 v[32:35], v4 offset:17408
  v_mfma_f32_16x16x32_bf16 v[100:103], v[68:71], v[72:75], v[100:103]
  ds_read_b128 v[36:39], v4 offset:18432
  ds_read_b64_tr_b16 v[40:41], v7 offset:17408
  v_mfma_f32_16x16x32_bf16 v[104:107], v[64:67], v[76:79], v[104:107]
  ds_read_b64_tr_b16 v[42:43], v7 offset:19712
  ds_read_b64_tr_b16 v[44:45], v7 offset:17440
  v_mfma_f32_16x16x32_bf16 v[108:111], v[68:71], v[76:79], v[108:111]
  ds_read_b64_tr_b16 v[46:47], v7 offset:19744
  v_mfma_f32_16x16x32_bf16 v[112:115], v[64:67], v[80:83], v[112:115]
  ds_read_b64_tr_b16 v[48:49], v7 offset:17472
  ds_read_b64_tr_b16 v[50:51], v7 offset:19776
  v_mfma_f32_16x16x32_bf16 v[116:119], v[68:71], v[80:83], v[116:119]
  ds_read_b64_tr_b16 v[52:53], v7 offset:17504
  ds_read_b64_tr_b16 v[54:55], v7 offset:19808
  v_mfma_f32_16x16x32_bf16 v[120:123], v[64:67], v[84:87], v[120:123]
  ds_read_b64_tr_b16 v[60:61], v10 offset:17408
  v_mfma_f32_16x16x32_bf16 v[124:127], v[68:71], v[84:87], v[124:127]
  ds_read_b64_tr_b16 v[62:63], v10 offset:19712
  s_add_u32 m0, s29, 87040
  v_mfma_f32_16x16x32_bf16 v[136:139], v[20:23], v[92:95], v[136:139]
  s_nop 0
  buffer_load_dwordx4 v1, s[4:7], s26 offen lds
  v_mfma_f32_16x16x32_bf16 v[140:143], v[64:67], v[64:67], v[140:143]
  s_add_u32 m0, s30, 87040
  v_mfma_f32_16x16x32_bf16 v[148:151], v[20:23], v[64:67], v[148:151]
  s_add_u32 s26, s26, 64
  buffer_load_dwordx4 v2, s[8:11], s27 offen lds
  v_mfma_f32_16x16x32_bf16 v[144:147], v[68:71], v[68:71], v[144:147]
  s_add_u32 m0, s53, 87040
  s_cmp_eq_u32 s26, 1152
  s_cselect_b32 s26, 0, s26
  v_mfma_f32_16x16x32_bf16 v[152:155], v[20:23], v[68:71], v[152:155]
  buffer_load_dword v3, s[8:11], s27 offen lds
  s_add_u32 s27, s27, s28
  s_cmp_eq_u32 s26, 0
  s_cselect_b32 s27, 0, s27
  s_waitcnt lgkmcnt(0)
  s_waitcnt vmcnt(6)
  s_barrier
  v_mfma_f32_16x16x32_bf16 v[96:99], v[32:35], v[40:43], v[96:99]
  ds_read_b128 v[64:67], v4 offset:34816
  v_mfma_f32_16x16x32_bf16 v[100:103], v[36:39], v[40:43], v[100:103]
  ds_read_b128 v[68:71], v4 offset:35840
  ds_read_b64_tr_b16 v[72:73], v7 offset:34816
  v_mfma_f32_16x16x32_bf16 v[104:107], v[32:35], v[44:47], v[104:107]
  ds_read_b64_tr_b16 v[74:75], v7 offset:37120
  ds_read_b64_tr_b16 v[76:77], v7 offset:34848
  v_mfma_f32_16x16x32_bf16 v[108:111], v[36:39], v[44:47], v[108:111]
  ds_read_b64_tr_b16 v[78:79], v7 offset:37152
  v_mfma_f32_16x16x32_bf16 v[112:115], v[32:35], v[48:51], v[112:115]
  ds_read_b64_tr_b16 v[80:81], v7 offset:34880
  ds_read_b64_tr_b16 v[82:83], v7 offset:37184
  v_mfma_f32_16x16x32_bf16 v[116:119], v[36:39], v[48:51], v[116:119]
  ds_read_b64_tr_b16 v[84:85], v7 offset:34912
  ds_read_b64_tr_b16 v[86:87], v7 offset:37216
  v_mfma_f32_16x16x32_bf16 v[120:123], v[32:35], v[52:55], v[120:123]
  ds_read_b64_tr_b16 v[92:93], v10 offset:34816
  v_mfma_f32_16x16x32_bf16 v[124:127], v[36:39], v[52:55], v[124:127]
  ds_read_b64_tr_b16 v[94:95], v10 offset:37120
  s_add_u32 m0, s29, 104448
  v_mfma_f32_16x16x32_bf16 v[136:139], v[20:23], v[60:63], v[136:139]
  s_nop 0
  buffer_load_dwordx4 v1, s[4:7], s26 offen lds
  v_mfma_f32_16x16x32_bf16 v[140:143], v[32:35], v[32:35], v[140:143]
  s_add_u32 m0, s30, 104448
  v_mfma_f32_16x16x32_bf16 v[148:151], v[20:23], v[32:35], v[148:151]
  s_add_u32 s26, s26, 64
  buffer_load_dwordx4 v2, s[8:11], s27 offen lds
  v_mfma_f32_16x16x32_bf16 v[144:147], v[36:39], v[36:39], v[144:147]
  s_add_u32 m0, s53, 104448
  s_cmp_eq_u32 s26, 1152
  s_cselect_b32 s26, 0, s26
  v_mfma_f32_16x16x32_bf16 v[152:155], v[20:23], v[36:39], v[152:155]
  buffer_load_dword v3, s[8:11], s27 offen lds
  s_add_u32 s27, s27, s28
  s_cmp_eq_u32 s26, 0
  s_cselect_b32 s27, 0, s27
  s_waitcnt lgkmcnt(0)
  v_mfma_f32_16x16x32_bf16 v[96:99], v[64:67], v[72:75], v[96:99]
  ds_read_b128 v[32:35], v5 offset:0
  v_mfma_f32_16x16x32_bf16 v[100:103], v[68:71], v[72:75], v[100:103]
  ds_read_b128 v[36:39], v5 offset:1024
  ds_read_b64_tr_b16 v[40:41], v8 offset:0
  v_mfma_f32_16x16x32_bf16 v[104:107], v[64:67], v[76:79], v[104:107]
  ds_read_b64_tr_b16 v[42:43], v8 offset:2304
  ds_read_b64_tr_b16 v[44:45], v8 offset:32
  v_mfma_f32_16x16x32_bf16 v[108:111], v[68:71], v[76:79], v[108:111]
  ds_read_b64_tr_b16 v[46:47], v8 offset:2336
  v_mfma_f32_16x16x32_bf16 v[112:115], v[64:67], v[80:83], v[112:115]
  ds_read_b64_tr_b16 v[48:49], v8 offset:64
  ds_read_b64_tr_b16 v[50:51], v8 offset:2368
  v_mfma_f32_16x16x32_bf16 v[116:119], v[68:71], v[80:83], v[116:119]
  ds_read_b64_tr_b16 v[52:53], v8 offset:96
  ds_read_b64_tr_b16 v[54:55], v8 offset:2400
  v_mfma_f32_16x16x32_bf16 v[120:123], v[64:67], v[84:87], v[120:123]
  ds_read_b64_tr_b16 v[60:61], v11 offset:0
  v_mfma_f32_16x16x32_bf16 v[124:127], v[68:71], v[84:87], v[124:127]
  ds_read_b64_tr_b16 v[62:63], v11 offset:2304
  s_add_u32 m0, s29, 121856
  v_mfma_f32_16x16x32_bf16 v[136:139], v[20:23], v[92:95], v[136:139]
  s_nop 0
  buffer_load_dwordx4 v1, s[4:7], s26 offen lds
  v_mfma_f32_16x16x32_bf16 v[140:143], v[64:67], v[64:67], v[140:143]
  s_add_u32 m0, s30, 121856
  v_mfma_f32_16x16x32_bf16 v[148:151], v[20:23], v[64:67], v[148:151]
  s_add_u32 s26, s26, 64
  buffer_load_dwordx4 v2, s[8:11], s27 offen lds
  v_mfma_f32_16x16x32_bf16 v[144:147], v[68:71], v[68:71], v[144:147]
  s_add_u32 m0, s53, 121856
  s_cmp_eq_u32 s26, 1152
  s_cselect_b32 s26, 0, s26
  v_mfma_f32_16x16x32_bf16 v[152:155], v[20:23], v[68:71], v[152:155]
  buffer_load_dword v3, s[8:11], s27 offen lds
  s_add_u32 s27, s27, s28
  s_cmp_eq_u32 s26, 0
  s_cselect_b32 s27, 0, s27
  s_waitcnt lgkmcnt(0)
  s_waitcnt vmcnt(6)
  s_barrier
  v_mfma_f32_16x16x32_bf16 v[96:99], v[32:35], v[40:43], v[96:99]
  ds_read_b128 v[64:67], v5 offset:17408
  v_mfma_f32_16x16x32_bf16 v[100:103], v[36:39], v[40:43], v[100:103]
  ds_read_b128 v[68:71], v5 offset:18432
  ds_read_b64_tr_b16 v[72:73], v8 offset:17408
  v_mfma_f32_16x16x32_bf16 v[104:107], v[32:35], v[44:47], v[104:107]
  ds_read_b64_tr_b16 v[74:75], v8 offset:19712
  ds_read_b64_tr_b16 v[76:77], v8 offset:17440
  v_mfma_f32_16x16x32_bf16 v[108:111], v[36:39], v[44:47], v[108:111]
  ds_read_b64_tr_b16 v[78:79], v8 offset:19744
  v_mfma_f32_16x16x32_bf16 v[112:115], v[32:35], v[48:51], v[112:115]
  ds_read_b64_tr_b16 v[80:81], v8 offset:17472
  ds_read_b64_tr_b16 v[82:83], v8 offset:19776
  v_mfma_f32_16x16x32_bf16 v[116:119], v[36:39], v[48:51], v[116:119]
  ds_read_b64_tr_b16 v[84:85], v8 offset:17504
  ds_read_b64_tr_b16 v[86:87], v8 offset:19808
  v_mfma_f32_16x16x32_bf16 v[120:123], v[32:35], v[52:55], v[120:123]
  ds_read_b64_tr_b16 v[92:93], v11 offset:17408
  v_mfma_f32_16x16x32_bf16 v[124:127], v[36:39], v[52:55], v[124:127]
  ds_read_b64_tr_b16 v[94:95], v11 offset:19712
  s_add_u32 m0, s29, 139264
  v_mfma_f32_16x16x32_bf16 v[136:139], v[20:23], v[60:63], v[136:139]
  s_nop 0
  buffer_load_dwordx4 v1, s[4:7], s26 offen lds
  v_mfma_f32_16x16x32_bf16 v[140:143], v[32:35], v[32:35], v[140:143]
  s_add_u32 m0, s30, 139264
  v_mfma_f32_16x16x32_bf16 v[148:151], v[20:23], v[32:35], v[148:151]
  s_add_u32 s26, s26, 64
  buffer_load_dwordx4 v2, s[8:11], s27 offen lds
  v_mfma_f32_16x16x32_bf16 v[144:147], v[36:39], v[36:39], v[144:147]
  s_add_u32 m0, s53, 139264
  s_cmp_eq_u32 s26, 1152
  s_cselect_b32 s26, 0, s26
  v_mfma_f32_16x16x32_bf16 v[152:155], v[20:23], v[36:39], v[152:155]
  buffer_load_dword v3, s[8:11], s27 offen lds
  s_add_u32 s27, s27, s28
  s_cmp_eq_u32 s26, 0
  s_cselect_b32 s27, 0, s27
  s_waitcnt lgkmcnt(0)
  v_mfma_f32_16x16x32_bf16 v[96:99], v[64:67], v[72:75], v[96:99]
  v_mfma_f32_16x16x32_bf16 v[100:103], v[68:71], v[72:75], v[100:103]
  ds_read_b128 v[32:35], v5 offset:34816
  v_mfma_f32_16x16x32_bf16 v[104:107], v[64:67], v[76:79], v[104:107]
  ds_read_b128 v[36:39], v5 offset:35840
  v_mfma_f32_16x16x32_bf16 v[108:111], v[68:71], v[76:79], v[108:111]
  ds_read_b64_tr_b16 v[40:41], v8 offset:34816
  v_mfma_f32_16x16x32_bf16 v[112:115], v[64:67], v[80:83], v[112:115]
  ds_read_b64_tr_b16 v[42:43], v8 offset:37120
  v_mfma_f32_16x16x32_bf16 v[116:119], v[68:71], v[80:83], v[116:119]
  ds_read_b64_tr_b16 v[44:45], v8 offset:34848
  v_mfma_f32_16x16x32_bf16 v[120:123], v[64:67], v[84:87], v[120:123]
  ds_read_b64_tr_b16 v[46:47], v8 offset:37152
  v_mfma_f32_16x16x32_bf16 v[124:127], v[68:71], v[84:87], v[124:127]
  ds_read_b64_tr_b16 v[48:49], v8 offset:34880
  v_mfma_f32_16x16x32_bf16 v[136:139], v[20:23], v[92:95], v[136:139]
  ds_read_b64_tr_b16 v[50:51], v8 offset:37184
  v_mfma_f32_16x16x32_bf16 v[140:143], v[64:67], v[64:67], v[140:143]
  ds_read_b64_tr_b16 v[52:53], v8 offset:34912
  v_mfma_f32_16x16x32_bf16 v[148:151], v[20:23], v[64:67], v[148:151]
  ds_read_b64_tr_b16 v[54:55], v8 offset:37216
  v_mfma_f32_16x16x32_bf16 v[144:147], v[68:71], v[68:71], v[144:147]
  ds_read_b64_tr_b16 v[60:61], v11 offset:34816
  v_mfma_f32_16x16x32_bf16 v[152:155], v[20:23], v[68:71], v[152:155]
  ds_read_b64_tr_b16 v[62:63], v11 offset:37120
  s_waitcnt lgkmcnt(0)
  s_waitcnt vmcnt(3)
  s_barrier
  v_mfma_f32_16x16x32_bf16 v[96:99], v[32:35], v[40:43], v[96:99]
  v_mfma_f32_16x16x32_bf16 v[100:103], v[36:39], v[40:43], v[100:103]
  ds_read_b128 v[64:67], v6 offset:0
  v_mfma_f32_16x16x32_bf16 v[104:107], v[32:35], v[44:47], v[104:107]
  ds_read_b128 v[68:71], v6 offset:1024
  v_mfma_f32_16x16x32_bf16 v[108:111], v[36:39], v[44:47], v[108:111]
  ds_read_b64_tr_b16 v[72:73], v9 offset:0
  v_mfma_f32_16x16x32_bf16 v[112:115], v[32:35], v[48:51], v[112:115]
  ds_read_b64_tr_b16 v[74:75], v9 offset:2304
  v_mfma_f32_16x16x32_bf16 v[116:119], v[36:39], v[48:51], v[116:119]
  ds_read_b64_tr_b16 v[76:77], v9 offset:32
  v_mfma_f32_16x16x32_bf16 v[120:123], v[32:35], v[52:55], v[120:123]
  ds_read_b64_tr_b16 v[78:79], v9 offset:2336
  v_mfma_f32_16x16x32_bf16 v[124:127], v[36:39], v[52:55], v[124:127]
  ds_read_b64_tr_b16 v[80:81], v9 offset:64
  v_mfma_f32_16x16x32_bf16 v[136:139], v[20:23], v[60:63], v[136:139]
  ds_read_b64_tr_b16 v[82:83], v9 offset:2368
  v_mfma_f32_16x16x32_bf16 v[140:143], v[32:35], v[32:35], v[140:143]
  ds_read_b64_tr_b16 v[84:85], v9 offset:96
  v_mfma_f32_16x16x32_bf16 v[148:151], v[20:23], v[32:35], v[148:151]
  ds_read_b64_tr_b16 v[86:87], v9 offset:2400
  v_mfma_f32_16x16x32_bf16 v[144:147], v[36:39], v[36:39], v[144:147]
  ds_read_b64_tr_b16 v[92:93], v12 offset:0
  v_mfma_f32_16x16x32_bf16 v[152:155], v[20:23], v[36:39], v[152:155]
  ds_read_b64_tr_b16 v[94:95], v12 offset:2304
  s_waitcnt lgkmcnt(0)
  v_mfma_f32_16x16x32_bf16 v[96:99], v[64:67], v[72:75], v[96:99]
  v_mfma_f32_16x16x32_bf16 v[100:103], v[68:71], v[72:75], v[100:103]
  ds_read_b128 v[32:35], v6 offset:17408
  v_mfma_f32_16x16x32_bf16 v[104:107], v[64:67], v[76:79], v[104:107]
  ds_read_b128 v[36:39], v6 offset:18432
  v_mfma_f32_16x16x32_bf16 v[108:111], v[68:71], v[76:79], v[108:111]
  ds_read_b64_tr_b16 v[40:41], v9 offset:17408
  v_mfma_f32_16x16x32_bf16 v[112:115], v[64:67], v[80:83], v[112:115]
  ds_read_b64_tr_b16 v[42:43], v9 offset:19712
  v_mfma_f32_16x16x32_bf16 v[116:119], v[68:71], v[80:83], v[116:119]
  ds_read_b64_tr_b16 v[44:45], v9 offset:17440
  v_mfma_f32_16x16x32_bf16 v[120:123], v[64:67], v[84:87], v[120:123]
  ds_read_b64_tr_b16 v[46:47], v9 offset:19744
  v_mfma_f32_16x16x32_bf16 v[124:127], v[68:71], v[84:87], v[124:127]
  ds_read_b64_tr_b16 v[48:49], v9 offset:17472
  v_mfma_f32_16x16x32_bf16 v[136:139], v[20:23], v[92:95], v[136:139]
  ds_read_b64_tr_b16 v[50:51], v9 offset:19776
  v_mfma_f32_16x16x32_bf16 v[140:143], v[64:67], v[64:67], v[140:143]
  ds_read_b64_tr_b16 v[52:53], v9 offset:17504
  v_mfma_f32_16x16x32_bf16 v[148:151], v[20:23], v[64:67], v[148:151]
  ds_read_b64_tr_b16 v[54:55], v9 offset:19808
  v_mfma_f32_16x16x32_bf16 v[144:147], v[68:71], v[68:71], v[144:147]
  ds_read_b64_tr_b16 v[60:61], v12 offset:17408
  v_mfma_f32_16x16x32_bf16 v[152:155], v[20:23], v[68:71], v[152:155]
  ds_read_b64_tr_b16 v[62:63], v12 offset:19712
  s_waitcnt lgkmcnt(0)
  s_waitcnt vmcnt(0)
  s_barrier
  v_mfma_f32_16x16x32_bf16 v[96:99], v[32:35], v[40:43], v[96:99]
  ds_read_b128 v[64:67], v6 offset:34816
  v_mfma_f32_16x16x32_bf16 v[100:103], v[36:39], v[40:43], v[100:103]
  ds_read_b128 v[68:71], v6 offset:35840
  ds_read_b64_tr_b16 v[72:73], v9 offset:34816
  v_mfma_f32_16x16x32_bf16 v[104:107], v[32:35], v[44:47], v[104:107]
  ds_read_b64_tr_b16 v[74:75], v9 offset:37120
  v_mfma_f32_16x16x32_bf16 v[108:111], v[36:39], v[44:47], v[108:111]
  ds_read_b64_tr_b16 v[76:77], v9 offset:34848
  ds_read_b64_tr_b16 v[78:79], v9 offset:37152
  v_mfma_f32_16x16x32_bf16 v[112:115], v[32:35], v[48:51], v[112:115]
  ds_read_b64_tr_b16 v[80:81], v9 offset:34880
  ds_read_b64_tr_b16 v[82:83], v9 offset:37184
  v_mfma_f32_16x16x32_bf16 v[116:119], v[36:39], v[48:51], v[116:119]
  ds_read_b64_tr_b16 v[84:85], v9 offset:34912
  v_mfma_f32_16x16x32_bf16 v[120:123], v[32:35], v[52:55], v[120:123]
  ds_read_b64_tr_b16 v[86:87], v9 offset:37216
  ds_read_b64_tr_b16 v[92:93], v12 offset:34816
  v_mfma_f32_16x16x32_bf16 v[124:127], v[36:39], v[52:55], v[124:127]
  ds_read_b64_tr_b16 v[94:95], v12 offset:37120
  v_mfma_f32_16x16x32_bf16 v[136:139], v[20:23], v[60:63], v[136:139]
  buffer_load_dwordx4 v[24:27], v17, s[16:19], s52 offen
  buffer_load_dwordx4 v[28:31], v18, s[16:19], s52 offen offset:1024
  v_mfma_f32_16x16x32_bf16 v[140:143], v[32:35], v[32:35], v[140:143]
  s_mov_b32 s58, 663552
  s_mov_b32 s59, 0x20000
  s_sub_u32 s42, s52, 3456
  buffer_load_dwordx4 v[216:219], v18, s[56:59], s42 offen offset:1024
  v_mfma_f32_16x16x32_bf16 v[148:151], v[20:23], v[32:35], v[148:151]
  s_mul_i32 s42, s46, 20736
  v_mfma_f32_16x16x32_bf16 v[144:147], v[36:39], v[36:39], v[144:147]
  v_lshlrev_b32 v211, 4, v0
  buffer_load_dwordx4 v[212:215], v211, s[16:19], s42 offen
  s_add_u32 s42, s42, 8192
  v_mfma_f32_16x16x32_bf16 v[152:155], v[20:23], v[36:39], v[152:155]
  buffer_load_dwordx4 v[212:215], v211, s[16:19], s42 offen
  s_add_u32 s42, s42, 8192
  buffer_load_dwordx4 v[212:215], v211, s[16:19], s42 offen
  s_add_u32 s42, s42, 8192
  s_waitcnt lgkmcnt(0)
  v_mfma_f32_16x16x32_bf16 v[96:99], v[64:67], v[72:75], v[96:99]
  v_mfma_f32_16x16x32_bf16 v[100:103], v[68:71], v[72:75], v[100:103]
  v_mfma_f32_16x16x32_bf16 v[104:107], v[64:67], v[76:79], v[104:107]
  v_mfma_f32_16x16x32_bf16 v[108:111], v[68:71], v[76:79], v[108:111]
  v_mfma_f32_16x16x32_bf16 v[112:115], v[64:67], v[80:83], v[112:115]
  v_mfma_f32_16x16x32_bf16 v[116:119], v[68:71], v[80:83], v[116:119]
  v_mfma_f32_16x16x32_bf16 v[120:123], v[64:67], v[84:87], v[120:123]
  v_mfma_f32_16x16x32_bf16 v[124:127], v[68:71], v[84:87], v[124:127]
  v_mfma_f32_16x16x32_bf16 v[136:139], v[20:23], v[92:95], v[136:139]
  v_mfma_f32_16x16x32_bf16 v[140:143], v[64:67], v[64:67], v[140:143]
  v_mfma_f32_16x16x32_bf16 v[148:151], v[20:23], v[64:67], v[148:151]
  v_mfma_f32_16x16x32_bf16 v[144:147], v[68:71], v[68:71], v[144:147]
  v_mfma_f32_16x16x32_bf16 v[152:155], v[20:23], v[68:71], v[152:155]
  s_add_u32 s31, s49, 17
  s_sub_u32 s50, s31, 18
  s_cselect_b32 s31, s31, s50
  s_lshl_b32 s31, s31, 17
  s_add_u32 s31, s31, s51
  buffer_store_dwordx4 v[68:71], v210, s[12:15], s31 offen sc1
  s_and_b32 s31, s24, 13
  s_cmp_lg_u32 s31, 0
  s_cbranch_scc1 Lnx_19
  s_add_u32 s31, s49, 16
  s_sub_u32 s50, s31, 18
  s_cselect_b32 s31, s31, s50
  s_lshl_b32 s31, s31, 17
  s_add_u32 s31, s31, s51
  buffer_store_dwordx4 v[36:39], v210, s[12:15], s31 offen sc1
Lnx_19:
  v_and_b32 v14, 15, v13
  s_mul_i32 s31, s22, 5
  s_add_u32 s31, s31, s21
  s_lshl_b32 s31, s31, 4
  v_add_u32 v15, s31, v14
  v_lshlrev_b32 v15, 2, v15
  v_lshlrev_b32 v16, 2, v14
  v_add_u32 v15, 157696, v15
  v_add_u32 v16, 157952, v16
  s_lshl_b32 s31, s21, 5
  v_add_u32 v156, s31, v14
  v_lshlrev_b32 v156, 2, v156
  v_add_u32 v157, 156672, v156
  s_nop 1
  ds_write_b32 v15, v136
  v_cndmask_b32 v140, v140, v141, s[34:35]
  v_cndmask_b32 v140, v140, v142, s[36:37]
  v_cndmask_b32 v140, v140, v143, s[38:39]
  v_mul_f32 v148, 0x3ae38e39, v148
  v_mul_f32 v140, 0x3ae38e39, v140
  v_fma_f32 v140, -v148, v148, v140
  v_max_f32 v140, 0, v140
  v_add_f32 v141, 0x3727c5ac, v140
  v_rsq_f32 v141, v141
  v_cndmask_b32 v144, v144, v145, s[34:35]
  v_cndmask_b32 v144, v144, v146, s[36:37]
  v_cndmask_b32 v144, v144, v147, s[38:39]
  v_mul_f32 v152, 0x3ae38e39, v152
  v_mul_f32 v144, 0x3ae38e39, v144
  v_fma_f32 v144, -v152, v152, v144
  v_max_f32 v144, 0, v144
  v_add_f32 v145, 0x3727c5ac, v144
  v_rsq_f32 v145, v145
  s_nop 0
  s_mov_b64 exec, s[40:41]
  ds_write_b32 v157, v148 offset:0
  ds_write_b32 v157, v141 offset:512
  ds_write_b32 v157, v152 offset:64
  ds_write_b32 v157, v145 offset:576
  s_mov_b64 exec, -1
  s_waitcnt lgkmcnt(0)
  s_barrier
  v_lshrrev_b32 v14, 4, v13
  v_lshlrev_b32 v14, 4, v14
  s_lshl_b32 s31, s21, 7
  s_add_u32 s31, s31, 156672
  v_add_u32 v14, s31, v14
  v_and_b32 v15, 15, v13
  v_lshlrev_b32 v16, 2, v15
  v_add_u32 v16, 158016, v16
  ds_read_b128 v[164:167], v14 offset:0
  ds_read_b128 v[172:175], v14 offset:512
  ds_read_b128 v[168:171], v14 offset:64
  ds_read_b128 v[176:179], v14 offset:576
  ds_read_b32 v180, v16 offset:0
  ds_read_b32 v181, v16 offset:64
  ds_read_b32 v182, v16 offset:128
  ds_read_b32 v183, v16 offset:192
  v_lshrrev_b32 v14, 4, v13
  v_mul_u32_u24 v14, 320, v14
  s_lshl_b32 s31, s23, 2
  s_add_u32 s31, s31, s21
  s_mul_i32 s31, s31, 1280
  s_mul_i32 s42, s47, 655360
  s_add_u32 s31, s31, s42
  s_add_u32 s31, s31, 11796480
  s_mov_b32 s42, 81632
  v_add_u32 v196, 80, v15
  v_mul_u32_u24 v16, 3641, v196
  v_lshrrev_b32 v16, 16, v16
  v_lshl_add_u32 v196, v196, 4, v14
  v_mad_u32_u24 v196, v16, s42, v196
  v_add_u32 v197, 96, v15
  v_mul_u32_u24 v16, 3641, v197
  v_lshrrev_b32 v16, 16, v16
  v_lshl_add_u32 v197, v197, 4, v14
  v_mad_u32_u24 v197, v16, s42, v197
  v_add_u32 v198, 112, v15
  v_mul_u32_u24 v16, 3641, v198
  v_lshrrev_b32 v16, 16, v16
  v_lshl_add_u32 v198, v198, 4, v14
  v_mad_u32_u24 v198, v16, s42, v198
  v_add_u32 v199, 128, v15
  v_mul_u32_u24 v16, 3641, v199
  v_lshrrev_b32 v16, 16, v16
  v_lshl_add_u32 v199, v199, 4, v14
  v_mad_u32_u24 v199, v16, s42, v199
  v_bfe_u32 v14, v13, 2, 3
  v_mul_u32_u24 v14, 81920, v14
  v_and_b32 v16, 3, v13
  v_mul_u32_u24 v16, 320, v16
  v_add_u32 v14, v14, v16
  v_lshrrev_b32 v16, 5, v13
  v_lshl_add_u32 v14, v16, 4, v14
  s_mov_b32 exec_lo, 0
  v_mov_b32 v20, 0
  v_mov_b32 v21, 0
  v_mov_b32 v22, 0
  v_mov_b32 v23, 0
  s_mov_b32 exec_lo, -1
  buffer_store_dwordx4 v[20:23], v14, s[12:15], s31 offen offset:288 sc1
  s_waitcnt lgkmcnt(0)
  v_fma_f32 v96, -v164, v180, v96
  v_mul_f32 v96, v172, v96
  v_fma_f32 v97, -v165, v180, v97
  v_mul_f32 v97, v173, v97
  v_fma_f32 v98, -v166, v180, v98
  v_mul_f32 v98, v174, v98
  v_fma_f32 v99, -v167, v180, v99
  v_mul_f32 v99, v175, v99
  v_cvt_pk_bf16_f32 v188, v96, v97
  v_cvt_pk_bf16_f32 v189, v98, v99
  v_fma_f32 v100, -v168, v180, v100
  v_mul_f32 v100, v176, v100
  v_fma_f32 v101, -v169, v180, v101
  v_mul_f32 v101, v177, v101
  v_fma_f32 v102, -v170, v180, v102
  v_mul_f32 v102, v178, v102
  v_fma_f32 v103, -v171, v180, v103
  v_mul_f32 v103, v179, v103
  v_cvt_pk_bf16_f32 v190, v100, v101
  v_cvt_pk_bf16_f32 v191, v102, v103
  s_nop 1
  v_permlane32_swap_b32 v188, v190
  v_permlane32_swap_b32 v189, v191
  buffer_store_dwordx4 v[188:191], v196, s[12:15], s31 offen sc1
  v_fma_f32 v104, -v164, v181, v104
  v_mul_f32 v104, v172, v104
  v_fma_f32 v105, -v165, v181, v105
  v_mul_f32 v105, v173, v105
  v_fma_f32 v106, -v166, v181, v106
  v_mul_f32 v106, v174, v106
  v_fma_f32 v107, -v167, v181, v107
  v_mul_f32 v107, v175, v107
  v_cvt_pk_bf16_f32 v192, v104, v105
  v_cvt_pk_bf16_f32 v193, v106, v107
  v_fma_f32 v108, -v168, v181, v108
  v_mul_f32 v108, v176, v108
  v_fma_f32 v109, -v169, v181, v109
  v_mul_f32 v109, v177, v109
  v_fma_f32 v110, -v170, v181, v110
  v_mul_f32 v110, v178, v110
  v_fma_f32 v111, -v171, v181, v111
  v_mul_f32 v111, v179, v111
  v_cvt_pk_bf16_f32 v194, v108, v109
  v_cvt_pk_bf16_f32 v195, v110, v111
  s_nop 1
  v_permlane32_swap_b32 v192, v194
  v_permlane32_swap_b32 v193, v195
  buffer_store_dwordx4 v[192:195], v197, s[12:15], s31 offen sc1
  v_fma_f32 v112, -v164, v182, v112
  v_mul_f32 v112, v172, v112
  v_fma_f32 v113, -v165, v182, v113
  v_mul_f32 v113, v173, v113
  v_fma_f32 v114, -v166, v182, v114
  v_mul_f32 v114, v174, v114
  v_fma_f32 v115, -v167, v182, v115
  v_mul_f32 v115, v175, v115
  v_cvt_pk_bf16_f32 v188, v112, v113
  v_cvt_pk_bf16_f32 v189, v114, v115
  v_fma_f32 v116, -v168, v182, v116
  v_mul_f32 v116, v176, v116
  v_fma_f32 v117, -v169, v182, v117
  v_mul_f32 v117, v177, v117
  v_fma_f32 v118, -v170, v182, v118
  v_mul_f32 v118, v178, v118
  v_fma_f32 v119, -v171, v182, v119
  v_mul_f32 v119, v179, v119
  v_cvt_pk_bf16_f32 v190, v116, v117
  v_cvt_pk_bf16_f32 v191, v118, v119
  s_nop 1
  v_permlane32_swap_b32 v188, v190
  v_permlane32_swap_b32 v189, v191
  buffer_store_dwordx4 v[188:191], v198, s[12:15], s31 offen sc1
  v_fma_f32 v120, -v164, v183, v120
  v_mul_f32 v120, v172, v120
  v_fma_f32 v121, -v165, v183, v121
  v_mul_f32 v121, v173, v121
  v_fma_f32 v122, -v166, v183, v122
  v_mul_f32 v122, v174, v122
  v_fma_f32 v123, -v167, v183, v123
  v_mul_f32 v123, v175, v123
  v_cvt_pk_bf16_f32 v192, v120, v121
  v_cvt_pk_bf16_f32 v193, v122, v123
  v_fma_f32 v124, -v168, v183, v124
  v_mul_f32 v124, v176, v124
  v_fma_f32 v125, -v169, v183, v125
  v_mul_f32 v125, v177, v125
  v_fma_f32 v126, -v170, v183, v126
  v_mul_f32 v126, v178, v126
  v_fma_f32 v127, -v171, v183, v127
  v_mul_f32 v127, v179, v127
  v_cvt_pk_bf16_f32 v194, v124, v125
  v_cvt_pk_bf16_f32 v195, v126, v127
  s_nop 1
  v_permlane32_swap_b32 v192, v194
  v_permlane32_swap_b32 v193, v195
  buffer_store_dwordx4 v[192:195], v199, s[12:15], s31 offen sc1
  s_branch Lbarjob_10
Lbarjob_10:
  s_cmp_ge_u32 s20, 3
  s_cbranch_scc1 Lwox_23
  s_waitcnt vmcnt(0)
  v_mov_b32 v157, 0
  v_mov_b32 v164, v28
  v_mov_b32 v165, v29
  v_mov_b32 v166, v30
  v_mov_b32 v167, v31
  v_lshlrev_b32 v156, 16, v24
  v_and_b32 v24, 0xffff0000, v24
  v_add_f32 v157, v157, v156
  v_add_f32 v157, v157, v24
  v_lshlrev_b32 v156, 16, v25
  v_and_b32 v25, 0xffff0000, v25
  v_add_f32 v157, v157, v156
  v_add_f32 v157, v157, v25
  v_lshlrev_b32 v156, 16, v26
  v_and_b32 v26, 0xffff0000, v26
  v_add_f32 v157, v157, v156
  v_add_f32 v157, v157, v26
  v_lshlrev_b32 v156, 16, v27
  v_and_b32 v27, 0xffff0000, v27
  v_add_f32 v157, v157, v156
  v_add_f32 v157, v157, v27
  v_lshlrev_b32 v156, 16, v28
  v_and_b32 v28, 0xffff0000, v28
  v_add_f32 v157, v157, v156
  v_add_f32 v157, v157, v28
  v_lshlrev_b32 v156, 16, v29
  v_and_b32 v29, 0xffff0000, v29
  v_add_f32 v157, v157, v156
  v_add_f32 v157, v157, v29
  v_lshlrev_b32 v156, 16, v30
  v_and_b32 v30, 0xffff0000, v30
  v_add_f32 v157, v157, v156
  v_add_f32 v157, v157, v30
  v_lshlrev_b32 v156, 16, v31
  v_and_b32 v31, 0xffff0000, v31
  v_add_f32 v157, v157, v156
  v_add_f32 v157, v157, v31
  s_nop 1
  v_add_f32_dpp v157, v157, v157 quad_perm:[1,0,3,2] row_mask:0xf bank_mask:0xf
  s_nop 1
  v_add_f32_dpp v157, v157, v157 quad_perm:[2,3,0,1] row_mask:0xf bank_mask:0xf
  s_nop 1
  v_add_f32_dpp v157, v157, v157 row_half_mirror row_mask:0xf bank_mask:0xf
  s_nop 1
  v_add_f32_dpp v157, v157, v157 row_mirror row_mask:0xf bank_mask:0xf
  v_mov_b32 v156, v157
  s_nop 1
  v_permlane16_swap_b32 v157, v156
  v_add_f32 v157, v157, v156
  v_mov_b32 v156, v157
  s_nop 1
  v_permlane32_swap_b32 v157, v156
  v_add_f32 v157, v157, v156
  v_mul_f32 v157, 0x3ae38e39, v157
  v_cvt_pk_bf16_f32 v156, v157, v157
  v_and_b32 v158, 0xffff0000, v156
  v_sub_f32 v158, v157, v158
  v_cvt_pk_bf16_f32 v160, v157, v158
  s_lshl_b32 s31, s44, 5
  s_add_u32 s31, s31, 14438400
  v_mov_b32 v161, 0
  v_mov_b32 v162, 0
  v_mov_b32 v163, 0
  v_mul_u32_u24 v159, 18432, v13
  s_mov_b64 exec, 0xff
  buffer_store_dwordx4 v[164:167], v159, s[12:15], s31 offen
  buffer_store_dwordx4 v[160:163], v159, s[12:15], s31 offen offset:16
  s_branch Ldone_1
Lwox_23:
  s_cmp_ge_u32 s20, 6
  s_cbranch_scc1 Ldone_1
  s_sub_u32 s31, s44, 3
  s_mul_i32 s50, s31, 3641
  s_lshr_b32 s50, s50, 16
  s_mul_i32 s49, s50, 18
  s_sub_u32 s49, s31, s49
  s_and_b32 s31, s49, 3
  s_and_b32 s42, s49, 4
  s_lshl_b32 s42, s42, 1
  s_add_u32 s31, s31, s42
  s_and_b32 s42, s49, 8
  s_lshr_b32 s42, s42, 1
  s_add_u32 s31, s31, s42
  s_lshl_b32 s42, s50, 4
  s_add_u32 s31, s31, s42
  s_lshl_b32 s42, s50, 1
  s_add_u32 s42, s42, s49
  s_add_u32 s42, s42, 496
  s_cmp_ge_u32 s49, 16
  s_cselect_b32 s31, s42, s31
  s_lshl_b32 s31, s31, 4
  s_add_u32 s31, s31, 14585856
  v_mul_u32_u24 v159, 9216, v13
  s_waitcnt vmcnt(0)
  s_mov_b64 exec, 0xff
  buffer_store_dwordx4 v[216:219], v159, s[12:15], s31 offen
Ldone_1:
Ldone2_2:
  s_endpgm
.text
.globl main_kernel
.p2align 8
.type main_kernel,@function
main_kernel:
  s_cmp_lt_u32 s2, 512
  s_cbranch_scc1 Lgo_24
  s_endpgm
Lgo_24:
  s_and_b32 s3, s2, 255
  s_cmp_ge_u32 s2, 256
  s_cbranch_scc1 Lmlprole_25
  s_setprio 3
  s_load_dwordx2 s[12:13], s[0:1], 80
  v_lshrrev_b32 v6, 6, v0
  v_and_b32 v1, 63, v0
  v_readfirstlane_b32 s20, v6
  s_and_b32 s21, s3, 7
  s_lshl_b32 s21, s21, 2
  s_bfe_u32 s27, s3, 0x20003
  s_add_u32 s21, s21, s27
  s_lshr_b32 s22, s3, 5
  s_mul_i32 s27, s21, 18
  s_and_b32 s23, s27, 7
  s_lshr_b32 s27, s27, 3
  s_lshl_b32 s27, s27, 15
  s_add_u32 s32, s27, 2359296
  s_mul_i32 s33, s21, 81920
  s_add_u32 s33, s33, 11796480
  v_lshlrev_b32 v2, 4, v0
  s_lshl_b32 s26, s20, 10
  s_mov_b32 s14, 268435456
  s_mov_b32 s15, 0x20000
  s_mov_b32 s31, 0
  v_lshrrev_b32 v6, 5, v1
  v_and_b32 v7, 31, v1
  v_lshlrev_b32 v9, 15, v6
  v_lshl_add_u32 v9, v7, 4, v9
  v_lshlrev_b32 v8, 4, v7
  v_lshl_add_u32 v8, v6, 3, v8
  s_lshl_b32 s27, s22, 2
  s_add_u32 s27, s27, s20
  s_lshl_b32 s27, s27, 10
  s_add_u32 s27, s27, s32
  s_sub_u32 s27, s27, 2359296
  s_mov_b32 s24, s32
  s_mov_b32 s25, s33
  s_waitcnt lgkmcnt(0)
  s_add_u32 m0, s26, 0
  s_add_u32 s28, s24, 0
  buffer_load_dwordx4 v2, s[12:15], s28 offen lds
  s_add_u32 m0, s26, 4096
  s_add_u32 s28, s24, 32768
  buffer_load_dwordx4 v2, s[12:15], s28 offen lds
  s_add_u32 m0, s26, 8192
  s_add_u32 s28, s24, 65536
  buffer_load_dwordx4 v2, s[12:15], s28 offen lds
  s_add_u32 m0, s26, 12288
  s_add_u32 s28, s25, 0
  buffer_load_dwordx4 v2, s[12:15], s28 offen lds
  s_add_u32 m0, s26, 16384
  s_add_u32 s28, s25, 4096
  buffer_load_dwordx4 v2, s[12:15], s28 offen lds
  s_cmp_ge_u32 s20, 2
  s_cbranch_scc1 Lv3_26
  s_add_u32 m0, s26, 20480
  s_add_u32 s28, s25, 8192
  buffer_load_dwordx4 v2, s[12:15], s28 offen lds
Lv3_26:
  s_add_u32 s24, s24, 4096
  s_add_u32 s25, s25, 10240
  buffer_load_dwordx4 v[12:15], v9, s[12:15], s27 offen
  buffer_load_dwordx4 v[16:19], v9, s[12:15], s27 offen offset:512
  s_add_u32 s27, s27, 65536
  v_add_u32 v11, 8192, v8
  buffer_load_dwordx2 v[20:21], v8, s[12:15], s27 offen
  buffer_load_dwordx2 v[22:23], v8, s[12:15], s27 offen offset:512
  s_setprio 1
  v_lshlrev_b32 v10, 12, v6
  v_lshl_add_u32 v10, v7, 4, v10
  v_min_u32 v8, 19, v7
  v_mul_u32_u24 v60, 320, v6
  v_add_u32 v60, 12288, v60
  v_lshl_add_u32 v60, v8, 4, v60
  v_mov_b32 v61, 0x7f800000
  v_mov_b32 v8, 45056
  v_mov_b32 v7, 0
  ds_write_b32 v8, v7
  v_mov_b32 v128, 0
  v_mov_b32 v129, 0
  v_mov_b32 v130, 0
  v_mov_b32 v131, 0
  v_mov_b32 v132, 0
  v_mov_b32 v133, 0
  v_mov_b32 v134, 0
  v_mov_b32 v135, 0
  v_mov_b32 v136, 0
  v_mov_b32 v137, 0
  v_mov_b32 v138, 0
  v_mov_b32 v139, 0
  v_mov_b32 v140, 0
  v_mov_b32 v141, 0
  v_mov_b32 v142, 0
  v_mov_b32 v143, 0
  v_mov_b32 v144, 0
  v_mov_b32 v145, 0
  v_mov_b32 v146, 0
  v_mov_b32 v147, 0
  v_mov_b32 v148, 0
  v_mov_b32 v149, 0
  v_mov_b32 v150, 0
  v_mov_b32 v151, 0
  v_mov_b32 v152, 0
  v_mov_b32 v153, 0
  v_mov_b32 v154, 0
  v_mov_b32 v155, 0
  v_mov_b32 v156, 0
  v_mov_b32 v157, 0
  v_mov_b32 v158, 0
  v_mov_b32 v159, 0
  s_load_dwordx4 s[48:51], s[0:1], 48
  s_load_dwordx2 s[16:17], s[0:1], 16
  s_mov_b32 s18, 663552
  s_mov_b32 s19, 0x20000
  s_lshr_b32 s60, s3, 3
  s_lshl_b32 s60, s60, 2
  s_add_u32 s60, s60, s20
  s_mul_i32 s60, s60, 384
  v_add_u32 v163, s60, v1
  s_and_b32 s60, s3, 1
  s_lshl_b32 s60, s60, 2
  s_bfe_u32 s61, s3, 0x20001
  s_add_u32 s60, s60, s61
  s_mul_i32 s61, s60, 1152
  s_mul_i32 s62, s60, 663552
  s_waitcnt lgkmcnt(0)
  s_mov_b32 s52, s50
  s_mov_b32 s53, s51
  s_mov_b32 s50, 5308416
  s_mov_b32 s51, 0x20000
  s_add_u32 s54, s62, 663552
  s_mov_b32 s55, 0x20000
  s_mov_b32 s56, 58255
  v_lshlrev_b32 v7, 3, v6
  v_lshlrev_b32 v6, 2, v6
  s_waitcnt vmcnt(0)
  v_add_u32 v8, 0, v7
  v_cmp_le_u32 vcc, s23, v8
  s_nop 1
  v_cndmask_b32 v12, 0, v12, vcc
  v_cndmask_b32 v16, 0, v16, vcc
  v_add_u32 v8, 2, v7
  v_cmp_le_u32 vcc, s23, v8
  s_nop 1
  v_cndmask_b32 v13, 0, v13, vcc
  v_cndmask_b32 v17, 0, v17, vcc
  v_add_u32 v8, 4, v7
  v_cmp_le_u32 vcc, s23, v8
  s_nop 1
  v_cndmask_b32 v14, 0, v14, vcc
  v_cndmask_b32 v18, 0, v18, vcc
  v_add_u32 v8, 6, v7
  v_cmp_le_u32 vcc, s23, v8
  s_nop 1
  v_cndmask_b32 v15, 0, v15, vcc
  v_cndmask_b32 v19, 0, v19, vcc
  v_add_u32 v8, 0, v6
  v_cmp_ge_u32 vcc, s23, v8
  s_nop 1
  v_cndmask_b32 v20, 0, v20, vcc
  v_cndmask_b32 v22, 0, v22, vcc
  v_add_u32 v8, 2, v6
  v_cmp_ge_u32 vcc, s23, v8
  s_nop 1
  v_cndmask_b32 v21, 0, v21, vcc
  v_cndmask_b32 v23, 0, v23, vcc
Lastart_27:
  s_waitcnt lgkmcnt(0)
  s_barrier
  s_add_u32 s27, s26, 22528
  s_add_u32 m0, s27, 0
  s_add_u32 s28, s24, 0
  buffer_load_dwordx4 v2, s[12:15], s28 offen lds
  s_add_u32 m0, s27, 4096
  s_add_u32 s28, s24, 32768
  buffer_load_dwordx4 v2, s[12:15], s28 offen lds
  s_add_u32 m0, s27, 8192
  s_add_u32 s28, s24, 65536
  buffer_load_dwordx4 v2, s[12:15], s28 offen lds
  s_add_u32 m0, s27, 12288
  s_add_u32 s28, s25, 0
  buffer_load_dwordx4 v2, s[12:15], s28 offen lds
  s_add_u32 m0, s27, 16384
  s_add_u32 s28, s25, 4096
  buffer_load_dwordx4 v2, s[12:15], s28 offen lds
  s_cmp_ge_u32 s20, 2
  s_cbranch_scc1 Lv3_30
  s_add_u32 m0, s27, 20480
  s_add_u32 s28, s25, 8192
  buffer_load_dwordx4 v2, s[12:15], s28 offen lds
Lv3_30:
  s_add_u32 s24, s24, 4096
  s_add_u32 s25, s25, 10240
  v_mov_b32 v3, v10
  v_mov_b32 v4, v11
  v_mov_b32 v5, v60
  ds_read_b128 v[24:27], v3 offset:0
  ds_read_b64 v[32:33], v4 offset:0
  ds_read_b128 v[36:39], v5 offset:0
  ds_read_b128 v[40:43], v5 offset:640
  ds_read_b128 v[28:31], v3 offset:512
  ds_read_b64 v[34:35], v4 offset:512
  v_mov_b32 v96, 0
  v_mov_b32 v97, 0
  v_mov_b32 v98, 0
  v_mov_b32 v99, 0
  v_mov_b32 v100, 0
  v_mov_b32 v101, 0
  v_mov_b32 v102, 0
  v_mov_b32 v103, 0
  v_mov_b32 v104, 0
  v_mov_b32 v105, 0
  v_mov_b32 v106, 0
  v_mov_b32 v107, 0
  v_mov_b32 v108, 0
  v_mov_b32 v109, 0
  v_mov_b32 v110, 0
  v_mov_b32 v111, 0
  v_mov_b32 v112, 0
  v_mov_b32 v113, 0
  v_mov_b32 v114, 0
  v_mov_b32 v115, 0
  v_mov_b32 v116, 0
  v_mov_b32 v117, 0
  v_mov_b32 v118, 0
  v_mov_b32 v119, 0
  v_mov_b32 v120, 0
  v_mov_b32 v121, 0
  v_mov_b32 v122, 0
  v_mov_b32 v123, 0
  v_mov_b32 v124, 0
  v_mov_b32 v125, 0
  v_mov_b32 v126, 0
  v_mov_b32 v127, 0
  v_mov_b32 v52, 0
  v_mov_b32 v44, 0
  v_mov_b32 v53, 0
  v_mov_b32 v45, 0
  v_mov_b32 v54, 0
  v_mov_b32 v46, 0
  v_mov_b32 v55, 0
  v_mov_b32 v47, 0
  v_mov_b32 v56, 0
  v_mov_b32 v48, 0
  v_mov_b32 v57, 0
  v_mov_b32 v49, 0
  v_mov_b32 v58, 0
  v_mov_b32 v50, 0
  v_mov_b32 v59, 0
  v_mov_b32 v51, 0
  s_mov_b32 s29, 0
  s_mov_b32 s30, 22528
  s_waitcnt lgkmcnt(4)
  v_mfma_f32_32x32x8_bf16 v[64:79], v[32:33], v[20:21], v[128:143]
  v_mfma_f32_32x32x16_bf16 v[64:79], v[24:27], v[12:15], v[64:79]
  s_nop 7
  s_nop 3
.p2align 6
Laloop_28:
  v_exp_f32 v64, v64
  v_exp_f32 v65, v65
  v_exp_f32 v66, v66
  v_mfma_f32_32x32x16_bf16 v[112:127], v[48:51], v[56:59], v[112:127]
  ds_read_b128 v[44:47], v5 offset:1280
  ds_read_b128 v[48:51], v5 offset:1920
  v_cvt_pk_bf16_f32 v52, v64, v65
  v_exp_f32 v67, v67
  v_exp_f32 v68, v68
  v_cvt_pk_bf16_f32 v53, v66, v67
  v_exp_f32 v69, v69
  v_mfma_f32_32x32x8_bf16 v[80:95], v[32:33], v[22:23], v[144:159]
  v_exp_f32 v70, v70
  v_cvt_pk_bf16_f32 v54, v68, v69
  v_exp_f32 v71, v71
  v_exp_f32 v72, v72
  v_cvt_pk_bf16_f32 v55, v70, v71
  v_exp_f32 v73, v73
  v_mfma_f32_32x32x16_bf16 v[80:95], v[24:27], v[16:19], v[80:95]
  v_exp_f32 v74, v74
  v_cvt_pk_bf16_f32 v56, v72, v73
  v_exp_f32 v75, v75
  v_exp_f32 v76, v76
  v_cvt_pk_bf16_f32 v57, v74, v75
  s_waitcnt lgkmcnt(4)
  v_mfma_f32_32x32x16_bf16 v[96:111], v[36:39], v[52:55], v[96:111]
  v_exp_f32 v77, v77
  v_exp_f32 v78, v78
  v_exp_f32 v79, v79
  v_cvt_pk_bf16_f32 v58, v76, v77
  v_cvt_pk_bf16_f32 v59, v78, v79
  v_exp_f32 v80, v80
  v_exp_f32 v81, v81
  v_exp_f32 v82, v82
  v_mfma_f32_32x32x16_bf16 v[96:111], v[40:43], v[56:59], v[96:111]
  v_cvt_pk_bf16_f32 v52, v80, v81
  v_exp_f32 v83, v83
  v_exp_f32 v84, v84
  v_cvt_pk_bf16_f32 v53, v82, v83
  v_exp_f32 v85, v85
  s_waitcnt lgkmcnt(2)
  v_mfma_f32_32x32x8_bf16 v[64:79], v[34:35], v[20:21], v[128:143]
  v_exp_f32 v86, v86
  v_cvt_pk_bf16_f32 v54, v84, v85
  v_exp_f32 v87, v87
  v_exp_f32 v88, v88
  v_cvt_pk_bf16_f32 v55, v86, v87
  v_exp_f32 v89, v89
  v_mfma_f32_32x32x16_bf16 v[64:79], v[28:31], v[12:15], v[64:79]
  ds_read_b128 v[24:27], v3 offset:1024
  ds_read_b64 v[32:33], v4 offset:1024
  v_exp_f32 v90, v90
  v_cvt_pk_bf16_f32 v56, v88, v89
  v_exp_f32 v91, v91
  v_exp_f32 v92, v92
  v_cvt_pk_bf16_f32 v57, v90, v91
  v_mfma_f32_32x32x16_bf16 v[112:127], v[36:39], v[52:55], v[112:127]
  v_exp_f32 v93, v93
  v_exp_f32 v94, v94
  v_exp_f32 v95, v95
  v_cvt_pk_bf16_f32 v58, v92, v93
  v_cvt_pk_bf16_f32 v59, v94, v95
  v_exp_f32 v64, v64
  v_exp_f32 v65, v65
  v_exp_f32 v66, v66
  v_mfma_f32_32x32x16_bf16 v[112:127], v[40:43], v[56:59], v[112:127]
  ds_read_b128 v[36:39], v5 offset:2560
  ds_read_b128 v[40:43], v5 offset:3200
  v_cvt_pk_bf16_f32 v52, v64, v65
  v_exp_f32 v67, v67
  v_exp_f32 v68, v68
  v_cvt_pk_bf16_f32 v53, v66, v67
  v_exp_f32 v69, v69
  v_mfma_f32_32x32x8_bf16 v[80:95], v[34:35], v[22:23], v[144:159]
  v_exp_f32 v70, v70
  v_cvt_pk_bf16_f32 v54, v68, v69
  v_exp_f32 v71, v71
  v_exp_f32 v72, v72
  v_cvt_pk_bf16_f32 v55, v70, v71
  v_exp_f32 v73, v73
  v_mfma_f32_32x32x16_bf16 v[80:95], v[28:31], v[16:19], v[80:95]
  v_exp_f32 v74, v74
  v_cvt_pk_bf16_f32 v56, v72, v73
  v_exp_f32 v75, v75
  v_exp_f32 v76, v76
  v_cvt_pk_bf16_f32 v57, v74, v75
  s_waitcnt lgkmcnt(4)
  v_mfma_f32_32x32x16_bf16 v[96:111], v[44:47], v[52:55], v[96:111]
  v_exp_f32 v77, v77
  v_exp_f32 v78, v78
  v_exp_f32 v79, v79
  v_cvt_pk_bf16_f32 v58, v76, v77
  v_cvt_pk_bf16_f32 v59, v78, v79
  v_exp_f32 v80, v80
  v_exp_f32 v81, v81
  v_exp_f32 v82, v82
  v_mfma_f32_32x32x16_bf16 v[96:111], v[48:51], v[56:59], v[96:111]
  v_cvt_pk_bf16_f32 v52, v80, v81
  v_exp_f32 v83, v83
  v_exp_f32 v84, v84
  v_cvt_pk_bf16_f32 v53, v82, v83
  v_exp_f32 v85, v85
  s_waitcnt lgkmcnt(2)
  v_mfma_f32_32x32x8_bf16 v[64:79], v[32:33], v[20:21], v[128:143]
  v_exp_f32 v86, v86
  v_cvt_pk_bf16_f32 v54, v84, v85
  v_exp_f32 v87, v87
  v_exp_f32 v88, v88
  v_cvt_pk_bf16_f32 v55, v86, v87
  v_exp_f32 v89, v89
  v_mfma_f32_32x32x16_bf16 v[64:79], v[24:27], v[12:15], v[64:79]
  ds_read_b128 v[28:31], v3 offset:1536
  ds_read_b64 v[34:35], v4 offset:1536
  v_exp_f32 v90, v90
  v_cvt_pk_bf16_f32 v56, v88, v89
  v_exp_f32 v91, v91
  v_exp_f32 v92, v92
  v_cvt_pk_bf16_f32 v57, v90, v91
  v_mfma_f32_32x32x16_bf16 v[112:127], v[44:47], v[52:55], v[112:127]
  v_exp_f32 v93, v93
  v_exp_f32 v94, v94
  v_exp_f32 v95, v95
  v_cvt_pk_bf16_f32 v58, v92, v93
  v_cvt_pk_bf16_f32 v59, v94, v95
  v_exp_f32 v64, v64
  v_exp_f32 v65, v65
  v_exp_f32 v66, v66
  v_mfma_f32_32x32x16_bf16 v[112:127], v[48:51], v[56:59], v[112:127]
  ds_read_b128 v[44:47], v5 offset:3840
  ds_read_b128 v[48:51], v5 offset:4480
  v_cvt_pk_bf16_f32 v52, v64, v65
  v_exp_f32 v67, v67
  v_exp_f32 v68, v68
  v_cvt_pk_bf16_f32 v53, v66, v67
  v_exp_f32 v69, v69
  v_mfma_f32_32x32x8_bf16 v[80:95], v[32:33], v[22:23], v[144:159]
  v_exp_f32 v70, v70
  v_cvt_pk_bf16_f32 v54, v68, v69
  v_exp_f32 v71, v71
  v_exp_f32 v72, v72
  v_cvt_pk_bf16_f32 v55, v70, v71
  v_exp_f32 v73, v73
  v_mfma_f32_32x32x16_bf16 v[80:95], v[24:27], v[16:19], v[80:95]
  v_exp_f32 v74, v74
  v_cvt_pk_bf16_f32 v56, v72, v73
  v_exp_f32 v75, v75
  v_exp_f32 v76, v76
  v_cvt_pk_bf16_f32 v57, v74, v75
  s_waitcnt lgkmcnt(4)
  v_mfma_f32_32x32x16_bf16 v[96:111], v[36:39], v[52:55], v[96:111]
  v_exp_f32 v77, v77
  v_exp_f32 v78, v78
  v_exp_f32 v79, v79
  v_cvt_pk_bf16_f32 v58, v76, v77
  v_cvt_pk_bf16_f32 v59, v78, v79
  v_exp_f32 v80, v80
  v_exp_f32 v81, v81
  v_exp_f32 v82, v82
  v_mfma_f32_32x32x16_bf16 v[96:111], v[40:43], v[56:59], v[96:111]
  v_cvt_pk_bf16_f32 v52, v80, v81
  v_exp_f32 v83, v83
  v_exp_f32 v84, v84
  v_cvt_pk_bf16_f32 v53, v82, v83
  v_exp_f32 v85, v85
  s_waitcnt lgkmcnt(2)
  v_mfma_f32_32x32x8_bf16 v[64:79], v[34:35], v[20:21], v[128:143]
  v_exp_f32 v86, v86
  v_cvt_pk_bf16_f32 v54, v84, v85
  v_exp_f32 v87, v87
  v_exp_f32 v88, v88
  v_cvt_pk_bf16_f32 v55, v86, v87
  v_exp_f32 v89, v89
  v_mfma_f32_32x32x16_bf16 v[64:79], v[28:31], v[12:15], v[64:79]
  ds_read_b128 v[24:27], v3 offset:2048
  ds_read_b64 v[32:33], v4 offset:2048
  v_exp_f32 v90, v90
  v_cvt_pk_bf16_f32 v56, v88, v89
  v_exp_f32 v91, v91
  v_exp_f32 v92, v92
  v_cvt_pk_bf16_f32 v57, v90, v91
  v_mfma_f32_32x32x16_bf16 v[112:127], v[36:39], v[52:55], v[112:127]
  v_exp_f32 v93, v93
  v_exp_f32 v94, v94
  v_exp_f32 v95, v95
  v_cvt_pk_bf16_f32 v58, v92, v93
  v_cvt_pk_bf16_f32 v59, v94, v95
  v_exp_f32 v64, v64
  v_exp_f32 v65, v65
  v_exp_f32 v66, v66
  v_mfma_f32_32x32x16_bf16 v[112:127], v[40:43], v[56:59], v[112:127]
  ds_read_b128 v[36:39], v5 offset:5120
  ds_read_b128 v[40:43], v5 offset:5760
  v_cvt_pk_bf16_f32 v52, v64, v65
  v_exp_f32 v67, v67
  v_exp_f32 v68, v68
  v_cvt_pk_bf16_f32 v53, v66, v67
  v_exp_f32 v69, v69
  v_mfma_f32_32x32x8_bf16 v[80:95], v[34:35], v[22:23], v[144:159]
  v_exp_f32 v70, v70
  v_cvt_pk_bf16_f32 v54, v68, v69
  v_exp_f32 v71, v71
  v_exp_f32 v72, v72
  v_cvt_pk_bf16_f32 v55, v70, v71
  v_exp_f32 v73, v73
  v_mfma_f32_32x32x16_bf16 v[80:95], v[28:31], v[16:19], v[80:95]
  v_exp_f32 v74, v74
  v_cvt_pk_bf16_f32 v56, v72, v73
  v_exp_f32 v75, v75
  v_exp_f32 v76, v76
  v_cvt_pk_bf16_f32 v57, v74, v75
  s_waitcnt lgkmcnt(4)
  v_mfma_f32_32x32x16_bf16 v[96:111], v[44:47], v[52:55], v[96:111]
  v_exp_f32 v77, v77
  v_exp_f32 v78, v78
  v_exp_f32 v79, v79
  v_cvt_pk_bf16_f32 v58, v76, v77
  v_cvt_pk_bf16_f32 v59, v78, v79
  v_exp_f32 v80, v80
  v_exp_f32 v81, v81
  v_exp_f32 v82, v82
  v_mfma_f32_32x32x16_bf16 v[96:111], v[48:51], v[56:59], v[96:111]
  v_cvt_pk_bf16_f32 v52, v80, v81
  v_exp_f32 v83, v83
  v_exp_f32 v84, v84
  v_cvt_pk_bf16_f32 v53, v82, v83
  v_exp_f32 v85, v85
  s_waitcnt lgkmcnt(2)
  v_mfma_f32_32x32x8_bf16 v[64:79], v[32:33], v[20:21], v[128:143]
  v_exp_f32 v86, v86
  v_cvt_pk_bf16_f32 v54, v84, v85
  v_exp_f32 v87, v87
  v_exp_f32 v88, v88
  v_cvt_pk_bf16_f32 v55, v86, v87
  v_exp_f32 v89, v89
  v_mfma_f32_32x32x16_bf16 v[64:79], v[24:27], v[12:15], v[64:79]
  ds_read_b128 v[28:31], v3 offset:2560
  ds_read_b64 v[34:35], v4 offset:2560
  v_exp_f32 v90, v90
  v_cvt_pk_bf16_f32 v56, v88, v89
  v_exp_f32 v91, v91
  v_exp_f32 v92, v92
  v_cvt_pk_bf16_f32 v57, v90, v91
  v_mfma_f32_32x32x16_bf16 v[112:127], v[44:47], v[52:55], v[112:127]
  v_exp_f32 v93, v93
  v_exp_f32 v94, v94
  v_exp_f32 v95, v95
  v_cvt_pk_bf16_f32 v58, v92, v93
  v_cvt_pk_bf16_f32 v59, v94, v95
  v_exp_f32 v64, v64
  v_exp_f32 v65, v65
  v_exp_f32 v66, v66
  v_mfma_f32_32x32x16_bf16 v[112:127], v[48:51], v[56:59], v[112:127]
  ds_read_b128 v[44:47], v5 offset:6400
  ds_read_b128 v[48:51], v5 offset:7040
  v_cvt_pk_bf16_f32 v52, v64, v65
  v_exp_f32 v67, v67
  v_exp_f32 v68, v68
  v_cvt_pk_bf16_f32 v53, v66, v67
  v_exp_f32 v69, v69
  v_mfma_f32_32x32x8_bf16 v[80:95], v[32:33], v[22:23], v[144:159]
  v_exp_f32 v70, v70
  v_cvt_pk_bf16_f32 v54, v68, v69
  v_exp_f32 v71, v71
  v_exp_f32 v72, v72
  v_cvt_pk_bf16_f32 v55, v70, v71
  v_exp_f32 v73, v73
  v_mfma_f32_32x32x16_bf16 v[80:95], v[24:27], v[16:19], v[80:95]
  v_exp_f32 v74, v74
  v_cvt_pk_bf16_f32 v56, v72, v73
  v_exp_f32 v75, v75
  v_exp_f32 v76, v76
  v_cvt_pk_bf16_f32 v57, v74, v75
  s_waitcnt lgkmcnt(4)
  v_mfma_f32_32x32x16_bf16 v[96:111], v[36:39], v[52:55], v[96:111]
  v_exp_f32 v77, v77
  v_exp_f32 v78, v78
  v_exp_f32 v79, v79
  v_cvt_pk_bf16_f32 v58, v76, v77
  v_cvt_pk_bf16_f32 v59, v78, v79
  v_exp_f32 v80, v80
  v_exp_f32 v81, v81
  v_exp_f32 v82, v82
  v_mfma_f32_32x32x16_bf16 v[96:111], v[40:43], v[56:59], v[96:111]
  v_cvt_pk_bf16_f32 v52, v80, v81
  v_exp_f32 v83, v83
  v_exp_f32 v84, v84
  v_cvt_pk_bf16_f32 v53, v82, v83
  v_exp_f32 v85, v85
  s_waitcnt lgkmcnt(2)
  v_mfma_f32_32x32x8_bf16 v[64:79], v[34:35], v[20:21], v[128:143]
  v_exp_f32 v86, v86
  v_cvt_pk_bf16_f32 v54, v84, v85
  v_exp_f32 v87, v87
  v_exp_f32 v88, v88
  v_cvt_pk_bf16_f32 v55, v86, v87
  v_exp_f32 v89, v89
  v_mfma_f32_32x32x16_bf16 v[64:79], v[28:31], v[12:15], v[64:79]
  ds_read_b128 v[24:27], v3 offset:3072
  ds_read_b64 v[32:33], v4 offset:3072
  v_exp_f32 v90, v90
  v_cvt_pk_bf16_f32 v56, v88, v89
  v_exp_f32 v91, v91
  v_exp_f32 v92, v92
  v_cvt_pk_bf16_f32 v57, v90, v91
  v_mfma_f32_32x32x16_bf16 v[112:127], v[36:39], v[52:55], v[112:127]
  v_exp_f32 v93, v93
  v_exp_f32 v94, v94
  v_exp_f32 v95, v95
  v_cvt_pk_bf16_f32 v58, v92, v93
  v_cvt_pk_bf16_f32 v59, v94, v95
  v_exp_f32 v64, v64
  v_exp_f32 v65, v65
  v_exp_f32 v66, v66
  v_mfma_f32_32x32x16_bf16 v[112:127], v[40:43], v[56:59], v[112:127]
  ds_read_b128 v[36:39], v5 offset:7680
  ds_read_b128 v[40:43], v5 offset:8320
  v_cvt_pk_bf16_f32 v52, v64, v65
  v_exp_f32 v67, v67
  v_exp_f32 v68, v68
  v_cvt_pk_bf16_f32 v53, v66, v67
  v_exp_f32 v69, v69
  v_mfma_f32_32x32x8_bf16 v[80:95], v[34:35], v[22:23], v[144:159]
  v_exp_f32 v70, v70
  v_cvt_pk_bf16_f32 v54, v68, v69
  v_exp_f32 v71, v71
  v_exp_f32 v72, v72
  v_cvt_pk_bf16_f32 v55, v70, v71
  v_exp_f32 v73, v73
  v_mfma_f32_32x32x16_bf16 v[80:95], v[28:31], v[16:19], v[80:95]
  v_exp_f32 v74, v74
  v_cvt_pk_bf16_f32 v56, v72, v73
  v_exp_f32 v75, v75
  v_exp_f32 v76, v76
  v_cvt_pk_bf16_f32 v57, v74, v75
  s_waitcnt lgkmcnt(4)
  v_mfma_f32_32x32x16_bf16 v[96:111], v[44:47], v[52:55], v[96:111]
  v_exp_f32 v77, v77
  v_exp_f32 v78, v78
  v_exp_f32 v79, v79
  v_cvt_pk_bf16_f32 v58, v76, v77
  v_cvt_pk_bf16_f32 v59, v78, v79
  v_exp_f32 v80, v80
  v_exp_f32 v81, v81
  v_exp_f32 v82, v82
  v_mfma_f32_32x32x16_bf16 v[96:111], v[48:51], v[56:59], v[96:111]
  v_cvt_pk_bf16_f32 v52, v80, v81
  v_exp_f32 v83, v83
  v_exp_f32 v84, v84
  v_cvt_pk_bf16_f32 v53, v82, v83
  v_exp_f32 v85, v85
  s_waitcnt lgkmcnt(2)
  v_mfma_f32_32x32x8_bf16 v[64:79], v[32:33], v[20:21], v[128:143]
  v_exp_f32 v86, v86
  v_cvt_pk_bf16_f32 v54, v84, v85
  v_exp_f32 v87, v87
  v_exp_f32 v88, v88
  v_cvt_pk_bf16_f32 v55, v86, v87
  v_exp_f32 v89, v89
  v_mfma_f32_32x32x16_bf16 v[64:79], v[24:27], v[12:15], v[64:79]
  ds_read_b128 v[28:31], v3 offset:3584
  ds_read_b64 v[34:35], v4 offset:3584
  v_exp_f32 v90, v90
  v_cvt_pk_bf16_f32 v56, v88, v89
  v_exp_f32 v91, v91
  v_exp_f32 v92, v92
  v_cvt_pk_bf16_f32 v57, v90, v91
  v_mfma_f32_32x32x16_bf16 v[112:127], v[44:47], v[52:55], v[112:127]
  v_exp_f32 v93, v93
  v_exp_f32 v94, v94
  v_exp_f32 v95, v95
  v_cvt_pk_bf16_f32 v58, v92, v93
  v_cvt_pk_bf16_f32 v59, v94, v95
  v_exp_f32 v64, v64
  v_exp_f32 v65, v65
  v_exp_f32 v66, v66
  v_mfma_f32_32x32x16_bf16 v[112:127], v[48:51], v[56:59], v[112:127]
  ds_read_b128 v[44:47], v5 offset:8960
  ds_read_b128 v[48:51], v5 offset:9600
  v_cvt_pk_bf16_f32 v52, v64, v65
  v_exp_f32 v67, v67
  v_exp_f32 v68, v68
  v_cvt_pk_bf16_f32 v53, v66, v67
  v_exp_f32 v69, v69
  v_mfma_f32_32x32x8_bf16 v[80:95], v[32:33], v[22:23], v[144:159]
  v_exp_f32 v70, v70
  v_cvt_pk_bf16_f32 v54, v68, v69
  v_exp_f32 v71, v71
  v_exp_f32 v72, v72
  v_cvt_pk_bf16_f32 v55, v70, v71
  v_exp_f32 v73, v73
  v_mfma_f32_32x32x16_bf16 v[80:95], v[24:27], v[16:19], v[80:95]
  v_exp_f32 v74, v74
  v_cvt_pk_bf16_f32 v56, v72, v73
  v_exp_f32 v75, v75
  v_exp_f32 v76, v76
  v_cvt_pk_bf16_f32 v57, v74, v75
  s_waitcnt lgkmcnt(4)
  v_mfma_f32_32x32x16_bf16 v[96:111], v[36:39], v[52:55], v[96:111]
  v_exp_f32 v77, v77
  v_exp_f32 v78, v78
  v_exp_f32 v79, v79
  v_cvt_pk_bf16_f32 v58, v76, v77
  v_cvt_pk_bf16_f32 v59, v78, v79
  s_waitcnt vmcnt(0) lgkmcnt(0)
  s_barrier
  v_exp_f32 v80, v80
  v_exp_f32 v81, v81
  v_exp_f32 v82, v82
  v_mfma_f32_32x32x16_bf16 v[96:111], v[40:43], v[56:59], v[96:111]
  v_cvt_pk_bf16_f32 v52, v80, v81
  v_exp_f32 v83, v83
  v_exp_f32 v84, v84
  v_cvt_pk_bf16_f32 v53, v82, v83
  v_exp_f32 v85, v85
  v_mfma_f32_32x32x8_bf16 v[64:79], v[34:35], v[20:21], v[128:143]
  v_exp_f32 v86, v86
  v_cvt_pk_bf16_f32 v54, v84, v85
  v_exp_f32 v87, v87
  v_exp_f32 v88, v88
  v_cvt_pk_bf16_f32 v55, v86, v87
  v_exp_f32 v89, v89
  v_mfma_f32_32x32x16_bf16 v[64:79], v[28:31], v[12:15], v[64:79]
  v_add_u32 v3, s30, v3
  v_add_u32 v4, s30, v4
  ds_read_b128 v[24:27], v3 offset:0
  ds_read_b64 v[32:33], v4 offset:0
  v_exp_f32 v90, v90
  v_cvt_pk_bf16_f32 v56, v88, v89
  v_exp_f32 v91, v91
  v_exp_f32 v92, v92
  v_cvt_pk_bf16_f32 v57, v90, v91
  v_mfma_f32_32x32x16_bf16 v[112:127], v[36:39], v[52:55], v[112:127]
  v_exp_f32 v93, v93
  v_exp_f32 v94, v94
  v_exp_f32 v95, v95
  v_cvt_pk_bf16_f32 v58, v92, v93
  v_cvt_pk_bf16_f32 v59, v94, v95
  s_cmp_ge_u32 s29, 6
  s_cbranch_scc1 Lnodma_29
  s_and_b32 s27, s29, 1
  s_mul_i32 s27, s27, 22528
  s_add_u32 s27, s27, s26
  s_add_u32 m0, s27, 0
  s_add_u32 s28, s24, 0
  buffer_load_dwordx4 v2, s[12:15], s28 offen lds
  s_add_u32 m0, s27, 4096
  s_add_u32 s28, s24, 32768
  buffer_load_dwordx4 v2, s[12:15], s28 offen lds
  s_add_u32 m0, s27, 8192
  s_add_u32 s28, s24, 65536
  buffer_load_dwordx4 v2, s[12:15], s28 offen lds
  s_add_u32 m0, s27, 12288
  s_add_u32 s28, s25, 0
  buffer_load_dwordx4 v2, s[12:15], s28 offen lds
  s_add_u32 m0, s27, 16384
  s_add_u32 s28, s25, 4096
  buffer_load_dwordx4 v2, s[12:15], s28 offen lds
  s_cmp_ge_u32 s20, 2
  s_cbranch_scc1 Lv3_31
  s_add_u32 m0, s27, 20480
  s_add_u32 s28, s25, 8192
  buffer_load_dwordx4 v2, s[12:15], s28 offen lds
Lv3_31:
  s_add_u32 s24, s24, 4096
  s_add_u32 s25, s25, 10240
  s_cmp_ge_u32 s29, 4
  s_cbranch_scc1 Lpfo_34
  s_cmp_ge_u32 s29, 2
  s_cbranch_scc1 Lpf4_32
  v_mul_u32_u24 v160, s56, v163
  v_lshrrev_b32 v160, 22, v160
  v_mul_u32_u24 v160, 8064, v160
  v_lshl_add_u32 v160, v163, 4, v160
  buffer_load_dwordx4 v[164:167], v160, s[48:51], s61 offen
  v_add_u32 v163, 64, v163
  v_mul_u32_u24 v160, s56, v163
  v_lshrrev_b32 v160, 22, v160
  v_mul_u32_u24 v160, 8064, v160
  v_lshl_add_u32 v160, v163, 4, v160
  buffer_load_dwordx4 v[164:167], v160, s[48:51], s61 offen
  v_add_u32 v163, 64, v163
  v_mul_u32_u24 v160, s56, v163
  v_lshrrev_b32 v160, 22, v160
  v_mul_u32_u24 v160, 8064, v160
  v_lshl_add_u32 v160, v163, 4, v160
  buffer_load_dwordx4 v[164:167], v160, s[48:51], s61 offen
  v_add_u32 v163, 64, v163
  s_branch Lpfe_33
Lpf4_32:
  v_subrev_u32 v163, 64, v163
  v_lshlrev_b32 v160, 4, v163
  buffer_load_dwordx4 v[164:167], v160, s[52:55], s62 offen
  v_subrev_u32 v163, 64, v163
  v_lshlrev_b32 v160, 4, v163
  buffer_load_dwordx4 v[164:167], v160, s[52:55], s62 offen
  v_subrev_u32 v163, 64, v163
  v_lshlrev_b32 v160, 4, v163
  buffer_load_dwordx4 v[164:167], v160, s[52:55], s62 offen
  s_branch Lpfe_33
Lpfo_34:
  v_lshlrev_b32 v160, 4, v163
  buffer_load_dwordx4 v[164:167], v160, s[16:19], 0 offen
  v_add_u32 v163, 64, v163
  v_lshlrev_b32 v160, 4, v163
  buffer_load_dwordx4 v[164:167], v160, s[16:19], 0 offen
  v_add_u32 v163, 64, v163
  v_lshlrev_b32 v160, 4, v163
  buffer_load_dwordx4 v[164:167], v160, s[16:19], 0 offen
  v_add_u32 v163, 64, v163
Lpfe_33:
Lnodma_29:
  v_exp_f32 v64, v64
  v_exp_f32 v65, v65
  v_exp_f32 v66, v66
  v_mfma_f32_32x32x16_bf16 v[112:127], v[40:43], v[56:59], v[112:127]
  v_add_u32 v5, s30, v5
  ds_read_b128 v[36:39], v5 offset:0
  ds_read_b128 v[40:43], v5 offset:640
  v_cvt_pk_bf16_f32 v52, v64, v65
  v_exp_f32 v67, v67
  v_exp_f32 v68, v68
  v_cvt_pk_bf16_f32 v53, v66, v67
  v_exp_f32 v69, v69
  v_mfma_f32_32x32x8_bf16 v[80:95], v[34:35], v[22:23], v[144:159]
  v_exp_f32 v70, v70
  v_cvt_pk_bf16_f32 v54, v68, v69
  v_exp_f32 v71, v71
  v_exp_f32 v72, v72
  v_cvt_pk_bf16_f32 v55, v70, v71
  v_exp_f32 v73, v73
  v_mfma_f32_32x32x16_bf16 v[80:95], v[28:31], v[16:19], v[80:95]
  v_exp_f32 v74, v74
  v_cvt_pk_bf16_f32 v56, v72, v73
  v_exp_f32 v75, v75
  v_exp_f32 v76, v76
  v_cvt_pk_bf16_f32 v57, v74, v75
  s_waitcnt lgkmcnt(4)
  v_mfma_f32_32x32x16_bf16 v[96:111], v[44:47], v[52:55], v[96:111]
  v_exp_f32 v77, v77
  v_exp_f32 v78, v78
  v_exp_f32 v79, v79
  v_cvt_pk_bf16_f32 v58, v76, v77
  v_cvt_pk_bf16_f32 v59, v78, v79
  v_exp_f32 v80, v80
  v_exp_f32 v81, v81
  v_exp_f32 v82, v82
  v_mfma_f32_32x32x16_bf16 v[96:111], v[48:51], v[56:59], v[96:111]
  v_cvt_pk_bf16_f32 v52, v80, v81
  v_exp_f32 v83, v83
  v_exp_f32 v84, v84
  v_cvt_pk_bf16_f32 v53, v82, v83
  v_exp_f32 v85, v85
  s_waitcnt lgkmcnt(2)
  v_mfma_f32_32x32x8_bf16 v[64:79], v[32:33], v[20:21], v[128:143]
  v_exp_f32 v86, v86
  v_cvt_pk_bf16_f32 v54, v84, v85
  v_exp_f32 v87, v87
  v_exp_f32 v88, v88
  v_cvt_pk_bf16_f32 v55, v86, v87
  v_exp_f32 v89, v89
  v_mfma_f32_32x32x16_bf16 v[64:79], v[24:27], v[12:15], v[64:79]
  ds_read_b128 v[28:31], v3 offset:512
  ds_read_b64 v[34:35], v4 offset:512
  s_sub_u32 s30, 0, s30
  s_add_u32 s29, s29, 1
  s_cmp_lt_u32 s29, 8
  v_exp_f32 v90, v90
  v_cvt_pk_bf16_f32 v56, v88, v89
  v_exp_f32 v91, v91
  v_exp_f32 v92, v92
  v_cvt_pk_bf16_f32 v57, v90, v91
  v_mfma_f32_32x32x16_bf16 v[112:127], v[44:47], v[52:55], v[112:127]
  v_exp_f32 v93, v93
  v_exp_f32 v94, v94
  v_exp_f32 v95, v95
  v_cvt_pk_bf16_f32 v58, v92, v93
  v_cvt_pk_bf16_f32 v59, v94, v95
  s_cbranch_scc1 Laloop_28
  s_nop 1
  v_mfma_f32_32x32x16_bf16 v[112:127], v[48:51], v[56:59], v[112:127]
  s_setprio 3
  s_lshl_b32 s27, s22, 2
  s_add_u32 s27, s27, s20
  s_lshl_b32 s27, s27, 10
  s_lshl_b32 s28, s21, 16
  s_add_u32 s28, s28, s27
  s_add_u32 s28, s28, 9437184
  s_lshr_b32 s24, s21, 2
  s_lshl_b32 s24, s24, 15
  s_add_u32 s27, s27, s24
  s_and_b32 s24, s21, 3
  s_lshl_b32 s24, s24, 2
  s_add_u32 s27, s27, s24
  s_add_u32 s27, s27, 11534336
  s_mov_b64 s[36:37], 0
  s_waitcnt lgkmcnt(0)
  v_mov_b32 v3, v106
  v_add_f32 v6, abs(v96), abs(v97)
  v_add_f32 v7, abs(v98), abs(v99)
  v_permlane32_swap_b32 v3, v106
  v_add_f32 v6, v6, abs(v100)
  v_add_f32 v7, v7, abs(v101)
  v_add_f32 v6, v6, abs(v102)
  v_add_f32 v7, v7, abs(v103)
  v_add_f32 v6, v6, abs(v104)
  v_add_f32 v7, v7, abs(v105)
  v_rcp_f32 v107, v3
  v_add_f32 v6, v6, v7
  v_cmp_nlt_f32 vcc, v6, v61
  s_or_b64 s[36:37], s[36:37], vcc
  v_cmp_nle_f32 vcc, 0x12800000, v3
  s_or_b64 s[36:37], s[36:37], vcc
  v_cmp_nge_f32 vcc, 0x71800000, v3
  s_or_b64 s[36:37], s[36:37], vcc
  v_mul_f32 v96, v107, v96
  v_mul_f32 v97, v107, v97
  v_mul_f32 v98, v107, v98
  v_mul_f32 v99, v107, v99
  v_mul_f32 v100, v107, v100
  v_mul_f32 v101, v107, v101
  v_mul_f32 v102, v107, v102
  v_mul_f32 v103, v107, v103
  v_mul_f32 v104, v107, v104
  v_mul_f32 v105, v107, v105
  v_cvt_pk_bf16_f32 v52, v96, v97
  v_cvt_pk_bf16_f32 v53, v98, v99
  v_cvt_pk_bf16_f32 v54, v100, v101
  v_cvt_pk_bf16_f32 v55, v102, v103
  v_cvt_pk_bf16_f32 v5, v104, v105
  buffer_store_dwordx4 v[52:55], v9, s[12:15], s28 offen offset:0 sc1
  v_mov_b32 v4, v122
  v_add_f32 v6, abs(v112), abs(v113)
  v_add_f32 v7, abs(v114), abs(v115)
  v_permlane32_swap_b32 v4, v122
  v_add_f32 v6, v6, abs(v116)
  v_add_f32 v7, v7, abs(v117)
  v_add_f32 v6, v6, abs(v118)
  v_add_f32 v7, v7, abs(v119)
  v_add_f32 v6, v6, abs(v120)
  v_add_f32 v7, v7, abs(v121)
  v_rcp_f32 v123, v4
  v_add_f32 v6, v6, v7
  v_cmp_nlt_f32 vcc, v6, v61
  s_or_b64 s[36:37], s[36:37], vcc
  v_cmp_nle_f32 vcc, 0x12800000, v4
  s_or_b64 s[36:37], s[36:37], vcc
  v_cmp_nge_f32 vcc, 0x71800000, v4
  s_or_b64 s[36:37], s[36:37], vcc
  v_mul_f32 v112, v123, v112
  v_mul_f32 v113, v123, v113
  v_mul_f32 v114, v123, v114
  v_mul_f32 v115, v123, v115
  v_mul_f32 v116, v123, v116
  v_mul_f32 v117, v123, v117
  v_mul_f32 v118, v123, v118
  v_mul_f32 v119, v123, v119
  v_mul_f32 v120, v123, v120
  v_mul_f32 v121, v123, v121
  v_cvt_pk_bf16_f32 v56, v112, v113
  v_cvt_pk_bf16_f32 v57, v114, v115
  v_cvt_pk_bf16_f32 v58, v116, v117
  v_cvt_pk_bf16_f32 v59, v118, v119
  v_cvt_pk_bf16_f32 v8, v120, v121
  buffer_store_dwordx4 v[56:59], v9, s[12:15], s28 offen offset:512 sc1
  v_lshlrev_b32 v6, 4, v1
  v_permlane32_swap_b32 v5, v8
  buffer_store_dword v5, v6, s[12:15], s27 offen sc1
  s_cmp_lg_u32 s31, 0
  s_cbranch_scc1 Lafin_36
  v_mov_b32 v7, 45056
  s_cmp_eq_u64 s[36:37], 0
  s_cbranch_scc1 Lokw_37
  v_mov_b32 v6, 1
  ds_write_b32 v7, v6
Lokw_37:
  s_waitcnt lgkmcnt(0)
  s_barrier
  ds_read_b32 v6, v7
  s_waitcnt lgkmcnt(0)
  v_readfirstlane_b32 s31, v6
  s_nop 3
  s_cmp_eq_u32 s31, 0
  s_cbranch_scc1 Lafin_36
  s_mov_b32 s24, s32
  s_mov_b32 s25, s33
  s_mov_b32 s29, 0
  v_mov_b32 v128, 0xff800000
  v_mov_b32 v144, 0xff800000
Lmloop_38:
  s_waitcnt vmcnt(0)
  s_barrier
  s_add_u32 m0, s26, 0
  s_add_u32 s28, s24, 0
  buffer_load_dwordx4 v2, s[12:15], s28 offen lds
  s_add_u32 m0, s26, 4096
  s_add_u32 s28, s24, 32768
  buffer_load_dwordx4 v2, s[12:15], s28 offen lds
  s_add_u32 m0, s26, 8192
  s_add_u32 s28, s24, 65536
  buffer_load_dwordx4 v2, s[12:15], s28 offen lds
  s_add_u32 m0, s26, 12288
  s_add_u32 s28, s25, 0
  buffer_load_dwordx4 v2, s[12:15], s28 offen lds
  s_add_u32 m0, s26, 16384
  s_add_u32 s28, s25, 4096
  buffer_load_dwordx4 v2, s[12:15], s28 offen lds
  s_cmp_ge_u32 s20, 2
  s_cbranch_scc1 Lv3_40
  s_add_u32 m0, s26, 20480
  s_add_u32 s28, s25, 8192
  buffer_load_dwordx4 v2, s[12:15], s28 offen lds
Lv3_40:
  s_add_u32 s24, s24, 4096
  s_add_u32 s25, s25, 10240
  v_mov_b32 v3, v10
  v_mov_b32 v4, v11
  s_mov_b32 s30, 0
  s_waitcnt vmcnt(0)
  s_barrier
Lmkt_39:
  ds_read_b128 v[24:27], v3 offset:0
  ds_read_b64 v[32:33], v4 offset:0
  v_add_u32 v3, 512, v3
  v_add_u32 v4, 512, v4
  s_waitcnt lgkmcnt(0)
  v_mfma_f32_32x32x8_bf16 v[64:79], v[32:33], v[20:21], 0
  v_mfma_f32_32x32x16_bf16 v[64:79], v[24:27], v[12:15], v[64:79]
  v_mfma_f32_32x32x8_bf16 v[80:95], v[32:33], v[22:23], 0
  v_mfma_f32_32x32x16_bf16 v[80:95], v[24:27], v[16:19], v[80:95]
  s_nop 15
  v_max3_f32 v128, v64, v65, v128
  v_max3_f32 v128, v66, v67, v128
  v_max3_f32 v128, v68, v69, v128
  v_max3_f32 v128, v70, v71, v128
  v_max3_f32 v128, v72, v73, v128
  v_max3_f32 v128, v74, v75, v128
  v_max3_f32 v128, v76, v77, v128
  v_max3_f32 v128, v78, v79, v128
  v_max3_f32 v144, v80, v81, v144
  v_max3_f32 v144, v82, v83, v144
  v_max3_f32 v144, v84, v85, v144
  v_max3_f32 v144, v86, v87, v144
  v_max3_f32 v144, v88, v89, v144
  v_max3_f32 v144, v90, v91, v144
  v_max3_f32 v144, v92, v93, v144
  v_max3_f32 v144, v94, v95, v144
  s_add_u32 s30, s30, 1
  s_cmp_lt_u32 s30, 8
  s_cbranch_scc1 Lmkt_39
  s_add_u32 s29, s29, 1
  s_cmp_lt_u32 s29, 8
  s_cbranch_scc1 Lmloop_38
  v_mov_b32 v6, v128
  s_nop 1
  v_permlane32_swap_b32 v6, v128
  v_max_f32 v6, v6, v128
  v_sub_f32 v128, 0, v6
  v_sub_f32 v129, 0, v6
  v_sub_f32 v130, 0, v6
  v_sub_f32 v131, 0, v6
  v_sub_f32 v132, 0, v6
  v_sub_f32 v133, 0, v6
  v_sub_f32 v134, 0, v6
  v_sub_f32 v135, 0, v6
  v_sub_f32 v136, 0, v6
  v_sub_f32 v137, 0, v6
  v_sub_f32 v138, 0, v6
  v_sub_f32 v139, 0, v6
  v_sub_f32 v140, 0, v6
  v_sub_f32 v141, 0, v6
  v_sub_f32 v142, 0, v6
  v_sub_f32 v143, 0, v6
  v_mov_b32 v6, v144
  s_nop 1
  v_permlane32_swap_b32 v6, v144
  v_max_f32 v6, v6, v144
  v_sub_f32 v144, 0, v6
  v_sub_f32 v145, 0, v6
  v_sub_f32 v146, 0, v6
  v_sub_f32 v147, 0, v6
  v_sub_f32 v148, 0, v6
  v_sub_f32 v149, 0, v6
  v_sub_f32 v150, 0, v6
  v_sub_f32 v151, 0, v6
  v_sub_f32 v152, 0, v6
  v_sub_f32 v153, 0, v6
  v_sub_f32 v154, 0, v6
  v_sub_f32 v155, 0, v6
  v_sub_f32 v156, 0, v6
  v_sub_f32 v157, 0, v6
  v_sub_f32 v158, 0, v6
  v_sub_f32 v159, 0, v6
  s_mov_b32 s24, s32
  s_mov_b32 s25, s33
  s_barrier
  s_add_u32 m0, s26, 0
  s_add_u32 s28, s24, 0
  buffer_load_dwordx4 v2, s[12:15], s28 offen lds
  s_add_u32 m0, s26, 4096
  s_add_u32 s28, s24, 32768
  buffer_load_dwordx4 v2, s[12:15], s28 offen lds
  s_add_u32 m0, s26, 8192
  s_add_u32 s28, s24, 65536
  buffer_load_dwordx4 v2, s[12:15], s28 offen lds
  s_add_u32 m0, s26, 12288
  s_add_u32 s28, s25, 0
  buffer_load_dwordx4 v2, s[12:15], s28 offen lds
  s_add_u32 m0, s26, 16384
  s_add_u32 s28, s25, 4096
  buffer_load_dwordx4 v2, s[12:15], s28 offen lds
  s_cmp_ge_u32 s20, 2
  s_cbranch_scc1 Lv3_41
  s_add_u32 m0, s26, 20480
  s_add_u32 s28, s25, 8192
  buffer_load_dwordx4 v2, s[12:15], s28 offen lds
Lv3_41:
  s_add_u32 s24, s24, 4096
  s_add_u32 s25, s25, 10240
  s_waitcnt vmcnt(0)
  s_branch Lastart_27
Lafin_36:
  s_lshl_b32 s27, s22, 2
  s_add_u32 s27, s27, s20
  s_lshl_b32 s27, s27, 5
  s_add_u32 s27, s27, s21
  s_lshl_b32 s27, s27, 2
  s_add_u32 s27, s27, 36036608
  s_waitcnt vmcnt(0)
  v_mov_b32 v6, 1
  v_min_u32 v7, 1, v1
  v_lshlrev_b32 v7, 30, v7
  buffer_store_dword v6, v7, s[12:15], s27 offen sc1
  s_endpgm
.p2align 6
Lmlprole_25:
  s_setprio 2
  s_load_dwordx2 s[4:5], s[0:1], 0
  s_load_dwordx4 s[40:43], s[0:1], 40
  s_load_dwordx2 s[44:45], s[0:1], 56
  s_load_dwordx2 s[12:13], s[0:1], 80
  v_lshrrev_b32 v8, 6, v0
  v_and_b32 v1, 63, v0
  v_readfirstlane_b32 s20, v8
  s_and_b32 s26, s3, 7
  s_lshr_b32 s30, s3, 3
  s_and_b32 s25, s30, 3
  s_lshl_b32 s34, s26, 2
  s_add_u32 s34, s34, s25
  s_lshr_b32 s29, s30, 2
  s_and_b32 s23, s26, 1
  s_lshl_b32 s23, s23, 2
  s_lshr_b32 s24, s30, 3
  s_add_u32 s23, s23, s24
  s_lshr_b32 s24, s26, 1
  s_lshl_b32 s24, s24, 3
  s_and_b32 s25, s30, 7
  s_add_u32 s24, s24, s25
  s_mov_b32 s6, 2359296
  s_mov_b32 s7, 0x20000
  s_mov_b32 s11, 0x20000
  s_mov_b32 s14, 268435456
  s_mov_b32 s15, 0x20000
  s_and_b32 s21, s20, 1
  s_lshr_b32 s22, s20, 1
  s_lshl_b32 s28, s20, 10
  s_lshl_b32 s25, s34, 1
  s_add_u32 s25, s25, s21
  s_lshl_b32 s25, s25, 5
  v_and_b32 v253, 31, v1
  v_add_u32 v253, s25, v253
  v_lshrrev_b32 v8, 5, v1
  v_lshlrev_b32 v252, 15, v8
  v_lshl_add_u32 v252, v253, 4, v252
  v_lshrrev_b32 v8, 3, v1
  v_lshlrev_b32 v9, 1, v8
  v_and_b32 v9, 4, v9
  v_xor_b32 v9, v9, v1
  v_and_b32 v9, 7, v9
  v_mul_u32_u24 v8, 1152, v8
  v_lshl_add_u32 v2, v9, 4, v8
  v_lshlrev_b32 v255, 4, v1
  s_and_b32 s35, s29, 3
  s_add_u32 s25, s35, s20
  s_and_b32 s25, s25, 3
  s_mul_i32 s25, s25, 4608
  s_mul_i32 s30, s29, 18432
  s_add_u32 s30, s30, s25
  s_add_u32 s30, s30, 14438400
  s_mul_i32 s26, s20, 4608
  s_add_u32 m0, s26, 61440
  s_mul_i32 s28, s20, 3072
  s_lshl_b32 s27, s29, 7
  s_mul_i32 s25, s35, 165888
  s_add_u32 s27, s27, s25
  s_mul_i32 s25, s20, 27648
  s_add_u32 s27, s27, s25
  s_waitcnt lgkmcnt(0)
  s_mov_b32 s8, s40
  s_mov_b32 s9, s41
  s_mov_b32 s10, 663552
  buffer_load_dwordx4 v255, s[12:15], s30 offen offset:0 lds
  buffer_load_dwordx4 v255, s[12:15], s30 offen offset:1024 lds
  buffer_load_dwordx4 v255, s[12:15], s30 offen offset:2048 lds
  buffer_load_dwordx4 v255, s[12:15], s30 offen offset:3072 lds
  s_add_u32 m0, s26, 65536
  s_add_u32 s30, s30, 4096
  s_mov_b32 exec_hi, 0
  buffer_load_dwordx4 v255, s[12:15], s30 offen lds
  s_mov_b64 exec, -1
  s_add_u32 s25, s35, 0
  s_bfe_u32 s26, s25, 0x10001
  s_add_u32 s26, s26, 1
  s_and_b32 s25, s25, 1
  s_lshl_b32 s25, s25, 1
  s_sub_u32 s25, s25, 1
  s_mul_i32 s25, s25, s26
  v_add_u32 v8, s25, v253
  s_lshl_b32 s25, s25, 4
  v_cmp_gt_u32 vcc, 2048, v8
  v_add_u32 v9, s25, v252
  v_mov_b32 v10, 0x7fff0000
  v_cndmask_b32 v234, v10, v9, vcc
  s_add_u32 s25, s35, 1
  s_bfe_u32 s26, s25, 0x10001
  s_add_u32 s26, s26, 1
  s_and_b32 s25, s25, 1
  s_lshl_b32 s25, s25, 1
  s_sub_u32 s25, s25, 1
  s_mul_i32 s25, s25, s26
  v_add_u32 v8, s25, v253
  s_lshl_b32 s25, s25, 4
  v_cmp_gt_u32 vcc, 2048, v8
  v_add_u32 v9, s25, v252
  v_mov_b32 v10, 0x7fff0000
  v_cndmask_b32 v235, v10, v9, vcc
  s_add_u32 s25, s35, 2
  s_bfe_u32 s26, s25, 0x10001
  s_add_u32 s26, s26, 1
  s_and_b32 s25, s25, 1
  s_lshl_b32 s25, s25, 1
  s_sub_u32 s25, s25, 1
  s_mul_i32 s25, s25, s26
  v_add_u32 v8, s25, v253
  s_lshl_b32 s25, s25, 4
  v_cmp_gt_u32 vcc, 2048, v8
  v_add_u32 v9, s25, v252
  v_mov_b32 v10, 0x7fff0000
  v_cndmask_b32 v236, v10, v9, vcc
  s_add_u32 s25, s35, 3
  s_bfe_u32 s26, s25, 0x10001
  s_add_u32 s26, s26, 1
  s_and_b32 s25, s25, 1
  s_lshl_b32 s25, s25, 1
  s_sub_u32 s25, s25, 1
  s_mul_i32 s25, s25, s26
  v_add_u32 v8, s25, v253
  s_lshl_b32 s25, s25, 4
  v_cmp_gt_u32 vcc, 2048, v8
  v_add_u32 v9, s25, v252
  v_mov_b32 v10, 0x7fff0000
  v_cndmask_b32 v237, v10, v9, vcc
  s_mul_i32 s31, s35, 589824
  s_add_u32 s31, s31, 4718592
  s_cmp_ge_u32 s27, 663552
  s_cselect_b32 s26, 663552, 0
  s_sub_u32 s27, s27, s26
  s_add_u32 m0, s28, 0
  s_nop 0
  buffer_load_dwordx4 v2, s[8:11], s27 offen offset:0 lds
  s_add_u32 s27, s27, 8192
  buffer_load_dwordx4 v2, s[8:11], s27 offen offset:1024 lds
  s_add_u32 s27, s27, 8192
  buffer_load_dwordx4 v2, s[8:11], s27 offen offset:2048 lds
  s_add_u32 s27, s27, 94208
  s_cmp_ge_u32 s27, 663552
  s_cselect_b32 s26, 663552, 0
  s_sub_u32 s27, s27, s26
  s_add_u32 m0, s28, 12288
  s_nop 0
  buffer_load_dwordx4 v2, s[8:11], s27 offen offset:0 lds
  s_add_u32 s27, s27, 8192
  s_waitcnt vmcnt(8)
  buffer_load_dwordx4 v[12:15], v234, s[12:15], s31 offen
  s_add_u32 s31, s31, 65536
  s_waitcnt vmcnt(8)
  buffer_load_dwordx4 v[16:19], v234, s[12:15], s31 offen
  s_add_u32 s31, s31, 65536
  s_waitcnt vmcnt(8)
  buffer_load_dwordx4 v2, s[8:11], s27 offen offset:1024 lds
  s_add_u32 s27, s27, 8192
  s_waitcnt vmcnt(8)
  buffer_load_dwordx4 v[20:23], v234, s[12:15], s31 offen
  s_add_u32 s31, s31, 65536
  s_waitcnt vmcnt(8)
  buffer_load_dwordx4 v[24:27], v234, s[12:15], s31 offen
  s_add_u32 s31, s31, 65536
  s_waitcnt vmcnt(8)
  buffer_load_dwordx4 v2, s[8:11], s27 offen offset:2048 lds
  s_add_u32 s27, s27, 94208
  s_waitcnt vmcnt(8)
  buffer_load_dwordx4 v[28:31], v234, s[12:15], s31 offen
  s_add_u32 s31, s31, 65536
  s_waitcnt vmcnt(8)
  buffer_load_dwordx4 v[32:35], v234, s[12:15], s31 offen
  s_add_u32 s31, s31, 65536
  s_waitcnt vmcnt(8)
  s_cmp_ge_u32 s27, 663552
  s_cselect_b32 s26, 663552, 0
  s_sub_u32 s27, s27, s26
  s_add_u32 m0, s28, 24576
  s_nop 0
  buffer_load_dwordx4 v2, s[8:11], s27 offen offset:0 lds
  s_add_u32 s27, s27, 8192
  s_waitcnt vmcnt(8)
  buffer_load_dwordx4 v[36:39], v234, s[12:15], s31 offen
  s_add_u32 s31, s31, 65536
  v_and_b32 v8, 19, v1
  v_min_u32 v8, 3, v8
  v_lshlrev_b32 v8, 3, v8
  v_lshrrev_b32 v9, 5, v1
  v_bfe_u32 v10, v1, 2, 2
  v_lshl_add_u32 v10, v9, 3, v10
  v_lshl_add_u32 v8, v10, 5, v8
  v_add_u32 v233, 61440, v8
  v_lshlrev_b32 v254, 4, v253
  v_lshl_add_u32 v254, v9, 3, v254
  s_lshl_b32 s30, s29, 1
  s_add_u32 s30, s30, s22
  v_lshrrev_b32 v8, 5, v1
  v_bfe_u32 v9, v1, 2, 2
  v_mad_u32_u24 v8, v8, 8, v9
  v_lshlrev_b32 v8, 7, v8
  v_lshrrev_b32 v9, 1, v9
  v_xor_b32 v9, s22, v9
  v_lshl_add_u32 v8, v9, 6, v8
  v_bfe_u32 v9, v1, 4, 1
  v_lshl_add_u32 v8, v9, 5, v8
  v_and_b32 v9, 3, v1
  v_lshl_add_u32 v3, v9, 3, v8
  s_barrier
  ds_read_b64_tr_b16 v[188:189], v3 offset:0
  ds_read_b64_tr_b16 v[190:191], v3 offset:512
  ds_read_b64_tr_b16 v[204:205], v233 offset:0
  ds_read_b64_tr_b16 v[206:207], v233 offset:128
  ds_read_b64_tr_b16 v[192:193], v3 offset:2048
  ds_read_b64_tr_b16 v[194:195], v3 offset:2560
  ds_read_b64_tr_b16 v[208:209], v233 offset:512
  ds_read_b64_tr_b16 v[210:211], v233 offset:640
  ds_read_b64_tr_b16 v[196:197], v3 offset:4096
  ds_read_b64_tr_b16 v[198:199], v3 offset:4608
  ds_read_b64_tr_b16 v[212:213], v233 offset:1024
  ds_read_b64_tr_b16 v[214:215], v233 offset:1152
  s_waitcnt lgkmcnt(8)
  v_mfma_f32_32x32x16_bf16 v[156:171], v[188:191], v[12:15], 0
  buffer_load_dwordx4 v[40:43], v234, s[12:15], s31 offen
  s_add_u32 s31, s31, 65536
  buffer_load_dwordx4 v2, s[8:11], s27 offen offset:1024 lds
  s_add_u32 s27, s27, 8192
  v_mfma_f32_32x32x16_bf16 v[172:187], v[204:207], v[12:15], 0
  ds_read_b64_tr_b16 v[200:201], v3 offset:6144
  ds_read_b64_tr_b16 v[202:203], v3 offset:6656
  ds_read_b64_tr_b16 v[216:217], v233 offset:1536
  ds_read_b64_tr_b16 v[218:219], v233 offset:1664
  s_waitcnt vmcnt(10)
  s_waitcnt lgkmcnt(8)
  v_mfma_f32_32x32x16_bf16 v[156:171], v[192:195], v[16:19], v[156:171]
  buffer_load_dwordx4 v[44:47], v234, s[12:15], s31 offen
  s_add_u32 s31, s31, 65536
  s_cmp_eq_u32 s31, 7077888
  s_cselect_b32 s31, 4718592, s31
  v_mfma_f32_32x32x16_bf16 v[172:187], v[208:211], v[16:19], v[172:187]
  ds_read_b64_tr_b16 v[188:189], v3 offset:8192
  ds_read_b64_tr_b16 v[190:191], v3 offset:8704
  ds_read_b64_tr_b16 v[204:205], v233 offset:2048
  ds_read_b64_tr_b16 v[206:207], v233 offset:2176
  s_waitcnt vmcnt(9)
  s_waitcnt lgkmcnt(8)
  v_mfma_f32_32x32x16_bf16 v[156:171], v[196:199], v[20:23], v[156:171]
  buffer_load_dwordx4 v[48:51], v235, s[12:15], s31 offen
  s_add_u32 s31, s31, 65536
  buffer_load_dwordx4 v2, s[8:11], s27 offen offset:2048 lds
  s_add_u32 s27, s27, 94208
  v_mfma_f32_32x32x16_bf16 v[172:187], v[212:215], v[20:23], v[172:187]
  ds_read_b64_tr_b16 v[192:193], v3 offset:10240
  ds_read_b64_tr_b16 v[194:195], v3 offset:10752
  ds_read_b64_tr_b16 v[208:209], v233 offset:2560
  ds_read_b64_tr_b16 v[210:211], v233 offset:2688
  s_waitcnt vmcnt(10)
  s_waitcnt lgkmcnt(8)
  v_mfma_f32_32x32x16_bf16 v[156:171], v[200:203], v[24:27], v[156:171]
  buffer_load_dwordx4 v[52:55], v235, s[12:15], s31 offen
  s_add_u32 s31, s31, 65536
  v_mfma_f32_32x32x16_bf16 v[172:187], v[216:219], v[24:27], v[172:187]
  s_waitcnt vmcnt(10)
  s_barrier
  ds_read_b64_tr_b16 v[196:197], v3 offset:12288
  ds_read_b64_tr_b16 v[198:199], v3 offset:12800
  ds_read_b64_tr_b16 v[212:213], v233 offset:3072
  ds_read_b64_tr_b16 v[214:215], v233 offset:3200
  s_waitcnt vmcnt(9)
  s_waitcnt lgkmcnt(8)
  v_mfma_f32_32x32x16_bf16 v[156:171], v[188:191], v[28:31], v[156:171]
  buffer_load_dwordx4 v[56:59], v235, s[12:15], s31 offen
  s_add_u32 s31, s31, 65536
  s_cmp_ge_u32 s27, 663552
  s_cselect_b32 s26, 663552, 0
  s_sub_u32 s27, s27, s26
  s_add_u32 m0, s28, 36864
  s_nop 0
  buffer_load_dwordx4 v2, s[8:11], s27 offen offset:0 lds
  s_add_u32 s27, s27, 8192
  v_mfma_f32_32x32x16_bf16 v[172:187], v[204:207], v[28:31], v[172:187]
  ds_read_b64_tr_b16 v[200:201], v3 offset:14336
  ds_read_b64_tr_b16 v[202:203], v3 offset:14848
  ds_read_b64_tr_b16 v[216:217], v233 offset:3584
  ds_read_b64_tr_b16 v[218:219], v233 offset:3712
  s_waitcnt vmcnt(10)
  s_waitcnt lgkmcnt(8)
  v_mfma_f32_32x32x16_bf16 v[156:171], v[192:195], v[32:35], v[156:171]
  buffer_load_dwordx4 v[60:63], v235, s[12:15], s31 offen
  s_add_u32 s31, s31, 65536
  v_mfma_f32_32x32x16_bf16 v[172:187], v[208:211], v[32:35], v[172:187]
  ds_read_b64_tr_b16 v[188:189], v3 offset:16384
  ds_read_b64_tr_b16 v[190:191], v3 offset:16896
  ds_read_b64_tr_b16 v[204:205], v233 offset:4096
  ds_read_b64_tr_b16 v[206:207], v233 offset:4224
  s_waitcnt vmcnt(9)
  s_waitcnt lgkmcnt(8)
  v_mfma_f32_32x32x16_bf16 v[156:171], v[196:199], v[36:39], v[156:171]
  buffer_load_dwordx4 v[64:67], v235, s[12:15], s31 offen
  s_add_u32 s31, s31, 65536
  buffer_load_dwordx4 v2, s[8:11], s27 offen offset:1024 lds
  s_add_u32 s27, s27, 8192
  v_mfma_f32_32x32x16_bf16 v[172:187], v[212:215], v[36:39], v[172:187]
  ds_read_b64_tr_b16 v[192:193], v3 offset:18432
  ds_read_b64_tr_b16 v[194:195], v3 offset:18944
  ds_read_b64_tr_b16 v[208:209], v233 offset:4608
  ds_read_b64_tr_b16 v[210:211], v233 offset:4736
  s_waitcnt vmcnt(10)
  s_waitcnt lgkmcnt(8)
  v_mfma_f32_32x32x16_bf16 v[156:171], v[200:203], v[40:43], v[156:171]
  buffer_load_dwordx4 v[68:71], v235, s[12:15], s31 offen
  s_add_u32 s31, s31, 65536
  v_mfma_f32_32x32x16_bf16 v[172:187], v[216:219], v[40:43], v[172:187]
  ds_read_b64_tr_b16 v[196:197], v3 offset:20480
  ds_read_b64_tr_b16 v[198:199], v3 offset:20992
  ds_read_b64_tr_b16 v[212:213], v233 offset:5120
  ds_read_b64_tr_b16 v[214:215], v233 offset:5248
  s_waitcnt vmcnt(9)
  s_waitcnt lgkmcnt(8)
  v_mfma_f32_32x32x16_bf16 v[156:171], v[188:191], v[44:47], v[156:171]
  buffer_load_dwordx4 v[72:75], v235, s[12:15], s31 offen
  s_add_u32 s31, s31, 65536
  buffer_load_dwordx4 v2, s[8:11], s27 offen offset:2048 lds
  s_add_u32 s27, s27, 94208
  v_mfma_f32_32x32x16_bf16 v[172:187], v[204:207], v[44:47], v[172:187]
  ds_read_b64_tr_b16 v[200:201], v3 offset:22528
  ds_read_b64_tr_b16 v[202:203], v3 offset:23040
  ds_read_b64_tr_b16 v[216:217], v233 offset:5632
  ds_read_b64_tr_b16 v[218:219], v233 offset:5760
  s_waitcnt vmcnt(10)
  s_waitcnt lgkmcnt(8)
  v_mfma_f32_32x32x16_bf16 v[156:171], v[192:195], v[48:51], v[156:171]
  buffer_load_dwordx4 v[76:79], v235, s[12:15], s31 offen
  s_add_u32 s31, s31, 65536
  v_mfma_f32_32x32x16_bf16 v[172:187], v[208:211], v[48:51], v[172:187]
  s_waitcnt vmcnt(10)
  s_barrier
  ds_read_b64_tr_b16 v[188:189], v3 offset:24576
  ds_read_b64_tr_b16 v[190:191], v3 offset:25088
  ds_read_b64_tr_b16 v[204:205], v233 offset:6144
  ds_read_b64_tr_b16 v[206:207], v233 offset:6272
  s_waitcnt vmcnt(9)
  s_waitcnt lgkmcnt(8)
  v_mfma_f32_32x32x16_bf16 v[156:171], v[196:199], v[52:55], v[156:171]
  buffer_load_dwordx4 v[80:83], v235, s[12:15], s31 offen
  s_add_u32 s31, s31, 65536
  s_cmp_eq_u32 s31, 7077888
  s_cselect_b32 s31, 4718592, s31
  s_cmp_ge_u32 s27, 663552
  s_cselect_b32 s26, 663552, 0
  s_sub_u32 s27, s27, s26
  s_add_u32 m0, s28, 49152
  s_nop 0
  buffer_load_dwordx4 v2, s[8:11], s27 offen offset:0 lds
  s_add_u32 s27, s27, 8192
  v_mfma_f32_32x32x16_bf16 v[172:187], v[212:215], v[52:55], v[172:187]
  ds_read_b64_tr_b16 v[192:193], v3 offset:26624
  ds_read_b64_tr_b16 v[194:195], v3 offset:27136
  ds_read_b64_tr_b16 v[208:209], v233 offset:6656
  ds_read_b64_tr_b16 v[210:211], v233 offset:6784
  s_waitcnt vmcnt(10)
  s_waitcnt lgkmcnt(8)
  v_mfma_f32_32x32x16_bf16 v[156:171], v[200:203], v[56:59], v[156:171]
  buffer_load_dwordx4 v[84:87], v236, s[12:15], s31 offen
  s_add_u32 s31, s31, 65536
  v_mfma_f32_32x32x16_bf16 v[172:187], v[216:219], v[56:59], v[172:187]
  ds_read_b64_tr_b16 v[196:197], v3 offset:28672
  ds_read_b64_tr_b16 v[198:199], v3 offset:29184
  ds_read_b64_tr_b16 v[212:213], v233 offset:7168
  ds_read_b64_tr_b16 v[214:215], v233 offset:7296
  s_waitcnt vmcnt(9)
  s_waitcnt lgkmcnt(8)
  v_mfma_f32_32x32x16_bf16 v[156:171], v[188:191], v[60:63], v[156:171]
  buffer_load_dwordx4 v[88:91], v236, s[12:15], s31 offen
  s_add_u32 s31, s31, 65536
  buffer_load_dwordx4 v2, s[8:11], s27 offen offset:1024 lds
  s_add_u32 s27, s27, 8192
  v_mfma_f32_32x32x16_bf16 v[172:187], v[204:207], v[60:63], v[172:187]
  ds_read_b64_tr_b16 v[200:201], v3 offset:30720
  ds_read_b64_tr_b16 v[202:203], v3 offset:31232
  ds_read_b64_tr_b16 v[216:217], v233 offset:7680
  ds_read_b64_tr_b16 v[218:219], v233 offset:7808
  s_waitcnt vmcnt(10)
  s_waitcnt lgkmcnt(8)
  v_mfma_f32_32x32x16_bf16 v[156:171], v[192:195], v[64:67], v[156:171]
  buffer_load_dwordx4 v[92:95], v236, s[12:15], s31 offen
  s_add_u32 s31, s31, 65536
  v_mfma_f32_32x32x16_bf16 v[172:187], v[208:211], v[64:67], v[172:187]
  ds_read_b64_tr_b16 v[188:189], v3 offset:32768
  ds_read_b64_tr_b16 v[190:191], v3 offset:33280
  ds_read_b64_tr_b16 v[204:205], v233 offset:8192
  ds_read_b64_tr_b16 v[206:207], v233 offset:8320
  s_waitcnt vmcnt(9)
  s_waitcnt lgkmcnt(8)
  v_mfma_f32_32x32x16_bf16 v[156:171], v[196:199], v[68:71], v[156:171]
  buffer_load_dwordx4 v[96:99], v236, s[12:15], s31 offen
  s_add_u32 s31, s31, 65536
  buffer_load_dwordx4 v2, s[8:11], s27 offen offset:2048 lds
  s_add_u32 s27, s27, 94208
  v_mfma_f32_32x32x16_bf16 v[172:187], v[212:215], v[68:71], v[172:187]
  ds_read_b64_tr_b16 v[192:193], v3 offset:34816
  ds_read_b64_tr_b16 v[194:195], v3 offset:35328
  ds_read_b64_tr_b16 v[208:209], v233 offset:8704
  ds_read_b64_tr_b16 v[210:211], v233 offset:8832
  s_waitcnt vmcnt(10)
  s_waitcnt lgkmcnt(8)
  v_mfma_f32_32x32x16_bf16 v[156:171], v[200:203], v[72:75], v[156:171]
  buffer_load_dwordx4 v[100:103], v236, s[12:15], s31 offen
  s_add_u32 s31, s31, 65536
  v_mfma_f32_32x32x16_bf16 v[172:187], v[216:219], v[72:75], v[172:187]
  s_waitcnt vmcnt(10)
  s_barrier
  ds_read_b64_tr_b16 v[196:197], v3 offset:36864
  ds_read_b64_tr_b16 v[198:199], v3 offset:37376
  ds_read_b64_tr_b16 v[212:213], v233 offset:9216
  ds_read_b64_tr_b16 v[214:215], v233 offset:9344
  s_waitcnt vmcnt(9)
  s_waitcnt lgkmcnt(8)
  v_mfma_f32_32x32x16_bf16 v[156:171], v[188:191], v[76:79], v[156:171]
  buffer_load_dwordx4 v[104:107], v236, s[12:15], s31 offen
  s_add_u32 s31, s31, 65536
  s_cmp_ge_u32 s27, 663552
  s_cselect_b32 s26, 663552, 0
  s_sub_u32 s27, s27, s26
  s_add_u32 m0, s28, 0
  s_nop 0
  buffer_load_dwordx4 v2, s[8:11], s27 offen offset:0 lds
  s_add_u32 s27, s27, 8192
  v_mfma_f32_32x32x16_bf16 v[172:187], v[204:207], v[76:79], v[172:187]
  ds_read_b64_tr_b16 v[200:201], v3 offset:38912
  ds_read_b64_tr_b16 v[202:203], v3 offset:39424
  ds_read_b64_tr_b16 v[216:217], v233 offset:9728
  ds_read_b64_tr_b16 v[218:219], v233 offset:9856
  s_waitcnt vmcnt(10)
  s_waitcnt lgkmcnt(8)
  v_mfma_f32_32x32x16_bf16 v[156:171], v[192:195], v[80:83], v[156:171]
  buffer_load_dwordx4 v[108:111], v236, s[12:15], s31 offen
  s_add_u32 s31, s31, 65536
  v_mfma_f32_32x32x16_bf16 v[172:187], v[208:211], v[80:83], v[172:187]
  ds_read_b64_tr_b16 v[188:189], v3 offset:40960
  ds_read_b64_tr_b16 v[190:191], v3 offset:41472
  ds_read_b64_tr_b16 v[204:205], v233 offset:10240
  ds_read_b64_tr_b16 v[206:207], v233 offset:10368
  s_waitcnt vmcnt(9)
  s_waitcnt lgkmcnt(8)
  v_mfma_f32_32x32x16_bf16 v[156:171], v[196:199], v[84:87], v[156:171]
  buffer_load_dwordx4 v[112:115], v236, s[12:15], s31 offen
  s_add_u32 s31, s31, 65536
  buffer_load_dwordx4 v2, s[8:11], s27 offen offset:1024 lds
  s_add_u32 s27, s27, 8192
  v_mfma_f32_32x32x16_bf16 v[172:187], v[212:215], v[84:87], v[172:187]
  ds_read_b64_tr_b16 v[192:193], v3 offset:43008
  ds_read_b64_tr_b16 v[194:195], v3 offset:43520
  ds_read_b64_tr_b16 v[208:209], v233 offset:10752
  ds_read_b64_tr_b16 v[210:211], v233 offset:10880
  s_waitcnt vmcnt(10)
  s_waitcnt lgkmcnt(8)
  v_mfma_f32_32x32x16_bf16 v[156:171], v[200:203], v[88:91], v[156:171]
  buffer_load_dwordx4 v[116:119], v236, s[12:15], s31 offen
  s_add_u32 s31, s31, 65536
  s_cmp_eq_u32 s31, 7077888
  s_cselect_b32 s31, 4718592, s31
  v_mfma_f32_32x32x16_bf16 v[172:187], v[216:219], v[88:91], v[172:187]
  ds_read_b64_tr_b16 v[196:197], v3 offset:45056
  ds_read_b64_tr_b16 v[198:199], v3 offset:45568
  ds_read_b64_tr_b16 v[212:213], v233 offset:11264
  ds_read_b64_tr_b16 v[214:215], v233 offset:11392
  s_waitcnt vmcnt(9)
  s_waitcnt lgkmcnt(8)
  v_mfma_f32_32x32x16_bf16 v[156:171], v[188:191], v[92:95], v[156:171]
  buffer_load_dwordx4 v[120:123], v237, s[12:15], s31 offen
  s_add_u32 s31, s31, 65536
  buffer_load_dwordx4 v2, s[8:11], s27 offen offset:2048 lds
  s_add_u32 s27, s27, 94208
  v_mfma_f32_32x32x16_bf16 v[172:187], v[204:207], v[92:95], v[172:187]
  ds_read_b64_tr_b16 v[200:201], v3 offset:47104
  ds_read_b64_tr_b16 v[202:203], v3 offset:47616
  ds_read_b64_tr_b16 v[216:217], v233 offset:11776
  ds_read_b64_tr_b16 v[218:219], v233 offset:11904
  s_waitcnt vmcnt(10)
  s_waitcnt lgkmcnt(8)
  v_mfma_f32_32x32x16_bf16 v[156:171], v[192:195], v[96:99], v[156:171]
  buffer_load_dwordx4 v[124:127], v237, s[12:15], s31 offen
  s_add_u32 s31, s31, 65536
  v_mfma_f32_32x32x16_bf16 v[172:187], v[208:211], v[96:99], v[172:187]
  s_waitcnt vmcnt(10)
  s_barrier
  ds_read_b64_tr_b16 v[188:189], v3 offset:49152
  ds_read_b64_tr_b16 v[190:191], v3 offset:49664
  ds_read_b64_tr_b16 v[204:205], v233 offset:12288
  ds_read_b64_tr_b16 v[206:207], v233 offset:12416
  s_waitcnt vmcnt(9)
  s_waitcnt lgkmcnt(8)
  v_mfma_f32_32x32x16_bf16 v[156:171], v[196:199], v[100:103], v[156:171]
  buffer_load_dwordx4 v[128:131], v237, s[12:15], s31 offen
  s_add_u32 s31, s31, 65536
  buffer_load_dwordx4 v[132:135], v237, s[12:15], s31 offen
  s_add_u32 s31, s31, 65536
  v_mfma_f32_32x32x16_bf16 v[172:187], v[212:215], v[100:103], v[172:187]
  ds_read_b64_tr_b16 v[192:193], v3 offset:51200
  ds_read_b64_tr_b16 v[194:195], v3 offset:51712
  ds_read_b64_tr_b16 v[208:209], v233 offset:12800
  ds_read_b64_tr_b16 v[210:211], v233 offset:12928
  s_waitcnt vmcnt(10)
  s_waitcnt lgkmcnt(8)
  v_mfma_f32_32x32x16_bf16 v[156:171], v[200:203], v[104:107], v[156:171]
  buffer_load_dwordx4 v[136:139], v237, s[12:15], s31 offen
  s_add_u32 s31, s31, 65536
  v_mfma_f32_32x32x16_bf16 v[172:187], v[216:219], v[104:107], v[172:187]
  ds_read_b64_tr_b16 v[196:197], v3 offset:53248
  ds_read_b64_tr_b16 v[198:199], v3 offset:53760
  ds_read_b64_tr_b16 v[212:213], v233 offset:13312
  ds_read_b64_tr_b16 v[214:215], v233 offset:13440
  s_waitcnt vmcnt(9)
  s_waitcnt lgkmcnt(8)
  v_mfma_f32_32x32x16_bf16 v[156:171], v[188:191], v[108:111], v[156:171]
  buffer_load_dwordx4 v[140:143], v237, s[12:15], s31 offen
  s_add_u32 s31, s31, 65536
  buffer_load_dwordx4 v[144:147], v237, s[12:15], s31 offen
  s_add_u32 s31, s31, 65536
  v_mfma_f32_32x32x16_bf16 v[172:187], v[204:207], v[108:111], v[172:187]
  ds_read_b64_tr_b16 v[200:201], v3 offset:55296
  ds_read_b64_tr_b16 v[202:203], v3 offset:55808
  ds_read_b64_tr_b16 v[216:217], v233 offset:13824
  ds_read_b64_tr_b16 v[218:219], v233 offset:13952
  s_waitcnt vmcnt(10)
  s_waitcnt lgkmcnt(8)
  v_mfma_f32_32x32x16_bf16 v[156:171], v[192:195], v[112:115], v[156:171]
  buffer_load_dwordx4 v[148:151], v237, s[12:15], s31 offen
  s_add_u32 s31, s31, 65536
  v_mfma_f32_32x32x16_bf16 v[172:187], v[208:211], v[112:115], v[172:187]
  ds_read_b64_tr_b16 v[188:189], v3 offset:57344
  ds_read_b64_tr_b16 v[190:191], v3 offset:57856
  ds_read_b64_tr_b16 v[204:205], v233 offset:14336
  ds_read_b64_tr_b16 v[206:207], v233 offset:14464
  s_waitcnt vmcnt(9)
  s_waitcnt lgkmcnt(8)
  v_mfma_f32_32x32x16_bf16 v[156:171], v[196:199], v[116:119], v[156:171]
  buffer_load_dwordx4 v[152:155], v237, s[12:15], s31 offen
  s_add_u32 s31, s31, 65536
  s_cmp_eq_u32 s31, 7077888
  s_cselect_b32 s31, 4718592, s31
  v_lshlrev_b32 v8, 2, v253
  s_mov_b32 s25, 14422016
  buffer_load_dword v230, v8, s[12:15], s25 offen
  v_mfma_f32_32x32x16_bf16 v[172:187], v[212:215], v[116:119], v[172:187]
  ds_read_b64_tr_b16 v[192:193], v3 offset:59392
  ds_read_b64_tr_b16 v[194:195], v3 offset:59904
  ds_read_b64_tr_b16 v[208:209], v233 offset:14848
  ds_read_b64_tr_b16 v[210:211], v233 offset:14976
  s_waitcnt vmcnt(10)
  s_waitcnt lgkmcnt(8)
  v_mfma_f32_32x32x16_bf16 v[156:171], v[200:203], v[120:123], v[156:171]
  s_mov_b32 s25, 14430208
  buffer_load_dword v231, v8, s[12:15], s25 offen
  v_mfma_f32_32x32x16_bf16 v[172:187], v[216:219], v[120:123], v[172:187]
  s_waitcnt vmcnt(10)
  s_barrier
  ds_read_b64_tr_b16 v[196:197], v3 offset:0
  ds_read_b64_tr_b16 v[198:199], v3 offset:512
  ds_read_b64_tr_b16 v[212:213], v233 offset:15360
  ds_read_b64_tr_b16 v[214:215], v233 offset:15488
  s_waitcnt vmcnt(9)
  s_waitcnt lgkmcnt(8)
  v_mfma_f32_32x32x16_bf16 v[156:171], v[188:191], v[124:127], v[156:171]
  s_lshl_b32 s25, s30, 17
  s_add_u32 s25, s25, 14798848
  buffer_load_dwordx4 v[220:223], v252, s[12:15], s25 offen
  s_add_u32 s25, s25, 65536
  buffer_load_dwordx4 v[224:227], v252, s[12:15], s25 offen
  v_mfma_f32_32x32x16_bf16 v[172:187], v[204:207], v[124:127], v[172:187]
  ds_read_b64_tr_b16 v[200:201], v3 offset:2048
  ds_read_b64_tr_b16 v[202:203], v3 offset:2560
  ds_read_b64_tr_b16 v[216:217], v233 offset:15872
  ds_read_b64_tr_b16 v[218:219], v233 offset:16000
  s_waitcnt vmcnt(10)
  s_waitcnt lgkmcnt(8)
  v_mfma_f32_32x32x16_bf16 v[156:171], v[192:195], v[128:131], v[156:171]
  s_lshl_b32 s25, s29, 15
  s_add_u32 s25, s25, 16896000
  buffer_load_dwordx2 v[228:229], v254, s[12:15], s25 offen
  v_mfma_f32_32x32x16_bf16 v[172:187], v[208:211], v[128:131], v[172:187]
  ds_read_b64_tr_b16 v[188:189], v3 offset:4096
  ds_read_b64_tr_b16 v[190:191], v3 offset:4608
  ds_read_b64_tr_b16 v[204:205], v233 offset:16384
  ds_read_b64_tr_b16 v[206:207], v233 offset:16512
  s_waitcnt vmcnt(10)
  s_waitcnt lgkmcnt(8)
  v_mfma_f32_32x32x16_bf16 v[156:171], v[196:199], v[132:135], v[156:171]
  v_mfma_f32_32x32x16_bf16 v[172:187], v[212:215], v[132:135], v[172:187]
  ds_read_b64_tr_b16 v[192:193], v3 offset:6144
  ds_read_b64_tr_b16 v[194:195], v3 offset:6656
  ds_read_b64_tr_b16 v[208:209], v233 offset:16896
  ds_read_b64_tr_b16 v[210:211], v233 offset:17024
  s_waitcnt vmcnt(9)
  s_waitcnt lgkmcnt(8)
  v_mfma_f32_32x32x16_bf16 v[156:171], v[200:203], v[136:139], v[156:171]
  v_mfma_f32_32x32x16_bf16 v[172:187], v[216:219], v[136:139], v[172:187]
  ds_read_b64_tr_b16 v[196:197], v3 offset:8192
  ds_read_b64_tr_b16 v[198:199], v3 offset:8704
  ds_read_b64_tr_b16 v[212:213], v233 offset:17408
  ds_read_b64_tr_b16 v[214:215], v233 offset:17536
  s_waitcnt vmcnt(8)
  s_waitcnt lgkmcnt(8)
  v_mfma_f32_32x32x16_bf16 v[156:171], v[188:191], v[140:143], v[156:171]
  v_mfma_f32_32x32x16_bf16 v[172:187], v[204:207], v[140:143], v[172:187]
  ds_read_b64_tr_b16 v[200:201], v3 offset:10240
  ds_read_b64_tr_b16 v[202:203], v3 offset:10752
  ds_read_b64_tr_b16 v[216:217], v233 offset:17920
  ds_read_b64_tr_b16 v[218:219], v233 offset:18048
  s_waitcnt vmcnt(7)
  s_waitcnt lgkmcnt(8)
  v_mfma_f32_32x32x16_bf16 v[156:171], v[192:195], v[144:147], v[156:171]
  v_mfma_f32_32x32x16_bf16 v[172:187], v[208:211], v[144:147], v[172:187]
  s_waitcnt vmcnt(6)
  s_waitcnt lgkmcnt(4)
  v_mfma_f32_32x32x16_bf16 v[156:171], v[196:199], v[148:151], v[156:171]
  v_mfma_f32_32x32x16_bf16 v[172:187], v[212:215], v[148:151], v[172:187]
  s_waitcnt vmcnt(5)
  s_waitcnt lgkmcnt(0)
  v_mfma_f32_32x32x16_bf16 v[156:171], v[200:203], v[152:155], v[156:171]
  v_mfma_f32_32x32x16_bf16 v[172:187], v[216:219], v[152:155], v[172:187]
  s_waitcnt vmcnt(0)
  s_lshl_b32 s32, s30, 17
  s_add_u32 s32, s32, 7077888
  s_lshr_b32 s25, s30, 2
  s_lshl_b32 s25, s25, 15
  s_and_b32 s30, s30, 3
  s_lshl_b32 s30, s30, 2
  s_add_u32 s30, s30, s25
  s_add_u32 s30, s30, 14667776
  s_lshl_b32 s25, s29, 15
  s_add_u32 s25, s25, 9175040
  s_cmp_eq_u32 s29, 0
  s_mov_b32 s26, 0x40000000
  s_cselect_b32 s26, 14659584, s26
  v_mul_f32 v11, v230, v231
  v_mov_b32 v232, 0
  v_permlane32_swap_b32 v220, v222
  v_permlane32_swap_b32 v221, v223
  v_permlane32_swap_b32 v224, v226
  v_permlane32_swap_b32 v225, v227
  v_add_f32 v10, v176, v177
  v_add_f32 v9, v176, v177
  s_barrier
  s_cmp_eq_u32 s22, 1
  v_permlane32_swap_b32 v10, v9
  s_cbranch_scc1 Lnox_42
  v_lshlrev_b32 v8, 16, v228
  v_fma_f32 v9, v8, v231, -v11
  v_sub_f32 v172, v172, v10
  v_add_f32 v172, v172, v9
  v_fmac_f32 v232, v172, v172
  v_and_b32 v8, 0xffff0000, v228
  v_fma_f32 v9, v8, v231, -v11
  v_sub_f32 v173, v173, v10
  v_add_f32 v173, v173, v9
  v_fmac_f32 v232, v173, v173
  v_lshlrev_b32 v8, 16, v229
  v_fma_f32 v9, v8, v231, -v11
  v_sub_f32 v174, v174, v10
  v_add_f32 v174, v174, v9
  v_fmac_f32 v232, v174, v174
  v_and_b32 v8, 0xffff0000, v229
  v_fma_f32 v9, v8, v231, -v11
  v_sub_f32 v175, v175, v10
  v_add_f32 v175, v175, v9
  v_fmac_f32 v232, v175, v175
  v_cvt_pk_bf16_f32 v172, v172, v173
  v_cvt_pk_bf16_f32 v173, v174, v175
  v_lshlrev_b32 v9, 2, v253
  buffer_store_dwordx2 v[172:173], v254, s[12:15], s25 offen sc1
  buffer_store_dword v10, v9, s[12:15], s26 offen sc1
Lnox_42:
  v_lshlrev_b32 v8, 16, v220
  v_fma_f32 v9, v8, v231, -v11
  v_sub_f32 v156, v156, v10
  v_add_f32 v156, v156, v9
  v_fmac_f32 v232, v156, v156
  v_and_b32 v8, 0xffff0000, v220
  v_fma_f32 v9, v8, v231, -v11
  v_sub_f32 v157, v157, v10
  v_add_f32 v157, v157, v9
  v_fmac_f32 v232, v157, v157
  v_lshlrev_b32 v8, 16, v221
  v_fma_f32 v9, v8, v231, -v11
  v_sub_f32 v158, v158, v10
  v_add_f32 v158, v158, v9
  v_fmac_f32 v232, v158, v158
  v_and_b32 v8, 0xffff0000, v221
  v_fma_f32 v9, v8, v231, -v11
  v_sub_f32 v159, v159, v10
  v_add_f32 v159, v159, v9
  v_fmac_f32 v232, v159, v159
  v_lshlrev_b32 v8, 16, v222
  v_fma_f32 v9, v8, v231, -v11
  v_sub_f32 v160, v160, v10
  v_add_f32 v160, v160, v9
  v_fmac_f32 v232, v160, v160
  v_and_b32 v8, 0xffff0000, v222
  v_fma_f32 v9, v8, v231, -v11
  v_sub_f32 v161, v161, v10
  v_add_f32 v161, v161, v9
  v_fmac_f32 v232, v161, v161
  v_lshlrev_b32 v8, 16, v223
  v_fma_f32 v9, v8, v231, -v11
  v_sub_f32 v162, v162, v10
  v_add_f32 v162, v162, v9
  v_fmac_f32 v232, v162, v162
  v_and_b32 v8, 0xffff0000, v223
  v_fma_f32 v9, v8, v231, -v11
  v_sub_f32 v163, v163, v10
  v_add_f32 v163, v163, v9
  v_fmac_f32 v232, v163, v163
  v_lshlrev_b32 v8, 16, v224
  v_fma_f32 v9, v8, v231, -v11
  v_sub_f32 v164, v164, v10
  v_add_f32 v164, v164, v9
  v_fmac_f32 v232, v164, v164
  v_and_b32 v8, 0xffff0000, v224
  v_fma_f32 v9, v8, v231, -v11
  v_sub_f32 v165, v165, v10
  v_add_f32 v165, v165, v9
  v_fmac_f32 v232, v165, v165
  v_lshlrev_b32 v8, 16, v225
  v_fma_f32 v9, v8, v231, -v11
  v_sub_f32 v166, v166, v10
  v_add_f32 v166, v166, v9
  v_fmac_f32 v232, v166, v166
  v_and_b32 v8, 0xffff0000, v225
  v_fma_f32 v9, v8, v231, -v11
  v_sub_f32 v167, v167, v10
  v_add_f32 v167, v167, v9
  v_fmac_f32 v232, v167, v167
  v_lshlrev_b32 v8, 16, v226
  v_fma_f32 v9, v8, v231, -v11
  v_sub_f32 v168, v168, v10
  v_add_f32 v168, v168, v9
  v_fmac_f32 v232, v168, v168
  v_and_b32 v8, 0xffff0000, v226
  v_fma_f32 v9, v8, v231, -v11
  v_sub_f32 v169, v169, v10
  v_add_f32 v169, v169, v9
  v_fmac_f32 v232, v169, v169
  v_lshlrev_b32 v8, 16, v227
  v_fma_f32 v9, v8, v231, -v11
  v_sub_f32 v170, v170, v10
  v_add_f32 v170, v170, v9
  v_fmac_f32 v232, v170, v170
  v_and_b32 v8, 0xffff0000, v227
  v_fma_f32 v9, v8, v231, -v11
  v_sub_f32 v171, v171, v10
  v_add_f32 v171, v171, v9
  v_fmac_f32 v232, v171, v171
  v_mov_b32 v8, v232
  v_cvt_pk_bf16_f32 v156, v156, v157
  v_cvt_pk_bf16_f32 v157, v158, v159
  v_cvt_pk_bf16_f32 v158, v160, v161
  v_cvt_pk_bf16_f32 v159, v162, v163
  v_cvt_pk_bf16_f32 v160, v164, v165
  v_cvt_pk_bf16_f32 v161, v166, v167
  v_cvt_pk_bf16_f32 v162, v168, v169
  v_cvt_pk_bf16_f32 v163, v170, v171
  v_permlane32_swap_b32 v156, v158
  v_permlane32_swap_b32 v157, v159
  buffer_store_dwordx4 v[156:159], v252, s[12:15], s32 offen sc1
  s_add_u32 s32, s32, 65536
  v_permlane32_swap_b32 v160, v162
  v_permlane32_swap_b32 v161, v163
  buffer_store_dwordx4 v[160:163], v252, s[12:15], s32 offen sc1
  s_add_u32 s32, s32, 65536
  v_permlane32_swap_b32 v8, v232
  v_lshlrev_b32 v9, 4, v253
  v_add_f32 v8, v8, v232
  buffer_store_dword v8, v9, s[12:15], s30 offen sc1
  s_lshl_b32 s25, s34, 3
  s_add_u32 s25, s25, s29
  s_lshl_b32 s25, s25, 2
  s_add_u32 s25, s25, s20
  s_lshl_b32 s25, s25, 2
  s_add_u32 s25, s25, 36032512
  s_waitcnt vmcnt(0)
  v_mov_b32 v8, 1
  v_min_u32 v9, 1, v1
  v_lshlrev_b32 v9, 30, v9
  buffer_store_dword v8, v9, s[12:15], s25 offen sc1
  s_load_dwordx2 s[48:49], s[0:1], 16
  s_load_dwordx2 s[50:51], s[0:1], 64
  s_mul_i32 s25, s20, 24
  v_lshrrev_b32 v8, 3, v1
  v_lshlrev_b32 v9, 1, v8
  v_and_b32 v9, 4, v9
  v_xor_b32 v9, v9, v1
  v_and_b32 v9, 7, v9
  v_add_u32 v8, s25, v8
  v_mul_u32_u24 v8, 9216, v8
  v_lshl_add_u32 v2, v9, 4, v8
  s_mov_b32 s8, s42
  s_mov_b32 s9, s43
  s_mov_b32 s10, 5308416
  s_mul_i32 s27, s23, 1152
  s_add_u32 m0, s28, 0
  s_nop 0
  buffer_load_dwordx4 v2, s[8:11], s27 offen offset:0 lds
  s_add_u32 s27, s27, 72704
  buffer_load_dwordx4 v2, s[8:11], s27 offen offset:1024 lds
  s_add_u32 s27, s27, 72704
  buffer_load_dwordx4 v2, s[8:11], s27 offen offset:2048 lds
  s_add_u32 m0, s28, 12288
  s_add_u32 s27, s27, 739328
  buffer_load_dwordx4 v2, s[8:11], s27 offen offset:0 lds
  s_add_u32 s27, s27, 72704
  buffer_load_dwordx4 v2, s[8:11], s27 offen offset:1024 lds
  s_add_u32 s27, s27, 72704
  buffer_load_dwordx4 v2, s[8:11], s27 offen offset:2048 lds
  s_add_u32 m0, s28, 24576
  s_add_u32 s27, s27, 739328
  buffer_load_dwordx4 v2, s[8:11], s27 offen offset:0 lds
  s_add_u32 s27, s27, 72704
  buffer_load_dwordx4 v2, s[8:11], s27 offen offset:1024 lds
  s_add_u32 s27, s27, 72704
  buffer_load_dwordx4 v2, s[8:11], s27 offen offset:2048 lds
  s_add_u32 m0, s28, 36864
  s_add_u32 s27, s27, 739328
  buffer_load_dwordx4 v2, s[8:11], s27 offen offset:0 lds
  s_add_u32 s27, s27, 72704
  buffer_load_dwordx4 v2, s[8:11], s27 offen offset:1024 lds
  s_add_u32 s27, s27, 72704
  buffer_load_dwordx4 v2, s[8:11], s27 offen offset:2048 lds
  s_lshl_b32 s25, s24, 1
  s_add_u32 s25, s25, s21
  s_lshl_b32 s25, s25, 5
  v_and_b32 v253, 31, v1
  v_add_u32 v253, s25, v253
  v_lshrrev_b32 v8, 5, v1
  v_lshlrev_b32 v252, 15, v8
  v_lshl_add_u32 v252, v253, 4, v252
  v_lshrrev_b32 v8, 5, v1
  v_bfe_u32 v9, v1, 2, 2
  v_mad_u32_u24 v8, v8, 8, v9
  v_lshlrev_b32 v8, 7, v8
  v_lshrrev_b32 v9, 1, v9
  v_xor_b32 v9, s22, v9
  v_lshl_add_u32 v8, v9, 6, v8
  v_bfe_u32 v9, v1, 4, 1
  v_lshl_add_u32 v8, v9, 5, v8
  v_and_b32 v9, 3, v1
  v_lshl_add_u32 v3, v9, 3, v8
  s_lshl_b32 s25, s24, 7
  s_add_u32 s38, s25, 36036608
  s_add_u32 s25, s25, 36032512
  v_lshlrev_b32 v8, 2, v1
  s_mov_b32 s26, 0
  s_mov_b32 exec_hi, 0
Lpoll_43:
  buffer_load_dword v9, v8, s[12:15], s25 offen sc1
  s_add_u32 s26, s26, 1
  s_waitcnt vmcnt(0)
  v_cmp_ne_u32 vcc, 1, v9
  s_cbranch_vccz Lgot_44
  s_cmp_lt_u32 s26, 0x40000
  s_sleep 1
  s_cbranch_scc1 Lpoll_43
Lgot_44:
  s_mov_b64 exec, -1
  s_mov_b32 s35, 7077888
  v_mov_b32 v4, v252
  buffer_load_dwordx4 v[12:15], v4, s[12:15], s35 offen sc1
  s_add_u32 s35, s35, 65536
  buffer_load_dwordx4 v[16:19], v4, s[12:15], s35 offen sc1
  s_add_u32 s35, s35, 65536
  buffer_load_dwordx4 v[20:23], v4, s[12:15], s35 offen sc1
  s_add_u32 s35, s35, 65536
  buffer_load_dwordx4 v[24:27], v4, s[12:15], s35 offen sc1
  s_add_u32 s35, s35, 65536
  buffer_load_dwordx4 v[28:31], v4, s[12:15], s35 offen sc1
  s_add_u32 s35, s35, 65536
  buffer_load_dwordx4 v[32:35], v4, s[12:15], s35 offen sc1
  s_add_u32 s35, s35, 65536
  v_lshrrev_b32 v8, 5, v1
  v_lshlrev_b32 v8, 16, v8
  v_lshl_add_u32 v5, v253, 4, v8
  s_mov_b32 s29, 14667776
  s_mov_b32 s34, 14700544
  s_lshl_b32 s25, s20, 12
  s_add_u32 s25, s25, 61440
  v_lshl_add_u32 v0, v1, 4, s25
  s_mov_b32 s4, s44
  s_mov_b32 s5, s45
  s_mov_b32 s6, 5308416
  s_lshl_b32 s25, s22, 17
  s_add_u32 s46, s25, 17158144
  s_mul_i32 s39, s24, 1152
  s_add_u32 s39, s39, 36040704
  s_lshl_b32 s25, s23, 4
  s_add_u32 s33, s39, s25
  s_lshl_b32 s25, s20, 2
  s_add_u32 s33, s33, s25
  s_waitcnt lgkmcnt(0)
  s_waitcnt vmcnt(15)
  s_barrier
  ds_read_b64_tr_b16 v[188:189], v3 offset:0
  ds_read_b64_tr_b16 v[190:191], v3 offset:512
  ds_read_b64_tr_b16 v[192:193], v3 offset:2048
  ds_read_b64_tr_b16 v[194:195], v3 offset:2560
  ds_read_b64_tr_b16 v[196:197], v3 offset:4096
  ds_read_b64_tr_b16 v[198:199], v3 offset:4608
  ds_read_b64_tr_b16 v[200:201], v3 offset:6144
  ds_read_b64_tr_b16 v[202:203], v3 offset:6656
  s_setprio 2
  s_waitcnt vmcnt(5)
  s_waitcnt lgkmcnt(6)
  v_mfma_f32_32x32x16_bf16 v[156:171], v[188:191], v[12:15], 0
  ds_read_b64_tr_b16 v[252:253], v3 offset:8192
  ds_read_b64_tr_b16 v[254:255], v3 offset:8704
  buffer_load_dwordx4 v[36:39], v4, s[12:15], s35 offen sc1
  s_add_u32 s35, s35, 65536
  s_waitcnt vmcnt(5)
  s_waitcnt lgkmcnt(6)
  v_mfma_f32_32x32x16_bf16 v[156:171], v[192:195], v[16:19], v[156:171]
  ds_read_b64_tr_b16 v[188:189], v3 offset:10240
  ds_read_b64_tr_b16 v[190:191], v3 offset:10752
  buffer_load_dwordx4 v[40:43], v4, s[12:15], s35 offen sc1
  s_add_u32 s35, s35, 65536
  s_waitcnt vmcnt(5)
  s_waitcnt lgkmcnt(6)
  v_mfma_f32_32x32x16_bf16 v[156:171], v[196:199], v[20:23], v[156:171]
  s_barrier
  ds_read_b64_tr_b16 v[192:193], v3 offset:12288
  ds_read_b64_tr_b16 v[194:195], v3 offset:12800
  s_add_u32 m0, s28, 49152
  s_add_u32 s27, s27, 739328
  buffer_load_dwordx4 v2, s[8:11], s27 offen offset:0 lds
  buffer_load_dwordx4 v[44:47], v4, s[12:15], s35 offen sc1
  s_add_u32 s35, s35, 65536
  s_waitcnt vmcnt(6)
  s_waitcnt lgkmcnt(6)
  v_mfma_f32_32x32x16_bf16 v[156:171], v[200:203], v[24:27], v[156:171]
  ds_read_b64_tr_b16 v[196:197], v3 offset:14336
  ds_read_b64_tr_b16 v[198:199], v3 offset:14848
  buffer_load_dwordx4 v[48:51], v4, s[12:15], s35 offen sc1
  s_add_u32 s35, s35, 65536
  s_waitcnt vmcnt(6)
  s_waitcnt lgkmcnt(6)
  v_mfma_f32_32x32x16_bf16 v[156:171], v[252:255], v[28:31], v[156:171]
  ds_read_b64_tr_b16 v[200:201], v3 offset:16384
  ds_read_b64_tr_b16 v[202:203], v3 offset:16896
  s_add_u32 s27, s27, 72704
  buffer_load_dwordx4 v2, s[8:11], s27 offen offset:1024 lds
  buffer_load_dwordx4 v[52:55], v4, s[12:15], s35 offen sc1
  s_add_u32 s35, s35, 65536
  s_waitcnt vmcnt(7)
  s_waitcnt lgkmcnt(6)
  v_mfma_f32_32x32x16_bf16 v[156:171], v[188:191], v[32:35], v[156:171]
  ds_read_b64_tr_b16 v[252:253], v3 offset:18432
  ds_read_b64_tr_b16 v[254:255], v3 offset:18944
  buffer_load_dwordx4 v[56:59], v4, s[12:15], s35 offen sc1
  s_add_u32 s35, s35, 65536
  s_waitcnt vmcnt(7)
  s_waitcnt lgkmcnt(6)
  v_mfma_f32_32x32x16_bf16 v[156:171], v[192:195], v[36:39], v[156:171]
  ds_read_b64_tr_b16 v[188:189], v3 offset:20480
  ds_read_b64_tr_b16 v[190:191], v3 offset:20992
  s_add_u32 s27, s27, 72704
  buffer_load_dwordx4 v2, s[8:11], s27 offen offset:2048 lds
  buffer_load_dwordx4 v[60:63], v4, s[12:15], s35 offen sc1
  s_add_u32 s35, s35, 65536
  s_waitcnt vmcnt(8)
  s_waitcnt lgkmcnt(6)
  v_mfma_f32_32x32x16_bf16 v[156:171], v[196:199], v[40:43], v[156:171]
  ds_read_b64_tr_b16 v[192:193], v3 offset:22528
  ds_read_b64_tr_b16 v[194:195], v3 offset:23040
  buffer_load_dwordx4 v[64:67], v4, s[12:15], s35 offen sc1
  s_add_u32 s35, s35, 65536
  s_waitcnt vmcnt(7)
  s_waitcnt lgkmcnt(6)
  v_mfma_f32_32x32x16_bf16 v[156:171], v[200:203], v[44:47], v[156:171]
  s_barrier
  ds_read_b64_tr_b16 v[196:197], v3 offset:24576
  ds_read_b64_tr_b16 v[198:199], v3 offset:25088
  s_add_u32 m0, s28, 0
  s_add_u32 s27, s27, 739328
  buffer_load_dwordx4 v2, s[8:11], s27 offen offset:0 lds
  buffer_load_dwordx4 v[68:71], v4, s[12:15], s35 offen sc1
  s_add_u32 s35, s35, 65536
  s_waitcnt vmcnt(8)
  s_waitcnt lgkmcnt(6)
  v_mfma_f32_32x32x16_bf16 v[156:171], v[252:255], v[48:51], v[156:171]
  ds_read_b64_tr_b16 v[200:201], v3 offset:26624
  ds_read_b64_tr_b16 v[202:203], v3 offset:27136
  buffer_load_dwordx4 v[72:75], v4, s[12:15], s35 offen sc1
  s_add_u32 s35, s35, 65536
  s_waitcnt vmcnt(7)
  s_waitcnt lgkmcnt(6)
  v_mfma_f32_32x32x16_bf16 v[156:171], v[188:191], v[52:55], v[156:171]
  ds_read_b64_tr_b16 v[252:253], v3 offset:28672
  ds_read_b64_tr_b16 v[254:255], v3 offset:29184
  s_add_u32 s27, s27, 72704
  buffer_load_dwordx4 v2, s[8:11], s27 offen offset:1024 lds
  buffer_load_dwordx4 v[76:79], v4, s[12:15], s35 offen sc1
  s_add_u32 s35, s35, 65536
  s_waitcnt vmcnt(8)
  s_waitcnt lgkmcnt(6)
  v_mfma_f32_32x32x16_bf16 v[156:171], v[192:195], v[56:59], v[156:171]
  ds_read_b64_tr_b16 v[188:189], v3 offset:30720
  ds_read_b64_tr_b16 v[190:191], v3 offset:31232
  buffer_load_dwordx4 v[80:83], v4, s[12:15], s35 offen sc1
  s_add_u32 s35, s35, 65536
  s_waitcnt vmcnt(7)
  s_waitcnt lgkmcnt(6)
  v_mfma_f32_32x32x16_bf16 v[156:171], v[196:199], v[60:63], v[156:171]
  ds_read_b64_tr_b16 v[192:193], v3 offset:32768
  ds_read_b64_tr_b16 v[194:195], v3 offset:33280
  s_add_u32 s27, s27, 72704
  buffer_load_dwordx4 v2, s[8:11], s27 offen offset:2048 lds
  buffer_load_dwordx4 v[84:87], v4, s[12:15], s35 offen sc1
  s_add_u32 s35, s35, 65536
  s_waitcnt vmcnt(8)
  s_waitcnt lgkmcnt(6)
  v_mfma_f32_32x32x16_bf16 v[156:171], v[200:203], v[64:67], v[156:171]
  ds_read_b64_tr_b16 v[196:197], v3 offset:34816
  ds_read_b64_tr_b16 v[198:199], v3 offset:35328
  buffer_load_dwordx4 v[88:91], v4, s[12:15], s35 offen sc1
  s_add_u32 s35, s35, 65536
  s_waitcnt vmcnt(7)
  s_waitcnt lgkmcnt(6)
  v_mfma_f32_32x32x16_bf16 v[156:171], v[252:255], v[68:71], v[156:171]
  s_barrier
  ds_read_b64_tr_b16 v[200:201], v3 offset:36864
  ds_read_b64_tr_b16 v[202:203], v3 offset:37376
  s_add_u32 m0, s28, 12288
  s_add_u32 s27, s27, 4290398336
  buffer_load_dwordx4 v2, s[8:11], s27 offen offset:0 lds
  buffer_load_dwordx4 v[92:95], v4, s[12:15], s35 offen sc1
  s_add_u32 s35, s35, 65536
  s_waitcnt vmcnt(8)
  s_waitcnt lgkmcnt(6)
  v_mfma_f32_32x32x16_bf16 v[156:171], v[188:191], v[72:75], v[156:171]
  ds_read_b64_tr_b16 v[252:253], v3 offset:38912
  ds_read_b64_tr_b16 v[254:255], v3 offset:39424
  buffer_load_dwordx4 v[96:99], v4, s[12:15], s35 offen sc1
  s_add_u32 s35, s35, 65536
  s_waitcnt vmcnt(7)
  s_waitcnt lgkmcnt(6)
  v_mfma_f32_32x32x16_bf16 v[156:171], v[192:195], v[76:79], v[156:171]
  ds_read_b64_tr_b16 v[188:189], v3 offset:40960
  ds_read_b64_tr_b16 v[190:191], v3 offset:41472
  s_add_u32 s27, s27, 72704
  buffer_load_dwordx4 v2, s[8:11], s27 offen offset:1024 lds
  buffer_load_dwordx4 v[100:103], v4, s[12:15], s35 offen sc1
  s_add_u32 s35, s35, 65536
  s_waitcnt vmcnt(8)
  s_waitcnt lgkmcnt(6)
  v_mfma_f32_32x32x16_bf16 v[156:171], v[196:199], v[80:83], v[156:171]
  ds_read_b64_tr_b16 v[192:193], v3 offset:43008
  ds_read_b64_tr_b16 v[194:195], v3 offset:43520
  buffer_load_dwordx4 v[104:107], v4, s[12:15], s35 offen sc1
  s_add_u32 s35, s35, 65536
  s_waitcnt vmcnt(7)
  s_waitcnt lgkmcnt(6)
  v_mfma_f32_32x32x16_bf16 v[156:171], v[200:203], v[84:87], v[156:171]
  ds_read_b64_tr_b16 v[196:197], v3 offset:45056
  ds_read_b64_tr_b16 v[198:199], v3 offset:45568
  s_add_u32 s27, s27, 72704
  buffer_load_dwordx4 v2, s[8:11], s27 offen offset:2048 lds
  buffer_load_dwordx4 v[108:111], v4, s[12:15], s35 offen sc1
  s_add_u32 s35, s35, 65536
  s_waitcnt vmcnt(8)
  s_waitcnt lgkmcnt(6)
  v_mfma_f32_32x32x16_bf16 v[156:171], v[252:255], v[88:91], v[156:171]
  ds_read_b64_tr_b16 v[200:201], v3 offset:47104
  ds_read_b64_tr_b16 v[202:203], v3 offset:47616
  buffer_load_dwordx4 v[112:115], v4, s[12:15], s35 offen sc1
  s_add_u32 s35, s35, 65536
  s_waitcnt vmcnt(7)
  s_waitcnt lgkmcnt(6)
  v_mfma_f32_32x32x16_bf16 v[156:171], v[188:191], v[92:95], v[156:171]
  s_barrier
  ds_read_b64_tr_b16 v[252:253], v3 offset:49152
  ds_read_b64_tr_b16 v[254:255], v3 offset:49664
  s_add_u32 m0, s28, 24576
  s_add_u32 s27, s27, 739328
  buffer_load_dwordx4 v2, s[8:11], s27 offen offset:0 lds
  buffer_load_dwordx4 v[116:119], v4, s[12:15], s35 offen sc1
  s_add_u32 s35, s35, 65536
  s_waitcnt vmcnt(8)
  s_waitcnt lgkmcnt(6)
  v_mfma_f32_32x32x16_bf16 v[156:171], v[192:195], v[96:99], v[156:171]
  ds_read_b64_tr_b16 v[188:189], v3 offset:51200
  ds_read_b64_tr_b16 v[190:191], v3 offset:51712
  buffer_load_dwordx4 v[120:123], v4, s[12:15], s35 offen sc1
  s_add_u32 s35, s35, 65536
  s_waitcnt vmcnt(7)
  s_waitcnt lgkmcnt(6)
  v_mfma_f32_32x32x16_bf16 v[156:171], v[196:199], v[100:103], v[156:171]
  ds_read_b64_tr_b16 v[192:193], v3 offset:53248
  ds_read_b64_tr_b16 v[194:195], v3 offset:53760
  s_add_u32 s27, s27, 72704
  buffer_load_dwordx4 v2, s[8:11], s27 offen offset:1024 lds
  buffer_load_dwordx4 v[124:127], v4, s[12:15], s35 offen sc1
  s_add_u32 s35, s35, 65536
  s_waitcnt vmcnt(8)
  s_waitcnt lgkmcnt(6)
  v_mfma_f32_32x32x16_bf16 v[156:171], v[200:203], v[104:107], v[156:171]
  ds_read_b64_tr_b16 v[196:197], v3 offset:55296
  ds_read_b64_tr_b16 v[198:199], v3 offset:55808
  buffer_load_dwordx4 v[128:131], v4, s[12:15], s35 offen sc1
  s_add_u32 s35, s35, 65536
  s_waitcnt vmcnt(7)
  s_waitcnt lgkmcnt(6)
  v_mfma_f32_32x32x16_bf16 v[156:171], v[252:255], v[108:111], v[156:171]
  ds_read_b64_tr_b16 v[200:201], v3 offset:57344
  ds_read_b64_tr_b16 v[202:203], v3 offset:57856
  s_add_u32 s27, s27, 72704
  buffer_load_dwordx4 v2, s[8:11], s27 offen offset:2048 lds
  buffer_load_dwordx4 v[132:135], v4, s[12:15], s35 offen sc1
  s_add_u32 s35, s35, 65536
  s_waitcnt vmcnt(8)
  s_waitcnt lgkmcnt(6)
  v_mfma_f32_32x32x16_bf16 v[156:171], v[188:191], v[112:115], v[156:171]
  ds_read_b64_tr_b16 v[252:253], v3 offset:59392
  ds_read_b64_tr_b16 v[254:255], v3 offset:59904
  buffer_load_dwordx4 v[136:139], v4, s[12:15], s35 offen sc1
  s_add_u32 s35, s35, 65536
  s_waitcnt vmcnt(7)
  s_waitcnt lgkmcnt(6)
  v_mfma_f32_32x32x16_bf16 v[156:171], v[192:195], v[116:119], v[156:171]
  s_barrier
  ds_read_b64_tr_b16 v[188:189], v3 offset:0
  ds_read_b64_tr_b16 v[190:191], v3 offset:512
  s_add_u32 m0, s28, 36864
  s_add_u32 s27, s27, 739328
  buffer_load_dwordx4 v2, s[8:11], s27 offen offset:0 lds
  buffer_load_dwordx4 v[140:143], v4, s[12:15], s35 offen sc1
  s_add_u32 s35, s35, 65536
  s_waitcnt vmcnt(8)
  s_waitcnt lgkmcnt(6)
  v_mfma_f32_32x32x16_bf16 v[156:171], v[196:199], v[120:123], v[156:171]
  ds_read_b64_tr_b16 v[192:193], v3 offset:2048
  ds_read_b64_tr_b16 v[194:195], v3 offset:2560
  buffer_load_dwordx4 v[144:147], v4, s[12:15], s35 offen sc1
  s_add_u32 s35, s35, 65536
  s_waitcnt vmcnt(7)
  s_waitcnt lgkmcnt(6)
  v_mfma_f32_32x32x16_bf16 v[156:171], v[200:203], v[124:127], v[156:171]
  ds_read_b64_tr_b16 v[196:197], v3 offset:4096
  ds_read_b64_tr_b16 v[198:199], v3 offset:4608
  s_add_u32 s27, s27, 72704
  buffer_load_dwordx4 v2, s[8:11], s27 offen offset:1024 lds
  buffer_load_dwordx4 v[148:151], v4, s[12:15], s35 offen sc1
  s_add_u32 s35, s35, 65536
  s_waitcnt vmcnt(8)
  s_waitcnt lgkmcnt(6)
  v_mfma_f32_32x32x16_bf16 v[156:171], v[252:255], v[128:131], v[156:171]
  ds_read_b64_tr_b16 v[200:201], v3 offset:6144
  ds_read_b64_tr_b16 v[202:203], v3 offset:6656
  buffer_load_dwordx4 v[152:155], v4, s[12:15], s35 offen sc1
  s_add_u32 s35, s35, 65536
  s_waitcnt vmcnt(7)
  s_waitcnt lgkmcnt(6)
  v_mfma_f32_32x32x16_bf16 v[156:171], v[188:191], v[132:135], v[156:171]
  ds_read_b64_tr_b16 v[252:253], v3 offset:8192
  ds_read_b64_tr_b16 v[254:255], v3 offset:8704
  s_add_u32 s27, s27, 72704
  buffer_load_dwordx4 v2, s[8:11], s27 offen offset:2048 lds
  buffer_load_dwordx4 v[204:207], v5, s[12:15], s29 offen sc1
  buffer_load_dwordx4 v[208:211], v5, s[12:15], s34 offen sc1
  s_waitcnt vmcnt(9)
  s_waitcnt lgkmcnt(6)
  v_mfma_f32_32x32x16_bf16 v[156:171], v[192:195], v[136:139], v[156:171]
  ds_read_b64_tr_b16 v[188:189], v3 offset:10240
  ds_read_b64_tr_b16 v[190:191], v3 offset:10752
  s_waitcnt vmcnt(7)
  s_waitcnt lgkmcnt(6)
  v_mfma_f32_32x32x16_bf16 v[156:171], v[196:199], v[140:143], v[156:171]
  s_barrier
  ds_read_b64_tr_b16 v[192:193], v3 offset:12288
  ds_read_b64_tr_b16 v[194:195], v3 offset:12800
  s_add_u32 m0, s28, 49152
  s_add_u32 s27, s27, 739328
  buffer_load_dwordx4 v2, s[8:11], s27 offen offset:0 lds
  s_waitcnt vmcnt(7)
  s_waitcnt lgkmcnt(6)
  v_mfma_f32_32x32x16_bf16 v[156:171], v[200:203], v[144:147], v[156:171]
  ds_read_b64_tr_b16 v[196:197], v3 offset:14336
  ds_read_b64_tr_b16 v[198:199], v3 offset:14848
  s_waitcnt vmcnt(5)
  s_waitcnt lgkmcnt(6)
  v_mfma_f32_32x32x16_bf16 v[156:171], v[252:255], v[148:151], v[156:171]
  ds_read_b64_tr_b16 v[200:201], v3 offset:16384
  ds_read_b64_tr_b16 v[202:203], v3 offset:16896
  s_add_u32 s27, s27, 72704
  buffer_load_dwordx4 v2, s[8:11], s27 offen offset:1024 lds
  s_waitcnt vmcnt(5)
  s_waitcnt lgkmcnt(6)
  v_mfma_f32_32x32x16_bf16 v[156:171], v[188:191], v[152:155], v[156:171]
  ds_read_b64_tr_b16 v[252:253], v3 offset:18432
  ds_read_b64_tr_b16 v[254:255], v3 offset:18944
  s_waitcnt lgkmcnt(6)
  v_mfma_f32_32x32x16_bf16 v[172:187], v[192:195], v[12:15], 0
  ds_read_b64_tr_b16 v[188:189], v3 offset:20480
  ds_read_b64_tr_b16 v[190:191], v3 offset:20992
  s_add_u32 s27, s27, 72704
  buffer_load_dwordx4 v2, s[8:11], s27 offen offset:2048 lds
  s_waitcnt vmcnt(3)
  v_add_f32 v204, v204, v205
  v_add_f32 v204, v204, v206
  v_add_f32 v204, v204, v207
  v_add_f32 v204, v204, v208
  v_add_f32 v204, v204, v209
  v_add_f32 v204, v204, v210
  s_waitcnt lgkmcnt(6)
  v_mfma_f32_32x32x16_bf16 v[172:187], v[196:199], v[16:19], v[172:187]
  ds_read_b64_tr_b16 v[192:193], v3 offset:22528
  ds_read_b64_tr_b16 v[194:195], v3 offset:23040
  v_add_f32 v204, v204, v211
  v_mov_b32 v205, v204
  v_mov_b32 v8, 0x3727c5ac
  s_nop 0
  v_permlane32_swap_b32 v204, v205
  v_add_f32 v204, v204, v205
  v_fmac_f32 v8, 0x3ae38e39, v204
  s_waitcnt lgkmcnt(6)
  v_mfma_f32_32x32x16_bf16 v[172:187], v[200:203], v[20:23], v[172:187]
  s_barrier
  ds_read_b64_tr_b16 v[196:197], v3 offset:24576
  ds_read_b64_tr_b16 v[198:199], v3 offset:25088
  s_add_u32 m0, s28, 0
  s_add_u32 s27, s27, 739328
  buffer_load_dwordx4 v2, s[8:11], s27 offen offset:0 lds
  v_rsq_f32 v9, v8
  v_sqrt_f32 v7, v8
  s_nop 0
  v_mul_f32 v5, 0xc0135761, v9
  v_mul_f32 v6, v9, v9
  v_mul_f32 v6, v6, v9
  v_mul_f32 v6, 0xbdd2d3e8, v6
  s_waitcnt lgkmcnt(6)
  v_mfma_f32_32x32x16_bf16 v[172:187], v[252:255], v[24:27], v[172:187]
  ds_read_b64_tr_b16 v[200:201], v3 offset:26624
  ds_read_b64_tr_b16 v[202:203], v3 offset:27136
  v_mul_f32 v8, v156, v156
  v_mul_f32 v9, v157, v157
  v_mul_f32 v10, v158, v158
  v_mul_f32 v11, v159, v159
  v_fma_f32 v8, v8, v6, v5
  s_waitcnt lgkmcnt(6)
  v_mfma_f32_32x32x16_bf16 v[172:187], v[188:191], v[28:31], v[172:187]
  ds_read_b64_tr_b16 v[252:253], v3 offset:28672
  ds_read_b64_tr_b16 v[254:255], v3 offset:29184
  v_fma_f32 v9, v9, v6, v5
  v_fma_f32 v10, v10, v6, v5
  v_fma_f32 v11, v11, v6, v5
  v_mul_f32 v8, v8, v156
  s_add_u32 s27, s27, 72704
  buffer_load_dwordx4 v2, s[8:11], s27 offen offset:1024 lds
  s_waitcnt lgkmcnt(6)
  v_mfma_f32_32x32x16_bf16 v[172:187], v[192:195], v[32:35], v[172:187]
  ds_read_b64_tr_b16 v[188:189], v3 offset:30720
  ds_read_b64_tr_b16 v[190:191], v3 offset:31232
  v_mul_f32 v9, v9, v157
  v_mul_f32 v10, v10, v158
  v_mul_f32 v11, v11, v159
  v_exp_f32 v8, v8
  s_waitcnt lgkmcnt(6)
  v_mfma_f32_32x32x16_bf16 v[172:187], v[196:199], v[36:39], v[172:187]
  ds_read_b64_tr_b16 v[192:193], v3 offset:32768
  ds_read_b64_tr_b16 v[194:195], v3 offset:33280
  v_exp_f32 v9, v9
  v_exp_f32 v10, v10
  v_exp_f32 v11, v11
  v_fma_f32 v8, v8, v7, v7
  s_add_u32 s27, s27, 72704
  buffer_load_dwordx4 v2, s[8:11], s27 offen offset:2048 lds
  s_waitcnt lgkmcnt(6)
  v_mfma_f32_32x32x16_bf16 v[172:187], v[200:203], v[40:43], v[172:187]
  ds_read_b64_tr_b16 v[196:197], v3 offset:34816
  ds_read_b64_tr_b16 v[198:199], v3 offset:35328
  v_fma_f32 v9, v9, v7, v7
  v_fma_f32 v10, v10, v7, v7
  v_fma_f32 v11, v11, v7, v7
  v_rcp_f32 v8, v8
  v_rcp_f32 v9, v9
  s_waitcnt lgkmcnt(6)
  v_mfma_f32_32x32x16_bf16 v[172:187], v[252:255], v[44:47], v[172:187]
  s_barrier
  ds_read_b64_tr_b16 v[200:201], v3 offset:36864
  ds_read_b64_tr_b16 v[202:203], v3 offset:37376
  v_rcp_f32 v10, v10
  v_rcp_f32 v11, v11
  v_mul_f32 v156, v156, v8
  v_mul_f32 v157, v157, v9
  s_add_u32 m0, s28, 12288
  s_add_u32 s27, s27, 739328
  buffer_load_dwordx4 v2, s[8:11], s27 offen offset:0 lds
  s_waitcnt lgkmcnt(6)
  v_mfma_f32_32x32x16_bf16 v[172:187], v[188:191], v[48:51], v[172:187]
  ds_read_b64_tr_b16 v[252:253], v3 offset:38912
  ds_read_b64_tr_b16 v[254:255], v3 offset:39424
  v_mul_f32 v158, v158, v10
  v_mul_f32 v159, v159, v11
  v_cvt_pk_bf16_f32 v156, v156, v157
  v_cvt_pk_bf16_f32 v157, v158, v159
  s_waitcnt lgkmcnt(6)
  v_mfma_f32_32x32x16_bf16 v[172:187], v[192:195], v[52:55], v[172:187]
  ds_read_b64_tr_b16 v[188:189], v3 offset:40960
  ds_read_b64_tr_b16 v[190:191], v3 offset:41472
  v_mul_f32 v8, v160, v160
  v_mul_f32 v9, v161, v161
  v_mul_f32 v10, v162, v162
  v_mul_f32 v11, v163, v163
  s_add_u32 s27, s27, 72704
  buffer_load_dwordx4 v2, s[8:11], s27 offen offset:1024 lds
  s_waitcnt lgkmcnt(6)
  v_mfma_f32_32x32x16_bf16 v[172:187], v[196:199], v[56:59], v[172:187]
  ds_read_b64_tr_b16 v[192:193], v3 offset:43008
  ds_read_b64_tr_b16 v[194:195], v3 offset:43520
  v_fma_f32 v8, v8, v6, v5
  v_fma_f32 v9, v9, v6, v5
  v_fma_f32 v10, v10, v6, v5
  v_fma_f32 v11, v11, v6, v5
  s_waitcnt lgkmcnt(6)
  v_mfma_f32_32x32x16_bf16 v[172:187], v[200:203], v[60:63], v[172:187]
  ds_read_b64_tr_b16 v[196:197], v3 offset:45056
  ds_read_b64_tr_b16 v[198:199], v3 offset:45568
  v_mul_f32 v8, v8, v160
  v_mul_f32 v9, v9, v161
  v_mul_f32 v10, v10, v162
  v_mul_f32 v11, v11, v163
  v_exp_f32 v8, v8
  s_add_u32 s27, s27, 72704
  buffer_load_dwordx4 v2, s[8:11], s27 offen offset:2048 lds
  s_waitcnt lgkmcnt(6)
  v_mfma_f32_32x32x16_bf16 v[172:187], v[252:255], v[64:67], v[172:187]
  ds_read_b64_tr_b16 v[200:201], v3 offset:47104
  ds_read_b64_tr_b16 v[202:203], v3 offset:47616
  v_exp_f32 v9, v9
  v_exp_f32 v10, v10
  v_exp_f32 v11, v11
  v_fma_f32 v8, v8, v7, v7
  s_waitcnt lgkmcnt(6)
  v_mfma_f32_32x32x16_bf16 v[172:187], v[188:191], v[68:71], v[172:187]
  s_waitcnt vmcnt(6)
  s_barrier
  ds_read_b64_tr_b16 v[252:253], v3 offset:49152
  ds_read_b64_tr_b16 v[254:255], v3 offset:49664
  v_fma_f32 v9, v9, v7, v7
  v_fma_f32 v10, v10, v7, v7
  v_fma_f32 v11, v11, v7, v7
  v_rcp_f32 v8, v8
  s_add_u32 m0, s28, 24576
  s_add_u32 s27, s27, 4290398336
  buffer_load_dwordx4 v2, s[8:11], s27 offen offset:0 lds
  s_waitcnt lgkmcnt(6)
  v_mfma_f32_32x32x16_bf16 v[172:187], v[192:195], v[72:75], v[172:187]
  ds_read_b64_tr_b16 v[188:189], v3 offset:51200
  ds_read_b64_tr_b16 v[190:191], v3 offset:51712
  v_rcp_f32 v9, v9
  v_rcp_f32 v10, v10
  v_rcp_f32 v11, v11
  v_mul_f32 v160, v160, v8
  s_waitcnt lgkmcnt(6)
  v_mfma_f32_32x32x16_bf16 v[172:187], v[196:199], v[76:79], v[172:187]
  ds_read_b64_tr_b16 v[192:193], v3 offset:53248
  ds_read_b64_tr_b16 v[194:195], v3 offset:53760
  v_mul_f32 v161, v161, v9
  v_mul_f32 v162, v162, v10
  v_mul_f32 v163, v163, v11
  v_cvt_pk_bf16_f32 v158, v160, v161
  s_add_u32 s27, s27, 72704
  buffer_load_dwordx4 v2, s[8:11], s27 offen offset:1024 lds
  s_waitcnt lgkmcnt(6)
  v_mfma_f32_32x32x16_bf16 v[172:187], v[200:203], v[80:83], v[172:187]
  ds_read_b64_tr_b16 v[196:197], v3 offset:55296
  ds_read_b64_tr_b16 v[198:199], v3 offset:55808
  v_cvt_pk_bf16_f32 v159, v162, v163
  v_mul_f32 v8, v164, v164
  v_mul_f32 v9, v165, v165
  v_mul_f32 v10, v166, v166
  v_mul_f32 v11, v167, v167
  s_waitcnt lgkmcnt(6)
  v_mfma_f32_32x32x16_bf16 v[172:187], v[252:255], v[84:87], v[172:187]
  ds_read_b64_tr_b16 v[200:201], v3 offset:57344
  ds_read_b64_tr_b16 v[202:203], v3 offset:57856
  v_fma_f32 v8, v8, v6, v5
  v_fma_f32 v9, v9, v6, v5
  v_fma_f32 v10, v10, v6, v5
  v_fma_f32 v11, v11, v6, v5
  s_add_u32 s27, s27, 72704
  buffer_load_dwordx4 v2, s[8:11], s27 offen offset:2048 lds
  s_waitcnt lgkmcnt(6)
  v_mfma_f32_32x32x16_bf16 v[172:187], v[188:191], v[88:91], v[172:187]
  ds_read_b64_tr_b16 v[252:253], v3 offset:59392
  ds_read_b64_tr_b16 v[254:255], v3 offset:59904
  v_mul_f32 v8, v8, v164
  v_mul_f32 v9, v9, v165
  v_mul_f32 v10, v10, v166
  v_mul_f32 v11, v11, v167
  s_waitcnt lgkmcnt(6)
  v_mfma_f32_32x32x16_bf16 v[172:187], v[192:195], v[92:95], v[172:187]
  s_waitcnt vmcnt(6)
  s_barrier
  ds_read_b64_tr_b16 v[188:189], v3 offset:0
  ds_read_b64_tr_b16 v[190:191], v3 offset:512
  v_exp_f32 v8, v8
  v_exp_f32 v9, v9
  v_exp_f32 v10, v10
  v_exp_f32 v11, v11
  s_add_u32 m0, s28, 36864
  s_add_u32 s27, s27, 739328
  buffer_load_dwordx4 v2, s[8:11], s27 offen offset:0 lds
  s_waitcnt lgkmcnt(6)
  v_mfma_f32_32x32x16_bf16 v[172:187], v[196:199], v[96:99], v[172:187]
  ds_read_b64_tr_b16 v[192:193], v3 offset:2048
  ds_read_b64_tr_b16 v[194:195], v3 offset:2560
  v_fma_f32 v8, v8, v7, v7
  v_fma_f32 v9, v9, v7, v7
  v_fma_f32 v10, v10, v7, v7
  v_fma_f32 v11, v11, v7, v7
  s_waitcnt lgkmcnt(6)
  v_mfma_f32_32x32x16_bf16 v[172:187], v[200:203], v[100:103], v[172:187]
  ds_read_b64_tr_b16 v[196:197], v3 offset:4096
  ds_read_b64_tr_b16 v[198:199], v3 offset:4608
  v_rcp_f32 v8, v8
  v_rcp_f32 v9, v9
  v_rcp_f32 v10, v10
  v_rcp_f32 v11, v11
  v_mul_f32 v164, v164, v8
  s_add_u32 s27, s27, 72704
  buffer_load_dwordx4 v2, s[8:11], s27 offen offset:1024 lds
  s_waitcnt lgkmcnt(6)
  v_mfma_f32_32x32x16_bf16 v[172:187], v[252:255], v[104:107], v[172:187]
  ds_read_b64_tr_b16 v[200:201], v3 offset:6144
  ds_read_b64_tr_b16 v[202:203], v3 offset:6656
  v_mul_f32 v165, v165, v9
  v_mul_f32 v166, v166, v10
  v_mul_f32 v167, v167, v11
  v_cvt_pk_bf16_f32 v160, v164, v165
  s_waitcnt lgkmcnt(6)
  v_mfma_f32_32x32x16_bf16 v[172:187], v[188:191], v[108:111], v[172:187]
  ds_read_b64_tr_b16 v[252:253], v3 offset:8192
  ds_read_b64_tr_b16 v[254:255], v3 offset:8704
  v_cvt_pk_bf16_f32 v161, v166, v167
  v_mul_f32 v8, v168, v168
  v_mul_f32 v9, v169, v169
  v_mul_f32 v10, v170, v170
  s_add_u32 s27, s27, 72704
  buffer_load_dwordx4 v2, s[8:11], s27 offen offset:2048 lds
  s_waitcnt lgkmcnt(6)
  v_mfma_f32_32x32x16_bf16 v[172:187], v[192:195], v[112:115], v[172:187]
  ds_read_b64_tr_b16 v[188:189], v3 offset:10240
  ds_read_b64_tr_b16 v[190:191], v3 offset:10752
  v_mul_f32 v11, v171, v171
  v_fma_f32 v8, v8, v6, v5
  v_fma_f32 v9, v9, v6, v5
  v_fma_f32 v10, v10, v6, v5
  s_waitcnt lgkmcnt(6)
  v_mfma_f32_32x32x16_bf16 v[172:187], v[196:199], v[116:119], v[172:187]
  s_waitcnt vmcnt(6)
  s_barrier
  ds_read_b64_tr_b16 v[192:193], v3 offset:12288
  ds_read_b64_tr_b16 v[194:195], v3 offset:12800
  v_fma_f32 v11, v11, v6, v5
  v_mul_f32 v8, v8, v168
  v_mul_f32 v9, v9, v169
  v_mul_f32 v10, v10, v170
  s_add_u32 m0, s28, 49152
  s_add_u32 s27, s27, 739328
  buffer_load_dwordx4 v2, s[8:11], s27 offen offset:0 lds
  s_waitcnt lgkmcnt(6)
  v_mfma_f32_32x32x16_bf16 v[172:187], v[200:203], v[120:123], v[172:187]
  ds_read_b64_tr_b16 v[196:197], v3 offset:14336
  ds_read_b64_tr_b16 v[198:199], v3 offset:14848
  v_mul_f32 v11, v11, v171
  v_exp_f32 v8, v8
  v_exp_f32 v9, v9
  v_exp_f32 v10, v10
  v_exp_f32 v11, v11
  s_waitcnt lgkmcnt(6)
  v_mfma_f32_32x32x16_bf16 v[172:187], v[252:255], v[124:127], v[172:187]
  ds_read_b64_tr_b16 v[200:201], v3 offset:16384
  ds_read_b64_tr_b16 v[202:203], v3 offset:16896
  v_fma_f32 v8, v8, v7, v7
  v_fma_f32 v9, v9, v7, v7
  v_fma_f32 v10, v10, v7, v7
  v_fma_f32 v11, v11, v7, v7
  s_add_u32 s27, s27, 72704
  buffer_load_dwordx4 v2, s[8:11], s27 offen offset:1024 lds
  s_waitcnt lgkmcnt(6)
  v_mfma_f32_32x32x16_bf16 v[172:187], v[188:191], v[128:131], v[172:187]
  ds_read_b64_tr_b16 v[252:253], v3 offset:18432
  ds_read_b64_tr_b16 v[254:255], v3 offset:18944
  v_rcp_f32 v8, v8
  v_rcp_f32 v9, v9
  v_rcp_f32 v10, v10
  v_rcp_f32 v11, v11
  s_waitcnt lgkmcnt(6)
  v_mfma_f32_32x32x16_bf16 v[172:187], v[192:195], v[132:135], v[172:187]
  ds_read_b64_tr_b16 v[188:189], v3 offset:20480
  ds_read_b64_tr_b16 v[190:191], v3 offset:20992
  v_mul_f32 v168, v168, v8
  v_mul_f32 v169, v169, v9
  v_mul_f32 v170, v170, v10
  v_mul_f32 v171, v171, v11
  s_add_u32 s27, s27, 72704
  buffer_load_dwordx4 v2, s[8:11], s27 offen offset:2048 lds
  s_waitcnt lgkmcnt(6)
  v_mfma_f32_32x32x16_bf16 v[172:187], v[196:199], v[136:139], v[172:187]
  ds_read_b64_tr_b16 v[192:193], v3 offset:22528
  ds_read_b64_tr_b16 v[194:195], v3 offset:23040
  v_cvt_pk_bf16_f32 v162, v168, v169
  v_cvt_pk_bf16_f32 v163, v170, v171
  ds_write_b128 v0, v[156:159] offset:0
  ds_write_b128 v0, v[160:163] offset:1024
  s_waitcnt lgkmcnt(6)
  v_mfma_f32_32x32x16_bf16 v[172:187], v[200:203], v[140:143], v[172:187]
  s_waitcnt vmcnt(6)
  s_barrier
  ds_read_b64_tr_b16 v[196:197], v3 offset:24576
  ds_read_b64_tr_b16 v[198:199], v3 offset:25088
  s_add_u32 m0, s28, 0
  s_add_u32 s27, s27, 739328
  buffer_load_dwordx4 v2, s[8:11], s27 offen offset:0 lds
  s_waitcnt lgkmcnt(6)
  v_mfma_f32_32x32x16_bf16 v[172:187], v[252:255], v[144:147], v[172:187]
  ds_read_b64_tr_b16 v[200:201], v3 offset:26624
  ds_read_b64_tr_b16 v[202:203], v3 offset:27136
  s_waitcnt lgkmcnt(6)
  v_mfma_f32_32x32x16_bf16 v[172:187], v[188:191], v[148:151], v[172:187]
  ds_read_b64_tr_b16 v[252:253], v3 offset:28672
  ds_read_b64_tr_b16 v[254:255], v3 offset:29184
  s_add_u32 s27, s27, 72704
  buffer_load_dwordx4 v2, s[8:11], s27 offen offset:1024 lds
  s_waitcnt lgkmcnt(6)
  v_mfma_f32_32x32x16_bf16 v[172:187], v[192:195], v[152:155], v[172:187]
  ds_read_b64_tr_b16 v[188:189], v3 offset:30720
  ds_read_b64_tr_b16 v[190:191], v3 offset:31232
  s_waitcnt lgkmcnt(6)
  v_mfma_f32_32x32x16_bf16 v[156:171], v[196:199], v[12:15], 0
  ds_read_b64_tr_b16 v[192:193], v3 offset:32768
  ds_read_b64_tr_b16 v[194:195], v3 offset:33280
  s_add_u32 s27, s27, 72704
  buffer_load_dwordx4 v2, s[8:11], s27 offen offset:2048 lds
  s_waitcnt lgkmcnt(6)
  v_mfma_f32_32x32x16_bf16 v[156:171], v[200:203], v[16:19], v[156:171]
  ds_read_b64_tr_b16 v[196:197], v3 offset:34816
  ds_read_b64_tr_b16 v[198:199], v3 offset:35328
  s_waitcnt lgkmcnt(6)
  v_mfma_f32_32x32x16_bf16 v[156:171], v[252:255], v[20:23], v[156:171]
  s_waitcnt vmcnt(6)
  s_barrier
  ds_read_b64_tr_b16 v[200:201], v3 offset:36864
  ds_read_b64_tr_b16 v[202:203], v3 offset:37376
  s_add_u32 m0, s28, 12288
  s_add_u32 s27, s27, 739328
  buffer_load_dwordx4 v2, s[8:11], s27 offen offset:0 lds
  s_waitcnt lgkmcnt(6)
  v_mfma_f32_32x32x16_bf16 v[156:171], v[188:191], v[24:27], v[156:171]
  ds_read_b64_tr_b16 v[252:253], v3 offset:38912
  ds_read_b64_tr_b16 v[254:255], v3 offset:39424
  v_mul_f32 v8, v172, v172
  v_mul_f32 v9, v173, v173
  v_mul_f32 v10, v174, v174
  v_mul_f32 v11, v175, v175
  v_fma_f32 v8, v8, v6, v5
  s_waitcnt lgkmcnt(6)
  v_mfma_f32_32x32x16_bf16 v[156:171], v[192:195], v[28:31], v[156:171]
  ds_read_b64_tr_b16 v[188:189], v3 offset:40960
  ds_read_b64_tr_b16 v[190:191], v3 offset:41472
  v_fma_f32 v9, v9, v6, v5
  v_fma_f32 v10, v10, v6, v5
  v_fma_f32 v11, v11, v6, v5
  v_mul_f32 v8, v8, v172
  s_add_u32 s27, s27, 72704
  buffer_load_dwordx4 v2, s[8:11], s27 offen offset:1024 lds
  s_waitcnt lgkmcnt(6)
  v_mfma_f32_32x32x16_bf16 v[156:171], v[196:199], v[32:35], v[156:171]
  ds_read_b64_tr_b16 v[192:193], v3 offset:43008
  ds_read_b64_tr_b16 v[194:195], v3 offset:43520
  v_mul_f32 v9, v9, v173
  v_mul_f32 v10, v10, v174
  v_mul_f32 v11, v11, v175
  v_exp_f32 v8, v8
  s_waitcnt lgkmcnt(6)
  v_mfma_f32_32x32x16_bf16 v[156:171], v[200:203], v[36:39], v[156:171]
  ds_read_b64_tr_b16 v[196:197], v3 offset:45056
  ds_read_b64_tr_b16 v[198:199], v3 offset:45568
  v_exp_f32 v9, v9
  v_exp_f32 v10, v10
  v_exp_f32 v11, v11
  v_fma_f32 v8, v8, v7, v7
  s_add_u32 s27, s27, 72704
  buffer_load_dwordx4 v2, s[8:11], s27 offen offset:2048 lds
  s_waitcnt lgkmcnt(6)
  v_mfma_f32_32x32x16_bf16 v[156:171], v[252:255], v[40:43], v[156:171]
  ds_read_b64_tr_b16 v[200:201], v3 offset:47104
  ds_read_b64_tr_b16 v[202:203], v3 offset:47616
  v_fma_f32 v9, v9, v7, v7
  v_fma_f32 v10, v10, v7, v7
  v_fma_f32 v11, v11, v7, v7
  v_rcp_f32 v8, v8
  v_rcp_f32 v9, v9
  s_waitcnt lgkmcnt(6)
  v_mfma_f32_32x32x16_bf16 v[156:171], v[188:191], v[44:47], v[156:171]
  s_waitcnt vmcnt(6)
  s_barrier
  ds_read_b64_tr_b16 v[252:253], v3 offset:49152
  ds_read_b64_tr_b16 v[254:255], v3 offset:49664
  v_rcp_f32 v10, v10
  v_rcp_f32 v11, v11
  v_mul_f32 v172, v172, v8
  v_mul_f32 v173, v173, v9
  s_add_u32 m0, s28, 24576
  s_add_u32 s27, s27, 739328
  buffer_load_dwordx4 v2, s[8:11], s27 offen offset:0 lds
  s_waitcnt lgkmcnt(6)
  v_mfma_f32_32x32x16_bf16 v[156:171], v[192:195], v[48:51], v[156:171]
  ds_read_b64_tr_b16 v[188:189], v3 offset:51200
  ds_read_b64_tr_b16 v[190:191], v3 offset:51712
  v_mul_f32 v174, v174, v10
  v_mul_f32 v175, v175, v11
  v_cvt_pk_bf16_f32 v172, v172, v173
  v_cvt_pk_bf16_f32 v173, v174, v175
  s_waitcnt lgkmcnt(6)
  v_mfma_f32_32x32x16_bf16 v[156:171], v[196:199], v[52:55], v[156:171]
  ds_read_b64_tr_b16 v[192:193], v3 offset:53248
  ds_read_b64_tr_b16 v[194:195], v3 offset:53760
  v_mul_f32 v8, v176, v176
  v_mul_f32 v9, v177, v177
  v_mul_f32 v10, v178, v178
  v_mul_f32 v11, v179, v179
  s_add_u32 s27, s27, 72704
  buffer_load_dwordx4 v2, s[8:11], s27 offen offset:1024 lds
  s_waitcnt lgkmcnt(6)
  v_mfma_f32_32x32x16_bf16 v[156:171], v[200:203], v[56:59], v[156:171]
  ds_read_b64_tr_b16 v[196:197], v3 offset:55296
  ds_read_b64_tr_b16 v[198:199], v3 offset:55808
  v_fma_f32 v8, v8, v6, v5
  v_fma_f32 v9, v9, v6, v5
  v_fma_f32 v10, v10, v6, v5
  v_fma_f32 v11, v11, v6, v5
  s_waitcnt lgkmcnt(6)
  v_mfma_f32_32x32x16_bf16 v[156:171], v[252:255], v[60:63], v[156:171]
  ds_read_b64_tr_b16 v[200:201], v3 offset:57344
  ds_read_b64_tr_b16 v[202:203], v3 offset:57856
  v_mul_f32 v8, v8, v176
  v_mul_f32 v9, v9, v177
  v_mul_f32 v10, v10, v178
  v_mul_f32 v11, v11, v179
  v_exp_f32 v8, v8
  s_add_u32 s27, s27, 72704
  buffer_load_dwordx4 v2, s[8:11], s27 offen offset:2048 lds
  s_waitcnt lgkmcnt(6)
  v_mfma_f32_32x32x16_bf16 v[156:171], v[188:191], v[64:67], v[156:171]
  ds_read_b64_tr_b16 v[252:253], v3 offset:59392
  ds_read_b64_tr_b16 v[254:255], v3 offset:59904
  v_exp_f32 v9, v9
  v_exp_f32 v10, v10
  v_exp_f32 v11, v11
  v_fma_f32 v8, v8, v7, v7
  s_waitcnt lgkmcnt(6)
  v_mfma_f32_32x32x16_bf16 v[156:171], v[192:195], v[68:71], v[156:171]
  s_waitcnt vmcnt(6)
  s_barrier
  ds_read_b64_tr_b16 v[188:189], v3 offset:0
  ds_read_b64_tr_b16 v[190:191], v3 offset:512
  v_fma_f32 v9, v9, v7, v7
  v_fma_f32 v10, v10, v7, v7
  v_fma_f32 v11, v11, v7, v7
  v_rcp_f32 v8, v8
  s_add_u32 m0, s28, 36864
  s_add_u32 s27, s27, 4290398336
  buffer_load_dwordx4 v2, s[8:11], s27 offen offset:0 lds
  s_waitcnt lgkmcnt(6)
  v_mfma_f32_32x32x16_bf16 v[156:171], v[196:199], v[72:75], v[156:171]
  ds_read_b64_tr_b16 v[192:193], v3 offset:2048
  ds_read_b64_tr_b16 v[194:195], v3 offset:2560
  v_rcp_f32 v9, v9
  v_rcp_f32 v10, v10
  v_rcp_f32 v11, v11
  v_mul_f32 v176, v176, v8
  s_waitcnt lgkmcnt(6)
  v_mfma_f32_32x32x16_bf16 v[156:171], v[200:203], v[76:79], v[156:171]
  ds_read_b64_tr_b16 v[196:197], v3 offset:4096
  ds_read_b64_tr_b16 v[198:199], v3 offset:4608
  v_mul_f32 v177, v177, v9
  v_mul_f32 v178, v178, v10
  v_mul_f32 v179, v179, v11
  v_cvt_pk_bf16_f32 v174, v176, v177
  s_add_u32 s27, s27, 72704
  buffer_load_dwordx4 v2, s[8:11], s27 offen offset:1024 lds
  s_waitcnt lgkmcnt(6)
  v_mfma_f32_32x32x16_bf16 v[156:171], v[252:255], v[80:83], v[156:171]
  ds_read_b64_tr_b16 v[200:201], v3 offset:6144
  ds_read_b64_tr_b16 v[202:203], v3 offset:6656
  v_cvt_pk_bf16_f32 v175, v178, v179
  v_mul_f32 v8, v180, v180
  v_mul_f32 v9, v181, v181
  v_mul_f32 v10, v182, v182
  v_mul_f32 v11, v183, v183
  s_waitcnt lgkmcnt(6)
  v_mfma_f32_32x32x16_bf16 v[156:171], v[188:191], v[84:87], v[156:171]
  ds_read_b64_tr_b16 v[252:253], v3 offset:8192
  ds_read_b64_tr_b16 v[254:255], v3 offset:8704
  v_fma_f32 v8, v8, v6, v5
  v_fma_f32 v9, v9, v6, v5
  v_fma_f32 v10, v10, v6, v5
  v_fma_f32 v11, v11, v6, v5
  s_add_u32 s27, s27, 72704
  buffer_load_dwordx4 v2, s[8:11], s27 offen offset:2048 lds
  s_waitcnt lgkmcnt(6)
  v_mfma_f32_32x32x16_bf16 v[156:171], v[192:195], v[88:91], v[156:171]
  ds_read_b64_tr_b16 v[188:189], v3 offset:10240
  ds_read_b64_tr_b16 v[190:191], v3 offset:10752
  v_mul_f32 v8, v8, v180
  v_mul_f32 v9, v9, v181
  v_mul_f32 v10, v10, v182
  v_mul_f32 v11, v11, v183
  s_waitcnt lgkmcnt(6)
  v_mfma_f32_32x32x16_bf16 v[156:171], v[196:199], v[92:95], v[156:171]
  s_waitcnt vmcnt(6)
  s_barrier
  ds_read_b64_tr_b16 v[192:193], v3 offset:12288
  ds_read_b64_tr_b16 v[194:195], v3 offset:12800
  v_exp_f32 v8, v8
  v_exp_f32 v9, v9
  v_exp_f32 v10, v10
  v_exp_f32 v11, v11
  s_add_u32 m0, s28, 49152
  s_add_u32 s27, s27, 739328
  buffer_load_dwordx4 v2, s[8:11], s27 offen offset:0 lds
  s_waitcnt lgkmcnt(6)
  v_mfma_f32_32x32x16_bf16 v[156:171], v[200:203], v[96:99], v[156:171]
  ds_read_b64_tr_b16 v[196:197], v3 offset:14336
  ds_read_b64_tr_b16 v[198:199], v3 offset:14848
  v_fma_f32 v8, v8, v7, v7
  v_fma_f32 v9, v9, v7, v7
  v_fma_f32 v10, v10, v7, v7
  v_fma_f32 v11, v11, v7, v7
  s_waitcnt lgkmcnt(6)
  v_mfma_f32_32x32x16_bf16 v[156:171], v[252:255], v[100:103], v[156:171]
  ds_read_b64_tr_b16 v[200:201], v3 offset:16384
  ds_read_b64_tr_b16 v[202:203], v3 offset:16896
  v_rcp_f32 v8, v8
  v_rcp_f32 v9, v9
  v_rcp_f32 v10, v10
  v_rcp_f32 v11, v11
  v_mul_f32 v180, v180, v8
  s_add_u32 s27, s27, 72704
  buffer_load_dwordx4 v2, s[8:11], s27 offen offset:1024 lds
  s_waitcnt lgkmcnt(6)
  v_mfma_f32_32x32x16_bf16 v[156:171], v[188:191], v[104:107], v[156:171]
  ds_read_b64_tr_b16 v[252:253], v3 offset:18432
  ds_read_b64_tr_b16 v[254:255], v3 offset:18944
  v_mul_f32 v181, v181, v9
  v_mul_f32 v182, v182, v10
  v_mul_f32 v183, v183, v11
  v_cvt_pk_bf16_f32 v176, v180, v181
  s_waitcnt lgkmcnt(6)
  v_mfma_f32_32x32x16_bf16 v[156:171], v[192:195], v[108:111], v[156:171]
  ds_read_b64_tr_b16 v[188:189], v3 offset:20480
  ds_read_b64_tr_b16 v[190:191], v3 offset:20992
  v_cvt_pk_bf16_f32 v177, v182, v183
  v_mul_f32 v8, v184, v184
  v_mul_f32 v9, v185, v185
  v_mul_f32 v10, v186, v186
  s_add_u32 s27, s27, 72704
  buffer_load_dwordx4 v2, s[8:11], s27 offen offset:2048 lds
  s_waitcnt lgkmcnt(6)
  v_mfma_f32_32x32x16_bf16 v[156:171], v[196:199], v[112:115], v[156:171]
  ds_read_b64_tr_b16 v[192:193], v3 offset:22528
  ds_read_b64_tr_b16 v[194:195], v3 offset:23040
  v_mul_f32 v11, v187, v187
  v_fma_f32 v8, v8, v6, v5
  v_fma_f32 v9, v9, v6, v5
  v_fma_f32 v10, v10, v6, v5
  s_waitcnt lgkmcnt(6)
  v_mfma_f32_32x32x16_bf16 v[156:171], v[200:203], v[116:119], v[156:171]
  s_waitcnt vmcnt(6)
  s_barrier
  ds_read_b64_tr_b16 v[196:197], v3 offset:24576
  ds_read_b64_tr_b16 v[198:199], v3 offset:25088
  v_fma_f32 v11, v11, v6, v5
  v_mul_f32 v8, v8, v184
  v_mul_f32 v9, v9, v185
  v_mul_f32 v10, v10, v186
  s_add_u32 m0, s28, 0
  s_add_u32 s27, s27, 739328
  buffer_load_dwordx4 v2, s[8:11], s27 offen offset:0 lds
  s_waitcnt lgkmcnt(6)
  v_mfma_f32_32x32x16_bf16 v[156:171], v[252:255], v[120:123], v[156:171]
  ds_read_b64_tr_b16 v[200:201], v3 offset:26624
  ds_read_b64_tr_b16 v[202:203], v3 offset:27136
  v_mul_f32 v11, v11, v187
  v_exp_f32 v8, v8
  v_exp_f32 v9, v9
  v_exp_f32 v10, v10
  v_exp_f32 v11, v11
  s_waitcnt lgkmcnt(6)
  v_mfma_f32_32x32x16_bf16 v[156:171], v[188:191], v[124:127], v[156:171]
  ds_read_b64_tr_b16 v[252:253], v3 offset:28672
  ds_read_b64_tr_b16 v[254:255], v3 offset:29184
  v_fma_f32 v8, v8, v7, v7
  v_fma_f32 v9, v9, v7, v7
  v_fma_f32 v10, v10, v7, v7
  v_fma_f32 v11, v11, v7, v7
  s_add_u32 s27, s27, 72704
  buffer_load_dwordx4 v2, s[8:11], s27 offen offset:1024 lds
  s_waitcnt lgkmcnt(6)
  v_mfma_f32_32x32x16_bf16 v[156:171], v[192:195], v[128:131], v[156:171]
  ds_read_b64_tr_b16 v[188:189], v3 offset:30720
  ds_read_b64_tr_b16 v[190:191], v3 offset:31232
  v_rcp_f32 v8, v8
  v_rcp_f32 v9, v9
  v_rcp_f32 v10, v10
  v_rcp_f32 v11, v11
  s_waitcnt lgkmcnt(6)
  v_mfma_f32_32x32x16_bf16 v[156:171], v[196:199], v[132:135], v[156:171]
  ds_read_b64_tr_b16 v[192:193], v3 offset:32768
  ds_read_b64_tr_b16 v[194:195], v3 offset:33280
  v_mul_f32 v184, v184, v8
  v_mul_f32 v185, v185, v9
  v_mul_f32 v186, v186, v10
  v_mul_f32 v187, v187, v11
  s_add_u32 s27, s27, 72704
  buffer_load_dwordx4 v2, s[8:11], s27 offen offset:2048 lds
  s_waitcnt lgkmcnt(6)
  v_mfma_f32_32x32x16_bf16 v[156:171], v[200:203], v[136:139], v[156:171]
  ds_read_b64_tr_b16 v[196:197], v3 offset:34816
  ds_read_b64_tr_b16 v[198:199], v3 offset:35328
  v_cvt_pk_bf16_f32 v178, v184, v185
  v_cvt_pk_bf16_f32 v179, v186, v187
  ds_write_b128 v0, v[172:175] offset:2048
  ds_write_b128 v0, v[176:179] offset:3072
  s_waitcnt lgkmcnt(6)
  v_mfma_f32_32x32x16_bf16 v[156:171], v[252:255], v[140:143], v[156:171]
  s_waitcnt vmcnt(6)
  s_barrier
  ds_read_b64_tr_b16 v[200:201], v3 offset:36864
  ds_read_b64_tr_b16 v[202:203], v3 offset:37376
  s_add_u32 m0, s28, 12288
  s_add_u32 s27, s27, 739328
  buffer_load_dwordx4 v2, s[8:11], s27 offen offset:0 lds
  s_waitcnt lgkmcnt(6)
  v_mfma_f32_32x32x16_bf16 v[156:171], v[188:191], v[144:147], v[156:171]
  ds_read_b64_tr_b16 v[252:253], v3 offset:38912
  ds_read_b64_tr_b16 v[254:255], v3 offset:39424
  s_waitcnt lgkmcnt(6)
  v_mfma_f32_32x32x16_bf16 v[156:171], v[192:195], v[148:151], v[156:171]
  ds_read_b64_tr_b16 v[188:189], v3 offset:40960
  ds_read_b64_tr_b16 v[190:191], v3 offset:41472
  s_add_u32 s27, s27, 72704
  buffer_load_dwordx4 v2, s[8:11], s27 offen offset:1024 lds
  s_waitcnt lgkmcnt(6)
  v_mfma_f32_32x32x16_bf16 v[156:171], v[196:199], v[152:155], v[156:171]
  ds_read_b64_tr_b16 v[192:193], v3 offset:43008
  ds_read_b64_tr_b16 v[194:195], v3 offset:43520
  s_waitcnt lgkmcnt(6)
  v_mfma_f32_32x32x16_bf16 v[172:187], v[200:203], v[12:15], 0
  ds_read_b64_tr_b16 v[196:197], v3 offset:45056
  ds_read_b64_tr_b16 v[198:199], v3 offset:45568
  s_add_u32 s27, s27, 72704
  buffer_load_dwordx4 v2, s[8:11], s27 offen offset:2048 lds
  s_waitcnt lgkmcnt(6)
  v_mfma_f32_32x32x16_bf16 v[172:187], v[252:255], v[16:19], v[172:187]
  ds_read_b64_tr_b16 v[200:201], v3 offset:47104
  ds_read_b64_tr_b16 v[202:203], v3 offset:47616
  s_waitcnt lgkmcnt(6)
  v_mfma_f32_32x32x16_bf16 v[172:187], v[188:191], v[20:23], v[172:187]
  s_waitcnt vmcnt(6)
  s_barrier
  ds_read_b64_tr_b16 v[252:253], v3 offset:49152
  ds_read_b64_tr_b16 v[254:255], v3 offset:49664
  s_add_u32 m0, s28, 24576
  s_add_u32 s27, s27, 739328
  buffer_load_dwordx4 v2, s[8:11], s27 offen offset:0 lds
  s_waitcnt lgkmcnt(6)
  v_mfma_f32_32x32x16_bf16 v[172:187], v[192:195], v[24:27], v[172:187]
  ds_read_b64_tr_b16 v[188:189], v3 offset:51200
  ds_read_b64_tr_b16 v[190:191], v3 offset:51712
  v_mul_f32 v8, v156, v156
  v_mul_f32 v9, v157, v157
  v_mul_f32 v10, v158, v158
  v_mul_f32 v11, v159, v159
  v_fma_f32 v8, v8, v6, v5
  s_waitcnt lgkmcnt(6)
  v_mfma_f32_32x32x16_bf16 v[172:187], v[196:199], v[28:31], v[172:187]
  ds_read_b64_tr_b16 v[192:193], v3 offset:53248
  ds_read_b64_tr_b16 v[194:195], v3 offset:53760
  v_fma_f32 v9, v9, v6, v5
  v_fma_f32 v10, v10, v6, v5
  v_fma_f32 v11, v11, v6, v5
  v_mul_f32 v8, v8, v156
  s_add_u32 s27, s27, 72704
  buffer_load_dwordx4 v2, s[8:11], s27 offen offset:1024 lds
  s_waitcnt lgkmcnt(6)
  v_mfma_f32_32x32x16_bf16 v[172:187], v[200:203], v[32:35], v[172:187]
  ds_read_b64_tr_b16 v[196:197], v3 offset:55296
  ds_read_b64_tr_b16 v[198:199], v3 offset:55808
  v_mul_f32 v9, v9, v157
  v_mul_f32 v10, v10, v158
  v_mul_f32 v11, v11, v159
  v_exp_f32 v8, v8
  s_waitcnt lgkmcnt(6)
  v_mfma_f32_32x32x16_bf16 v[172:187], v[252:255], v[36:39], v[172:187]
  ds_read_b64_tr_b16 v[200:201], v3 offset:57344
  ds_read_b64_tr_b16 v[202:203], v3 offset:57856
  v_exp_f32 v9, v9
  v_exp_f32 v10, v10
  v_exp_f32 v11, v11
  v_fma_f32 v8, v8, v7, v7
  s_add_u32 s27, s27, 72704
  buffer_load_dwordx4 v2, s[8:11], s27 offen offset:2048 lds
  s_waitcnt lgkmcnt(6)
  v_mfma_f32_32x32x16_bf16 v[172:187], v[188:191], v[40:43], v[172:187]
  ds_read_b64_tr_b16 v[252:253], v3 offset:59392
  ds_read_b64_tr_b16 v[254:255], v3 offset:59904
  v_fma_f32 v9, v9, v7, v7
  v_fma_f32 v10, v10, v7, v7
  v_fma_f32 v11, v11, v7, v7
  v_rcp_f32 v8, v8
  s_waitcnt lgkmcnt(6)
  v_mfma_f32_32x32x16_bf16 v[172:187], v[192:195], v[44:47], v[172:187]
  s_waitcnt vmcnt(6)
  s_barrier
  ds_read_b64_tr_b16 v[188:189], v3 offset:0
  ds_read_b64_tr_b16 v[190:191], v3 offset:512
  v_rcp_f32 v9, v9
  v_rcp_f32 v10, v10
  v_rcp_f32 v11, v11
  v_mul_f32 v156, v156, v8
  s_add_u32 m0, s28, 36864
  s_add_u32 s27, s27, 739328
  buffer_load_dwordx4 v2, s[8:11], s27 offen offset:0 lds
  s_waitcnt lgkmcnt(6)
  v_mfma_f32_32x32x16_bf16 v[172:187], v[196:199], v[48:51], v[172:187]
  ds_read_b64_tr_b16 v[192:193], v3 offset:2048
  ds_read_b64_tr_b16 v[194:195], v3 offset:2560
  v_mul_f32 v157, v157, v9
  v_mul_f32 v158, v158, v10
  v_mul_f32 v159, v159, v11
  v_cvt_pk_bf16_f32 v204, v156, v157
  s_waitcnt lgkmcnt(6)
  v_mfma_f32_32x32x16_bf16 v[172:187], v[200:203], v[52:55], v[172:187]
  ds_read_b64_tr_b16 v[196:197], v3 offset:4096
  ds_read_b64_tr_b16 v[198:199], v3 offset:4608
  v_cvt_pk_bf16_f32 v205, v158, v159
  v_mul_f32 v8, v160, v160
  v_mul_f32 v9, v161, v161
  v_mul_f32 v10, v162, v162
  v_mul_f32 v11, v163, v163
  s_add_u32 s27, s27, 72704
  buffer_load_dwordx4 v2, s[8:11], s27 offen offset:1024 lds
  s_waitcnt lgkmcnt(6)
  v_mfma_f32_32x32x16_bf16 v[172:187], v[252:255], v[56:59], v[172:187]
  ds_read_b64_tr_b16 v[200:201], v3 offset:6144
  ds_read_b64_tr_b16 v[202:203], v3 offset:6656
  v_fma_f32 v8, v8, v6, v5
  v_fma_f32 v9, v9, v6, v5
  v_fma_f32 v10, v10, v6, v5
  v_fma_f32 v11, v11, v6, v5
  s_waitcnt lgkmcnt(6)
  v_mfma_f32_32x32x16_bf16 v[172:187], v[188:191], v[60:63], v[172:187]
  ds_read_b64_tr_b16 v[252:253], v3 offset:8192
  ds_read_b64_tr_b16 v[254:255], v3 offset:8704
  v_mul_f32 v8, v8, v160
  v_mul_f32 v9, v9, v161
  v_mul_f32 v10, v10, v162
  v_mul_f32 v11, v11, v163
  s_add_u32 s27, s27, 72704
  buffer_load_dwordx4 v2, s[8:11], s27 offen offset:2048 lds
  s_waitcnt lgkmcnt(6)
  v_mfma_f32_32x32x16_bf16 v[172:187], v[192:195], v[64:67], v[172:187]
  ds_read_b64_tr_b16 v[188:189], v3 offset:10240
  ds_read_b64_tr_b16 v[190:191], v3 offset:10752
  v_exp_f32 v8, v8
  v_exp_f32 v9, v9
  v_exp_f32 v10, v10
  v_exp_f32 v11, v11
  s_waitcnt lgkmcnt(6)
  v_mfma_f32_32x32x16_bf16 v[172:187], v[196:199], v[68:71], v[172:187]
  s_waitcnt vmcnt(6)
  s_barrier
  ds_read_b64_tr_b16 v[192:193], v3 offset:12288
  ds_read_b64_tr_b16 v[194:195], v3 offset:12800
  v_fma_f32 v8, v8, v7, v7
  v_fma_f32 v9, v9, v7, v7
  v_fma_f32 v10, v10, v7, v7
  v_fma_f32 v11, v11, v7, v7
  s_add_u32 m0, s28, 49152
  s_add_u32 s27, s27, 4290398336
  buffer_load_dwordx4 v2, s[8:11], s27 offen offset:0 lds
  s_waitcnt lgkmcnt(6)
  v_mfma_f32_32x32x16_bf16 v[172:187], v[200:203], v[72:75], v[172:187]
  ds_read_b64_tr_b16 v[196:197], v3 offset:14336
  ds_read_b64_tr_b16 v[198:199], v3 offset:14848
  v_rcp_f32 v8, v8
  v_rcp_f32 v9, v9
  v_rcp_f32 v10, v10
  v_rcp_f32 v11, v11
  s_waitcnt lgkmcnt(6)
  v_mfma_f32_32x32x16_bf16 v[172:187], v[252:255], v[76:79], v[172:187]
  ds_read_b64_tr_b16 v[200:201], v3 offset:16384
  ds_read_b64_tr_b16 v[202:203], v3 offset:16896
  v_mul_f32 v160, v160, v8
  v_mul_f32 v161, v161, v9
  v_mul_f32 v162, v162, v10
  v_mul_f32 v163, v163, v11
  s_add_u32 s27, s27, 72704
  buffer_load_dwordx4 v2, s[8:11], s27 offen offset:1024 lds
  s_waitcnt lgkmcnt(6)
  v_mfma_f32_32x32x16_bf16 v[172:187], v[188:191], v[80:83], v[172:187]
  ds_read_b64_tr_b16 v[252:253], v3 offset:18432
  ds_read_b64_tr_b16 v[254:255], v3 offset:18944
  v_cvt_pk_bf16_f32 v206, v160, v161
  v_cvt_pk_bf16_f32 v207, v162, v163
  v_mul_f32 v8, v164, v164
  v_mul_f32 v9, v165, v165
  v_mul_f32 v10, v166, v166
  s_waitcnt lgkmcnt(6)
  v_mfma_f32_32x32x16_bf16 v[172:187], v[192:195], v[84:87], v[172:187]
  ds_read_b64_tr_b16 v[188:189], v3 offset:20480
  ds_read_b64_tr_b16 v[190:191], v3 offset:20992
  v_mul_f32 v11, v167, v167
  v_fma_f32 v8, v8, v6, v5
  v_fma_f32 v9, v9, v6, v5
  v_fma_f32 v10, v10, v6, v5
  s_add_u32 s27, s27, 72704
  buffer_load_dwordx4 v2, s[8:11], s27 offen offset:2048 lds
  s_waitcnt lgkmcnt(6)
  v_mfma_f32_32x32x16_bf16 v[172:187], v[196:199], v[88:91], v[172:187]
  ds_read_b64_tr_b16 v[192:193], v3 offset:22528
  ds_read_b64_tr_b16 v[194:195], v3 offset:23040
  v_fma_f32 v11, v11, v6, v5
  v_mul_f32 v8, v8, v164
  v_mul_f32 v9, v9, v165
  v_mul_f32 v10, v10, v166
  s_waitcnt lgkmcnt(6)
  v_mfma_f32_32x32x16_bf16 v[172:187], v[200:203], v[92:95], v[172:187]
  s_waitcnt vmcnt(6)
  s_barrier
  ds_read_b64_tr_b16 v[196:197], v3 offset:24576
  ds_read_b64_tr_b16 v[198:199], v3 offset:25088
  v_mul_f32 v11, v11, v167
  v_exp_f32 v8, v8
  v_exp_f32 v9, v9
  v_exp_f32 v10, v10
  s_add_u32 m0, s28, 0
  s_add_u32 s27, s27, 739328
  buffer_load_dwordx4 v2, s[8:11], s27 offen offset:0 lds
  s_waitcnt lgkmcnt(6)
  v_mfma_f32_32x32x16_bf16 v[172:187], v[252:255], v[96:99], v[172:187]
  ds_read_b64_tr_b16 v[200:201], v3 offset:26624
  ds_read_b64_tr_b16 v[202:203], v3 offset:27136
  v_exp_f32 v11, v11
  v_fma_f32 v8, v8, v7, v7
  v_fma_f32 v9, v9, v7, v7
  v_fma_f32 v10, v10, v7, v7
  s_waitcnt lgkmcnt(6)
  v_mfma_f32_32x32x16_bf16 v[172:187], v[188:191], v[100:103], v[172:187]
  ds_read_b64_tr_b16 v[252:253], v3 offset:28672
  ds_read_b64_tr_b16 v[254:255], v3 offset:29184
  v_fma_f32 v11, v11, v7, v7
  v_rcp_f32 v8, v8
  v_rcp_f32 v9, v9
  v_rcp_f32 v10, v10
  s_add_u32 s27, s27, 72704
  buffer_load_dwordx4 v2, s[8:11], s27 offen offset:1024 lds
  s_waitcnt lgkmcnt(6)
  v_mfma_f32_32x32x16_bf16 v[172:187], v[192:195], v[104:107], v[172:187]
  ds_read_b64_tr_b16 v[188:189], v3 offset:30720
  ds_read_b64_tr_b16 v[190:191], v3 offset:31232
  v_rcp_f32 v11, v11
  v_mul_f32 v164, v164, v8
  v_mul_f32 v165, v165, v9
  v_mul_f32 v166, v166, v10
  s_waitcnt lgkmcnt(6)
  v_mfma_f32_32x32x16_bf16 v[172:187], v[196:199], v[108:111], v[172:187]
  ds_read_b64_tr_b16 v[192:193], v3 offset:32768
  ds_read_b64_tr_b16 v[194:195], v3 offset:33280
  v_mul_f32 v167, v167, v11
  v_cvt_pk_bf16_f32 v208, v164, v165
  v_cvt_pk_bf16_f32 v209, v166, v167
  v_mul_f32 v8, v168, v168
  v_mul_f32 v9, v169, v169
  s_add_u32 s27, s27, 72704
  buffer_load_dwordx4 v2, s[8:11], s27 offen offset:2048 lds
  s_waitcnt lgkmcnt(6)
  v_mfma_f32_32x32x16_bf16 v[172:187], v[200:203], v[112:115], v[172:187]
  ds_read_b64_tr_b16 v[196:197], v3 offset:34816
  ds_read_b64_tr_b16 v[198:199], v3 offset:35328
  v_mul_f32 v10, v170, v170
  v_mul_f32 v11, v171, v171
  v_fma_f32 v8, v8, v6, v5
  v_fma_f32 v9, v9, v6, v5
  s_waitcnt lgkmcnt(6)
  v_mfma_f32_32x32x16_bf16 v[172:187], v[252:255], v[116:119], v[172:187]
  s_waitcnt vmcnt(6)
  s_barrier
  ds_read_b64_tr_b16 v[200:201], v3 offset:36864
  ds_read_b64_tr_b16 v[202:203], v3 offset:37376
  v_fma_f32 v10, v10, v6, v5
  v_fma_f32 v11, v11, v6, v5
  v_mul_f32 v8, v8, v168
  v_mul_f32 v9, v9, v169
  s_add_u32 m0, s28, 12288
  s_add_u32 s27, s27, 739328
  buffer_load_dwordx4 v2, s[8:11], s27 offen offset:0 lds
  s_waitcnt lgkmcnt(6)
  v_mfma_f32_32x32x16_bf16 v[172:187], v[188:191], v[120:123], v[172:187]
  ds_read_b64_tr_b16 v[252:253], v3 offset:38912
  ds_read_b64_tr_b16 v[254:255], v3 offset:39424
  v_mul_f32 v10, v10, v170
  v_mul_f32 v11, v11, v171
  v_exp_f32 v8, v8
  v_exp_f32 v9, v9
  s_waitcnt lgkmcnt(6)
  v_mfma_f32_32x32x16_bf16 v[172:187], v[192:195], v[124:127], v[172:187]
  ds_read_b64_tr_b16 v[188:189], v3 offset:40960
  ds_read_b64_tr_b16 v[190:191], v3 offset:41472
  v_exp_f32 v10, v10
  v_exp_f32 v11, v11
  v_fma_f32 v8, v8, v7, v7
  v_fma_f32 v9, v9, v7, v7
  s_add_u32 s27, s27, 72704
  buffer_load_dwordx4 v2, s[8:11], s27 offen offset:1024 lds
  s_waitcnt lgkmcnt(6)
  v_mfma_f32_32x32x16_bf16 v[172:187], v[196:199], v[128:131], v[172:187]
  ds_read_b64_tr_b16 v[192:193], v3 offset:43008
  ds_read_b64_tr_b16 v[194:195], v3 offset:43520
  v_fma_f32 v10, v10, v7, v7
  v_fma_f32 v11, v11, v7, v7
  v_rcp_f32 v8, v8
  v_rcp_f32 v9, v9
  s_waitcnt lgkmcnt(6)
  v_mfma_f32_32x32x16_bf16 v[172:187], v[200:203], v[132:135], v[172:187]
  ds_read_b64_tr_b16 v[196:197], v3 offset:45056
  ds_read_b64_tr_b16 v[198:199], v3 offset:45568
  v_rcp_f32 v10, v10
  v_rcp_f32 v11, v11
  v_mul_f32 v168, v168, v8
  v_mul_f32 v169, v169, v9
  s_add_u32 s27, s27, 72704
  buffer_load_dwordx4 v2, s[8:11], s27 offen offset:2048 lds
  s_waitcnt lgkmcnt(6)
  v_mfma_f32_32x32x16_bf16 v[172:187], v[252:255], v[136:139], v[172:187]
  ds_read_b64_tr_b16 v[200:201], v3 offset:47104
  ds_read_b64_tr_b16 v[202:203], v3 offset:47616
  v_mul_f32 v170, v170, v10
  v_mul_f32 v171, v171, v11
  v_cvt_pk_bf16_f32 v210, v168, v169
  v_cvt_pk_bf16_f32 v211, v170, v171
  s_waitcnt lgkmcnt(6)
  v_mfma_f32_32x32x16_bf16 v[172:187], v[188:191], v[140:143], v[172:187]
  s_waitcnt vmcnt(6)
  s_barrier
  ds_read_b64_tr_b16 v[252:253], v3 offset:49152
  ds_read_b64_tr_b16 v[254:255], v3 offset:49664
  s_add_u32 m0, s28, 24576
  s_add_u32 s27, s27, 739328
  buffer_load_dwordx4 v2, s[8:11], s27 offen offset:0 lds
  s_waitcnt lgkmcnt(6)
  v_mfma_f32_32x32x16_bf16 v[172:187], v[192:195], v[144:147], v[172:187]
  ds_read_b64_tr_b16 v[188:189], v3 offset:51200
  ds_read_b64_tr_b16 v[190:191], v3 offset:51712
  s_waitcnt lgkmcnt(6)
  v_mfma_f32_32x32x16_bf16 v[172:187], v[196:199], v[148:151], v[172:187]
  ds_read_b64_tr_b16 v[192:193], v3 offset:53248
  ds_read_b64_tr_b16 v[194:195], v3 offset:53760
  s_add_u32 s27, s27, 72704
  buffer_load_dwordx4 v2, s[8:11], s27 offen offset:1024 lds
  s_waitcnt lgkmcnt(6)
  v_mfma_f32_32x32x16_bf16 v[172:187], v[200:203], v[152:155], v[172:187]
  ds_read_b64_tr_b16 v[196:197], v3 offset:55296
  ds_read_b64_tr_b16 v[198:199], v3 offset:55808
  s_waitcnt lgkmcnt(6)
  v_mfma_f32_32x32x16_bf16 v[156:171], v[252:255], v[12:15], 0
  ds_read_b64_tr_b16 v[200:201], v3 offset:57344
  ds_read_b64_tr_b16 v[202:203], v3 offset:57856
  s_add_u32 s27, s27, 72704
  buffer_load_dwordx4 v2, s[8:11], s27 offen offset:2048 lds
  s_waitcnt lgkmcnt(6)
  v_mfma_f32_32x32x16_bf16 v[156:171], v[188:191], v[16:19], v[156:171]
  ds_read_b64_tr_b16 v[252:253], v3 offset:59392
  ds_read_b64_tr_b16 v[254:255], v3 offset:59904
  s_waitcnt lgkmcnt(6)
  v_mfma_f32_32x32x16_bf16 v[156:171], v[192:195], v[20:23], v[156:171]
  s_waitcnt vmcnt(6)
  s_barrier
  ds_read_b64_tr_b16 v[188:189], v3 offset:0
  ds_read_b64_tr_b16 v[190:191], v3 offset:512
  s_add_u32 m0, s28, 36864
  s_add_u32 s27, s27, 739328
  buffer_load_dwordx4 v2, s[8:11], s27 offen offset:0 lds
  s_waitcnt lgkmcnt(6)
  v_mfma_f32_32x32x16_bf16 v[156:171], v[196:199], v[24:27], v[156:171]
  ds_read_b64_tr_b16 v[192:193], v3 offset:2048
  ds_read_b64_tr_b16 v[194:195], v3 offset:2560
  v_mul_f32 v8, v172, v172
  v_mul_f32 v9, v173, v173
  v_mul_f32 v10, v174, v174
  v_mul_f32 v11, v175, v175
  v_fma_f32 v8, v8, v6, v5
  s_waitcnt lgkmcnt(6)
  v_mfma_f32_32x32x16_bf16 v[156:171], v[200:203], v[28:31], v[156:171]
  ds_read_b64_tr_b16 v[196:197], v3 offset:4096
  ds_read_b64_tr_b16 v[198:199], v3 offset:4608
  v_fma_f32 v9, v9, v6, v5
  v_fma_f32 v10, v10, v6, v5
  v_fma_f32 v11, v11, v6, v5
  v_mul_f32 v8, v8, v172
  s_add_u32 s27, s27, 72704
  buffer_load_dwordx4 v2, s[8:11], s27 offen offset:1024 lds
  s_waitcnt lgkmcnt(6)
  v_mfma_f32_32x32x16_bf16 v[156:171], v[252:255], v[32:35], v[156:171]
  ds_read_b64_tr_b16 v[200:201], v3 offset:6144
  ds_read_b64_tr_b16 v[202:203], v3 offset:6656
  v_mul_f32 v9, v9, v173
  v_mul_f32 v10, v10, v174
  v_mul_f32 v11, v11, v175
  v_exp_f32 v8, v8
  s_waitcnt lgkmcnt(6)
  v_mfma_f32_32x32x16_bf16 v[156:171], v[188:191], v[36:39], v[156:171]
  ds_read_b64_tr_b16 v[252:253], v3 offset:8192
  ds_read_b64_tr_b16 v[254:255], v3 offset:8704
  v_exp_f32 v9, v9
  v_exp_f32 v10, v10
  v_exp_f32 v11, v11
  v_fma_f32 v8, v8, v7, v7
  s_add_u32 s27, s27, 72704
  buffer_load_dwordx4 v2, s[8:11], s27 offen offset:2048 lds
  s_waitcnt lgkmcnt(6)
  v_mfma_f32_32x32x16_bf16 v[156:171], v[192:195], v[40:43], v[156:171]
  ds_read_b64_tr_b16 v[188:189], v3 offset:10240
  ds_read_b64_tr_b16 v[190:191], v3 offset:10752
  v_fma_f32 v9, v9, v7, v7
  v_fma_f32 v10, v10, v7, v7
  v_fma_f32 v11, v11, v7, v7
  v_rcp_f32 v8, v8
  s_waitcnt lgkmcnt(6)
  v_mfma_f32_32x32x16_bf16 v[156:171], v[196:199], v[44:47], v[156:171]
  s_waitcnt vmcnt(6)
  s_barrier
  ds_read_b64_tr_b16 v[192:193], v3 offset:12288
  ds_read_b64_tr_b16 v[194:195], v3 offset:12800
  v_rcp_f32 v9, v9
  v_rcp_f32 v10, v10
  v_rcp_f32 v11, v11
  v_mul_f32 v172, v172, v8
  s_add_u32 m0, s28, 49152
  s_add_u32 s27, s27, 739328
  buffer_load_dwordx4 v2, s[8:11], s27 offen offset:0 lds
  s_waitcnt lgkmcnt(6)
  v_mfma_f32_32x32x16_bf16 v[156:171], v[200:203], v[48:51], v[156:171]
  ds_read_b64_tr_b16 v[196:197], v3 offset:14336
  ds_read_b64_tr_b16 v[198:199], v3 offset:14848
  v_mul_f32 v173, v173, v9
  v_mul_f32 v174, v174, v10
  v_mul_f32 v175, v175, v11
  v_cvt_pk_bf16_f32 v212, v172, v173
  s_waitcnt lgkmcnt(6)
  v_mfma_f32_32x32x16_bf16 v[156:171], v[252:255], v[52:55], v[156:171]
  ds_read_b64_tr_b16 v[200:201], v3 offset:16384
  ds_read_b64_tr_b16 v[202:203], v3 offset:16896
  v_cvt_pk_bf16_f32 v213, v174, v175
  v_mul_f32 v8, v176, v176
  v_mul_f32 v9, v177, v177
  v_mul_f32 v10, v178, v178
  v_mul_f32 v11, v179, v179
  s_add_u32 s27, s27, 72704
  buffer_load_dwordx4 v2, s[8:11], s27 offen offset:1024 lds
  s_waitcnt lgkmcnt(6)
  v_mfma_f32_32x32x16_bf16 v[156:171], v[188:191], v[56:59], v[156:171]
  ds_read_b64_tr_b16 v[252:253], v3 offset:18432
  ds_read_b64_tr_b16 v[254:255], v3 offset:18944
  v_fma_f32 v8, v8, v6, v5
  v_fma_f32 v9, v9, v6, v5
  v_fma_f32 v10, v10, v6, v5
  v_fma_f32 v11, v11, v6, v5
  s_waitcnt lgkmcnt(6)
  v_mfma_f32_32x32x16_bf16 v[156:171], v[192:195], v[60:63], v[156:171]
  ds_read_b64_tr_b16 v[188:189], v3 offset:20480
  ds_read_b64_tr_b16 v[190:191], v3 offset:20992
  v_mul_f32 v8, v8, v176
  v_mul_f32 v9, v9, v177
  v_mul_f32 v10, v10, v178
  v_mul_f32 v11, v11, v179
  s_add_u32 s27, s27, 72704
  buffer_load_dwordx4 v2, s[8:11], s27 offen offset:2048 lds
  s_waitcnt lgkmcnt(6)
  v_mfma_f32_32x32x16_bf16 v[156:171], v[196:199], v[64:67], v[156:171]
  ds_read_b64_tr_b16 v[192:193], v3 offset:22528
  ds_read_b64_tr_b16 v[194:195], v3 offset:23040
  v_exp_f32 v8, v8
  v_exp_f32 v9, v9
  v_exp_f32 v10, v10
  v_exp_f32 v11, v11
  s_waitcnt lgkmcnt(6)
  v_mfma_f32_32x32x16_bf16 v[156:171], v[200:203], v[68:71], v[156:171]
  s_waitcnt vmcnt(6)
  s_barrier
  ds_read_b64_tr_b16 v[196:197], v3 offset:24576
  ds_read_b64_tr_b16 v[198:199], v3 offset:25088
  v_fma_f32 v8, v8, v7, v7
  v_fma_f32 v9, v9, v7, v7
  v_fma_f32 v10, v10, v7, v7
  v_fma_f32 v11, v11, v7, v7
  s_add_u32 m0, s28, 0
  s_add_u32 s27, s27, 4290398336
  buffer_load_dwordx4 v2, s[8:11], s27 offen offset:0 lds
  s_waitcnt lgkmcnt(6)
  v_mfma_f32_32x32x16_bf16 v[156:171], v[252:255], v[72:75], v[156:171]
  ds_read_b64_tr_b16 v[200:201], v3 offset:26624
  ds_read_b64_tr_b16 v[202:203], v3 offset:27136
  v_rcp_f32 v8, v8
  v_rcp_f32 v9, v9
  v_rcp_f32 v10, v10
  v_rcp_f32 v11, v11
  s_waitcnt lgkmcnt(6)
  v_mfma_f32_32x32x16_bf16 v[156:171], v[188:191], v[76:79], v[156:171]
  ds_read_b64_tr_b16 v[252:253], v3 offset:28672
  ds_read_b64_tr_b16 v[254:255], v3 offset:29184
  v_mul_f32 v176, v176, v8
  v_mul_f32 v177, v177, v9
  v_mul_f32 v178, v178, v10
  v_mul_f32 v179, v179, v11
  s_add_u32 s27, s27, 72704
  buffer_load_dwordx4 v2, s[8:11], s27 offen offset:1024 lds
  s_waitcnt lgkmcnt(6)
  v_mfma_f32_32x32x16_bf16 v[156:171], v[192:195], v[80:83], v[156:171]
  ds_read_b64_tr_b16 v[188:189], v3 offset:30720
  ds_read_b64_tr_b16 v[190:191], v3 offset:31232
  v_cvt_pk_bf16_f32 v214, v176, v177
  v_cvt_pk_bf16_f32 v215, v178, v179
  v_mul_f32 v8, v180, v180
  v_mul_f32 v9, v181, v181
  v_mul_f32 v10, v182, v182
  s_waitcnt lgkmcnt(6)
  v_mfma_f32_32x32x16_bf16 v[156:171], v[196:199], v[84:87], v[156:171]
  ds_read_b64_tr_b16 v[192:193], v3 offset:32768
  ds_read_b64_tr_b16 v[194:195], v3 offset:33280
  v_mul_f32 v11, v183, v183
  v_fma_f32 v8, v8, v6, v5
  v_fma_f32 v9, v9, v6, v5
  v_fma_f32 v10, v10, v6, v5
  s_add_u32 s27, s27, 72704
  buffer_load_dwordx4 v2, s[8:11], s27 offen offset:2048 lds
  s_waitcnt lgkmcnt(6)
  v_mfma_f32_32x32x16_bf16 v[156:171], v[200:203], v[88:91], v[156:171]
  ds_read_b64_tr_b16 v[196:197], v3 offset:34816
  ds_read_b64_tr_b16 v[198:199], v3 offset:35328
  v_fma_f32 v11, v11, v6, v5
  v_mul_f32 v8, v8, v180
  v_mul_f32 v9, v9, v181
  v_mul_f32 v10, v10, v182
  s_waitcnt lgkmcnt(6)
  v_mfma_f32_32x32x16_bf16 v[156:171], v[252:255], v[92:95], v[156:171]
  s_waitcnt vmcnt(6)
  s_barrier
  ds_read_b64_tr_b16 v[200:201], v3 offset:36864
  ds_read_b64_tr_b16 v[202:203], v3 offset:37376
  v_mul_f32 v11, v11, v183
  v_exp_f32 v8, v8
  v_exp_f32 v9, v9
  v_exp_f32 v10, v10
  s_add_u32 m0, s28, 12288
  s_add_u32 s27, s27, 739328
  buffer_load_dwordx4 v2, s[8:11], s27 offen offset:0 lds
  s_waitcnt lgkmcnt(6)
  v_mfma_f32_32x32x16_bf16 v[156:171], v[188:191], v[96:99], v[156:171]
  ds_read_b64_tr_b16 v[252:253], v3 offset:38912
  ds_read_b64_tr_b16 v[254:255], v3 offset:39424
  v_exp_f32 v11, v11
  v_fma_f32 v8, v8, v7, v7
  v_fma_f32 v9, v9, v7, v7
  v_fma_f32 v10, v10, v7, v7
  s_waitcnt lgkmcnt(6)
  v_mfma_f32_32x32x16_bf16 v[156:171], v[192:195], v[100:103], v[156:171]
  ds_read_b64_tr_b16 v[188:189], v3 offset:40960
  ds_read_b64_tr_b16 v[190:191], v3 offset:41472
  v_fma_f32 v11, v11, v7, v7
  v_rcp_f32 v8, v8
  v_rcp_f32 v9, v9
  v_rcp_f32 v10, v10
  s_add_u32 s27, s27, 72704
  buffer_load_dwordx4 v2, s[8:11], s27 offen offset:1024 lds
  s_waitcnt lgkmcnt(6)
  v_mfma_f32_32x32x16_bf16 v[156:171], v[196:199], v[104:107], v[156:171]
  ds_read_b64_tr_b16 v[192:193], v3 offset:43008
  ds_read_b64_tr_b16 v[194:195], v3 offset:43520
  v_rcp_f32 v11, v11
  v_mul_f32 v180, v180, v8
  v_mul_f32 v181, v181, v9
  v_mul_f32 v182, v182, v10
  s_waitcnt lgkmcnt(6)
  v_mfma_f32_32x32x16_bf16 v[156:171], v[200:203], v[108:111], v[156:171]
  ds_read_b64_tr_b16 v[196:197], v3 offset:45056
  ds_read_b64_tr_b16 v[198:199], v3 offset:45568
  v_mul_f32 v183, v183, v11
  v_cvt_pk_bf16_f32 v216, v180, v181
  v_cvt_pk_bf16_f32 v217, v182, v183
  v_mul_f32 v8, v184, v184
  v_mul_f32 v9, v185, v185
  s_add_u32 s27, s27, 72704
  buffer_load_dwordx4 v2, s[8:11], s27 offen offset:2048 lds
  s_waitcnt lgkmcnt(6)
  v_mfma_f32_32x32x16_bf16 v[156:171], v[252:255], v[112:115], v[156:171]
  ds_read_b64_tr_b16 v[200:201], v3 offset:47104
  ds_read_b64_tr_b16 v[202:203], v3 offset:47616
  v_mul_f32 v10, v186, v186
  v_mul_f32 v11, v187, v187
  v_fma_f32 v8, v8, v6, v5
  v_fma_f32 v9, v9, v6, v5
  s_waitcnt lgkmcnt(6)
  v_mfma_f32_32x32x16_bf16 v[156:171], v[188:191], v[116:119], v[156:171]
  s_waitcnt vmcnt(6)
  s_barrier
  ds_read_b64_tr_b16 v[252:253], v3 offset:49152
  ds_read_b64_tr_b16 v[254:255], v3 offset:49664
  v_fma_f32 v10, v10, v6, v5
  v_fma_f32 v11, v11, v6, v5
  v_mul_f32 v8, v8, v184
  v_mul_f32 v9, v9, v185
  s_add_u32 m0, s28, 24576
  s_add_u32 s27, s27, 739328
  buffer_load_dwordx4 v2, s[8:11], s27 offen offset:0 lds
  s_waitcnt lgkmcnt(6)
  v_mfma_f32_32x32x16_bf16 v[156:171], v[192:195], v[120:123], v[156:171]
  ds_read_b64_tr_b16 v[188:189], v3 offset:51200
  ds_read_b64_tr_b16 v[190:191], v3 offset:51712
  v_mul_f32 v10, v10, v186
  v_mul_f32 v11, v11, v187
  v_exp_f32 v8, v8
  v_exp_f32 v9, v9
  s_waitcnt lgkmcnt(6)
  v_mfma_f32_32x32x16_bf16 v[156:171], v[196:199], v[124:127], v[156:171]
  ds_read_b64_tr_b16 v[192:193], v3 offset:53248
  ds_read_b64_tr_b16 v[194:195], v3 offset:53760
  v_exp_f32 v10, v10
  v_exp_f32 v11, v11
  v_fma_f32 v8, v8, v7, v7
  v_fma_f32 v9, v9, v7, v7
  s_add_u32 s27, s27, 72704
  buffer_load_dwordx4 v2, s[8:11], s27 offen offset:1024 lds
  s_waitcnt lgkmcnt(6)
  v_mfma_f32_32x32x16_bf16 v[156:171], v[200:203], v[128:131], v[156:171]
  ds_read_b64_tr_b16 v[196:197], v3 offset:55296
  ds_read_b64_tr_b16 v[198:199], v3 offset:55808
  v_fma_f32 v10, v10, v7, v7
  v_fma_f32 v11, v11, v7, v7
  v_rcp_f32 v8, v8
  v_rcp_f32 v9, v9
  s_waitcnt lgkmcnt(6)
  v_mfma_f32_32x32x16_bf16 v[156:171], v[252:255], v[132:135], v[156:171]
  ds_read_b64_tr_b16 v[200:201], v3 offset:57344
  ds_read_b64_tr_b16 v[202:203], v3 offset:57856
  v_rcp_f32 v10, v10
  v_rcp_f32 v11, v11
  v_mul_f32 v184, v184, v8
  v_mul_f32 v185, v185, v9
  s_add_u32 s27, s27, 72704
  buffer_load_dwordx4 v2, s[8:11], s27 offen offset:2048 lds
  s_waitcnt lgkmcnt(6)
  v_mfma_f32_32x32x16_bf16 v[156:171], v[188:191], v[136:139], v[156:171]
  ds_read_b64_tr_b16 v[252:253], v3 offset:59392
  ds_read_b64_tr_b16 v[254:255], v3 offset:59904
  v_mul_f32 v186, v186, v10
  v_mul_f32 v187, v187, v11
  v_cvt_pk_bf16_f32 v218, v184, v185
  v_cvt_pk_bf16_f32 v219, v186, v187
  s_waitcnt lgkmcnt(6)
  v_mfma_f32_32x32x16_bf16 v[156:171], v[192:195], v[140:143], v[156:171]
  s_waitcnt vmcnt(6)
  s_barrier
  ds_read_b64_tr_b16 v[188:189], v3 offset:0
  ds_read_b64_tr_b16 v[190:191], v3 offset:512
  s_add_u32 m0, s28, 36864
  s_add_u32 s27, s27, 739328
  buffer_load_dwordx4 v2, s[8:11], s27 offen offset:0 lds
  s_waitcnt lgkmcnt(6)
  v_mfma_f32_32x32x16_bf16 v[156:171], v[196:199], v[144:147], v[156:171]
  ds_read_b64_tr_b16 v[192:193], v3 offset:2048
  ds_read_b64_tr_b16 v[194:195], v3 offset:2560
  s_waitcnt lgkmcnt(6)
  v_mfma_f32_32x32x16_bf16 v[156:171], v[200:203], v[148:151], v[156:171]
  ds_read_b64_tr_b16 v[196:197], v3 offset:4096
  ds_read_b64_tr_b16 v[198:199], v3 offset:4608
  s_add_u32 s27, s27, 72704
  buffer_load_dwordx4 v2, s[8:11], s27 offen offset:1024 lds
  s_waitcnt lgkmcnt(6)
  v_mfma_f32_32x32x16_bf16 v[156:171], v[252:255], v[152:155], v[156:171]
  ds_read_b64_tr_b16 v[200:201], v3 offset:6144
  ds_read_b64_tr_b16 v[202:203], v3 offset:6656
  s_waitcnt lgkmcnt(6)
  v_mfma_f32_32x32x16_bf16 v[172:187], v[188:191], v[12:15], 0
  ds_read_b64_tr_b16 v[252:253], v3 offset:8192
  ds_read_b64_tr_b16 v[254:255], v3 offset:8704
  s_add_u32 s27, s27, 72704
  buffer_load_dwordx4 v2, s[8:11], s27 offen offset:2048 lds
  s_waitcnt lgkmcnt(6)
  v_mfma_f32_32x32x16_bf16 v[172:187], v[192:195], v[16:19], v[172:187]
  ds_read_b64_tr_b16 v[188:189], v3 offset:10240
  ds_read_b64_tr_b16 v[190:191], v3 offset:10752
  s_waitcnt lgkmcnt(6)
  v_mfma_f32_32x32x16_bf16 v[172:187], v[196:199], v[20:23], v[172:187]
  s_waitcnt vmcnt(6)
  s_barrier
  ds_read_b64_tr_b16 v[192:193], v3 offset:12288
  ds_read_b64_tr_b16 v[194:195], v3 offset:12800
  s_add_u32 m0, s28, 49152
  s_add_u32 s27, s27, 739328
  buffer_load_dwordx4 v2, s[8:11], s27 offen offset:0 lds
  s_waitcnt lgkmcnt(6)
  v_mfma_f32_32x32x16_bf16 v[172:187], v[200:203], v[24:27], v[172:187]
  ds_read_b64_tr_b16 v[196:197], v3 offset:14336
  ds_read_b64_tr_b16 v[198:199], v3 offset:14848
  v_mul_f32 v8, v156, v156
  v_mul_f32 v9, v157, v157
  v_mul_f32 v10, v158, v158
  v_mul_f32 v11, v159, v159
  v_fma_f32 v8, v8, v6, v5
  s_waitcnt lgkmcnt(6)
  v_mfma_f32_32x32x16_bf16 v[172:187], v[252:255], v[28:31], v[172:187]
  ds_read_b64_tr_b16 v[200:201], v3 offset:16384
  ds_read_b64_tr_b16 v[202:203], v3 offset:16896
  v_fma_f32 v9, v9, v6, v5
  v_fma_f32 v10, v10, v6, v5
  v_fma_f32 v11, v11, v6, v5
  v_mul_f32 v8, v8, v156
  s_add_u32 s27, s27, 72704
  buffer_load_dwordx4 v2, s[8:11], s27 offen offset:1024 lds
  s_waitcnt lgkmcnt(6)
  v_mfma_f32_32x32x16_bf16 v[172:187], v[188:191], v[32:35], v[172:187]
  ds_read_b64_tr_b16 v[252:253], v3 offset:18432
  ds_read_b64_tr_b16 v[254:255], v3 offset:18944
  v_mul_f32 v9, v9, v157
  v_mul_f32 v10, v10, v158
  v_mul_f32 v11, v11, v159
  v_exp_f32 v8, v8
  s_waitcnt lgkmcnt(6)
  v_mfma_f32_32x32x16_bf16 v[172:187], v[192:195], v[36:39], v[172:187]
  ds_read_b64_tr_b16 v[188:189], v3 offset:20480
  ds_read_b64_tr_b16 v[190:191], v3 offset:20992
  v_exp_f32 v9, v9
  v_exp_f32 v10, v10
  v_exp_f32 v11, v11
  v_fma_f32 v8, v8, v7, v7
  s_add_u32 s27, s27, 72704
  buffer_load_dwordx4 v2, s[8:11], s27 offen offset:2048 lds
  s_waitcnt lgkmcnt(6)
  v_mfma_f32_32x32x16_bf16 v[172:187], v[196:199], v[40:43], v[172:187]
  ds_read_b64_tr_b16 v[192:193], v3 offset:22528
  ds_read_b64_tr_b16 v[194:195], v3 offset:23040
  v_fma_f32 v9, v9, v7, v7
  v_fma_f32 v10, v10, v7, v7
  v_fma_f32 v11, v11, v7, v7
  v_rcp_f32 v8, v8
  s_waitcnt lgkmcnt(6)
  v_mfma_f32_32x32x16_bf16 v[172:187], v[200:203], v[44:47], v[172:187]
  s_waitcnt vmcnt(6)
  s_barrier
  ds_read_b64_tr_b16 v[196:197], v3 offset:24576
  ds_read_b64_tr_b16 v[198:199], v3 offset:25088
  v_rcp_f32 v9, v9
  v_rcp_f32 v10, v10
  v_rcp_f32 v11, v11
  v_mul_f32 v156, v156, v8
  s_add_u32 m0, s28, 0
  s_add_u32 s27, s27, 739328
  buffer_load_dwordx4 v2, s[8:11], s27 offen offset:0 lds
  s_waitcnt lgkmcnt(6)
  v_mfma_f32_32x32x16_bf16 v[172:187], v[252:255], v[48:51], v[172:187]
  ds_read_b64_tr_b16 v[200:201], v3 offset:26624
  ds_read_b64_tr_b16 v[202:203], v3 offset:27136
  v_mul_f32 v157, v157, v9
  v_mul_f32 v158, v158, v10
  v_mul_f32 v159, v159, v11
  v_cvt_pk_bf16_f32 v220, v156, v157
  s_waitcnt lgkmcnt(6)
  v_mfma_f32_32x32x16_bf16 v[172:187], v[188:191], v[52:55], v[172:187]
  ds_read_b64_tr_b16 v[252:253], v3 offset:28672
  ds_read_b64_tr_b16 v[254:255], v3 offset:29184
  v_cvt_pk_bf16_f32 v221, v158, v159
  v_mul_f32 v8, v160, v160
  v_mul_f32 v9, v161, v161
  v_mul_f32 v10, v162, v162
  v_mul_f32 v11, v163, v163
  s_add_u32 s27, s27, 72704
  buffer_load_dwordx4 v2, s[8:11], s27 offen offset:1024 lds
  s_waitcnt lgkmcnt(6)
  v_mfma_f32_32x32x16_bf16 v[172:187], v[192:195], v[56:59], v[172:187]
  ds_read_b64_tr_b16 v[188:189], v3 offset:30720
  ds_read_b64_tr_b16 v[190:191], v3 offset:31232
  v_fma_f32 v8, v8, v6, v5
  v_fma_f32 v9, v9, v6, v5
  v_fma_f32 v10, v10, v6, v5
  v_fma_f32 v11, v11, v6, v5
  s_waitcnt lgkmcnt(6)
  v_mfma_f32_32x32x16_bf16 v[172:187], v[196:199], v[60:63], v[172:187]
  ds_read_b64_tr_b16 v[192:193], v3 offset:32768
  ds_read_b64_tr_b16 v[194:195], v3 offset:33280
  v_mul_f32 v8, v8, v160
  v_mul_f32 v9, v9, v161
  v_mul_f32 v10, v10, v162
  v_mul_f32 v11, v11, v163
  s_add_u32 s27, s27, 72704
  buffer_load_dwordx4 v2, s[8:11], s27 offen offset:2048 lds
  s_waitcnt lgkmcnt(6)
  v_mfma_f32_32x32x16_bf16 v[172:187], v[200:203], v[64:67], v[172:187]
  ds_read_b64_tr_b16 v[196:197], v3 offset:34816
  ds_read_b64_tr_b16 v[198:199], v3 offset:35328
  v_exp_f32 v8, v8
  v_exp_f32 v9, v9
  v_exp_f32 v10, v10
  v_exp_f32 v11, v11
  s_waitcnt lgkmcnt(6)
  v_mfma_f32_32x32x16_bf16 v[172:187], v[252:255], v[68:71], v[172:187]
  s_waitcnt vmcnt(6)
  s_barrier
  ds_read_b64_tr_b16 v[200:201], v3 offset:36864
  ds_read_b64_tr_b16 v[202:203], v3 offset:37376
  v_fma_f32 v8, v8, v7, v7
  v_fma_f32 v9, v9, v7, v7
  v_fma_f32 v10, v10, v7, v7
  v_fma_f32 v11, v11, v7, v7
  s_add_u32 m0, s28, 12288
  s_add_u32 s27, s27, 4290398336
  buffer_load_dwordx4 v2, s[8:11], s27 offen offset:0 lds
  s_waitcnt lgkmcnt(6)
  v_mfma_f32_32x32x16_bf16 v[172:187], v[188:191], v[72:75], v[172:187]
  ds_read_b64_tr_b16 v[252:253], v3 offset:38912
  ds_read_b64_tr_b16 v[254:255], v3 offset:39424
  v_rcp_f32 v8, v8
  v_rcp_f32 v9, v9
  v_rcp_f32 v10, v10
  v_rcp_f32 v11, v11
  s_waitcnt lgkmcnt(6)
  v_mfma_f32_32x32x16_bf16 v[172:187], v[192:195], v[76:79], v[172:187]
  ds_read_b64_tr_b16 v[188:189], v3 offset:40960
  ds_read_b64_tr_b16 v[190:191], v3 offset:41472
  v_mul_f32 v160, v160, v8
  v_mul_f32 v161, v161, v9
  v_mul_f32 v162, v162, v10
  v_mul_f32 v163, v163, v11
  s_add_u32 s27, s27, 72704
  buffer_load_dwordx4 v2, s[8:11], s27 offen offset:1024 lds
  s_waitcnt lgkmcnt(6)
  v_mfma_f32_32x32x16_bf16 v[172:187], v[196:199], v[80:83], v[172:187]
  ds_read_b64_tr_b16 v[192:193], v3 offset:43008
  ds_read_b64_tr_b16 v[194:195], v3 offset:43520
  v_cvt_pk_bf16_f32 v222, v160, v161
  v_cvt_pk_bf16_f32 v223, v162, v163
  v_mul_f32 v8, v164, v164
  v_mul_f32 v9, v165, v165
  v_mul_f32 v10, v166, v166
  s_waitcnt lgkmcnt(6)
  v_mfma_f32_32x32x16_bf16 v[172:187], v[200:203], v[84:87], v[172:187]
  ds_read_b64_tr_b16 v[196:197], v3 offset:45056
  ds_read_b64_tr_b16 v[198:199], v3 offset:45568
  v_mul_f32 v11, v167, v167
  v_fma_f32 v8, v8, v6, v5
  v_fma_f32 v9, v9, v6, v5
  v_fma_f32 v10, v10, v6, v5
  s_add_u32 s27, s27, 72704
  buffer_load_dwordx4 v2, s[8:11], s27 offen offset:2048 lds
  s_waitcnt lgkmcnt(6)
  v_mfma_f32_32x32x16_bf16 v[172:187], v[252:255], v[88:91], v[172:187]
  ds_read_b64_tr_b16 v[200:201], v3 offset:47104
  ds_read_b64_tr_b16 v[202:203], v3 offset:47616
  v_fma_f32 v11, v11, v6, v5
  v_mul_f32 v8, v8, v164
  v_mul_f32 v9, v9, v165
  v_mul_f32 v10, v10, v166
  s_waitcnt lgkmcnt(6)
  v_mfma_f32_32x32x16_bf16 v[172:187], v[188:191], v[92:95], v[172:187]
  s_waitcnt vmcnt(6)
  s_barrier
  ds_read_b64_tr_b16 v[252:253], v3 offset:49152
  ds_read_b64_tr_b16 v[254:255], v3 offset:49664
  v_mul_f32 v11, v11, v167
  v_exp_f32 v8, v8
  v_exp_f32 v9, v9
  v_exp_f32 v10, v10
  s_add_u32 m0, s28, 24576
  s_add_u32 s27, s27, 739328
  buffer_load_dwordx4 v2, s[8:11], s27 offen offset:0 lds
  s_waitcnt lgkmcnt(6)
  v_mfma_f32_32x32x16_bf16 v[172:187], v[192:195], v[96:99], v[172:187]
  ds_read_b64_tr_b16 v[188:189], v3 offset:51200
  ds_read_b64_tr_b16 v[190:191], v3 offset:51712
  v_exp_f32 v11, v11
  v_fma_f32 v8, v8, v7, v7
  v_fma_f32 v9, v9, v7, v7
  v_fma_f32 v10, v10, v7, v7
  s_waitcnt lgkmcnt(6)
  v_mfma_f32_32x32x16_bf16 v[172:187], v[196:199], v[100:103], v[172:187]
  ds_read_b64_tr_b16 v[192:193], v3 offset:53248
  ds_read_b64_tr_b16 v[194:195], v3 offset:53760
  v_fma_f32 v11, v11, v7, v7
  v_rcp_f32 v8, v8
  v_rcp_f32 v9, v9
  v_rcp_f32 v10, v10
  s_add_u32 s27, s27, 72704
  buffer_load_dwordx4 v2, s[8:11], s27 offen offset:1024 lds
  s_waitcnt lgkmcnt(6)
  v_mfma_f32_32x32x16_bf16 v[172:187], v[200:203], v[104:107], v[172:187]
  ds_read_b64_tr_b16 v[196:197], v3 offset:55296
  ds_read_b64_tr_b16 v[198:199], v3 offset:55808
  v_rcp_f32 v11, v11
  v_mul_f32 v164, v164, v8
  v_mul_f32 v165, v165, v9
  v_mul_f32 v166, v166, v10
  s_waitcnt lgkmcnt(6)
  v_mfma_f32_32x32x16_bf16 v[172:187], v[252:255], v[108:111], v[172:187]
  ds_read_b64_tr_b16 v[200:201], v3 offset:57344
  ds_read_b64_tr_b16 v[202:203], v3 offset:57856
  v_mul_f32 v167, v167, v11
  v_cvt_pk_bf16_f32 v224, v164, v165
  v_cvt_pk_bf16_f32 v225, v166, v167
  v_mul_f32 v8, v168, v168
  v_mul_f32 v9, v169, v169
  s_add_u32 s27, s27, 72704
  buffer_load_dwordx4 v2, s[8:11], s27 offen offset:2048 lds
  s_waitcnt lgkmcnt(6)
  v_mfma_f32_32x32x16_bf16 v[172:187], v[188:191], v[112:115], v[172:187]
  ds_read_b64_tr_b16 v[252:253], v3 offset:59392
  ds_read_b64_tr_b16 v[254:255], v3 offset:59904
  v_mul_f32 v10, v170, v170
  v_mul_f32 v11, v171, v171
  v_fma_f32 v8, v8, v6, v5
  v_fma_f32 v9, v9, v6, v5
  s_waitcnt lgkmcnt(6)
  v_mfma_f32_32x32x16_bf16 v[172:187], v[192:195], v[116:119], v[172:187]
  s_waitcnt vmcnt(6)
  s_barrier
  ds_read_b64_tr_b16 v[188:189], v3 offset:0
  ds_read_b64_tr_b16 v[190:191], v3 offset:512
  v_fma_f32 v10, v10, v6, v5
  v_fma_f32 v11, v11, v6, v5
  v_mul_f32 v8, v8, v168
  v_mul_f32 v9, v9, v169
  s_add_u32 m0, s28, 36864
  s_add_u32 s27, s27, 739328
  buffer_load_dwordx4 v2, s[8:11], s27 offen offset:0 lds
  s_waitcnt lgkmcnt(6)
  v_mfma_f32_32x32x16_bf16 v[172:187], v[196:199], v[120:123], v[172:187]
  ds_read_b64_tr_b16 v[192:193], v3 offset:2048
  ds_read_b64_tr_b16 v[194:195], v3 offset:2560
  v_mul_f32 v10, v10, v170
  v_mul_f32 v11, v11, v171
  v_exp_f32 v8, v8
  v_exp_f32 v9, v9
  s_waitcnt lgkmcnt(6)
  v_mfma_f32_32x32x16_bf16 v[172:187], v[200:203], v[124:127], v[172:187]
  ds_read_b64_tr_b16 v[196:197], v3 offset:4096
  ds_read_b64_tr_b16 v[198:199], v3 offset:4608
  v_exp_f32 v10, v10
  v_exp_f32 v11, v11
  v_fma_f32 v8, v8, v7, v7
  v_fma_f32 v9, v9, v7, v7
  s_add_u32 s27, s27, 72704
  buffer_load_dwordx4 v2, s[8:11], s27 offen offset:1024 lds
  s_waitcnt lgkmcnt(6)
  v_mfma_f32_32x32x16_bf16 v[172:187], v[252:255], v[128:131], v[172:187]
  ds_read_b64_tr_b16 v[200:201], v3 offset:6144
  ds_read_b64_tr_b16 v[202:203], v3 offset:6656
  v_fma_f32 v10, v10, v7, v7
  v_fma_f32 v11, v11, v7, v7
  v_rcp_f32 v8, v8
  v_rcp_f32 v9, v9
  s_waitcnt lgkmcnt(6)
  v_mfma_f32_32x32x16_bf16 v[172:187], v[188:191], v[132:135], v[172:187]
  ds_read_b64_tr_b16 v[252:253], v3 offset:8192
  ds_read_b64_tr_b16 v[254:255], v3 offset:8704
  v_rcp_f32 v10, v10
  v_rcp_f32 v11, v11
  v_mul_f32 v168, v168, v8
  v_mul_f32 v169, v169, v9
  s_add_u32 s27, s27, 72704
  buffer_load_dwordx4 v2, s[8:11], s27 offen offset:2048 lds
  s_waitcnt lgkmcnt(6)
  v_mfma_f32_32x32x16_bf16 v[172:187], v[192:195], v[136:139], v[172:187]
  ds_read_b64_tr_b16 v[188:189], v3 offset:10240
  ds_read_b64_tr_b16 v[190:191], v3 offset:10752
  v_mul_f32 v170, v170, v10
  v_mul_f32 v171, v171, v11
  v_cvt_pk_bf16_f32 v226, v168, v169
  v_cvt_pk_bf16_f32 v227, v170, v171
  s_waitcnt lgkmcnt(6)
  v_mfma_f32_32x32x16_bf16 v[172:187], v[196:199], v[140:143], v[172:187]
  s_waitcnt vmcnt(6)
  s_barrier
  ds_read_b64_tr_b16 v[192:193], v3 offset:12288
  ds_read_b64_tr_b16 v[194:195], v3 offset:12800
  s_add_u32 m0, s28, 49152
  s_add_u32 s27, s27, 739328
  buffer_load_dwordx4 v2, s[8:11], s27 offen offset:0 lds
  s_waitcnt lgkmcnt(6)
  v_mfma_f32_32x32x16_bf16 v[172:187], v[200:203], v[144:147], v[172:187]
  ds_read_b64_tr_b16 v[196:197], v3 offset:14336
  ds_read_b64_tr_b16 v[198:199], v3 offset:14848
  s_waitcnt lgkmcnt(6)
  v_mfma_f32_32x32x16_bf16 v[172:187], v[252:255], v[148:151], v[172:187]
  ds_read_b64_tr_b16 v[200:201], v3 offset:16384
  ds_read_b64_tr_b16 v[202:203], v3 offset:16896
  s_add_u32 s27, s27, 72704
  buffer_load_dwordx4 v2, s[8:11], s27 offen offset:1024 lds
  s_waitcnt lgkmcnt(6)
  v_mfma_f32_32x32x16_bf16 v[172:187], v[188:191], v[152:155], v[172:187]
  ds_read_b64_tr_b16 v[252:253], v3 offset:18432
  ds_read_b64_tr_b16 v[254:255], v3 offset:18944
  s_waitcnt lgkmcnt(6)
  v_mfma_f32_32x32x16_bf16 v[156:171], v[192:195], v[12:15], 0
  ds_read_b64_tr_b16 v[188:189], v3 offset:20480
  ds_read_b64_tr_b16 v[190:191], v3 offset:20992
  s_add_u32 s27, s27, 72704
  buffer_load_dwordx4 v2, s[8:11], s27 offen offset:2048 lds
  s_waitcnt lgkmcnt(6)
  v_mfma_f32_32x32x16_bf16 v[156:171], v[196:199], v[16:19], v[156:171]
  ds_read_b64_tr_b16 v[192:193], v3 offset:22528
  ds_read_b64_tr_b16 v[194:195], v3 offset:23040
  s_waitcnt lgkmcnt(6)
  v_mfma_f32_32x32x16_bf16 v[156:171], v[200:203], v[20:23], v[156:171]
  s_waitcnt vmcnt(6)
  s_barrier
  ds_read_b64_tr_b16 v[196:197], v3 offset:24576
  ds_read_b64_tr_b16 v[198:199], v3 offset:25088
  s_add_u32 m0, s28, 0
  s_add_u32 s27, s27, 739328
  buffer_load_dwordx4 v2, s[8:11], s27 offen offset:0 lds
  s_waitcnt lgkmcnt(6)
  v_mfma_f32_32x32x16_bf16 v[156:171], v[252:255], v[24:27], v[156:171]
  ds_read_b64_tr_b16 v[200:201], v3 offset:26624
  ds_read_b64_tr_b16 v[202:203], v3 offset:27136
  v_mul_f32 v8, v172, v172
  v_mul_f32 v9, v173, v173
  v_mul_f32 v10, v174, v174
  v_mul_f32 v11, v175, v175
  v_fma_f32 v8, v8, v6, v5
  s_waitcnt lgkmcnt(6)
  v_mfma_f32_32x32x16_bf16 v[156:171], v[188:191], v[28:31], v[156:171]
  ds_read_b64_tr_b16 v[252:253], v3 offset:28672
  ds_read_b64_tr_b16 v[254:255], v3 offset:29184
  v_fma_f32 v9, v9, v6, v5
  v_fma_f32 v10, v10, v6, v5
  v_fma_f32 v11, v11, v6, v5
  v_mul_f32 v8, v8, v172
  s_add_u32 s27, s27, 72704
  buffer_load_dwordx4 v2, s[8:11], s27 offen offset:1024 lds
  s_waitcnt lgkmcnt(6)
  v_mfma_f32_32x32x16_bf16 v[156:171], v[192:195], v[32:35], v[156:171]
  ds_read_b64_tr_b16 v[188:189], v3 offset:30720
  ds_read_b64_tr_b16 v[190:191], v3 offset:31232
  v_mul_f32 v9, v9, v173
  v_mul_f32 v10, v10, v174
  v_mul_f32 v11, v11, v175
  v_exp_f32 v8, v8
  s_waitcnt lgkmcnt(6)
  v_mfma_f32_32x32x16_bf16 v[156:171], v[196:199], v[36:39], v[156:171]
  ds_read_b64_tr_b16 v[192:193], v3 offset:32768
  ds_read_b64_tr_b16 v[194:195], v3 offset:33280
  v_exp_f32 v9, v9
  v_exp_f32 v10, v10
  v_exp_f32 v11, v11
  v_fma_f32 v8, v8, v7, v7
  s_add_u32 s27, s27, 72704
  buffer_load_dwordx4 v2, s[8:11], s27 offen offset:2048 lds
  s_waitcnt lgkmcnt(6)
  v_mfma_f32_32x32x16_bf16 v[156:171], v[200:203], v[40:43], v[156:171]
  ds_read_b64_tr_b16 v[196:197], v3 offset:34816
  ds_read_b64_tr_b16 v[198:199], v3 offset:35328
  v_fma_f32 v9, v9, v7, v7
  v_fma_f32 v10, v10, v7, v7
  v_fma_f32 v11, v11, v7, v7
  v_rcp_f32 v8, v8
  s_waitcnt lgkmcnt(6)
  v_mfma_f32_32x32x16_bf16 v[156:171], v[252:255], v[44:47], v[156:171]
  s_waitcnt vmcnt(6)
  s_barrier
  ds_read_b64_tr_b16 v[200:201], v3 offset:36864
  ds_read_b64_tr_b16 v[202:203], v3 offset:37376
  v_rcp_f32 v9, v9
  v_rcp_f32 v10, v10
  v_rcp_f32 v11, v11
  v_mul_f32 v172, v172, v8
  s_add_u32 m0, s28, 12288
  s_add_u32 s27, s27, 739328
  buffer_load_dwordx4 v2, s[8:11], s27 offen offset:0 lds
  s_waitcnt lgkmcnt(6)
  v_mfma_f32_32x32x16_bf16 v[156:171], v[188:191], v[48:51], v[156:171]
  ds_read_b64_tr_b16 v[252:253], v3 offset:38912
  ds_read_b64_tr_b16 v[254:255], v3 offset:39424
  v_mul_f32 v173, v173, v9
  v_mul_f32 v174, v174, v10
  v_mul_f32 v175, v175, v11
  v_cvt_pk_bf16_f32 v228, v172, v173
  s_waitcnt lgkmcnt(6)
  v_mfma_f32_32x32x16_bf16 v[156:171], v[192:195], v[52:55], v[156:171]
  ds_read_b64_tr_b16 v[188:189], v3 offset:40960
  ds_read_b64_tr_b16 v[190:191], v3 offset:41472
  v_cvt_pk_bf16_f32 v229, v174, v175
  v_mul_f32 v8, v176, v176
  v_mul_f32 v9, v177, v177
  v_mul_f32 v10, v178, v178
  v_mul_f32 v11, v179, v179
  s_add_u32 s27, s27, 72704
  buffer_load_dwordx4 v2, s[8:11], s27 offen offset:1024 lds
  s_waitcnt lgkmcnt(6)
  v_mfma_f32_32x32x16_bf16 v[156:171], v[196:199], v[56:59], v[156:171]
  ds_read_b64_tr_b16 v[192:193], v3 offset:43008
  ds_read_b64_tr_b16 v[194:195], v3 offset:43520
  v_fma_f32 v8, v8, v6, v5
  v_fma_f32 v9, v9, v6, v5
  v_fma_f32 v10, v10, v6, v5
  v_fma_f32 v11, v11, v6, v5
  s_waitcnt lgkmcnt(6)
  v_mfma_f32_32x32x16_bf16 v[156:171], v[200:203], v[60:63], v[156:171]
  ds_read_b64_tr_b16 v[196:197], v3 offset:45056
  ds_read_b64_tr_b16 v[198:199], v3 offset:45568
  v_mul_f32 v8, v8, v176
  v_mul_f32 v9, v9, v177
  v_mul_f32 v10, v10, v178
  v_mul_f32 v11, v11, v179
  s_add_u32 s27, s27, 72704
  buffer_load_dwordx4 v2, s[8:11], s27 offen offset:2048 lds
  s_waitcnt lgkmcnt(6)
  v_mfma_f32_32x32x16_bf16 v[156:171], v[252:255], v[64:67], v[156:171]
  ds_read_b64_tr_b16 v[200:201], v3 offset:47104
  ds_read_b64_tr_b16 v[202:203], v3 offset:47616
  v_exp_f32 v8, v8
  v_exp_f32 v9, v9
  v_exp_f32 v10, v10
  v_exp_f32 v11, v11
  s_waitcnt lgkmcnt(6)
  v_mfma_f32_32x32x16_bf16 v[156:171], v[188:191], v[68:71], v[156:171]
  s_waitcnt vmcnt(6)
  s_barrier
  ds_read_b64_tr_b16 v[252:253], v3 offset:49152
  ds_read_b64_tr_b16 v[254:255], v3 offset:49664
  v_fma_f32 v8, v8, v7, v7
  v_fma_f32 v9, v9, v7, v7
  v_fma_f32 v10, v10, v7, v7
  v_fma_f32 v11, v11, v7, v7
  s_add_u32 m0, s28, 24576
  s_add_u32 s27, s27, 4290398336
  buffer_load_dwordx4 v2, s[8:11], s27 offen offset:0 lds
  s_waitcnt lgkmcnt(6)
  v_mfma_f32_32x32x16_bf16 v[156:171], v[192:195], v[72:75], v[156:171]
  ds_read_b64_tr_b16 v[188:189], v3 offset:51200
  ds_read_b64_tr_b16 v[190:191], v3 offset:51712
  v_rcp_f32 v8, v8
  v_rcp_f32 v9, v9
  v_rcp_f32 v10, v10
  v_rcp_f32 v11, v11
  s_waitcnt lgkmcnt(6)
  v_mfma_f32_32x32x16_bf16 v[156:171], v[196:199], v[76:79], v[156:171]
  ds_read_b64_tr_b16 v[192:193], v3 offset:53248
  ds_read_b64_tr_b16 v[194:195], v3 offset:53760
  v_mul_f32 v176, v176, v8
  v_mul_f32 v177, v177, v9
  v_mul_f32 v178, v178, v10
  v_mul_f32 v179, v179, v11
  s_add_u32 s27, s27, 72704
  buffer_load_dwordx4 v2, s[8:11], s27 offen offset:1024 lds
  s_waitcnt lgkmcnt(6)
  v_mfma_f32_32x32x16_bf16 v[156:171], v[200:203], v[80:83], v[156:171]
  ds_read_b64_tr_b16 v[196:197], v3 offset:55296
  ds_read_b64_tr_b16 v[198:199], v3 offset:55808
  v_cvt_pk_bf16_f32 v230, v176, v177
  v_cvt_pk_bf16_f32 v231, v178, v179
  v_mul_f32 v8, v180, v180
  v_mul_f32 v9, v181, v181
  v_mul_f32 v10, v182, v182
  s_waitcnt lgkmcnt(6)
  v_mfma_f32_32x32x16_bf16 v[156:171], v[252:255], v[84:87], v[156:171]
  ds_read_b64_tr_b16 v[200:201], v3 offset:57344
  ds_read_b64_tr_b16 v[202:203], v3 offset:57856
  v_mul_f32 v11, v183, v183
  v_fma_f32 v8, v8, v6, v5
  v_fma_f32 v9, v9, v6, v5
  v_fma_f32 v10, v10, v6, v5
  s_add_u32 s27, s27, 72704
  buffer_load_dwordx4 v2, s[8:11], s27 offen offset:2048 lds
  s_waitcnt lgkmcnt(6)
  v_mfma_f32_32x32x16_bf16 v[156:171], v[188:191], v[88:91], v[156:171]
  ds_read_b64_tr_b16 v[252:253], v3 offset:59392
  ds_read_b64_tr_b16 v[254:255], v3 offset:59904
  v_fma_f32 v11, v11, v6, v5
  v_mul_f32 v8, v8, v180
  v_mul_f32 v9, v9, v181
  v_mul_f32 v10, v10, v182
  s_waitcnt lgkmcnt(6)
  v_mfma_f32_32x32x16_bf16 v[156:171], v[192:195], v[92:95], v[156:171]
  s_waitcnt vmcnt(6)
  s_barrier
  ds_read_b64_tr_b16 v[188:189], v3 offset:0
  ds_read_b64_tr_b16 v[190:191], v3 offset:512
  v_mul_f32 v11, v11, v183
  v_exp_f32 v8, v8
  v_exp_f32 v9, v9
  v_exp_f32 v10, v10
  s_add_u32 m0, s28, 36864
  s_add_u32 s27, s27, 739328
  buffer_load_dwordx4 v2, s[8:11], s27 offen offset:0 lds
  s_waitcnt lgkmcnt(6)
  v_mfma_f32_32x32x16_bf16 v[156:171], v[196:199], v[96:99], v[156:171]
  ds_read_b64_tr_b16 v[192:193], v3 offset:2048
  ds_read_b64_tr_b16 v[194:195], v3 offset:2560
  v_exp_f32 v11, v11
  v_fma_f32 v8, v8, v7, v7
  v_fma_f32 v9, v9, v7, v7
  v_fma_f32 v10, v10, v7, v7
  s_waitcnt lgkmcnt(6)
  v_mfma_f32_32x32x16_bf16 v[156:171], v[200:203], v[100:103], v[156:171]
  ds_read_b64_tr_b16 v[196:197], v3 offset:4096
  ds_read_b64_tr_b16 v[198:199], v3 offset:4608
  v_fma_f32 v11, v11, v7, v7
  v_rcp_f32 v8, v8
  v_rcp_f32 v9, v9
  v_rcp_f32 v10, v10
  s_add_u32 s27, s27, 72704
  buffer_load_dwordx4 v2, s[8:11], s27 offen offset:1024 lds
  s_waitcnt lgkmcnt(6)
  v_mfma_f32_32x32x16_bf16 v[156:171], v[252:255], v[104:107], v[156:171]
  ds_read_b64_tr_b16 v[200:201], v3 offset:6144
  ds_read_b64_tr_b16 v[202:203], v3 offset:6656
  v_rcp_f32 v11, v11
  v_mul_f32 v180, v180, v8
  v_mul_f32 v181, v181, v9
  v_mul_f32 v182, v182, v10
  s_waitcnt lgkmcnt(6)
  v_mfma_f32_32x32x16_bf16 v[156:171], v[188:191], v[108:111], v[156:171]
  ds_read_b64_tr_b16 v[252:253], v3 offset:8192
  ds_read_b64_tr_b16 v[254:255], v3 offset:8704
  v_mul_f32 v183, v183, v11
  v_cvt_pk_bf16_f32 v232, v180, v181
  v_cvt_pk_bf16_f32 v233, v182, v183
  v_mul_f32 v8, v184, v184
  v_mul_f32 v9, v185, v185
  s_add_u32 s27, s27, 72704
  buffer_load_dwordx4 v2, s[8:11], s27 offen offset:2048 lds
  s_waitcnt lgkmcnt(6)
  v_mfma_f32_32x32x16_bf16 v[156:171], v[192:195], v[112:115], v[156:171]
  ds_read_b64_tr_b16 v[188:189], v3 offset:10240
  ds_read_b64_tr_b16 v[190:191], v3 offset:10752
  v_mul_f32 v10, v186, v186
  v_mul_f32 v11, v187, v187
  v_fma_f32 v8, v8, v6, v5
  v_fma_f32 v9, v9, v6, v5
  s_waitcnt lgkmcnt(6)
  v_mfma_f32_32x32x16_bf16 v[156:171], v[196:199], v[116:119], v[156:171]
  s_waitcnt vmcnt(6)
  s_barrier
  ds_read_b64_tr_b16 v[192:193], v3 offset:12288
  ds_read_b64_tr_b16 v[194:195], v3 offset:12800
  v_fma_f32 v10, v10, v6, v5
  v_fma_f32 v11, v11, v6, v5
  v_mul_f32 v8, v8, v184
  v_mul_f32 v9, v9, v185
  s_add_u32 m0, s28, 49152
  s_add_u32 s27, s27, 739328
  buffer_load_dwordx4 v2, s[8:11], s27 offen offset:0 lds
  s_waitcnt lgkmcnt(6)
  v_mfma_f32_32x32x16_bf16 v[156:171], v[200:203], v[120:123], v[156:171]
  ds_read_b64_tr_b16 v[196:197], v3 offset:14336
  ds_read_b64_tr_b16 v[198:199], v3 offset:14848
  v_mul_f32 v10, v10, v186
  v_mul_f32 v11, v11, v187
  v_exp_f32 v8, v8
  v_exp_f32 v9, v9
  s_waitcnt lgkmcnt(6)
  v_mfma_f32_32x32x16_bf16 v[156:171], v[252:255], v[124:127], v[156:171]
  ds_read_b64_tr_b16 v[200:201], v3 offset:16384
  ds_read_b64_tr_b16 v[202:203], v3 offset:16896
  v_exp_f32 v10, v10
  v_exp_f32 v11, v11
  v_fma_f32 v8, v8, v7, v7
  v_fma_f32 v9, v9, v7, v7
  s_add_u32 s27, s27, 72704
  buffer_load_dwordx4 v2, s[8:11], s27 offen offset:1024 lds
  s_waitcnt lgkmcnt(6)
  v_mfma_f32_32x32x16_bf16 v[156:171], v[188:191], v[128:131], v[156:171]
  ds_read_b64_tr_b16 v[252:253], v3 offset:18432
  ds_read_b64_tr_b16 v[254:255], v3 offset:18944
  v_fma_f32 v10, v10, v7, v7
  v_fma_f32 v11, v11, v7, v7
  v_rcp_f32 v8, v8
  v_rcp_f32 v9, v9
  s_waitcnt lgkmcnt(6)
  v_mfma_f32_32x32x16_bf16 v[156:171], v[192:195], v[132:135], v[156:171]
  ds_read_b64_tr_b16 v[188:189], v3 offset:20480
  ds_read_b64_tr_b16 v[190:191], v3 offset:20992
  v_rcp_f32 v10, v10
  v_rcp_f32 v11, v11
  v_mul_f32 v184, v184, v8
  v_mul_f32 v185, v185, v9
  s_add_u32 s27, s27, 72704
  buffer_load_dwordx4 v2, s[8:11], s27 offen offset:2048 lds
  s_waitcnt lgkmcnt(6)
  v_mfma_f32_32x32x16_bf16 v[156:171], v[196:199], v[136:139], v[156:171]
  ds_read_b64_tr_b16 v[192:193], v3 offset:22528
  ds_read_b64_tr_b16 v[194:195], v3 offset:23040
  v_mul_f32 v186, v186, v10
  v_mul_f32 v187, v187, v11
  v_cvt_pk_bf16_f32 v234, v184, v185
  v_cvt_pk_bf16_f32 v235, v186, v187
  s_waitcnt lgkmcnt(6)
  v_mfma_f32_32x32x16_bf16 v[156:171], v[200:203], v[140:143], v[156:171]
  s_waitcnt vmcnt(6)
  s_barrier
  ds_read_b64_tr_b16 v[196:197], v3 offset:24576
  ds_read_b64_tr_b16 v[198:199], v3 offset:25088
  s_add_u32 m0, s28, 0
  s_add_u32 s27, s27, 739328
  buffer_load_dwordx4 v2, s[8:11], s27 offen offset:0 lds
  s_waitcnt lgkmcnt(6)
  v_mfma_f32_32x32x16_bf16 v[156:171], v[252:255], v[144:147], v[156:171]
  ds_read_b64_tr_b16 v[200:201], v3 offset:26624
  ds_read_b64_tr_b16 v[202:203], v3 offset:27136
  s_waitcnt lgkmcnt(6)
  v_mfma_f32_32x32x16_bf16 v[156:171], v[188:191], v[148:151], v[156:171]
  ds_read_b64_tr_b16 v[252:253], v3 offset:28672
  ds_read_b64_tr_b16 v[254:255], v3 offset:29184
  s_add_u32 s27, s27, 72704
  buffer_load_dwordx4 v2, s[8:11], s27 offen offset:1024 lds
  s_waitcnt lgkmcnt(6)
  v_mfma_f32_32x32x16_bf16 v[156:171], v[192:195], v[152:155], v[156:171]
  ds_read_b64_tr_b16 v[188:189], v3 offset:30720
  ds_read_b64_tr_b16 v[190:191], v3 offset:31232
  s_waitcnt lgkmcnt(6)
  v_mfma_f32_32x32x16_bf16 v[172:187], v[196:199], v[12:15], 0
  ds_read_b64_tr_b16 v[192:193], v3 offset:32768
  ds_read_b64_tr_b16 v[194:195], v3 offset:33280
  s_add_u32 s27, s27, 72704
  buffer_load_dwordx4 v2, s[8:11], s27 offen offset:2048 lds
  s_waitcnt lgkmcnt(6)
  v_mfma_f32_32x32x16_bf16 v[172:187], v[200:203], v[16:19], v[172:187]
  ds_read_b64_tr_b16 v[196:197], v3 offset:34816
  ds_read_b64_tr_b16 v[198:199], v3 offset:35328
  s_waitcnt lgkmcnt(6)
  v_mfma_f32_32x32x16_bf16 v[172:187], v[252:255], v[20:23], v[172:187]
  s_waitcnt vmcnt(6)
  s_barrier
  ds_read_b64_tr_b16 v[200:201], v3 offset:36864
  ds_read_b64_tr_b16 v[202:203], v3 offset:37376
  s_add_u32 m0, s28, 12288
  s_add_u32 s27, s27, 739328
  buffer_load_dwordx4 v2, s[8:11], s27 offen offset:0 lds
  s_waitcnt lgkmcnt(6)
  v_mfma_f32_32x32x16_bf16 v[172:187], v[188:191], v[24:27], v[172:187]
  ds_read_b64_tr_b16 v[252:253], v3 offset:38912
  ds_read_b64_tr_b16 v[254:255], v3 offset:39424
  v_mul_f32 v8, v156, v156
  v_mul_f32 v9, v157, v157
  v_mul_f32 v10, v158, v158
  v_mul_f32 v11, v159, v159
  v_fma_f32 v8, v8, v6, v5
  s_waitcnt lgkmcnt(6)
  v_mfma_f32_32x32x16_bf16 v[172:187], v[192:195], v[28:31], v[172:187]
  ds_read_b64_tr_b16 v[188:189], v3 offset:40960
  ds_read_b64_tr_b16 v[190:191], v3 offset:41472
  v_fma_f32 v9, v9, v6, v5
  v_fma_f32 v10, v10, v6, v5
  v_fma_f32 v11, v11, v6, v5
  v_mul_f32 v8, v8, v156
  s_add_u32 s27, s27, 72704
  buffer_load_dwordx4 v2, s[8:11], s27 offen offset:1024 lds
  s_waitcnt lgkmcnt(6)
  v_mfma_f32_32x32x16_bf16 v[172:187], v[196:199], v[32:35], v[172:187]
  ds_read_b64_tr_b16 v[192:193], v3 offset:43008
  ds_read_b64_tr_b16 v[194:195], v3 offset:43520
  v_mul_f32 v9, v9, v157
  v_mul_f32 v10, v10, v158
  v_mul_f32 v11, v11, v159
  v_exp_f32 v8, v8
  s_waitcnt lgkmcnt(6)
  v_mfma_f32_32x32x16_bf16 v[172:187], v[200:203], v[36:39], v[172:187]
  ds_read_b64_tr_b16 v[196:197], v3 offset:45056
  ds_read_b64_tr_b16 v[198:199], v3 offset:45568
  v_exp_f32 v9, v9
  v_exp_f32 v10, v10
  v_exp_f32 v11, v11
  v_fma_f32 v8, v8, v7, v7
  s_add_u32 s27, s27, 72704
  buffer_load_dwordx4 v2, s[8:11], s27 offen offset:2048 lds
  s_waitcnt lgkmcnt(6)
  v_mfma_f32_32x32x16_bf16 v[172:187], v[252:255], v[40:43], v[172:187]
  ds_read_b64_tr_b16 v[200:201], v3 offset:47104
  ds_read_b64_tr_b16 v[202:203], v3 offset:47616
  v_fma_f32 v9, v9, v7, v7
  v_fma_f32 v10, v10, v7, v7
  v_fma_f32 v11, v11, v7, v7
  v_rcp_f32 v8, v8
  s_waitcnt lgkmcnt(6)
  v_mfma_f32_32x32x16_bf16 v[172:187], v[188:191], v[44:47], v[172:187]
  s_waitcnt vmcnt(6)
  s_barrier
  ds_read_b64_tr_b16 v[252:253], v3 offset:49152
  ds_read_b64_tr_b16 v[254:255], v3 offset:49664
  v_rcp_f32 v9, v9
  v_rcp_f32 v10, v10
  v_rcp_f32 v11, v11
  v_mul_f32 v156, v156, v8
  s_add_u32 m0, s28, 24576
  s_add_u32 s27, s27, 739328
  buffer_load_dwordx4 v2, s[8:11], s27 offen offset:0 lds
  s_waitcnt lgkmcnt(6)
  v_mfma_f32_32x32x16_bf16 v[172:187], v[192:195], v[48:51], v[172:187]
  ds_read_b64_tr_b16 v[188:189], v3 offset:51200
  ds_read_b64_tr_b16 v[190:191], v3 offset:51712
  v_mul_f32 v157, v157, v9
  v_mul_f32 v158, v158, v10
  v_mul_f32 v159, v159, v11
  v_cvt_pk_bf16_f32 v236, v156, v157
  s_waitcnt lgkmcnt(6)
  v_mfma_f32_32x32x16_bf16 v[172:187], v[196:199], v[52:55], v[172:187]
  ds_read_b64_tr_b16 v[192:193], v3 offset:53248
  ds_read_b64_tr_b16 v[194:195], v3 offset:53760
  v_cvt_pk_bf16_f32 v237, v158, v159
  v_mul_f32 v8, v160, v160
  v_mul_f32 v9, v161, v161
  v_mul_f32 v10, v162, v162
  v_mul_f32 v11, v163, v163
  s_add_u32 s27, s27, 72704
  buffer_load_dwordx4 v2, s[8:11], s27 offen offset:1024 lds
  s_waitcnt lgkmcnt(6)
  v_mfma_f32_32x32x16_bf16 v[172:187], v[200:203], v[56:59], v[172:187]
  ds_read_b64_tr_b16 v[196:197], v3 offset:55296
  ds_read_b64_tr_b16 v[198:199], v3 offset:55808
  v_fma_f32 v8, v8, v6, v5
  v_fma_f32 v9, v9, v6, v5
  v_fma_f32 v10, v10, v6, v5
  v_fma_f32 v11, v11, v6, v5
  s_waitcnt lgkmcnt(6)
  v_mfma_f32_32x32x16_bf16 v[172:187], v[252:255], v[60:63], v[172:187]
  ds_read_b64_tr_b16 v[200:201], v3 offset:57344
  ds_read_b64_tr_b16 v[202:203], v3 offset:57856
  v_mul_f32 v8, v8, v160
  v_mul_f32 v9, v9, v161
  v_mul_f32 v10, v10, v162
  v_mul_f32 v11, v11, v163
  s_add_u32 s27, s27, 72704
  buffer_load_dwordx4 v2, s[8:11], s27 offen offset:2048 lds
  s_waitcnt lgkmcnt(6)
  v_mfma_f32_32x32x16_bf16 v[172:187], v[188:191], v[64:67], v[172:187]
  ds_read_b64_tr_b16 v[252:253], v3 offset:59392
  ds_read_b64_tr_b16 v[254:255], v3 offset:59904
  v_exp_f32 v8, v8
  v_exp_f32 v9, v9
  v_exp_f32 v10, v10
  v_exp_f32 v11, v11
  s_waitcnt lgkmcnt(6)
  v_mfma_f32_32x32x16_bf16 v[172:187], v[192:195], v[68:71], v[172:187]
  s_waitcnt vmcnt(6)
  s_barrier
  ds_read_b64_tr_b16 v[188:189], v3 offset:0
  ds_read_b64_tr_b16 v[190:191], v3 offset:512
  v_fma_f32 v8, v8, v7, v7
  v_fma_f32 v9, v9, v7, v7
  v_fma_f32 v10, v10, v7, v7
  v_fma_f32 v11, v11, v7, v7
  s_add_u32 m0, s28, 36864
  s_add_u32 s27, s27, 4290398336
  buffer_load_dwordx4 v2, s[8:11], s27 offen offset:0 lds
  s_waitcnt lgkmcnt(6)
  v_mfma_f32_32x32x16_bf16 v[172:187], v[196:199], v[72:75], v[172:187]
  ds_read_b64_tr_b16 v[192:193], v3 offset:2048
  ds_read_b64_tr_b16 v[194:195], v3 offset:2560
  v_rcp_f32 v8, v8
  v_rcp_f32 v9, v9
  v_rcp_f32 v10, v10
  v_rcp_f32 v11, v11
  s_waitcnt lgkmcnt(6)
  v_mfma_f32_32x32x16_bf16 v[172:187], v[200:203], v[76:79], v[172:187]
  ds_read_b64_tr_b16 v[196:197], v3 offset:4096
  ds_read_b64_tr_b16 v[198:199], v3 offset:4608
  v_mul_f32 v160, v160, v8
  v_mul_f32 v161, v161, v9
  v_mul_f32 v162, v162, v10
  v_mul_f32 v163, v163, v11
  s_add_u32 s27, s27, 72704
  buffer_load_dwordx4 v2, s[8:11], s27 offen offset:1024 lds
  s_waitcnt lgkmcnt(6)
  v_mfma_f32_32x32x16_bf16 v[172:187], v[252:255], v[80:83], v[172:187]
  ds_read_b64_tr_b16 v[200:201], v3 offset:6144
  ds_read_b64_tr_b16 v[202:203], v3 offset:6656
  v_cvt_pk_bf16_f32 v238, v160, v161
  v_cvt_pk_bf16_f32 v239, v162, v163
  v_mul_f32 v8, v164, v164
  v_mul_f32 v9, v165, v165
  v_mul_f32 v10, v166, v166
  s_waitcnt lgkmcnt(6)
  v_mfma_f32_32x32x16_bf16 v[172:187], v[188:191], v[84:87], v[172:187]
  ds_read_b64_tr_b16 v[252:253], v3 offset:8192
  ds_read_b64_tr_b16 v[254:255], v3 offset:8704
  v_mul_f32 v11, v167, v167
  v_fma_f32 v8, v8, v6, v5
  v_fma_f32 v9, v9, v6, v5
  v_fma_f32 v10, v10, v6, v5
  s_add_u32 s27, s27, 72704
  buffer_load_dwordx4 v2, s[8:11], s27 offen offset:2048 lds
  s_waitcnt lgkmcnt(6)
  v_mfma_f32_32x32x16_bf16 v[172:187], v[192:195], v[88:91], v[172:187]
  ds_read_b64_tr_b16 v[188:189], v3 offset:10240
  ds_read_b64_tr_b16 v[190:191], v3 offset:10752
  v_fma_f32 v11, v11, v6, v5
  v_mul_f32 v8, v8, v164
  v_mul_f32 v9, v9, v165
  v_mul_f32 v10, v10, v166
  s_waitcnt lgkmcnt(6)
  v_mfma_f32_32x32x16_bf16 v[172:187], v[196:199], v[92:95], v[172:187]
  s_waitcnt vmcnt(6)
  s_barrier
  ds_read_b64_tr_b16 v[192:193], v3 offset:12288
  ds_read_b64_tr_b16 v[194:195], v3 offset:12800
  v_mul_f32 v11, v11, v167
  v_exp_f32 v8, v8
  v_exp_f32 v9, v9
  v_exp_f32 v10, v10
  s_add_u32 m0, s28, 49152
  s_add_u32 s27, s27, 739328
  buffer_load_dwordx4 v2, s[8:11], s27 offen offset:0 lds
  s_waitcnt lgkmcnt(6)
  v_mfma_f32_32x32x16_bf16 v[172:187], v[200:203], v[96:99], v[172:187]
  ds_read_b64_tr_b16 v[196:197], v3 offset:14336
  ds_read_b64_tr_b16 v[198:199], v3 offset:14848
  v_exp_f32 v11, v11
  v_fma_f32 v8, v8, v7, v7
  v_fma_f32 v9, v9, v7, v7
  v_fma_f32 v10, v10, v7, v7
  s_waitcnt lgkmcnt(6)
  v_mfma_f32_32x32x16_bf16 v[172:187], v[252:255], v[100:103], v[172:187]
  ds_read_b64_tr_b16 v[200:201], v3 offset:16384
  ds_read_b64_tr_b16 v[202:203], v3 offset:16896
  v_fma_f32 v11, v11, v7, v7
  v_rcp_f32 v8, v8
  v_rcp_f32 v9, v9
  v_rcp_f32 v10, v10
  s_add_u32 s27, s27, 72704
  buffer_load_dwordx4 v2, s[8:11], s27 offen offset:1024 lds
  s_waitcnt lgkmcnt(6)
  v_mfma_f32_32x32x16_bf16 v[172:187], v[188:191], v[104:107], v[172:187]
  ds_read_b64_tr_b16 v[252:253], v3 offset:18432
  ds_read_b64_tr_b16 v[254:255], v3 offset:18944
  v_rcp_f32 v11, v11
  v_mul_f32 v164, v164, v8
  v_mul_f32 v165, v165, v9
  v_mul_f32 v166, v166, v10
  s_waitcnt lgkmcnt(6)
  v_mfma_f32_32x32x16_bf16 v[172:187], v[192:195], v[108:111], v[172:187]
  ds_read_b64_tr_b16 v[188:189], v3 offset:20480
  ds_read_b64_tr_b16 v[190:191], v3 offset:20992
  v_mul_f32 v167, v167, v11
  v_cvt_pk_bf16_f32 v240, v164, v165
  v_cvt_pk_bf16_f32 v241, v166, v167
  v_mul_f32 v8, v168, v168
  v_mul_f32 v9, v169, v169
  s_add_u32 s27, s27, 72704
  buffer_load_dwordx4 v2, s[8:11], s27 offen offset:2048 lds
  s_waitcnt lgkmcnt(6)
  v_mfma_f32_32x32x16_bf16 v[172:187], v[196:199], v[112:115], v[172:187]
  ds_read_b64_tr_b16 v[192:193], v3 offset:22528
  ds_read_b64_tr_b16 v[194:195], v3 offset:23040
  v_mul_f32 v10, v170, v170
  v_mul_f32 v11, v171, v171
  v_fma_f32 v8, v8, v6, v5
  v_fma_f32 v9, v9, v6, v5
  s_waitcnt lgkmcnt(6)
  v_mfma_f32_32x32x16_bf16 v[172:187], v[200:203], v[116:119], v[172:187]
  s_waitcnt vmcnt(6)
  s_barrier
  ds_read_b64_tr_b16 v[196:197], v3 offset:24576
  ds_read_b64_tr_b16 v[198:199], v3 offset:25088
  v_fma_f32 v10, v10, v6, v5
  v_fma_f32 v11, v11, v6, v5
  v_mul_f32 v8, v8, v168
  v_mul_f32 v9, v9, v169
  s_add_u32 m0, s28, 0
  s_add_u32 s27, s27, 739328
  buffer_load_dwordx4 v2, s[8:11], s27 offen offset:0 lds
  s_waitcnt lgkmcnt(6)
  v_mfma_f32_32x32x16_bf16 v[172:187], v[252:255], v[120:123], v[172:187]
  ds_read_b64_tr_b16 v[200:201], v3 offset:26624
  ds_read_b64_tr_b16 v[202:203], v3 offset:27136
  v_mul_f32 v10, v10, v170
  v_mul_f32 v11, v11, v171
  v_exp_f32 v8, v8
  v_exp_f32 v9, v9
  s_waitcnt lgkmcnt(6)
  v_mfma_f32_32x32x16_bf16 v[172:187], v[188:191], v[124:127], v[172:187]
  ds_read_b64_tr_b16 v[252:253], v3 offset:28672
  ds_read_b64_tr_b16 v[254:255], v3 offset:29184
  v_exp_f32 v10, v10
  v_exp_f32 v11, v11
  v_fma_f32 v8, v8, v7, v7
  v_fma_f32 v9, v9, v7, v7
  s_add_u32 s27, s27, 72704
  buffer_load_dwordx4 v2, s[8:11], s27 offen offset:1024 lds
  s_waitcnt lgkmcnt(6)
  v_mfma_f32_32x32x16_bf16 v[172:187], v[192:195], v[128:131], v[172:187]
  ds_read_b64_tr_b16 v[188:189], v3 offset:30720
  ds_read_b64_tr_b16 v[190:191], v3 offset:31232
  v_fma_f32 v10, v10, v7, v7
  v_fma_f32 v11, v11, v7, v7
  v_rcp_f32 v8, v8
  v_rcp_f32 v9, v9
  s_waitcnt lgkmcnt(6)
  v_mfma_f32_32x32x16_bf16 v[172:187], v[196:199], v[132:135], v[172:187]
  ds_read_b64_tr_b16 v[192:193], v3 offset:32768
  ds_read_b64_tr_b16 v[194:195], v3 offset:33280
  v_rcp_f32 v10, v10
  v_rcp_f32 v11, v11
  v_mul_f32 v168, v168, v8
  v_mul_f32 v169, v169, v9
  s_add_u32 s27, s27, 72704
  buffer_load_dwordx4 v2, s[8:11], s27 offen offset:2048 lds
  s_waitcnt lgkmcnt(6)
  v_mfma_f32_32x32x16_bf16 v[172:187], v[200:203], v[136:139], v[172:187]
  ds_read_b64_tr_b16 v[196:197], v3 offset:34816
  ds_read_b64_tr_b16 v[198:199], v3 offset:35328
  v_mul_f32 v170, v170, v10
  v_mul_f32 v171, v171, v11
  v_cvt_pk_bf16_f32 v242, v168, v169
  v_cvt_pk_bf16_f32 v243, v170, v171
  s_waitcnt lgkmcnt(6)
  v_mfma_f32_32x32x16_bf16 v[172:187], v[252:255], v[140:143], v[172:187]
  s_waitcnt vmcnt(6)
  s_barrier
  ds_read_b64_tr_b16 v[200:201], v3 offset:36864
  ds_read_b64_tr_b16 v[202:203], v3 offset:37376
  s_add_u32 m0, s28, 12288
  s_add_u32 s27, s27, 739328
  buffer_load_dwordx4 v2, s[8:11], s27 offen offset:0 lds
  s_waitcnt lgkmcnt(6)
  v_mfma_f32_32x32x16_bf16 v[172:187], v[188:191], v[144:147], v[172:187]
  ds_read_b64_tr_b16 v[252:253], v3 offset:38912
  ds_read_b64_tr_b16 v[254:255], v3 offset:39424
  s_waitcnt lgkmcnt(6)
  v_mfma_f32_32x32x16_bf16 v[172:187], v[192:195], v[148:151], v[172:187]
  ds_read_b64_tr_b16 v[188:189], v3 offset:40960
  ds_read_b64_tr_b16 v[190:191], v3 offset:41472
  s_add_u32 s27, s27, 72704
  buffer_load_dwordx4 v2, s[8:11], s27 offen offset:1024 lds
  s_waitcnt lgkmcnt(6)
  v_mfma_f32_32x32x16_bf16 v[172:187], v[196:199], v[152:155], v[172:187]
  ds_read_b64_tr_b16 v[192:193], v3 offset:43008
  ds_read_b64_tr_b16 v[194:195], v3 offset:43520
  s_waitcnt lgkmcnt(6)
  v_mfma_f32_32x32x16_bf16 v[156:171], v[200:203], v[12:15], 0
  ds_read_b64_tr_b16 v[196:197], v3 offset:45056
  ds_read_b64_tr_b16 v[198:199], v3 offset:45568
  s_add_u32 s27, s27, 72704
  buffer_load_dwordx4 v2, s[8:11], s27 offen offset:2048 lds
  s_waitcnt lgkmcnt(6)
  v_mfma_f32_32x32x16_bf16 v[156:171], v[252:255], v[16:19], v[156:171]
  ds_read_b64_tr_b16 v[200:201], v3 offset:47104
  ds_read_b64_tr_b16 v[202:203], v3 offset:47616
  s_lshl_b32 s25, s22, 14
  s_sub_u32 s25, 8192, s25
  s_waitcnt lgkmcnt(6)
  v_mfma_f32_32x32x16_bf16 v[156:171], v[188:191], v[20:23], v[156:171]
  s_waitcnt vmcnt(6)
  s_barrier
  ds_read_b64_tr_b16 v[252:253], v3 offset:49152
  ds_read_b64_tr_b16 v[254:255], v3 offset:49664
  s_add_u32 m0, s28, 24576
  s_add_u32 s27, s27, 739328
  buffer_load_dwordx4 v2, s[8:11], s27 offen offset:0 lds
  v_add_u32 v12, s25, v0
  s_waitcnt lgkmcnt(6)
  v_mfma_f32_32x32x16_bf16 v[156:171], v[192:195], v[24:27], v[156:171]
  ds_read_b64_tr_b16 v[188:189], v3 offset:51200
  ds_read_b64_tr_b16 v[190:191], v3 offset:51712
  v_mul_f32 v8, v172, v172
  v_mul_f32 v9, v173, v173
  v_mul_f32 v10, v174, v174
  v_mul_f32 v11, v175, v175
  v_fma_f32 v8, v8, v6, v5
  s_lshl_b32 s25, s22, 5
  s_lshl_b32 s26, s21, 3
  s_waitcnt lgkmcnt(6)
  v_mfma_f32_32x32x16_bf16 v[156:171], v[196:199], v[28:31], v[156:171]
  ds_read_b64_tr_b16 v[192:193], v3 offset:53248
  ds_read_b64_tr_b16 v[194:195], v3 offset:53760
  v_fma_f32 v9, v9, v6, v5
  v_fma_f32 v10, v10, v6, v5
  v_fma_f32 v11, v11, v6, v5
  v_mul_f32 v8, v8, v172
  s_add_u32 s27, s27, 72704
  buffer_load_dwordx4 v2, s[8:11], s27 offen offset:1024 lds
  s_add_u32 s25, s25, s26
  v_lshrrev_b32 v18, 3, v1
  s_waitcnt lgkmcnt(6)
  v_mfma_f32_32x32x16_bf16 v[156:171], v[200:203], v[32:35], v[156:171]
  ds_read_b64_tr_b16 v[196:197], v3 offset:55296
  ds_read_b64_tr_b16 v[198:199], v3 offset:55808
  v_mul_f32 v9, v9, v173
  v_mul_f32 v10, v10, v174
  v_mul_f32 v11, v11, v175
  v_exp_f32 v8, v8
  v_lshlrev_b32 v19, 1, v18
  v_and_b32 v19, 4, v19
  s_waitcnt lgkmcnt(6)
  v_mfma_f32_32x32x16_bf16 v[156:171], v[252:255], v[36:39], v[156:171]
  ds_read_b64_tr_b16 v[200:201], v3 offset:57344
  ds_read_b64_tr_b16 v[202:203], v3 offset:57856
  v_exp_f32 v9, v9
  v_exp_f32 v10, v10
  v_exp_f32 v11, v11
  v_fma_f32 v8, v8, v7, v7
  s_add_u32 s27, s27, 72704
  buffer_load_dwordx4 v2, s[8:11], s27 offen offset:2048 lds
  v_xor_b32 v19, v19, v1
  v_and_b32 v19, 7, v19
  ds_read_b128 v[20:23], v0 offset:0
  s_waitcnt lgkmcnt(6)
  v_mfma_f32_32x32x16_bf16 v[156:171], v[188:191], v[40:43], v[156:171]
  ds_read_b64_tr_b16 v[252:253], v3 offset:59392
  ds_read_b64_tr_b16 v[254:255], v3 offset:59904
  v_fma_f32 v9, v9, v7, v7
  v_fma_f32 v10, v10, v7, v7
  v_fma_f32 v11, v11, v7, v7
  v_rcp_f32 v8, v8
  v_add_u32 v18, s25, v18
  v_mul_u32_u24 v18, 1152, v18
  ds_read_b128 v[24:27], v0 offset:1024
  s_waitcnt lgkmcnt(6)
  v_mfma_f32_32x32x16_bf16 v[156:171], v[192:195], v[44:47], v[156:171]
  s_waitcnt vmcnt(6)
  s_barrier
  ds_read_b64_tr_b16 v[188:189], v3 offset:0
  ds_read_b64_tr_b16 v[190:191], v3 offset:512
  v_rcp_f32 v9, v9
  v_rcp_f32 v10, v10
  v_rcp_f32 v11, v11
  v_mul_f32 v172, v172, v8
  s_add_u32 m0, s28, 36864
  s_add_u32 s27, s27, 739328
  buffer_load_dwordx4 v2, s[8:11], s27 offen offset:0 lds
  v_lshl_add_u32 v15, v19, 4, v18
  ds_read_b128 v[28:31], v0 offset:2048
  s_waitcnt lgkmcnt(6)
  v_mfma_f32_32x32x16_bf16 v[156:171], v[196:199], v[48:51], v[156:171]
  ds_read_b64_tr_b16 v[192:193], v3 offset:2048
  ds_read_b64_tr_b16 v[194:195], v3 offset:2560
  v_mul_f32 v173, v173, v9
  v_mul_f32 v174, v174, v10
  v_mul_f32 v175, v175, v11
  v_cvt_pk_bf16_f32 v244, v172, v173
  s_mov_b32 s31, 8
  s_lshl_b32 s31, s31, 7
  ds_read_b128 v[32:35], v0 offset:3072
  s_waitcnt lgkmcnt(6)
  v_mfma_f32_32x32x16_bf16 v[156:171], v[200:203], v[52:55], v[156:171]
  ds_read_b64_tr_b16 v[196:197], v3 offset:4096
  ds_read_b64_tr_b16 v[198:199], v3 offset:4608
  v_cvt_pk_bf16_f32 v245, v174, v175
  v_mul_f32 v8, v176, v176
  v_mul_f32 v9, v177, v177
  v_mul_f32 v10, v178, v178
  v_mul_f32 v11, v179, v179
  s_add_u32 s27, s27, 72704
  buffer_load_dwordx4 v2, s[8:11], s27 offen offset:1024 lds
  s_mul_i32 s25, s23, 663552
  s_add_u32 s31, s31, s25
  ds_read_b128 v[36:39], v12 offset:0
  ds_read_b128 v[40:43], v12 offset:1024
  ds_read_b128 v[44:47], v12 offset:2048
  ds_read_b128 v[48:51], v12 offset:3072
  s_waitcnt lgkmcnt(6)
  v_mfma_f32_32x32x16_bf16 v[156:171], v[252:255], v[56:59], v[156:171]
  ds_read_b64_tr_b16 v[200:201], v3 offset:6144
  ds_read_b64_tr_b16 v[202:203], v3 offset:6656
  v_fma_f32 v8, v8, v6, v5
  v_fma_f32 v9, v9, v6, v5
  v_fma_f32 v10, v10, v6, v5
  v_fma_f32 v11, v11, v6, v5
  v_lshrrev_b32 v18, 5, v1
  v_bfe_u32 v19, v1, 2, 2
  s_waitcnt lgkmcnt(6)
  v_mfma_f32_32x32x16_bf16 v[156:171], v[188:191], v[60:63], v[156:171]
  ds_read_b64_tr_b16 v[252:253], v3 offset:8192
  ds_read_b64_tr_b16 v[254:255], v3 offset:8704
  v_mul_f32 v8, v8, v176
  v_mul_f32 v9, v9, v177
  v_mul_f32 v10, v10, v178
  v_mul_f32 v11, v11, v179
  s_add_u32 s27, s27, 72704
  buffer_load_dwordx4 v2, s[8:11], s27 offen offset:2048 lds
  v_mad_u32_u24 v18, v18, 4, v19
  v_lshlrev_b32 v18, 7, v18
  s_waitcnt lgkmcnt(6)
  v_mfma_f32_32x32x16_bf16 v[156:171], v[192:195], v[64:67], v[156:171]
  ds_read_b64_tr_b16 v[188:189], v3 offset:10240
  ds_read_b64_tr_b16 v[190:191], v3 offset:10752
  v_exp_f32 v8, v8
  v_exp_f32 v9, v9
  v_exp_f32 v10, v10
  v_exp_f32 v11, v11
  v_lshrrev_b32 v19, 1, v19
  s_waitcnt lgkmcnt(6)
  v_mfma_f32_32x32x16_bf16 v[156:171], v[196:199], v[68:71], v[156:171]
  s_waitcnt vmcnt(6)
  s_barrier
  ds_read_b64_tr_b16 v[192:193], v3 offset:12288
  ds_read_b64_tr_b16 v[194:195], v3 offset:12800
  v_fma_f32 v8, v8, v7, v7
  v_fma_f32 v9, v9, v7, v7
  v_fma_f32 v10, v10, v7, v7
  v_fma_f32 v11, v11, v7, v7
  s_add_u32 m0, s28, 49152
  s_mov_b32 s27, s31
  buffer_load_dwordx4 v15, s[4:7], s27 offen offset:0 lds
  v_xor_b32 v19, s22, v19
  v_lshl_add_u32 v18, v19, 6, v18
  s_waitcnt lgkmcnt(6)
  v_mfma_f32_32x32x16_bf16 v[156:171], v[200:203], v[72:75], v[156:171]
  ds_read_b64_tr_b16 v[196:197], v3 offset:14336
  ds_read_b64_tr_b16 v[198:199], v3 offset:14848
  v_rcp_f32 v8, v8
  v_rcp_f32 v9, v9
  v_rcp_f32 v10, v10
  v_rcp_f32 v11, v11
  v_bfe_u32 v19, v1, 4, 1
  ds_write_b128 v0, v[204:207] offset:0
  ds_write_b128 v0, v[208:211] offset:1024
  s_waitcnt lgkmcnt(6)
  v_mfma_f32_32x32x16_bf16 v[156:171], v[252:255], v[76:79], v[156:171]
  ds_read_b64_tr_b16 v[200:201], v3 offset:16384
  ds_read_b64_tr_b16 v[202:203], v3 offset:16896
  v_mul_f32 v176, v176, v8
  v_mul_f32 v177, v177, v9
  v_mul_f32 v178, v178, v10
  v_mul_f32 v179, v179, v11
  s_add_u32 s27, s27, 17408
  buffer_load_dwordx4 v15, s[4:7], s27 offen offset:1024 lds
  v_lshl_add_u32 v18, v19, 5, v18
  v_and_b32 v19, 3, v1
  ds_write_b128 v0, v[212:215] offset:2048
  ds_write_b128 v0, v[216:219] offset:3072
  s_waitcnt lgkmcnt(6)
  v_mfma_f32_32x32x16_bf16 v[156:171], v[188:191], v[80:83], v[156:171]
  ds_read_b64_tr_b16 v[252:253], v3 offset:18432
  ds_read_b64_tr_b16 v[254:255], v3 offset:18944
  v_cvt_pk_bf16_f32 v246, v176, v177
  v_cvt_pk_bf16_f32 v247, v178, v179
  v_mul_f32 v8, v180, v180
  v_mul_f32 v9, v181, v181
  v_mul_f32 v10, v182, v182
  v_lshl_add_u32 v13, v19, 3, v18
  s_waitcnt lgkmcnt(6)
  v_mfma_f32_32x32x16_bf16 v[156:171], v[192:195], v[84:87], v[156:171]
  ds_read_b64_tr_b16 v[188:189], v3 offset:20480
  ds_read_b64_tr_b16 v[190:191], v3 offset:20992
  v_mul_f32 v11, v183, v183
  v_fma_f32 v8, v8, v6, v5
  v_fma_f32 v9, v9, v6, v5
  v_fma_f32 v10, v10, v6, v5
  s_add_u32 s27, s27, 54272
  buffer_load_dwordx4 v15, s[4:7], s27 offen offset:2048 lds
  s_mul_i32 s25, s22, 6144
  v_add_u32 v13, s25, v13
  s_waitcnt lgkmcnt(6)
  v_mfma_f32_32x32x16_bf16 v[156:171], v[196:199], v[88:91], v[156:171]
  ds_read_b64_tr_b16 v[192:193], v3 offset:22528
  ds_read_b64_tr_b16 v[194:195], v3 offset:23040
  v_fma_f32 v11, v11, v6, v5
  v_mul_f32 v8, v8, v180
  v_mul_f32 v9, v9, v181
  v_mul_f32 v10, v10, v182
  v_xor_b32 v14, 6144, v13
  s_waitcnt lgkmcnt(6)
  v_mfma_f32_32x32x16_bf16 v[156:171], v[200:203], v[92:95], v[156:171]
  s_waitcnt vmcnt(6)
  s_barrier
  ds_read_b64_tr_b16 v[196:197], v3 offset:24576
  ds_read_b64_tr_b16 v[198:199], v3 offset:25088
  v_mul_f32 v11, v11, v183
  v_exp_f32 v8, v8
  v_exp_f32 v9, v9
  v_exp_f32 v10, v10
  s_add_u32 m0, s28, 0
  s_add_u32 s27, s27, 20480
  buffer_load_dwordx4 v15, s[4:7], s27 offen offset:0 lds
  s_waitcnt lgkmcnt(6)
  v_mfma_f32_32x32x16_bf16 v[156:171], v[252:255], v[96:99], v[156:171]
  ds_read_b64_tr_b16 v[200:201], v3 offset:26624
  ds_read_b64_tr_b16 v[202:203], v3 offset:27136
  v_exp_f32 v11, v11
  v_fma_f32 v8, v8, v7, v7
  v_fma_f32 v9, v9, v7, v7
  v_fma_f32 v10, v10, v7, v7
  ds_read_b128 v[52:55], v12 offset:0
  ds_read_b128 v[56:59], v12 offset:1024
  s_waitcnt lgkmcnt(6)
  v_mfma_f32_32x32x16_bf16 v[156:171], v[188:191], v[100:103], v[156:171]
  ds_read_b64_tr_b16 v[252:253], v3 offset:28672
  ds_read_b64_tr_b16 v[254:255], v3 offset:29184
  v_fma_f32 v11, v11, v7, v7
  v_rcp_f32 v8, v8
  v_rcp_f32 v9, v9
  v_rcp_f32 v10, v10
  s_add_u32 s27, s27, 54272
  buffer_load_dwordx4 v15, s[4:7], s27 offen offset:1024 lds
  ds_read_b128 v[60:63], v12 offset:2048
  ds_read_b128 v[64:67], v12 offset:3072
  s_waitcnt lgkmcnt(6)
  v_mfma_f32_32x32x16_bf16 v[156:171], v[192:195], v[104:107], v[156:171]
  ds_read_b64_tr_b16 v[188:189], v3 offset:30720
  ds_read_b64_tr_b16 v[190:191], v3 offset:31232
  v_rcp_f32 v11, v11
  v_mul_f32 v180, v180, v8
  v_mul_f32 v181, v181, v9
  v_mul_f32 v182, v182, v10
  s_waitcnt lgkmcnt(6)
  v_mfma_f32_32x32x16_bf16 v[156:171], v[196:199], v[108:111], v[156:171]
  ds_read_b64_tr_b16 v[192:193], v3 offset:32768
  ds_read_b64_tr_b16 v[194:195], v3 offset:33280
  v_mul_f32 v183, v183, v11
  v_cvt_pk_bf16_f32 v248, v180, v181
  v_cvt_pk_bf16_f32 v249, v182, v183
  v_mul_f32 v8, v184, v184
  v_mul_f32 v9, v185, v185
  s_add_u32 s27, s27, 17408
  buffer_load_dwordx4 v15, s[4:7], s27 offen offset:2048 lds
  s_waitcnt lgkmcnt(6)
  v_mfma_f32_32x32x16_bf16 v[156:171], v[200:203], v[112:115], v[156:171]
  ds_read_b64_tr_b16 v[196:197], v3 offset:34816
  ds_read_b64_tr_b16 v[198:199], v3 offset:35328
  v_mul_f32 v10, v186, v186
  v_mul_f32 v11, v187, v187
  v_fma_f32 v8, v8, v6, v5
  v_fma_f32 v9, v9, v6, v5
  s_waitcnt lgkmcnt(6)
  v_mfma_f32_32x32x16_bf16 v[156:171], v[252:255], v[116:119], v[156:171]
  s_waitcnt vmcnt(6)
  s_barrier
  ds_read_b64_tr_b16 v[200:201], v3 offset:36864
  ds_read_b64_tr_b16 v[202:203], v3 offset:37376
  v_fma_f32 v10, v10, v6, v5
  v_fma_f32 v11, v11, v6, v5
  v_mul_f32 v8, v8, v184
  v_mul_f32 v9, v9, v185
  s_add_u32 m0, s28, 12288
  s_add_u32 s27, s27, 57344
  buffer_load_dwordx4 v15, s[4:7], s27 offen offset:0 lds
  s_waitcnt lgkmcnt(6)
  v_mfma_f32_32x32x16_bf16 v[156:171], v[188:191], v[120:123], v[156:171]
  ds_read_b64_tr_b16 v[252:253], v3 offset:38912
  ds_read_b64_tr_b16 v[254:255], v3 offset:39424
  v_mul_f32 v10, v10, v186
  v_mul_f32 v11, v11, v187
  v_exp_f32 v8, v8
  v_exp_f32 v9, v9
  ds_write_b128 v0, v[220:223] offset:0
  ds_write_b128 v0, v[224:227] offset:1024
  s_waitcnt lgkmcnt(6)
  v_mfma_f32_32x32x16_bf16 v[156:171], v[192:195], v[124:127], v[156:171]
  ds_read_b64_tr_b16 v[188:189], v3 offset:40960
  ds_read_b64_tr_b16 v[190:191], v3 offset:41472
  v_exp_f32 v10, v10
  v_exp_f32 v11, v11
  v_fma_f32 v8, v8, v7, v7
  v_fma_f32 v9, v9, v7, v7
  s_add_u32 s27, s27, 17408
  buffer_load_dwordx4 v15, s[4:7], s27 offen offset:1024 lds
  ds_write_b128 v0, v[228:231] offset:2048
  ds_write_b128 v0, v[232:235] offset:3072
  s_waitcnt lgkmcnt(6)
  v_mfma_f32_32x32x16_bf16 v[156:171], v[196:199], v[128:131], v[156:171]
  ds_read_b64_tr_b16 v[192:193], v3 offset:43008
  ds_read_b64_tr_b16 v[194:195], v3 offset:43520
  v_fma_f32 v10, v10, v7, v7
  v_fma_f32 v11, v11, v7, v7
  v_rcp_f32 v8, v8
  v_rcp_f32 v9, v9
  s_waitcnt lgkmcnt(6)
  v_mfma_f32_32x32x16_bf16 v[156:171], v[200:203], v[132:135], v[156:171]
  ds_read_b64_tr_b16 v[196:197], v3 offset:45056
  ds_read_b64_tr_b16 v[198:199], v3 offset:45568
  v_rcp_f32 v10, v10
  v_rcp_f32 v11, v11
  v_mul_f32 v184, v184, v8
  v_mul_f32 v185, v185, v9
  s_add_u32 s27, s27, 54272
  buffer_load_dwordx4 v15, s[4:7], s27 offen offset:2048 lds
  s_waitcnt lgkmcnt(6)
  v_mfma_f32_32x32x16_bf16 v[156:171], v[252:255], v[136:139], v[156:171]
  ds_read_b64_tr_b16 v[200:201], v3 offset:47104
  ds_read_b64_tr_b16 v[202:203], v3 offset:47616
  v_mul_f32 v186, v186, v10
  v_mul_f32 v187, v187, v11
  v_cvt_pk_bf16_f32 v250, v184, v185
  v_cvt_pk_bf16_f32 v251, v186, v187
  s_waitcnt lgkmcnt(6)
  v_mfma_f32_32x32x16_bf16 v[156:171], v[188:191], v[140:143], v[156:171]
  s_waitcnt vmcnt(6)
  s_barrier
  ds_read_b64_tr_b16 v[252:253], v13 offset:49152
  ds_read_b64_tr_b16 v[254:255], v13 offset:52224
  s_add_u32 m0, s28, 24576
  s_add_u32 s27, s27, 20480
  buffer_load_dwordx4 v15, s[4:7], s27 offen offset:0 lds
  s_waitcnt lgkmcnt(6)
  v_mfma_f32_32x32x16_bf16 v[156:171], v[192:195], v[144:147], v[156:171]
  ds_read_b64_tr_b16 v[188:189], v13 offset:50176
  ds_read_b64_tr_b16 v[190:191], v13 offset:53248
  ds_read_b128 v[68:71], v12 offset:0
  ds_read_b128 v[72:75], v12 offset:1024
  s_waitcnt lgkmcnt(6)
  v_mfma_f32_32x32x16_bf16 v[156:171], v[196:199], v[148:151], v[156:171]
  ds_read_b64_tr_b16 v[192:193], v13 offset:51200
  ds_read_b64_tr_b16 v[194:195], v13 offset:54272
  s_add_u32 s27, s27, 54272
  buffer_load_dwordx4 v15, s[4:7], s27 offen offset:1024 lds
  ds_read_b128 v[76:79], v12 offset:2048
  ds_read_b128 v[80:83], v12 offset:3072
  s_waitcnt lgkmcnt(6)
  v_mfma_f32_32x32x16_bf16 v[156:171], v[200:203], v[152:155], v[156:171]
  ds_read_b64_tr_b16 v[196:197], v14 offset:49152
  ds_read_b64_tr_b16 v[198:199], v14 offset:52224
  s_waitcnt lgkmcnt(6)
  v_mfma_f32_32x32x16_bf16 v[172:187], v[252:255], v[20:23], 0
  ds_read_b64_tr_b16 v[200:201], v14 offset:50176
  ds_read_b64_tr_b16 v[202:203], v14 offset:53248
  s_add_u32 s27, s27, 17408
  buffer_load_dwordx4 v15, s[4:7], s27 offen offset:2048 lds
  s_setprio 2
  s_waitcnt lgkmcnt(6)
  v_mfma_f32_32x32x16_bf16 v[172:187], v[188:191], v[24:27], v[172:187]
  ds_read_b64_tr_b16 v[252:253], v14 offset:51200
  ds_read_b64_tr_b16 v[254:255], v14 offset:54272
  s_waitcnt lgkmcnt(6)
  v_mfma_f32_32x32x16_bf16 v[172:187], v[192:195], v[28:31], v[172:187]
  s_waitcnt vmcnt(6)
  s_barrier
  ds_read_b64_tr_b16 v[188:189], v13 offset:0
  ds_read_b64_tr_b16 v[190:191], v13 offset:3072
  s_add_u32 m0, s28, 36864
  s_add_u32 s27, s27, 57344
  buffer_load_dwordx4 v15, s[4:7], s27 offen offset:0 lds
  s_waitcnt lgkmcnt(6)
  v_mfma_f32_32x32x16_bf16 v[172:187], v[196:199], v[36:39], v[172:187]
  ds_read_b64_tr_b16 v[192:193], v13 offset:1024
  ds_read_b64_tr_b16 v[194:195], v13 offset:4096
  v_mul_f32 v8, v156, v156
  v_mul_f32 v9, v157, v157
  v_mul_f32 v10, v158, v158
  v_mul_f32 v11, v159, v159
  v_fma_f32 v8, v8, v6, v5
  v_fma_f32 v9, v9, v6, v5
  v_fma_f32 v10, v10, v6, v5
  ds_write_b128 v0, v[236:239] offset:0
  ds_write_b128 v0, v[240:243] offset:1024
  s_waitcnt lgkmcnt(6)
  v_mfma_f32_32x32x16_bf16 v[172:187], v[200:203], v[40:43], v[172:187]
  ds_read_b64_tr_b16 v[196:197], v13 offset:2048
  ds_read_b64_tr_b16 v[198:199], v13 offset:5120
  v_fma_f32 v11, v11, v6, v5
  v_mul_f32 v8, v8, v156
  v_mul_f32 v9, v9, v157
  v_mul_f32 v10, v10, v158
  v_mul_f32 v11, v11, v159
  v_exp_f32 v8, v8
  v_exp_f32 v9, v9
  s_add_u32 s27, s27, 17408
  buffer_load_dwordx4 v15, s[4:7], s27 offen offset:1024 lds
  ds_write_b128 v0, v[244:247] offset:2048
  ds_write_b128 v0, v[248:251] offset:3072
  s_waitcnt lgkmcnt(6)
  v_mfma_f32_32x32x16_bf16 v[172:187], v[252:255], v[44:47], v[172:187]
  ds_read_b64_tr_b16 v[200:201], v14 offset:0
  ds_read_b64_tr_b16 v[202:203], v14 offset:3072
  v_exp_f32 v10, v10
  v_exp_f32 v11, v11
  v_fma_f32 v8, v8, v7, v7
  v_fma_f32 v9, v9, v7, v7
  v_fma_f32 v10, v10, v7, v7
  v_fma_f32 v11, v11, v7, v7
  s_waitcnt lgkmcnt(6)
  v_mfma_f32_32x32x16_bf16 v[172:187], v[188:191], v[32:35], v[172:187]
  ds_read_b64_tr_b16 v[252:253], v14 offset:1024
  ds_read_b64_tr_b16 v[254:255], v14 offset:4096
  v_rcp_f32 v8, v8
  v_rcp_f32 v9, v9
  v_rcp_f32 v10, v10
  v_rcp_f32 v11, v11
  v_mul_f32 v156, v156, v8
  v_mul_f32 v157, v157, v9
  v_mul_f32 v158, v158, v10
  s_add_u32 s27, s27, 54272
  buffer_load_dwordx4 v15, s[4:7], s27 offen offset:2048 lds
  s_waitcnt lgkmcnt(6)
  v_mfma_f32_32x32x16_bf16 v[172:187], v[192:195], v[204:207], v[172:187]
  ds_read_b64_tr_b16 v[188:189], v14 offset:2048
  ds_read_b64_tr_b16 v[190:191], v14 offset:5120
  v_mul_f32 v159, v159, v11
  v_cvt_pk_bf16_f32 v100, v156, v157
  v_cvt_pk_bf16_f32 v101, v158, v159
  v_mul_f32 v8, v160, v160
  v_mul_f32 v9, v161, v161
  v_mul_f32 v10, v162, v162
  v_mul_f32 v11, v163, v163
  s_waitcnt lgkmcnt(6)
  v_mfma_f32_32x32x16_bf16 v[172:187], v[196:199], v[208:211], v[172:187]
  s_waitcnt vmcnt(6)
  s_barrier
  ds_read_b64_tr_b16 v[192:193], v13 offset:12288
  ds_read_b64_tr_b16 v[194:195], v13 offset:15360
  v_fma_f32 v8, v8, v6, v5
  v_fma_f32 v9, v9, v6, v5
  v_fma_f32 v10, v10, v6, v5
  v_fma_f32 v11, v11, v6, v5
  v_mul_f32 v8, v8, v160
  v_mul_f32 v9, v9, v161
  s_add_u32 m0, s28, 49152
  s_add_u32 s27, s27, 20480
  buffer_load_dwordx4 v15, s[4:7], s27 offen offset:0 lds
  s_waitcnt lgkmcnt(6)
  v_mfma_f32_32x32x16_bf16 v[172:187], v[200:203], v[48:51], v[172:187]
  ds_read_b64_tr_b16 v[196:197], v13 offset:13312
  ds_read_b64_tr_b16 v[198:199], v13 offset:16384
  v_mul_f32 v10, v10, v162
  v_mul_f32 v11, v11, v163
  v_exp_f32 v8, v8
  v_exp_f32 v9, v9
  v_exp_f32 v10, v10
  v_exp_f32 v11, v11
  v_fma_f32 v8, v8, v7, v7
  s_add_u32 s31, s23, 1
  s_and_b32 s31, s31, 7
  s_lshl_b32 s31, s31, 7
  ds_read_b128 v[84:87], v12 offset:0
  ds_read_b128 v[88:91], v12 offset:1024
  s_waitcnt lgkmcnt(6)
  v_mfma_f32_32x32x16_bf16 v[172:187], v[252:255], v[52:55], v[172:187]
  ds_read_b64_tr_b16 v[200:201], v13 offset:14336
  ds_read_b64_tr_b16 v[202:203], v13 offset:17408
  v_fma_f32 v9, v9, v7, v7
  v_fma_f32 v10, v10, v7, v7
  v_fma_f32 v11, v11, v7, v7
  v_rcp_f32 v8, v8
  v_rcp_f32 v9, v9
  v_rcp_f32 v10, v10
  v_rcp_f32 v11, v11
  s_add_u32 s27, s27, 54272
  buffer_load_dwordx4 v15, s[4:7], s27 offen offset:1024 lds
  s_mul_i32 s25, s23, 663552
  s_add_u32 s31, s31, s25
  ds_read_b128 v[92:95], v12 offset:2048
  ds_read_b128 v[96:99], v12 offset:3072
  s_waitcnt lgkmcnt(6)
  v_mfma_f32_32x32x16_bf16 v[172:187], v[188:191], v[56:59], v[172:187]
  ds_read_b64_tr_b16 v[252:253], v14 offset:12288
  ds_read_b64_tr_b16 v[254:255], v14 offset:15360
  v_mul_f32 v160, v160, v8
  v_mul_f32 v161, v161, v9
  v_mul_f32 v162, v162, v10
  v_mul_f32 v163, v163, v11
  v_cvt_pk_bf16_f32 v102, v160, v161
  v_cvt_pk_bf16_f32 v103, v162, v163
  s_waitcnt lgkmcnt(6)
  v_mfma_f32_32x32x16_bf16 v[172:187], v[192:195], v[212:215], v[172:187]
  ds_read_b64_tr_b16 v[188:189], v14 offset:13312
  ds_read_b64_tr_b16 v[190:191], v14 offset:16384
  v_mul_f32 v8, v164, v164
  v_mul_f32 v9, v165, v165
  v_mul_f32 v10, v166, v166
  v_mul_f32 v11, v167, v167
  v_fma_f32 v8, v8, v6, v5
  v_fma_f32 v9, v9, v6, v5
  v_fma_f32 v10, v10, v6, v5
  s_add_u32 s27, s27, 17408
  buffer_load_dwordx4 v15, s[4:7], s27 offen offset:2048 lds
  s_waitcnt lgkmcnt(6)
  v_mfma_f32_32x32x16_bf16 v[172:187], v[196:199], v[216:219], v[172:187]
  ds_read_b64_tr_b16 v[192:193], v14 offset:14336
  ds_read_b64_tr_b16 v[194:195], v14 offset:17408
  v_fma_f32 v11, v11, v6, v5
  v_mul_f32 v8, v8, v164
  v_mul_f32 v9, v9, v165
  v_mul_f32 v10, v10, v166
  v_mul_f32 v11, v11, v167
  v_exp_f32 v8, v8
  v_exp_f32 v9, v9
  s_waitcnt lgkmcnt(6)
  v_mfma_f32_32x32x16_bf16 v[172:187], v[200:203], v[220:223], v[172:187]
  s_waitcnt vmcnt(6)
  s_barrier
  ds_read_b64_tr_b16 v[196:197], v13 offset:24576
  ds_read_b64_tr_b16 v[198:199], v13 offset:27648
  v_exp_f32 v10, v10
  v_exp_f32 v11, v11
  v_fma_f32 v8, v8, v7, v7
  v_fma_f32 v9, v9, v7, v7
  v_fma_f32 v10, v10, v7, v7
  v_fma_f32 v11, v11, v7, v7
  s_add_u32 m0, s28, 0
  s_mov_b32 s27, s31
  buffer_load_dwordx4 v15, s[4:7], s27 offen offset:0 lds
  s_waitcnt lgkmcnt(6)
  v_mfma_f32_32x32x16_bf16 v[172:187], v[252:255], v[60:63], v[172:187]
  ds_read_b64_tr_b16 v[200:201], v13 offset:25600
  ds_read_b64_tr_b16 v[202:203], v13 offset:28672
  v_rcp_f32 v8, v8
  v_rcp_f32 v9, v9
  v_rcp_f32 v10, v10
  v_rcp_f32 v11, v11
  v_mul_f32 v164, v164, v8
  v_mul_f32 v165, v165, v9
  v_mul_f32 v166, v166, v10
  s_waitcnt lgkmcnt(6)
  v_mfma_f32_32x32x16_bf16 v[172:187], v[188:191], v[64:67], v[172:187]
  ds_read_b64_tr_b16 v[252:253], v13 offset:26624
  ds_read_b64_tr_b16 v[254:255], v13 offset:29696
  v_mul_f32 v167, v167, v11
  v_cvt_pk_bf16_f32 v104, v164, v165
  v_cvt_pk_bf16_f32 v105, v166, v167
  v_mul_f32 v8, v168, v168
  v_mul_f32 v9, v169, v169
  v_mul_f32 v10, v170, v170
  v_mul_f32 v11, v171, v171
  s_add_u32 s27, s27, 17408
  buffer_load_dwordx4 v15, s[4:7], s27 offen offset:1024 lds
  s_waitcnt lgkmcnt(6)
  v_mfma_f32_32x32x16_bf16 v[172:187], v[192:195], v[68:71], v[172:187]
  ds_read_b64_tr_b16 v[188:189], v14 offset:24576
  ds_read_b64_tr_b16 v[190:191], v14 offset:27648
  v_fma_f32 v8, v8, v6, v5
  v_fma_f32 v9, v9, v6, v5
  v_fma_f32 v10, v10, v6, v5
  v_fma_f32 v11, v11, v6, v5
  v_mul_f32 v8, v8, v168
  v_mul_f32 v9, v9, v169
  s_waitcnt lgkmcnt(6)
  v_mfma_f32_32x32x16_bf16 v[172:187], v[196:199], v[224:227], v[172:187]
  ds_read_b64_tr_b16 v[192:193], v14 offset:25600
  ds_read_b64_tr_b16 v[194:195], v14 offset:28672
  v_mul_f32 v10, v10, v170
  v_mul_f32 v11, v11, v171
  v_exp_f32 v8, v8
  v_exp_f32 v9, v9
  v_exp_f32 v10, v10
  v_exp_f32 v11, v11
  v_fma_f32 v8, v8, v7, v7
  s_add_u32 s27, s27, 54272
  buffer_load_dwordx4 v15, s[4:7], s27 offen offset:2048 lds
  s_waitcnt lgkmcnt(6)
  v_mfma_f32_32x32x16_bf16 v[172:187], v[200:203], v[228:231], v[172:187]
  ds_read_b64_tr_b16 v[196:197], v14 offset:26624
  ds_read_b64_tr_b16 v[198:199], v14 offset:29696
  v_fma_f32 v9, v9, v7, v7
  v_fma_f32 v10, v10, v7, v7
  v_fma_f32 v11, v11, v7, v7
  v_rcp_f32 v8, v8
  v_rcp_f32 v9, v9
  v_rcp_f32 v10, v10
  v_rcp_f32 v11, v11
  s_waitcnt lgkmcnt(6)
  v_mfma_f32_32x32x16_bf16 v[172:187], v[252:255], v[232:235], v[172:187]
  s_waitcnt vmcnt(6)
  s_barrier
  ds_read_b64_tr_b16 v[200:201], v13 offset:36864
  ds_read_b64_tr_b16 v[202:203], v13 offset:39936
  v_mul_f32 v168, v168, v8
  v_mul_f32 v169, v169, v9
  v_mul_f32 v170, v170, v10
  v_mul_f32 v171, v171, v11
  v_cvt_pk_bf16_f32 v106, v168, v169
  v_cvt_pk_bf16_f32 v107, v170, v171
  s_add_u32 m0, s28, 12288
  s_add_u32 s27, s27, 20480
  buffer_load_dwordx4 v15, s[4:7], s27 offen offset:0 lds
  s_waitcnt lgkmcnt(6)
  v_mfma_f32_32x32x16_bf16 v[172:187], v[188:191], v[72:75], v[172:187]
  ds_read_b64_tr_b16 v[252:253], v13 offset:37888
  ds_read_b64_tr_b16 v[254:255], v13 offset:40960
  ds_write_b128 v0, v[100:103] offset:0
  s_waitcnt lgkmcnt(6)
  v_mfma_f32_32x32x16_bf16 v[172:187], v[192:195], v[76:79], v[172:187]
  ds_read_b64_tr_b16 v[188:189], v13 offset:38912
  ds_read_b64_tr_b16 v[190:191], v13 offset:41984
  s_add_u32 s27, s27, 54272
  buffer_load_dwordx4 v15, s[4:7], s27 offen offset:1024 lds
  ds_write_b128 v0, v[104:107] offset:1024
  s_waitcnt lgkmcnt(6)
  v_mfma_f32_32x32x16_bf16 v[172:187], v[196:199], v[80:83], v[172:187]
  ds_read_b64_tr_b16 v[192:193], v14 offset:36864
  ds_read_b64_tr_b16 v[194:195], v14 offset:39936
  s_waitcnt lgkmcnt(6)
  v_mfma_f32_32x32x16_bf16 v[172:187], v[200:203], v[236:239], v[172:187]
  ds_read_b64_tr_b16 v[196:197], v14 offset:37888
  ds_read_b64_tr_b16 v[198:199], v14 offset:40960
  s_add_u32 s27, s27, 17408
  buffer_load_dwordx4 v15, s[4:7], s27 offen offset:2048 lds
  v_mov_b32 v16, 1
  s_waitcnt lgkmcnt(6)
  v_mfma_f32_32x32x16_bf16 v[172:187], v[252:255], v[240:243], v[172:187]
  ds_read_b64_tr_b16 v[200:201], v14 offset:38912
  ds_read_b64_tr_b16 v[202:203], v14 offset:41984
  v_min_u32 v17, 1, v1
  s_waitcnt lgkmcnt(6)
  v_mfma_f32_32x32x16_bf16 v[172:187], v[188:191], v[244:247], v[172:187]
  s_waitcnt vmcnt(6)
  s_barrier
  ds_read_b64_tr_b16 v[252:253], v13 offset:49152
  ds_read_b64_tr_b16 v[254:255], v13 offset:52224
  s_add_u32 m0, s28, 24576
  s_add_u32 s27, s27, 57344
  buffer_load_dwordx4 v15, s[4:7], s27 offen offset:0 lds
  v_lshlrev_b32 v17, 30, v17
  s_waitcnt lgkmcnt(6)
  v_mfma_f32_32x32x16_bf16 v[172:187], v[192:195], v[84:87], v[172:187]
  ds_read_b64_tr_b16 v[188:189], v13 offset:50176
  ds_read_b64_tr_b16 v[190:191], v13 offset:53248
  ds_read_b128 v[108:111], v12 offset:0
  s_waitcnt lgkmcnt(6)
  v_mfma_f32_32x32x16_bf16 v[172:187], v[196:199], v[88:91], v[172:187]
  ds_read_b64_tr_b16 v[192:193], v13 offset:51200
  ds_read_b64_tr_b16 v[194:195], v13 offset:54272
  s_add_u32 s27, s27, 17408
  buffer_load_dwordx4 v15, s[4:7], s27 offen offset:1024 lds
  ds_read_b128 v[112:115], v12 offset:1024
  s_waitcnt lgkmcnt(6)
  v_mfma_f32_32x32x16_bf16 v[172:187], v[200:203], v[92:95], v[172:187]
  ds_read_b64_tr_b16 v[196:197], v14 offset:49152
  ds_read_b64_tr_b16 v[198:199], v14 offset:52224
  s_waitcnt lgkmcnt(6)
  v_mfma_f32_32x32x16_bf16 v[172:187], v[252:255], v[248:251], v[172:187]
  ds_read_b64_tr_b16 v[200:201], v14 offset:50176
  ds_read_b64_tr_b16 v[202:203], v14 offset:53248
  s_add_u32 s27, s27, 54272
  buffer_load_dwordx4 v15, s[4:7], s27 offen offset:2048 lds
  s_waitcnt lgkmcnt(6)
  v_mfma_f32_32x32x16_bf16 v[172:187], v[188:191], v[100:103], v[172:187]
  ds_read_b64_tr_b16 v[252:253], v14 offset:51200
  ds_read_b64_tr_b16 v[254:255], v14 offset:54272
  s_waitcnt lgkmcnt(6)
  v_mfma_f32_32x32x16_bf16 v[172:187], v[192:195], v[104:107], v[172:187]
  s_waitcnt vmcnt(6)
  s_barrier
  ds_read_b64_tr_b16 v[188:189], v13 offset:0
  ds_read_b64_tr_b16 v[190:191], v13 offset:3072
  s_add_u32 m0, s28, 36864
  s_add_u32 s27, s27, 20480
  buffer_load_dwordx4 v15, s[4:7], s27 offen offset:0 lds
  s_waitcnt lgkmcnt(6)
  v_mfma_f32_32x32x16_bf16 v[172:187], v[196:199], v[96:99], v[172:187]
  ds_read_b64_tr_b16 v[192:193], v13 offset:1024
  ds_read_b64_tr_b16 v[194:195], v13 offset:4096
  s_waitcnt lgkmcnt(6)
  v_mfma_f32_32x32x16_bf16 v[172:187], v[200:203], v[108:111], v[172:187]
  ds_read_b64_tr_b16 v[196:197], v13 offset:2048
  ds_read_b64_tr_b16 v[198:199], v13 offset:5120
  s_add_u32 s27, s27, 54272
  buffer_load_dwordx4 v15, s[4:7], s27 offen offset:1024 lds
  s_waitcnt lgkmcnt(6)
  v_mfma_f32_32x32x16_bf16 v[172:187], v[252:255], v[112:115], v[172:187]
  ds_read_b64_tr_b16 v[200:201], v14 offset:0
  ds_read_b64_tr_b16 v[202:203], v14 offset:3072
  s_waitcnt lgkmcnt(6)
  v_mfma_f32_32x32x16_bf16 v[156:171], v[188:191], v[20:23], 0
  ds_read_b64_tr_b16 v[252:253], v14 offset:1024
  ds_read_b64_tr_b16 v[254:255], v14 offset:4096
  s_add_u32 s27, s27, 17408
  buffer_load_dwordx4 v15, s[4:7], s27 offen offset:2048 lds
  s_waitcnt lgkmcnt(6)
  v_mfma_f32_32x32x16_bf16 v[156:171], v[192:195], v[24:27], v[156:171]
  ds_read_b64_tr_b16 v[188:189], v14 offset:2048
  ds_read_b64_tr_b16 v[190:191], v14 offset:5120
  s_waitcnt lgkmcnt(6)
  v_mfma_f32_32x32x16_bf16 v[156:171], v[196:199], v[28:31], v[156:171]
  s_waitcnt vmcnt(6)
  s_barrier
  ds_read_b64_tr_b16 v[192:193], v13 offset:12288
  ds_read_b64_tr_b16 v[194:195], v13 offset:15360
  s_add_u32 m0, s28, 49152
  s_add_u32 s27, s27, 57344
  buffer_load_dwordx4 v15, s[4:7], s27 offen offset:0 lds
  s_waitcnt lgkmcnt(6)
  v_mfma_f32_32x32x16_bf16 v[156:171], v[200:203], v[36:39], v[156:171]
  ds_read_b64_tr_b16 v[196:197], v13 offset:13312
  ds_read_b64_tr_b16 v[198:199], v13 offset:16384
  s_waitcnt lgkmcnt(6)
  v_mfma_f32_32x32x16_bf16 v[156:171], v[252:255], v[40:43], v[156:171]
  ds_read_b64_tr_b16 v[200:201], v13 offset:14336
  ds_read_b64_tr_b16 v[202:203], v13 offset:17408
  s_mov_b32 s32, 8
  s_lshl_b32 s32, s32, 18
  s_add_u32 s27, s27, 17408
  buffer_load_dwordx4 v15, s[4:7], s27 offen offset:1024 lds
  s_waitcnt lgkmcnt(6)
  v_mfma_f32_32x32x16_bf16 v[156:171], v[188:191], v[44:47], v[156:171]
  ds_read_b64_tr_b16 v[252:253], v14 offset:12288
  ds_read_b64_tr_b16 v[254:255], v14 offset:15360
  s_add_u32 s32, s32, s46
  s_mul_i32 s26, s23, 2359296
  s_waitcnt lgkmcnt(6)
  v_mfma_f32_32x32x16_bf16 v[156:171], v[192:195], v[32:35], v[156:171]
  ds_read_b64_tr_b16 v[188:189], v14 offset:13312
  ds_read_b64_tr_b16 v[190:191], v14 offset:16384
  s_add_u32 s32, s32, s26
  s_add_u32 s27, s27, 54272
  buffer_load_dwordx4 v15, s[4:7], s27 offen offset:2048 lds
  s_waitcnt lgkmcnt(6)
  v_mfma_f32_32x32x16_bf16 v[156:171], v[196:199], v[204:207], v[156:171]
  ds_read_b64_tr_b16 v[192:193], v14 offset:14336
  ds_read_b64_tr_b16 v[194:195], v14 offset:17408
  v_cvt_pk_bf16_f32 v172, v172, v173
  v_cvt_pk_bf16_f32 v173, v174, v175
  s_waitcnt lgkmcnt(6)
  v_mfma_f32_32x32x16_bf16 v[156:171], v[200:203], v[208:211], v[156:171]
  s_waitcnt vmcnt(6)
  s_barrier
  ds_read_b64_tr_b16 v[196:197], v13 offset:24576
  ds_read_b64_tr_b16 v[198:199], v13 offset:27648
  v_cvt_pk_bf16_f32 v174, v176, v177
  v_cvt_pk_bf16_f32 v175, v178, v179
  s_add_u32 m0, s28, 0
  s_add_u32 s27, s27, 20480
  buffer_load_dwordx4 v15, s[4:7], s27 offen offset:0 lds
  s_waitcnt lgkmcnt(6)
  v_mfma_f32_32x32x16_bf16 v[156:171], v[252:255], v[48:51], v[156:171]
  ds_read_b64_tr_b16 v[200:201], v13 offset:25600
  ds_read_b64_tr_b16 v[202:203], v13 offset:28672
  v_cvt_pk_bf16_f32 v176, v180, v181
  s_add_u32 s31, s23, 2
  s_and_b32 s31, s31, 7
  s_lshl_b32 s31, s31, 7
  s_waitcnt lgkmcnt(6)
  v_mfma_f32_32x32x16_bf16 v[156:171], v[188:191], v[52:55], v[156:171]
  ds_read_b64_tr_b16 v[252:253], v13 offset:26624
  ds_read_b64_tr_b16 v[254:255], v13 offset:29696
  v_cvt_pk_bf16_f32 v177, v182, v183
  v_cvt_pk_bf16_f32 v178, v184, v185
  s_add_u32 s27, s27, 54272
  buffer_load_dwordx4 v15, s[4:7], s27 offen offset:1024 lds
  s_mul_i32 s25, s23, 663552
  s_add_u32 s31, s31, s25
  s_waitcnt lgkmcnt(6)
  v_mfma_f32_32x32x16_bf16 v[156:171], v[192:195], v[56:59], v[156:171]
  ds_read_b64_tr_b16 v[188:189], v14 offset:24576
  ds_read_b64_tr_b16 v[190:191], v14 offset:27648
  v_cvt_pk_bf16_f32 v179, v186, v187
  v_permlane32_swap_b32 v172, v174
  s_waitcnt lgkmcnt(6)
  v_mfma_f32_32x32x16_bf16 v[156:171], v[196:199], v[212:215], v[156:171]
  ds_read_b64_tr_b16 v[192:193], v14 offset:25600
  ds_read_b64_tr_b16 v[194:195], v14 offset:28672
  v_permlane32_swap_b32 v173, v175
  s_add_u32 s27, s27, 17408
  buffer_load_dwordx4 v15, s[4:7], s27 offen offset:2048 lds
  s_waitcnt lgkmcnt(6)
  v_mfma_f32_32x32x16_bf16 v[156:171], v[200:203], v[216:219], v[156:171]
  ds_read_b64_tr_b16 v[196:197], v14 offset:26624
  ds_read_b64_tr_b16 v[198:199], v14 offset:29696
  buffer_store_dwordx4 v[172:175], v4, s[12:15], s32 offen sc1
  s_add_u32 s32, s32, 65536
  s_waitcnt lgkmcnt(6)
  v_mfma_f32_32x32x16_bf16 v[156:171], v[252:255], v[220:223], v[156:171]
  s_waitcnt vmcnt(7)
  s_barrier
  ds_read_b64_tr_b16 v[200:201], v13 offset:36864
  ds_read_b64_tr_b16 v[202:203], v13 offset:39936
  v_permlane32_swap_b32 v176, v178
  v_permlane32_swap_b32 v177, v179
  s_add_u32 m0, s28, 12288
  s_mov_b32 s27, s31
  buffer_load_dwordx4 v15, s[4:7], s27 offen offset:0 lds
  s_waitcnt lgkmcnt(6)
  v_mfma_f32_32x32x16_bf16 v[156:171], v[188:191], v[60:63], v[156:171]
  ds_read_b64_tr_b16 v[252:253], v13 offset:37888
  ds_read_b64_tr_b16 v[254:255], v13 offset:40960
  buffer_store_dwordx4 v[176:179], v4, s[12:15], s32 offen sc1
  s_waitcnt lgkmcnt(6)
  v_mfma_f32_32x32x16_bf16 v[156:171], v[192:195], v[64:67], v[156:171]
  ds_read_b64_tr_b16 v[188:189], v13 offset:38912
  ds_read_b64_tr_b16 v[190:191], v13 offset:41984
  s_add_u32 s27, s27, 17408
  buffer_load_dwordx4 v15, s[4:7], s27 offen offset:1024 lds
  s_waitcnt lgkmcnt(6)
  v_mfma_f32_32x32x16_bf16 v[156:171], v[196:199], v[68:71], v[156:171]
  ds_read_b64_tr_b16 v[192:193], v14 offset:36864
  ds_read_b64_tr_b16 v[194:195], v14 offset:39936
  s_waitcnt lgkmcnt(6)
  v_mfma_f32_32x32x16_bf16 v[156:171], v[200:203], v[224:227], v[156:171]
  ds_read_b64_tr_b16 v[196:197], v14 offset:37888
  ds_read_b64_tr_b16 v[198:199], v14 offset:40960
  s_add_u32 s27, s27, 54272
  buffer_load_dwordx4 v15, s[4:7], s27 offen offset:2048 lds
  s_waitcnt lgkmcnt(6)
  v_mfma_f32_32x32x16_bf16 v[156:171], v[252:255], v[228:231], v[156:171]
  ds_read_b64_tr_b16 v[200:201], v14 offset:38912
  ds_read_b64_tr_b16 v[202:203], v14 offset:41984
  s_waitcnt lgkmcnt(6)
  v_mfma_f32_32x32x16_bf16 v[156:171], v[188:191], v[232:235], v[156:171]
  s_waitcnt vmcnt(8)
  s_barrier
  ds_read_b64_tr_b16 v[252:253], v13 offset:49152
  ds_read_b64_tr_b16 v[254:255], v13 offset:52224
  s_add_u32 m0, s28, 24576
  s_add_u32 s27, s27, 20480
  buffer_load_dwordx4 v15, s[4:7], s27 offen offset:0 lds
  v_and_b32 v18, 31, v1
  v_lshrrev_b32 v19, 5, v1
  s_waitcnt lgkmcnt(6)
  v_mfma_f32_32x32x16_bf16 v[156:171], v[192:195], v[72:75], v[156:171]
  ds_read_b64_tr_b16 v[188:189], v13 offset:50176
  ds_read_b64_tr_b16 v[190:191], v13 offset:53248
  v_lshlrev_b32 v19, 3, v19
  v_sub_u32 v19, v18, v19
  s_waitcnt lgkmcnt(6)
  v_mfma_f32_32x32x16_bf16 v[156:171], v[196:199], v[76:79], v[156:171]
  ds_read_b64_tr_b16 v[192:193], v13 offset:51200
  ds_read_b64_tr_b16 v[194:195], v13 offset:54272
  s_add_u32 s27, s27, 54272
  buffer_load_dwordx4 v15, s[4:7], s27 offen offset:1024 lds
  v_ashrrev_i32 v19, 1, v19
  s_waitcnt lgkmcnt(6)
  v_mfma_f32_32x32x16_bf16 v[156:171], v[200:203], v[80:83], v[156:171]
  ds_read_b64_tr_b16 v[196:197], v14 offset:49152
  ds_read_b64_tr_b16 v[198:199], v14 offset:52224
  v_lshrrev_b32 v9, 1, v18
  v_and_b32 v18, 1, v18
  s_waitcnt lgkmcnt(6)
  v_mfma_f32_32x32x16_bf16 v[156:171], v[252:255], v[236:239], v[156:171]
  ds_read_b64_tr_b16 v[200:201], v14 offset:50176
  ds_read_b64_tr_b16 v[202:203], v14 offset:53248
  s_add_u32 s27, s27, 17408
  buffer_load_dwordx4 v15, s[4:7], s27 offen offset:2048 lds
  v_lshlrev_b32 v18, 4, v18
  s_waitcnt lgkmcnt(6)
  v_mfma_f32_32x32x16_bf16 v[156:171], v[188:191], v[240:243], v[156:171]
  ds_read_b64_tr_b16 v[252:253], v14 offset:51200
  ds_read_b64_tr_b16 v[254:255], v14 offset:54272
  v_mov_b32 v5, 0x3f80
  v_lshlrev_b32 v18, v18, v5
  s_waitcnt lgkmcnt(6)
  v_mfma_f32_32x32x16_bf16 v[156:171], v[192:195], v[244:247], v[156:171]
  s_waitcnt vmcnt(8)
  s_barrier
  ds_read_b64_tr_b16 v[188:189], v13 offset:0
  ds_read_b64_tr_b16 v[190:191], v13 offset:3072
  s_add_u32 m0, s28, 36864
  s_add_u32 s27, s27, 57344
  buffer_load_dwordx4 v15, s[4:7], s27 offen offset:0 lds
  v_cmp_eq_u32 vcc, 0, v19
  s_nop 1
  v_cndmask_b32 v128, 0, v18, vcc
  s_waitcnt lgkmcnt(6)
  v_mfma_f32_32x32x16_bf16 v[156:171], v[196:199], v[84:87], v[156:171]
  ds_read_b64_tr_b16 v[192:193], v13 offset:1024
  ds_read_b64_tr_b16 v[194:195], v13 offset:4096
  v_cmp_eq_u32 vcc, 1, v19
  s_nop 1
  v_cndmask_b32 v129, 0, v18, vcc
  v_cmp_eq_u32 vcc, 2, v19
  s_nop 1
  v_cndmask_b32 v130, 0, v18, vcc
  s_waitcnt lgkmcnt(6)
  v_mfma_f32_32x32x16_bf16 v[156:171], v[200:203], v[88:91], v[156:171]
  ds_read_b64_tr_b16 v[196:197], v13 offset:2048
  ds_read_b64_tr_b16 v[198:199], v13 offset:5120
  s_add_u32 s27, s27, 17408
  buffer_load_dwordx4 v15, s[4:7], s27 offen offset:1024 lds
  v_cmp_eq_u32 vcc, 3, v19
  s_nop 1
  v_cndmask_b32 v131, 0, v18, vcc
  v_cmp_eq_u32 vcc, 8, v19
  s_nop 1
  v_cndmask_b32 v132, 0, v18, vcc
  s_waitcnt lgkmcnt(6)
  v_mfma_f32_32x32x16_bf16 v[156:171], v[252:255], v[92:95], v[156:171]
  ds_read_b64_tr_b16 v[200:201], v14 offset:0
  ds_read_b64_tr_b16 v[202:203], v14 offset:3072
  v_cmp_eq_u32 vcc, 9, v19
  s_nop 1
  v_cndmask_b32 v133, 0, v18, vcc
  s_waitcnt lgkmcnt(6)
  v_mfma_f32_32x32x16_bf16 v[156:171], v[188:191], v[248:251], v[156:171]
  ds_read_b64_tr_b16 v[252:253], v14 offset:1024
  ds_read_b64_tr_b16 v[254:255], v14 offset:4096
  s_add_u32 s27, s27, 54272
  buffer_load_dwordx4 v15, s[4:7], s27 offen offset:2048 lds
  v_cmp_eq_u32 vcc, 10, v19
  s_nop 1
  v_cndmask_b32 v134, 0, v18, vcc
  v_cmp_eq_u32 vcc, 11, v19
  s_nop 1
  v_cndmask_b32 v135, 0, v18, vcc
  s_waitcnt lgkmcnt(6)
  v_mfma_f32_32x32x16_bf16 v[156:171], v[192:195], v[100:103], v[156:171]
  ds_read_b64_tr_b16 v[188:189], v14 offset:2048
  ds_read_b64_tr_b16 v[190:191], v14 offset:5120
  s_waitcnt vmcnt(8)
  s_mov_b32 s25, 8
  s_lshl_b32 s25, s25, 7
  v_cmp_eq_u32 vcc, 0, v9
  s_nop 1
  v_cndmask_b32 v136, 0, v18, vcc
  s_waitcnt lgkmcnt(6)
  v_mfma_f32_32x32x16_bf16 v[156:171], v[196:199], v[104:107], v[156:171]
  s_waitcnt vmcnt(6)
  s_barrier
  ds_read_b64_tr_b16 v[192:193], v13 offset:12288
  ds_read_b64_tr_b16 v[194:195], v13 offset:15360
  s_add_u32 m0, s28, 49152
  s_add_u32 s27, s27, 20480
  buffer_load_dwordx4 v15, s[4:7], s27 offen offset:0 lds
  s_add_u32 s25, s25, s33
  buffer_store_dword v16, v17, s[12:15], s25 offen sc1
  v_cmp_eq_u32 vcc, 1, v9
  s_nop 1
  v_cndmask_b32 v137, 0, v18, vcc
  v_cmp_eq_u32 vcc, 2, v9
  s_nop 1
  v_cndmask_b32 v138, 0, v18, vcc
  s_waitcnt lgkmcnt(6)
  v_mfma_f32_32x32x16_bf16 v[156:171], v[200:203], v[96:99], v[156:171]
  ds_read_b64_tr_b16 v[196:197], v13 offset:13312
  ds_read_b64_tr_b16 v[198:199], v13 offset:16384
  v_cmp_eq_u32 vcc, 3, v9
  s_nop 1
  v_cndmask_b32 v139, 0, v18, vcc
  s_waitcnt lgkmcnt(6)
  v_mfma_f32_32x32x16_bf16 v[156:171], v[252:255], v[108:111], v[156:171]
  ds_read_b64_tr_b16 v[200:201], v13 offset:14336
  ds_read_b64_tr_b16 v[202:203], v13 offset:17408
  s_add_u32 s27, s27, 54272
  buffer_load_dwordx4 v15, s[4:7], s27 offen offset:1024 lds
  s_waitcnt lgkmcnt(6)
  v_mfma_f32_32x32x16_bf16 v[156:171], v[188:191], v[112:115], v[156:171]
  ds_read_b64_tr_b16 v[252:253], v14 offset:12288
  ds_read_b64_tr_b16 v[254:255], v14 offset:15360
  s_waitcnt lgkmcnt(6)
  v_mfma_f32_32x32x16_bf16 v[172:187], v[192:195], v[20:23], 0
  ds_read_b64_tr_b16 v[188:189], v14 offset:13312
  ds_read_b64_tr_b16 v[190:191], v14 offset:16384
  s_add_u32 s27, s27, 17408
  buffer_load_dwordx4 v15, s[4:7], s27 offen offset:2048 lds
  s_lshl_b32 s35, s23, 18
  s_add_u32 s35, s35, s46
  s_add_u32 s35, s35, 4284887040
  s_waitcnt lgkmcnt(6)
  v_mfma_f32_32x32x16_bf16 v[172:187], v[196:199], v[24:27], v[172:187]
  ds_read_b64_tr_b16 v[192:193], v14 offset:14336
  ds_read_b64_tr_b16 v[194:195], v14 offset:17408
  buffer_load_dwordx4 v[116:119], v4, s[12:15], s35 offen sc1
  s_add_u32 s35, s35, 65536
  buffer_load_dwordx4 v[120:123], v4, s[12:15], s35 offen sc1
  s_waitcnt lgkmcnt(6)
  v_mfma_f32_32x32x16_bf16 v[172:187], v[200:203], v[28:31], v[172:187]
  s_waitcnt vmcnt(9)
  s_barrier
  ds_read_b64_tr_b16 v[196:197], v13 offset:24576
  ds_read_b64_tr_b16 v[198:199], v13 offset:27648
  s_add_u32 m0, s28, 0
  s_add_u32 s27, s27, 57344
  buffer_load_dwordx4 v15, s[4:7], s27 offen offset:0 lds
  s_waitcnt lgkmcnt(6)
  v_mfma_f32_32x32x16_bf16 v[172:187], v[252:255], v[36:39], v[172:187]
  ds_read_b64_tr_b16 v[200:201], v13 offset:25600
  ds_read_b64_tr_b16 v[202:203], v13 offset:28672
  s_waitcnt lgkmcnt(6)
  v_mfma_f32_32x32x16_bf16 v[172:187], v[188:191], v[40:43], v[172:187]
  ds_read_b64_tr_b16 v[252:253], v13 offset:26624
  ds_read_b64_tr_b16 v[254:255], v13 offset:29696
  s_add_u32 s32, s23, 1
  s_and_b32 s32, s32, 7
  s_add_u32 s27, s27, 17408
  buffer_load_dwordx4 v15, s[4:7], s27 offen offset:1024 lds
  s_waitcnt lgkmcnt(6)
  v_mfma_f32_32x32x16_bf16 v[172:187], v[192:195], v[44:47], v[172:187]
  ds_read_b64_tr_b16 v[188:189], v14 offset:24576
  ds_read_b64_tr_b16 v[190:191], v14 offset:27648
  s_lshl_b32 s32, s32, 18
  s_add_u32 s32, s32, s46
  s_waitcnt lgkmcnt(6)
  v_mfma_f32_32x32x16_bf16 v[172:187], v[196:199], v[32:35], v[172:187]
  ds_read_b64_tr_b16 v[192:193], v14 offset:25600
  ds_read_b64_tr_b16 v[194:195], v14 offset:28672
  s_mul_i32 s26, s23, 2359296
  s_add_u32 s32, s32, s26
  s_add_u32 s27, s27, 54272
  buffer_load_dwordx4 v15, s[4:7], s27 offen offset:2048 lds
  s_waitcnt lgkmcnt(6)
  v_mfma_f32_32x32x16_bf16 v[172:187], v[200:203], v[204:207], v[172:187]
  ds_read_b64_tr_b16 v[196:197], v14 offset:26624
  ds_read_b64_tr_b16 v[198:199], v14 offset:29696
  v_cvt_pk_bf16_f32 v156, v156, v157
  s_waitcnt lgkmcnt(6)
  v_mfma_f32_32x32x16_bf16 v[172:187], v[252:255], v[208:211], v[172:187]
  s_waitcnt vmcnt(9)
  s_barrier
  ds_read_b64_tr_b16 v[200:201], v13 offset:36864
  ds_read_b64_tr_b16 v[202:203], v13 offset:39936
  v_cvt_pk_bf16_f32 v157, v158, v159
  v_cvt_pk_bf16_f32 v158, v160, v161
  s_add_u32 m0, s28, 12288
  s_add_u32 s27, s27, 20480
  buffer_load_dwordx4 v15, s[4:7], s27 offen offset:0 lds
  s_waitcnt lgkmcnt(6)
  v_mfma_f32_32x32x16_bf16 v[172:187], v[188:191], v[48:51], v[172:187]
  ds_read_b64_tr_b16 v[252:253], v13 offset:37888
  ds_read_b64_tr_b16 v[254:255], v13 offset:40960
  v_cvt_pk_bf16_f32 v159, v162, v163
  v_cvt_pk_bf16_f32 v160, v164, v165
  s_add_u32 s31, s23, 3
  s_and_b32 s31, s31, 7
  s_lshl_b32 s31, s31, 7
  s_waitcnt lgkmcnt(6)
  v_mfma_f32_32x32x16_bf16 v[172:187], v[192:195], v[52:55], v[172:187]
  ds_read_b64_tr_b16 v[188:189], v13 offset:38912
  ds_read_b64_tr_b16 v[190:191], v13 offset:41984
  v_cvt_pk_bf16_f32 v161, v166, v167
  v_cvt_pk_bf16_f32 v162, v168, v169
  s_add_u32 s27, s27, 54272
  buffer_load_dwordx4 v15, s[4:7], s27 offen offset:1024 lds
  s_mul_i32 s25, s23, 663552
  s_add_u32 s31, s31, s25
  s_waitcnt lgkmcnt(6)
  v_mfma_f32_32x32x16_bf16 v[172:187], v[196:199], v[56:59], v[172:187]
  ds_read_b64_tr_b16 v[192:193], v14 offset:36864
  ds_read_b64_tr_b16 v[194:195], v14 offset:39936
  v_cvt_pk_bf16_f32 v163, v170, v171
  s_waitcnt lgkmcnt(6)
  v_mfma_f32_32x32x16_bf16 v[172:187], v[200:203], v[212:215], v[172:187]
  ds_read_b64_tr_b16 v[196:197], v14 offset:37888
  ds_read_b64_tr_b16 v[198:199], v14 offset:40960
  v_permlane32_swap_b32 v156, v158
  v_permlane32_swap_b32 v157, v159
  s_add_u32 s27, s27, 17408
  buffer_load_dwordx4 v15, s[4:7], s27 offen offset:2048 lds
  s_waitcnt lgkmcnt(6)
  v_mfma_f32_32x32x16_bf16 v[172:187], v[252:255], v[216:219], v[172:187]
  ds_read_b64_tr_b16 v[200:201], v14 offset:38912
  ds_read_b64_tr_b16 v[202:203], v14 offset:41984
  buffer_store_dwordx4 v[156:159], v4, s[12:15], s32 offen sc1
  s_add_u32 s32, s32, 65536
  s_waitcnt lgkmcnt(6)
  v_mfma_f32_32x32x16_bf16 v[172:187], v[188:191], v[220:223], v[172:187]
  s_waitcnt vmcnt(9)
  s_barrier
  ds_read_b64_tr_b16 v[252:253], v13 offset:49152
  ds_read_b64_tr_b16 v[254:255], v13 offset:52224
  v_permlane32_swap_b32 v160, v162
  v_permlane32_swap_b32 v161, v163
  s_add_u32 m0, s28, 24576
  s_mov_b32 s27, s31
  buffer_load_dwordx4 v15, s[4:7], s27 offen offset:0 lds
  s_waitcnt lgkmcnt(6)
  v_mfma_f32_32x32x16_bf16 v[172:187], v[192:195], v[60:63], v[172:187]
  ds_read_b64_tr_b16 v[188:189], v13 offset:50176
  ds_read_b64_tr_b16 v[190:191], v13 offset:53248
  buffer_store_dwordx4 v[160:163], v4, s[12:15], s32 offen sc1
  s_waitcnt lgkmcnt(6)
  v_mfma_f32_32x32x16_bf16 v[172:187], v[196:199], v[64:67], v[172:187]
  ds_read_b64_tr_b16 v[192:193], v13 offset:51200
  ds_read_b64_tr_b16 v[194:195], v13 offset:54272
  s_add_u32 s27, s27, 17408
  buffer_load_dwordx4 v15, s[4:7], s27 offen offset:1024 lds
  s_waitcnt vmcnt(10)
  v_mfma_f32_32x32x16_bf16 v[140:155], v[128:131], v[116:119], 0
  v_mfma_f32_32x32x16_bf16 v[140:155], v[132:135], v[120:123], v[140:155]
  s_waitcnt lgkmcnt(6)
  v_mfma_f32_32x32x16_bf16 v[172:187], v[200:203], v[68:71], v[172:187]
  ds_read_b64_tr_b16 v[196:197], v14 offset:49152
  ds_read_b64_tr_b16 v[198:199], v14 offset:52224
  s_waitcnt lgkmcnt(6)
  v_mfma_f32_32x32x16_bf16 v[172:187], v[252:255], v[224:227], v[172:187]
  ds_read_b64_tr_b16 v[200:201], v14 offset:50176
  ds_read_b64_tr_b16 v[202:203], v14 offset:53248
  s_add_u32 s27, s27, 54272
  buffer_load_dwordx4 v15, s[4:7], s27 offen offset:2048 lds
  s_waitcnt lgkmcnt(6)
  v_mfma_f32_32x32x16_bf16 v[172:187], v[188:191], v[228:231], v[172:187]
  ds_read_b64_tr_b16 v[252:253], v14 offset:51200
  ds_read_b64_tr_b16 v[254:255], v14 offset:54272
  s_waitcnt lgkmcnt(6)
  v_mfma_f32_32x32x16_bf16 v[172:187], v[192:195], v[232:235], v[172:187]
  s_waitcnt vmcnt(8)
  s_barrier
  ds_read_b64_tr_b16 v[188:189], v13 offset:0
  ds_read_b64_tr_b16 v[190:191], v13 offset:3072
  s_add_u32 m0, s28, 36864
  s_add_u32 s27, s27, 20480
  buffer_load_dwordx4 v15, s[4:7], s27 offen offset:0 lds
  v_lshrrev_b32 v18, 5, v1
  v_bfe_u32 v19, v1, 2, 2
  v_lshl_add_u32 v19, v18, 3, v19
  s_waitcnt lgkmcnt(6)
  v_mfma_f32_32x32x16_bf16 v[172:187], v[196:199], v[72:75], v[172:187]
  ds_read_b64_tr_b16 v[192:193], v13 offset:1024
  ds_read_b64_tr_b16 v[194:195], v13 offset:4096
  v_and_b32 v3, 1, v1
  v_lshlrev_b32 v3, 3, v3
  v_lshl_add_u32 v3, v19, 4, v3
  s_waitcnt lgkmcnt(6)
  v_mfma_f32_32x32x16_bf16 v[172:187], v[200:203], v[76:79], v[172:187]
  ds_read_b64_tr_b16 v[196:197], v13 offset:2048
  ds_read_b64_tr_b16 v[198:199], v13 offset:5120
  s_add_u32 s27, s27, 54272
  buffer_load_dwordx4 v15, s[4:7], s27 offen offset:1024 lds
  s_mul_i32 s25, s22, 4608
  s_add_u32 s25, s25, 61440
  v_add_u32 v3, s25, v3
  s_waitcnt lgkmcnt(6)
  v_mfma_f32_32x32x16_bf16 v[172:187], v[252:255], v[80:83], v[172:187]
  ds_read_b64_tr_b16 v[200:201], v14 offset:0
  ds_read_b64_tr_b16 v[202:203], v14 offset:3072
  v_and_b32 v19, 0x7fff, v4
  s_lshl_b32 s25, s22, 30
  s_waitcnt lgkmcnt(6)
  v_mfma_f32_32x32x16_bf16 v[172:187], v[188:191], v[236:239], v[172:187]
  ds_read_b64_tr_b16 v[252:253], v14 offset:1024
  ds_read_b64_tr_b16 v[254:255], v14 offset:4096
  s_add_u32 s27, s27, 17408
  buffer_load_dwordx4 v15, s[4:7], s27 offen offset:2048 lds
  v_or_b32 v19, s25, v19
  s_mov_b32 s25, 2359296
  v_mad_u32_u24 v7, v18, s25, v19
  s_waitcnt lgkmcnt(6)
  v_mfma_f32_32x32x16_bf16 v[172:187], v[192:195], v[240:243], v[172:187]
  ds_read_b64_tr_b16 v[188:189], v14 offset:2048
  ds_read_b64_tr_b16 v[190:191], v14 offset:5120
  s_mov_b32 s25, 7720960
  v_mad_u32_u24 v8, v18, s25, v19
  v_and_b32 v19, 0x7fff, v4
  s_waitcnt lgkmcnt(6)
  v_mfma_f32_32x32x16_bf16 v[172:187], v[196:199], v[244:247], v[172:187]
  s_waitcnt vmcnt(8)
  s_barrier
  ds_read_b64_tr_b16 v[192:193], v13 offset:12288
  ds_read_b64_tr_b16 v[194:195], v13 offset:15360
  s_add_u32 m0, s28, 49152
  s_add_u32 s27, s27, 57344
  buffer_load_dwordx4 v15, s[4:7], s27 offen offset:0 lds
  v_mul_u32_u24 v10, 72, v19
  v_lshrrev_b32 v9, 2, v19
  s_waitcnt lgkmcnt(6)
  v_mfma_f32_32x32x16_bf16 v[172:187], v[200:203], v[84:87], v[172:187]
  ds_read_b64_tr_b16 v[196:197], v13 offset:13312
  ds_read_b64_tr_b16 v[198:199], v13 offset:16384
  v_lshlrev_b32 v5, 30, v18
  v_lshl_add_u32 v5, v1, 2, v5
  v_lshrrev_b32 v19, 2, v1
  s_waitcnt lgkmcnt(6)
  v_mfma_f32_32x32x16_bf16 v[172:187], v[252:255], v[88:91], v[172:187]
  ds_read_b64_tr_b16 v[200:201], v13 offset:14336
  ds_read_b64_tr_b16 v[202:203], v13 offset:17408
  s_add_u32 s27, s27, 17408
  buffer_load_dwordx4 v15, s[4:7], s27 offen offset:1024 lds
  v_min_u32 v19, 1, v19
  v_lshlrev_b32 v19, 30, v19
  v_lshl_add_u32 v6, v1, 2, v19
  s_waitcnt lgkmcnt(6)
  v_mfma_f32_32x32x16_bf16 v[172:187], v[188:191], v[92:95], v[172:187]
  ds_read_b64_tr_b16 v[252:253], v14 offset:12288
  ds_read_b64_tr_b16 v[254:255], v14 offset:15360
  s_mov_b32 s25, 14659584
  buffer_load_dword v9, v9, s[12:15], s25 offen sc1
  s_waitcnt lgkmcnt(6)
  v_mfma_f32_32x32x16_bf16 v[172:187], v[192:195], v[248:251], v[172:187]
  ds_read_b64_tr_b16 v[188:189], v14 offset:13312
  ds_read_b64_tr_b16 v[190:191], v14 offset:16384
  s_add_u32 s27, s27, 54272
  buffer_load_dwordx4 v15, s[4:7], s27 offen offset:2048 lds
  s_lshl_b32 s35, s23, 18
  s_add_u32 s35, s35, s46
  s_add_u32 s35, s35, 4292608000
  buffer_load_dwordx4 v[116:119], v4, s[12:15], s35 offen sc1
  s_add_u32 s35, s35, 65536
  buffer_load_dwordx4 v[120:123], v4, s[12:15], s35 offen sc1
  s_waitcnt lgkmcnt(6)
  v_mfma_f32_32x32x16_bf16 v[172:187], v[196:199], v[100:103], v[172:187]
  ds_read_b64_tr_b16 v[192:193], v14 offset:14336
  ds_read_b64_tr_b16 v[194:195], v14 offset:17408
  s_waitcnt vmcnt(11)
  s_add_u32 s25, s23, 1
  s_and_b32 s25, s25, 7
  s_waitcnt lgkmcnt(6)
  v_mfma_f32_32x32x16_bf16 v[172:187], v[200:203], v[104:107], v[172:187]
  s_waitcnt vmcnt(9)
  s_barrier
  ds_read_b64_tr_b16 v[196:197], v13 offset:24576
  ds_read_b64_tr_b16 v[198:199], v13 offset:27648
  s_add_u32 m0, s28, 0
  s_add_u32 s27, s27, 20480
  buffer_load_dwordx4 v15, s[4:7], s27 offen offset:0 lds
  s_lshl_b32 s25, s25, 7
  s_add_u32 s25, s25, s33
  buffer_store_dword v16, v17, s[12:15], s25 offen sc1
  s_waitcnt lgkmcnt(6)
  v_mfma_f32_32x32x16_bf16 v[172:187], v[252:255], v[96:99], v[172:187]
  ds_read_b64_tr_b16 v[200:201], v13 offset:25600
  ds_read_b64_tr_b16 v[202:203], v13 offset:28672
  s_waitcnt lgkmcnt(6)
  v_mfma_f32_32x32x16_bf16 v[172:187], v[188:191], v[108:111], v[172:187]
  ds_read_b64_tr_b16 v[252:253], v13 offset:26624
  ds_read_b64_tr_b16 v[254:255], v13 offset:29696
  s_add_u32 s27, s27, 54272
  buffer_load_dwordx4 v15, s[4:7], s27 offen offset:1024 lds
  s_waitcnt lgkmcnt(6)
  v_mfma_f32_32x32x16_bf16 v[172:187], v[192:195], v[112:115], v[172:187]
  ds_read_b64_tr_b16 v[188:189], v14 offset:24576
  ds_read_b64_tr_b16 v[190:191], v14 offset:27648
  s_waitcnt lgkmcnt(6)
  v_mfma_f32_32x32x16_bf16 v[156:171], v[196:199], v[20:23], 0
  ds_read_b64_tr_b16 v[192:193], v14 offset:25600
  ds_read_b64_tr_b16 v[194:195], v14 offset:28672
  s_add_u32 s27, s27, 17408
  buffer_load_dwordx4 v15, s[4:7], s27 offen offset:2048 lds
  s_waitcnt lgkmcnt(6)
  v_mfma_f32_32x32x16_bf16 v[156:171], v[200:203], v[24:27], v[156:171]
  ds_read_b64_tr_b16 v[196:197], v14 offset:26624
  ds_read_b64_tr_b16 v[198:199], v14 offset:29696
  s_waitcnt lgkmcnt(6)
  v_mfma_f32_32x32x16_bf16 v[156:171], v[252:255], v[28:31], v[156:171]
  s_waitcnt vmcnt(10)
  s_barrier
  ds_read_b64_tr_b16 v[200:201], v13 offset:36864
  ds_read_b64_tr_b16 v[202:203], v13 offset:39936
  s_add_u32 m0, s28, 12288
  s_add_u32 s27, s27, 57344
  buffer_load_dwordx4 v15, s[4:7], s27 offen offset:0 lds
  s_waitcnt lgkmcnt(6)
  v_mfma_f32_32x32x16_bf16 v[156:171], v[188:191], v[36:39], v[156:171]
  ds_read_b64_tr_b16 v[252:253], v13 offset:37888
  ds_read_b64_tr_b16 v[254:255], v13 offset:40960
  s_waitcnt lgkmcnt(6)
  v_mfma_f32_32x32x16_bf16 v[156:171], v[192:195], v[40:43], v[156:171]
  ds_read_b64_tr_b16 v[188:189], v13 offset:38912
  ds_read_b64_tr_b16 v[190:191], v13 offset:41984
  s_add_u32 s32, s23, 2
  s_and_b32 s32, s32, 7
  s_add_u32 s27, s27, 17408
  buffer_load_dwordx4 v15, s[4:7], s27 offen offset:1024 lds
  s_waitcnt lgkmcnt(6)
  v_mfma_f32_32x32x16_bf16 v[156:171], v[196:199], v[44:47], v[156:171]
  ds_read_b64_tr_b16 v[192:193], v14 offset:36864
  ds_read_b64_tr_b16 v[194:195], v14 offset:39936
  s_lshl_b32 s32, s32, 18
  s_add_u32 s32, s32, s46
  s_waitcnt lgkmcnt(6)
  v_mfma_f32_32x32x16_bf16 v[156:171], v[200:203], v[32:35], v[156:171]
  ds_read_b64_tr_b16 v[196:197], v14 offset:37888
  ds_read_b64_tr_b16 v[198:199], v14 offset:40960
  s_mul_i32 s26, s23, 2359296
  s_add_u32 s32, s32, s26
  s_add_u32 s27, s27, 54272
  buffer_load_dwordx4 v15, s[4:7], s27 offen offset:2048 lds
  s_waitcnt lgkmcnt(6)
  v_mfma_f32_32x32x16_bf16 v[156:171], v[252:255], v[204:207], v[156:171]
  ds_read_b64_tr_b16 v[200:201], v14 offset:38912
  ds_read_b64_tr_b16 v[202:203], v14 offset:41984
  v_cvt_pk_bf16_f32 v172, v172, v173
  s_waitcnt lgkmcnt(6)
  v_mfma_f32_32x32x16_bf16 v[156:171], v[188:191], v[208:211], v[156:171]
  s_waitcnt vmcnt(9)
  s_barrier
  ds_read_b64_tr_b16 v[252:253], v13 offset:49152
  ds_read_b64_tr_b16 v[254:255], v13 offset:52224
  v_cvt_pk_bf16_f32 v173, v174, v175
  v_cvt_pk_bf16_f32 v174, v176, v177
  s_add_u32 m0, s28, 24576
  s_add_u32 s27, s27, 20480
  buffer_load_dwordx4 v15, s[4:7], s27 offen offset:0 lds
  s_waitcnt lgkmcnt(6)
  v_mfma_f32_32x32x16_bf16 v[156:171], v[192:195], v[48:51], v[156:171]
  ds_read_b64_tr_b16 v[188:189], v13 offset:50176
  ds_read_b64_tr_b16 v[190:191], v13 offset:53248
  v_cvt_pk_bf16_f32 v175, v178, v179
  v_cvt_pk_bf16_f32 v176, v180, v181
  s_add_u32 s31, s23, 4
  s_and_b32 s31, s31, 7
  s_lshl_b32 s31, s31, 7
  s_waitcnt lgkmcnt(6)
  v_mfma_f32_32x32x16_bf16 v[156:171], v[196:199], v[52:55], v[156:171]
  ds_read_b64_tr_b16 v[192:193], v13 offset:51200
  ds_read_b64_tr_b16 v[194:195], v13 offset:54272
  v_cvt_pk_bf16_f32 v177, v182, v183
  v_cvt_pk_bf16_f32 v178, v184, v185
  s_add_u32 s27, s27, 54272
  buffer_load_dwordx4 v15, s[4:7], s27 offen offset:1024 lds
  s_mul_i32 s25, s23, 663552
  s_add_u32 s31, s31, s25
  s_waitcnt lgkmcnt(6)
  v_mfma_f32_32x32x16_bf16 v[156:171], v[200:203], v[56:59], v[156:171]
  ds_read_b64_tr_b16 v[196:197], v14 offset:49152
  ds_read_b64_tr_b16 v[198:199], v14 offset:52224
  v_cvt_pk_bf16_f32 v179, v186, v187
  s_waitcnt lgkmcnt(6)
  v_mfma_f32_32x32x16_bf16 v[156:171], v[252:255], v[212:215], v[156:171]
  ds_read_b64_tr_b16 v[200:201], v14 offset:50176
  ds_read_b64_tr_b16 v[202:203], v14 offset:53248
  v_permlane32_swap_b32 v172, v174
  v_permlane32_swap_b32 v173, v175
  s_add_u32 s27, s27, 17408
  buffer_load_dwordx4 v15, s[4:7], s27 offen offset:2048 lds
  s_waitcnt vmcnt(10)
  v_mfma_f32_32x32x16_bf16 v[140:155], v[128:131], v[116:119], v[140:155]
  v_mfma_f32_32x32x16_bf16 v[140:155], v[132:135], v[120:123], v[140:155]
  s_waitcnt lgkmcnt(6)
  v_mfma_f32_32x32x16_bf16 v[156:171], v[188:191], v[216:219], v[156:171]
  ds_read_b64_tr_b16 v[252:253], v14 offset:51200
  ds_read_b64_tr_b16 v[254:255], v14 offset:54272
  buffer_store_dwordx4 v[172:175], v4, s[12:15], s32 offen sc1
  s_add_u32 s32, s32, 65536
  s_waitcnt lgkmcnt(6)
  v_mfma_f32_32x32x16_bf16 v[156:171], v[192:195], v[220:223], v[156:171]
  s_waitcnt vmcnt(7)
  s_barrier
  ds_read_b64_tr_b16 v[188:189], v13 offset:0
  ds_read_b64_tr_b16 v[190:191], v13 offset:3072
  v_permlane32_swap_b32 v176, v178
  v_permlane32_swap_b32 v177, v179
  s_add_u32 m0, s28, 36864
  s_mov_b32 s27, s31
  buffer_load_dwordx4 v15, s[4:7], s27 offen offset:0 lds
  s_waitcnt lgkmcnt(6)
  v_mfma_f32_32x32x16_bf16 v[156:171], v[196:199], v[60:63], v[156:171]
  ds_read_b64_tr_b16 v[192:193], v13 offset:1024
  ds_read_b64_tr_b16 v[194:195], v13 offset:4096
  buffer_store_dwordx4 v[176:179], v4, s[12:15], s32 offen sc1
  s_waitcnt lgkmcnt(6)
  v_mfma_f32_32x32x16_bf16 v[156:171], v[200:203], v[64:67], v[156:171]
  ds_read_b64_tr_b16 v[196:197], v13 offset:2048
  ds_read_b64_tr_b16 v[198:199], v13 offset:5120
  s_add_u32 s27, s27, 17408
  buffer_load_dwordx4 v15, s[4:7], s27 offen offset:1024 lds
  s_sub_u32 s34, s23, 1
  s_and_b32 s34, s34, 7
  s_lshl_b32 s34, s34, 4
  s_lshl_b32 s29, s23, 7
  s_waitcnt lgkmcnt(6)
  v_mfma_f32_32x32x16_bf16 v[156:171], v[252:255], v[68:71], v[156:171]
  ds_read_b64_tr_b16 v[200:201], v14 offset:0
  ds_read_b64_tr_b16 v[202:203], v14 offset:3072
  s_add_u32 s34, s34, s29
  s_add_u32 s34, s34, s39
  buffer_load_dword v11, v6, s[12:15], s34 offen sc1
  s_waitcnt lgkmcnt(6)
  v_mfma_f32_32x32x16_bf16 v[156:171], v[188:191], v[224:227], v[156:171]
  ds_read_b64_tr_b16 v[252:253], v14 offset:1024
  ds_read_b64_tr_b16 v[254:255], v14 offset:4096
  s_add_u32 s27, s27, 54272
  buffer_load_dwordx4 v15, s[4:7], s27 offen offset:2048 lds
  s_waitcnt lgkmcnt(6)
  v_mfma_f32_32x32x16_bf16 v[156:171], v[192:195], v[228:231], v[156:171]
  ds_read_b64_tr_b16 v[188:189], v14 offset:2048
  ds_read_b64_tr_b16 v[190:191], v14 offset:5120
  s_waitcnt lgkmcnt(6)
  v_mfma_f32_32x32x16_bf16 v[156:171], v[196:199], v[232:235], v[156:171]
  s_waitcnt vmcnt(9)
  s_barrier
  ds_read_b64_tr_b16 v[192:193], v13 offset:12288
  ds_read_b64_tr_b16 v[194:195], v13 offset:15360
  s_add_u32 m0, s28, 49152
  s_add_u32 s27, s27, 20480
  buffer_load_dwordx4 v15, s[4:7], s27 offen offset:0 lds
  s_waitcnt lgkmcnt(6)
  v_mfma_f32_32x32x16_bf16 v[156:171], v[200:203], v[72:75], v[156:171]
  ds_read_b64_tr_b16 v[196:197], v13 offset:13312
  ds_read_b64_tr_b16 v[198:199], v13 offset:16384
  s_waitcnt lgkmcnt(6)
  v_mfma_f32_32x32x16_bf16 v[156:171], v[252:255], v[76:79], v[156:171]
  ds_read_b64_tr_b16 v[200:201], v13 offset:14336
  ds_read_b64_tr_b16 v[202:203], v13 offset:17408
  s_add_u32 s27, s27, 54272
  buffer_load_dwordx4 v15, s[4:7], s27 offen offset:1024 lds
  s_waitcnt lgkmcnt(6)
  v_mfma_f32_32x32x16_bf16 v[156:171], v[188:191], v[80:83], v[156:171]
  ds_read_b64_tr_b16 v[252:253], v14 offset:12288
  ds_read_b64_tr_b16 v[254:255], v14 offset:15360
  s_waitcnt lgkmcnt(6)
  v_mfma_f32_32x32x16_bf16 v[156:171], v[192:195], v[236:239], v[156:171]
  ds_read_b64_tr_b16 v[188:189], v14 offset:13312
  ds_read_b64_tr_b16 v[190:191], v14 offset:16384
  s_add_u32 s27, s27, 17408
  buffer_load_dwordx4 v15, s[4:7], s27 offen offset:2048 lds
  s_waitcnt lgkmcnt(6)
  v_mfma_f32_32x32x16_bf16 v[156:171], v[196:199], v[240:243], v[156:171]
  ds_read_b64_tr_b16 v[192:193], v14 offset:14336
  ds_read_b64_tr_b16 v[194:195], v14 offset:17408
  s_waitcnt lgkmcnt(6)
  v_mfma_f32_32x32x16_bf16 v[156:171], v[200:203], v[244:247], v[156:171]
  s_waitcnt vmcnt(9)
  s_barrier
  ds_read_b64_tr_b16 v[196:197], v13 offset:24576
  ds_read_b64_tr_b16 v[198:199], v13 offset:27648
  s_add_u32 m0, s28, 0
  s_add_u32 s27, s27, 57344
  buffer_load_dwordx4 v15, s[4:7], s27 offen offset:0 lds
  s_waitcnt lgkmcnt(6)
  v_mfma_f32_32x32x16_bf16 v[156:171], v[252:255], v[84:87], v[156:171]
  ds_read_b64_tr_b16 v[200:201], v13 offset:25600
  ds_read_b64_tr_b16 v[202:203], v13 offset:28672
  s_waitcnt lgkmcnt(6)
  v_mfma_f32_32x32x16_bf16 v[156:171], v[188:191], v[88:91], v[156:171]
  ds_read_b64_tr_b16 v[252:253], v13 offset:26624
  ds_read_b64_tr_b16 v[254:255], v13 offset:29696
  s_add_u32 s27, s27, 17408
  buffer_load_dwordx4 v15, s[4:7], s27 offen offset:1024 lds
  s_waitcnt lgkmcnt(6)
  v_mfma_f32_32x32x16_bf16 v[156:171], v[192:195], v[92:95], v[156:171]
  ds_read_b64_tr_b16 v[188:189], v14 offset:24576
  ds_read_b64_tr_b16 v[190:191], v14 offset:27648
  s_waitcnt lgkmcnt(6)
  v_mfma_f32_32x32x16_bf16 v[156:171], v[196:199], v[248:251], v[156:171]
  ds_read_b64_tr_b16 v[192:193], v14 offset:25600
  ds_read_b64_tr_b16 v[194:195], v14 offset:28672
  s_add_u32 s27, s27, 54272
  buffer_load_dwordx4 v15, s[4:7], s27 offen offset:2048 lds
  s_waitcnt vmcnt(7)
  v_lshrrev_b32 v18, 30, v6
  v_or_b32 v19, v18, v11
  v_cmp_ne_u32 vcc, 1, v19
  s_cbranch_vccz Lfok_45
  s_mov_b32 s26, 0
Lfwait_46:
  s_sleep 2
  buffer_load_dword v11, v6, s[12:15], s34 offen sc1
  s_add_u32 s26, s26, 1
  s_waitcnt vmcnt(0)
  v_or_b32 v19, v18, v11
  v_cmp_ne_u32 vcc, 1, v19
  s_cbranch_vccz Lfok_45
  s_cmp_lt_u32 s26, 0x40000
  s_cbranch_scc1 Lfwait_46
Lfok_45:
  s_sub_u32 s29, s23, 1
  s_and_b32 s29, s29, 7
  s_mul_i32 s29, s29, 2359296
  s_lshl_b32 s35, s23, 18
  s_add_u32 s35, s35, s46
  s_add_u32 s35, s35, s29
  buffer_load_dwordx4 v[116:119], v4, s[12:15], s35 offen sc1
  s_add_u32 s35, s35, 65536
  buffer_load_dwordx4 v[120:123], v4, s[12:15], s35 offen sc1
  s_waitcnt lgkmcnt(6)
  v_mfma_f32_32x32x16_bf16 v[156:171], v[200:203], v[100:103], v[156:171]
  ds_read_b64_tr_b16 v[196:197], v14 offset:26624
  ds_read_b64_tr_b16 v[198:199], v14 offset:29696
  s_add_u32 s25, s23, 2
  s_and_b32 s25, s25, 7
  s_waitcnt lgkmcnt(6)
  v_mfma_f32_32x32x16_bf16 v[156:171], v[252:255], v[104:107], v[156:171]
  s_waitcnt vmcnt(8)
  s_barrier
  ds_read_b64_tr_b16 v[200:201], v13 offset:36864
  ds_read_b64_tr_b16 v[202:203], v13 offset:39936
  s_add_u32 m0, s28, 12288
  s_add_u32 s27, s27, 20480
  buffer_load_dwordx4 v15, s[4:7], s27 offen offset:0 lds
  s_lshl_b32 s25, s25, 7
  s_add_u32 s25, s25, s33
  buffer_store_dword v16, v17, s[12:15], s25 offen sc1
  s_waitcnt lgkmcnt(6)
  v_mfma_f32_32x32x16_bf16 v[156:171], v[188:191], v[96:99], v[156:171]
  ds_read_b64_tr_b16 v[252:253], v13 offset:37888
  ds_read_b64_tr_b16 v[254:255], v13 offset:40960
  s_waitcnt lgkmcnt(6)
  v_mfma_f32_32x32x16_bf16 v[156:171], v[192:195], v[108:111], v[156:171]
  ds_read_b64_tr_b16 v[188:189], v13 offset:38912
  ds_read_b64_tr_b16 v[190:191], v13 offset:41984
  s_add_u32 s27, s27, 54272
  buffer_load_dwordx4 v15, s[4:7], s27 offen offset:1024 lds
  s_waitcnt lgkmcnt(6)
  v_mfma_f32_32x32x16_bf16 v[156:171], v[196:199], v[112:115], v[156:171]
  ds_read_b64_tr_b16 v[192:193], v14 offset:36864
  ds_read_b64_tr_b16 v[194:195], v14 offset:39936
  s_waitcnt lgkmcnt(6)
  v_mfma_f32_32x32x16_bf16 v[172:187], v[200:203], v[20:23], 0
  ds_read_b64_tr_b16 v[196:197], v14 offset:37888
  ds_read_b64_tr_b16 v[198:199], v14 offset:40960
  s_add_u32 s27, s27, 17408
  buffer_load_dwordx4 v15, s[4:7], s27 offen offset:2048 lds
  s_waitcnt lgkmcnt(6)
  v_mfma_f32_32x32x16_bf16 v[172:187], v[252:255], v[24:27], v[172:187]
  ds_read_b64_tr_b16 v[200:201], v14 offset:38912
  ds_read_b64_tr_b16 v[202:203], v14 offset:41984
  s_waitcnt lgkmcnt(6)
  v_mfma_f32_32x32x16_bf16 v[172:187], v[188:191], v[28:31], v[172:187]
  s_waitcnt vmcnt(9)
  s_barrier
  ds_read_b64_tr_b16 v[252:253], v13 offset:49152
  ds_read_b64_tr_b16 v[254:255], v13 offset:52224
  s_add_u32 m0, s28, 24576
  s_add_u32 s27, s27, 57344
  buffer_load_dwordx4 v15, s[4:7], s27 offen offset:0 lds
  s_waitcnt lgkmcnt(6)
  v_mfma_f32_32x32x16_bf16 v[172:187], v[192:195], v[36:39], v[172:187]
  ds_read_b64_tr_b16 v[188:189], v13 offset:50176
  ds_read_b64_tr_b16 v[190:191], v13 offset:53248
  s_waitcnt lgkmcnt(6)
  v_mfma_f32_32x32x16_bf16 v[172:187], v[196:199], v[40:43], v[172:187]
  ds_read_b64_tr_b16 v[192:193], v13 offset:51200
  ds_read_b64_tr_b16 v[194:195], v13 offset:54272
  s_add_u32 s32, s23, 3
  s_and_b32 s32, s32, 7
  s_add_u32 s27, s27, 17408
  buffer_load_dwordx4 v15, s[4:7], s27 offen offset:1024 lds
  s_waitcnt lgkmcnt(6)
  v_mfma_f32_32x32x16_bf16 v[172:187], v[200:203], v[44:47], v[172:187]
  ds_read_b64_tr_b16 v[196:197], v14 offset:49152
  ds_read_b64_tr_b16 v[198:199], v14 offset:52224
  s_lshl_b32 s32, s32, 18
  s_add_u32 s32, s32, s46
  s_waitcnt lgkmcnt(6)
  v_mfma_f32_32x32x16_bf16 v[172:187], v[252:255], v[32:35], v[172:187]
  ds_read_b64_tr_b16 v[200:201], v14 offset:50176
  ds_read_b64_tr_b16 v[202:203], v14 offset:53248
  s_mul_i32 s26, s23, 2359296
  s_add_u32 s32, s32, s26
  s_add_u32 s27, s27, 54272
  buffer_load_dwordx4 v15, s[4:7], s27 offen offset:2048 lds
  s_waitcnt lgkmcnt(6)
  v_mfma_f32_32x32x16_bf16 v[172:187], v[188:191], v[204:207], v[172:187]
  ds_read_b64_tr_b16 v[252:253], v14 offset:51200
  ds_read_b64_tr_b16 v[254:255], v14 offset:54272
  v_cvt_pk_bf16_f32 v156, v156, v157
  s_waitcnt lgkmcnt(6)
  v_mfma_f32_32x32x16_bf16 v[172:187], v[192:195], v[208:211], v[172:187]
  s_waitcnt vmcnt(9)
  s_barrier
  ds_read_b64_tr_b16 v[188:189], v13 offset:0
  ds_read_b64_tr_b16 v[190:191], v13 offset:3072
  v_cvt_pk_bf16_f32 v157, v158, v159
  v_cvt_pk_bf16_f32 v158, v160, v161
  s_add_u32 m0, s28, 36864
  s_add_u32 s27, s27, 20480
  buffer_load_dwordx4 v15, s[4:7], s27 offen offset:0 lds
  s_waitcnt lgkmcnt(6)
  v_mfma_f32_32x32x16_bf16 v[172:187], v[196:199], v[48:51], v[172:187]
  ds_read_b64_tr_b16 v[192:193], v13 offset:1024
  ds_read_b64_tr_b16 v[194:195], v13 offset:4096
  v_cvt_pk_bf16_f32 v159, v162, v163
  v_cvt_pk_bf16_f32 v160, v164, v165
  s_add_u32 s31, s23, 5
  s_and_b32 s31, s31, 7
  s_lshl_b32 s31, s31, 7
  s_waitcnt lgkmcnt(6)
  v_mfma_f32_32x32x16_bf16 v[172:187], v[200:203], v[52:55], v[172:187]
  ds_read_b64_tr_b16 v[196:197], v13 offset:2048
  ds_read_b64_tr_b16 v[198:199], v13 offset:5120
  v_cvt_pk_bf16_f32 v161, v166, v167
  v_cvt_pk_bf16_f32 v162, v168, v169
  s_add_u32 s27, s27, 54272
  buffer_load_dwordx4 v15, s[4:7], s27 offen offset:1024 lds
  s_mul_i32 s25, s23, 663552
  s_add_u32 s31, s31, s25
  s_waitcnt lgkmcnt(6)
  v_mfma_f32_32x32x16_bf16 v[172:187], v[252:255], v[56:59], v[172:187]
  ds_read_b64_tr_b16 v[200:201], v14 offset:0
  ds_read_b64_tr_b16 v[202:203], v14 offset:3072
  v_cvt_pk_bf16_f32 v163, v170, v171
  s_waitcnt lgkmcnt(6)
  v_mfma_f32_32x32x16_bf16 v[172:187], v[188:191], v[212:215], v[172:187]
  ds_read_b64_tr_b16 v[252:253], v14 offset:1024
  ds_read_b64_tr_b16 v[254:255], v14 offset:4096
  v_permlane32_swap_b32 v156, v158
  v_permlane32_swap_b32 v157, v159
  s_add_u32 s27, s27, 17408
  buffer_load_dwordx4 v15, s[4:7], s27 offen offset:2048 lds
  s_waitcnt vmcnt(10)
  v_mfma_f32_32x32x16_bf16 v[140:155], v[128:131], v[116:119], v[140:155]
  v_mfma_f32_32x32x16_bf16 v[140:155], v[132:135], v[120:123], v[140:155]
  s_waitcnt lgkmcnt(6)
  v_mfma_f32_32x32x16_bf16 v[172:187], v[192:195], v[216:219], v[172:187]
  ds_read_b64_tr_b16 v[188:189], v14 offset:2048
  ds_read_b64_tr_b16 v[190:191], v14 offset:5120
  buffer_store_dwordx4 v[156:159], v4, s[12:15], s32 offen sc1
  s_add_u32 s32, s32, 65536
  s_waitcnt lgkmcnt(6)
  v_mfma_f32_32x32x16_bf16 v[172:187], v[196:199], v[220:223], v[172:187]
  s_waitcnt vmcnt(7)
  s_barrier
  ds_read_b64_tr_b16 v[192:193], v13 offset:12288
  ds_read_b64_tr_b16 v[194:195], v13 offset:15360
  v_permlane32_swap_b32 v160, v162
  v_permlane32_swap_b32 v161, v163
  s_add_u32 m0, s28, 49152
  s_mov_b32 s27, s31
  buffer_load_dwordx4 v15, s[4:7], s27 offen offset:0 lds
  s_waitcnt lgkmcnt(6)
  v_mfma_f32_32x32x16_bf16 v[172:187], v[200:203], v[60:63], v[172:187]
  ds_read_b64_tr_b16 v[196:197], v13 offset:13312
  ds_read_b64_tr_b16 v[198:199], v13 offset:16384
  buffer_store_dwordx4 v[160:163], v4, s[12:15], s32 offen sc1
  s_waitcnt lgkmcnt(6)
  v_mfma_f32_32x32x16_bf16 v[172:187], v[252:255], v[64:67], v[172:187]
  ds_read_b64_tr_b16 v[200:201], v13 offset:14336
  ds_read_b64_tr_b16 v[202:203], v13 offset:17408
  s_add_u32 s27, s27, 17408
  buffer_load_dwordx4 v15, s[4:7], s27 offen offset:1024 lds
  s_sub_u32 s34, s23, 2
  s_and_b32 s34, s34, 7
  s_lshl_b32 s34, s34, 4
  s_lshl_b32 s29, s23, 7
  s_waitcnt lgkmcnt(6)
  v_mfma_f32_32x32x16_bf16 v[172:187], v[188:191], v[68:71], v[172:187]
  ds_read_b64_tr_b16 v[252:253], v14 offset:12288
  ds_read_b64_tr_b16 v[254:255], v14 offset:15360
  s_add_u32 s34, s34, s29
  s_add_u32 s34, s34, s39
  buffer_load_dword v11, v6, s[12:15], s34 offen sc1
  s_waitcnt lgkmcnt(6)
  v_mfma_f32_32x32x16_bf16 v[172:187], v[192:195], v[224:227], v[172:187]
  ds_read_b64_tr_b16 v[188:189], v14 offset:13312
  ds_read_b64_tr_b16 v[190:191], v14 offset:16384
  s_add_u32 s27, s27, 54272
  buffer_load_dwordx4 v15, s[4:7], s27 offen offset:2048 lds
  s_waitcnt lgkmcnt(6)
  v_mfma_f32_32x32x16_bf16 v[172:187], v[196:199], v[228:231], v[172:187]
  ds_read_b64_tr_b16 v[192:193], v14 offset:14336
  ds_read_b64_tr_b16 v[194:195], v14 offset:17408
  s_waitcnt lgkmcnt(6)
  v_mfma_f32_32x32x16_bf16 v[172:187], v[200:203], v[232:235], v[172:187]
  s_waitcnt vmcnt(9)
  s_barrier
  ds_read_b64_tr_b16 v[196:197], v13 offset:24576
  ds_read_b64_tr_b16 v[198:199], v13 offset:27648
  s_add_u32 m0, s28, 0
  s_add_u32 s27, s27, 20480
  buffer_load_dwordx4 v15, s[4:7], s27 offen offset:0 lds
  s_mul_i32 s26, s20, 2304
  s_mul_i32 s25, s23, 9216
  s_waitcnt lgkmcnt(6)
  v_mfma_f32_32x32x16_bf16 v[172:187], v[252:255], v[72:75], v[172:187]
  ds_read_b64_tr_b16 v[200:201], v13 offset:25600
  ds_read_b64_tr_b16 v[202:203], v13 offset:28672
  s_add_u32 s25, s25, s26
  s_add_u32 s36, s25, 14585856
  s_waitcnt lgkmcnt(6)
  v_mfma_f32_32x32x16_bf16 v[172:187], v[188:191], v[76:79], v[172:187]
  ds_read_b64_tr_b16 v[252:253], v13 offset:26624
  ds_read_b64_tr_b16 v[254:255], v13 offset:29696
  s_add_u32 s27, s27, 54272
  buffer_load_dwordx4 v15, s[4:7], s27 offen offset:1024 lds
  v_lshlrev_b32 v18, 4, v1
  v_lshlrev_b32 v19, 2, v1
  s_waitcnt lgkmcnt(6)
  v_mfma_f32_32x32x16_bf16 v[172:187], v[192:195], v[80:83], v[172:187]
  ds_read_b64_tr_b16 v[188:189], v14 offset:24576
  ds_read_b64_tr_b16 v[190:191], v14 offset:27648
  s_mul_i32 s26, s20, 2304
  s_mov_b32 s37, m0
  s_add_u32 m0, s26, 61440
  s_nop 0
  buffer_load_dwordx4 v18, s[12:15], s36 offen lds
  buffer_load_dwordx4 v18, s[12:15], s36 offen offset:1024 lds
  buffer_load_dword v19, s[12:15], s36 offen offset:2048 lds
  s_mov_b32 m0, s37
  s_waitcnt lgkmcnt(6)
  v_mfma_f32_32x32x16_bf16 v[172:187], v[196:199], v[236:239], v[172:187]
  ds_read_b64_tr_b16 v[192:193], v14 offset:25600
  ds_read_b64_tr_b16 v[194:195], v14 offset:28672
  s_add_u32 s27, s27, 17408
  buffer_load_dwordx4 v15, s[4:7], s27 offen offset:2048 lds
  s_waitcnt lgkmcnt(6)
  v_mfma_f32_32x32x16_bf16 v[172:187], v[200:203], v[240:243], v[172:187]
  ds_read_b64_tr_b16 v[196:197], v14 offset:26624
  ds_read_b64_tr_b16 v[198:199], v14 offset:29696
  s_waitcnt lgkmcnt(6)
  v_mfma_f32_32x32x16_bf16 v[172:187], v[252:255], v[244:247], v[172:187]
  s_waitcnt vmcnt(12)
  s_barrier
  ds_read_b64_tr_b16 v[200:201], v13 offset:36864
  ds_read_b64_tr_b16 v[202:203], v13 offset:39936
  s_add_u32 m0, s28, 12288
  s_add_u32 s27, s27, 57344
  buffer_load_dwordx4 v15, s[4:7], s27 offen offset:0 lds
  s_waitcnt lgkmcnt(6)
  v_mfma_f32_32x32x16_bf16 v[172:187], v[188:191], v[84:87], v[172:187]
  ds_read_b64_tr_b16 v[252:253], v13 offset:37888
  ds_read_b64_tr_b16 v[254:255], v13 offset:40960
  s_waitcnt lgkmcnt(6)
  v_mfma_f32_32x32x16_bf16 v[172:187], v[192:195], v[88:91], v[172:187]
  ds_read_b64_tr_b16 v[188:189], v13 offset:38912
  ds_read_b64_tr_b16 v[190:191], v13 offset:41984
  s_add_u32 s27, s27, 17408
  buffer_load_dwordx4 v15, s[4:7], s27 offen offset:1024 lds
  s_waitcnt lgkmcnt(6)
  v_mfma_f32_32x32x16_bf16 v[172:187], v[196:199], v[92:95], v[172:187]
  ds_read_b64_tr_b16 v[192:193], v14 offset:36864
  ds_read_b64_tr_b16 v[194:195], v14 offset:39936
  s_waitcnt lgkmcnt(6)
  v_mfma_f32_32x32x16_bf16 v[172:187], v[200:203], v[248:251], v[172:187]
  ds_read_b64_tr_b16 v[196:197], v14 offset:37888
  ds_read_b64_tr_b16 v[198:199], v14 offset:40960
  s_add_u32 s27, s27, 54272
  buffer_load_dwordx4 v15, s[4:7], s27 offen offset:2048 lds
  s_waitcnt vmcnt(10)
  v_lshrrev_b32 v18, 30, v6
  v_or_b32 v19, v18, v11
  v_cmp_ne_u32 vcc, 1, v19
  s_cbranch_vccz Lfok_47
  s_mov_b32 s26, 0
Lfwait_48:
  s_sleep 2
  buffer_load_dword v11, v6, s[12:15], s34 offen sc1
  s_add_u32 s26, s26, 1
  s_waitcnt vmcnt(0)
  v_or_b32 v19, v18, v11
  v_cmp_ne_u32 vcc, 1, v19
  s_cbranch_vccz Lfok_47
  s_cmp_lt_u32 s26, 0x40000
  s_cbranch_scc1 Lfwait_48
Lfok_47:
  s_sub_u32 s29, s23, 2
  s_and_b32 s29, s29, 7
  s_mul_i32 s29, s29, 2359296
  s_lshl_b32 s35, s23, 18
  s_add_u32 s35, s35, s46
  s_add_u32 s35, s35, s29
  buffer_load_dwordx4 v[116:119], v4, s[12:15], s35 offen sc1
  s_add_u32 s35, s35, 65536
  buffer_load_dwordx4 v[120:123], v4, s[12:15], s35 offen sc1
  s_waitcnt lgkmcnt(6)
  v_mfma_f32_32x32x16_bf16 v[172:187], v[252:255], v[100:103], v[172:187]
  ds_read_b64_tr_b16 v[200:201], v14 offset:38912
  ds_read_b64_tr_b16 v[202:203], v14 offset:41984
  s_add_u32 s25, s23, 3
  s_and_b32 s25, s25, 7
  s_waitcnt lgkmcnt(6)
  v_mfma_f32_32x32x16_bf16 v[172:187], v[188:191], v[104:107], v[172:187]
  s_waitcnt vmcnt(11)
  s_barrier
  ds_read_b64_tr_b16 v[252:253], v13 offset:49152
  ds_read_b64_tr_b16 v[254:255], v13 offset:52224
  s_add_u32 m0, s28, 24576
  s_add_u32 s27, s27, 20480
  buffer_load_dwordx4 v15, s[4:7], s27 offen offset:0 lds
  s_lshl_b32 s25, s25, 7
  s_add_u32 s25, s25, s33
  buffer_store_dword v16, v17, s[12:15], s25 offen sc1
  s_waitcnt lgkmcnt(6)
  v_mfma_f32_32x32x16_bf16 v[172:187], v[192:195], v[96:99], v[172:187]
  ds_read_b64_tr_b16 v[188:189], v13 offset:50176
  ds_read_b64_tr_b16 v[190:191], v13 offset:53248
  s_waitcnt lgkmcnt(6)
  v_mfma_f32_32x32x16_bf16 v[172:187], v[196:199], v[108:111], v[172:187]
  ds_read_b64_tr_b16 v[192:193], v13 offset:51200
  ds_read_b64_tr_b16 v[194:195], v13 offset:54272
  s_add_u32 s27, s27, 54272
  buffer_load_dwordx4 v15, s[4:7], s27 offen offset:1024 lds
  s_waitcnt lgkmcnt(6)
  v_mfma_f32_32x32x16_bf16 v[172:187], v[200:203], v[112:115], v[172:187]
  ds_read_b64_tr_b16 v[196:197], v14 offset:49152
  ds_read_b64_tr_b16 v[198:199], v14 offset:52224
  s_waitcnt lgkmcnt(6)
  v_mfma_f32_32x32x16_bf16 v[156:171], v[252:255], v[20:23], 0
  ds_read_b64_tr_b16 v[200:201], v14 offset:50176
  ds_read_b64_tr_b16 v[202:203], v14 offset:53248
  s_add_u32 s27, s27, 17408
  buffer_load_dwordx4 v15, s[4:7], s27 offen offset:2048 lds
  s_waitcnt lgkmcnt(6)
  v_mfma_f32_32x32x16_bf16 v[156:171], v[188:191], v[24:27], v[156:171]
  ds_read_b64_tr_b16 v[252:253], v14 offset:51200
  ds_read_b64_tr_b16 v[254:255], v14 offset:54272
  s_waitcnt lgkmcnt(6)
  v_mfma_f32_32x32x16_bf16 v[156:171], v[192:195], v[28:31], v[156:171]
  s_waitcnt vmcnt(9)
  s_barrier
  ds_read_b64_tr_b16 v[188:189], v13 offset:0
  ds_read_b64_tr_b16 v[190:191], v13 offset:3072
  s_add_u32 m0, s28, 36864
  s_add_u32 s27, s27, 57344
  buffer_load_dwordx4 v15, s[4:7], s27 offen offset:0 lds
  s_waitcnt lgkmcnt(6)
  v_mfma_f32_32x32x16_bf16 v[156:171], v[196:199], v[36:39], v[156:171]
  ds_read_b64_tr_b16 v[192:193], v13 offset:1024
  ds_read_b64_tr_b16 v[194:195], v13 offset:4096
  s_waitcnt lgkmcnt(6)
  v_mfma_f32_32x32x16_bf16 v[156:171], v[200:203], v[40:43], v[156:171]
  ds_read_b64_tr_b16 v[196:197], v13 offset:2048
  ds_read_b64_tr_b16 v[198:199], v13 offset:5120
  s_add_u32 s32, s23, 4
  s_and_b32 s32, s32, 7
  s_add_u32 s27, s27, 17408
  buffer_load_dwordx4 v15, s[4:7], s27 offen offset:1024 lds
  s_waitcnt lgkmcnt(6)
  v_mfma_f32_32x32x16_bf16 v[156:171], v[252:255], v[44:47], v[156:171]
  ds_read_b64_tr_b16 v[200:201], v14 offset:0
  ds_read_b64_tr_b16 v[202:203], v14 offset:3072
  s_lshl_b32 s32, s32, 18
  s_add_u32 s32, s32, s46
  s_waitcnt lgkmcnt(6)
  v_mfma_f32_32x32x16_bf16 v[156:171], v[188:191], v[32:35], v[156:171]
  ds_read_b64_tr_b16 v[252:253], v14 offset:1024
  ds_read_b64_tr_b16 v[254:255], v14 offset:4096
  s_mul_i32 s26, s23, 2359296
  s_add_u32 s32, s32, s26
  s_add_u32 s27, s27, 54272
  buffer_load_dwordx4 v15, s[4:7], s27 offen offset:2048 lds
  s_waitcnt lgkmcnt(6)
  v_mfma_f32_32x32x16_bf16 v[156:171], v[192:195], v[204:207], v[156:171]
  ds_read_b64_tr_b16 v[188:189], v14 offset:2048
  ds_read_b64_tr_b16 v[190:191], v14 offset:5120
  v_cvt_pk_bf16_f32 v172, v172, v173
  s_waitcnt lgkmcnt(6)
  v_mfma_f32_32x32x16_bf16 v[156:171], v[196:199], v[208:211], v[156:171]
  s_waitcnt vmcnt(9)
  s_barrier
  ds_read_b64_tr_b16 v[192:193], v13 offset:12288
  ds_read_b64_tr_b16 v[194:195], v13 offset:15360
  v_cvt_pk_bf16_f32 v173, v174, v175
  v_cvt_pk_bf16_f32 v174, v176, v177
  s_add_u32 m0, s28, 49152
  s_add_u32 s27, s27, 20480
  buffer_load_dwordx4 v15, s[4:7], s27 offen offset:0 lds
  s_waitcnt lgkmcnt(6)
  v_mfma_f32_32x32x16_bf16 v[156:171], v[200:203], v[48:51], v[156:171]
  ds_read_b64_tr_b16 v[196:197], v13 offset:13312
  ds_read_b64_tr_b16 v[198:199], v13 offset:16384
  v_cvt_pk_bf16_f32 v175, v178, v179
  v_cvt_pk_bf16_f32 v176, v180, v181
  s_add_u32 s31, s23, 6
  s_and_b32 s31, s31, 7
  s_lshl_b32 s31, s31, 7
  s_waitcnt lgkmcnt(6)
  v_mfma_f32_32x32x16_bf16 v[156:171], v[252:255], v[52:55], v[156:171]
  ds_read_b64_tr_b16 v[200:201], v13 offset:14336
  ds_read_b64_tr_b16 v[202:203], v13 offset:17408
  v_cvt_pk_bf16_f32 v177, v182, v183
  v_cvt_pk_bf16_f32 v178, v184, v185
  s_add_u32 s27, s27, 54272
  buffer_load_dwordx4 v15, s[4:7], s27 offen offset:1024 lds
  s_mul_i32 s25, s23, 663552
  s_add_u32 s31, s31, s25
  s_waitcnt lgkmcnt(6)
  v_mfma_f32_32x32x16_bf16 v[156:171], v[188:191], v[56:59], v[156:171]
  ds_read_b64_tr_b16 v[252:253], v14 offset:12288
  ds_read_b64_tr_b16 v[254:255], v14 offset:15360
  v_cvt_pk_bf16_f32 v179, v186, v187
  s_waitcnt lgkmcnt(6)
  v_mfma_f32_32x32x16_bf16 v[156:171], v[192:195], v[212:215], v[156:171]
  ds_read_b64_tr_b16 v[188:189], v14 offset:13312
  ds_read_b64_tr_b16 v[190:191], v14 offset:16384
  v_permlane32_swap_b32 v172, v174
  v_permlane32_swap_b32 v173, v175
  s_add_u32 s27, s27, 17408
  buffer_load_dwordx4 v15, s[4:7], s27 offen offset:2048 lds
  s_waitcnt vmcnt(10)
  v_mfma_f32_32x32x16_bf16 v[140:155], v[128:131], v[116:119], v[140:155]
  v_mfma_f32_32x32x16_bf16 v[140:155], v[132:135], v[120:123], v[140:155]
  s_waitcnt lgkmcnt(6)
  v_mfma_f32_32x32x16_bf16 v[156:171], v[196:199], v[216:219], v[156:171]
  ds_read_b64_tr_b16 v[192:193], v14 offset:14336
  ds_read_b64_tr_b16 v[194:195], v14 offset:17408
  buffer_store_dwordx4 v[172:175], v4, s[12:15], s32 offen sc1
  s_add_u32 s32, s32, 65536
  s_waitcnt lgkmcnt(6)
  v_mfma_f32_32x32x16_bf16 v[156:171], v[200:203], v[220:223], v[156:171]
  s_waitcnt vmcnt(7)
  s_barrier
  ds_read_b64_tr_b16 v[196:197], v13 offset:24576
  ds_read_b64_tr_b16 v[198:199], v13 offset:27648
  v_permlane32_swap_b32 v176, v178
  v_permlane32_swap_b32 v177, v179
  s_add_u32 m0, s28, 0
  s_mov_b32 s27, s31
  buffer_load_dwordx4 v15, s[4:7], s27 offen offset:0 lds
  s_waitcnt lgkmcnt(6)
  v_mfma_f32_32x32x16_bf16 v[156:171], v[252:255], v[60:63], v[156:171]
  ds_read_b64_tr_b16 v[200:201], v13 offset:25600
  ds_read_b64_tr_b16 v[202:203], v13 offset:28672
  buffer_store_dwordx4 v[176:179], v4, s[12:15], s32 offen sc1
  s_waitcnt lgkmcnt(6)
  v_mfma_f32_32x32x16_bf16 v[156:171], v[188:191], v[64:67], v[156:171]
  ds_read_b64_tr_b16 v[252:253], v13 offset:26624
  ds_read_b64_tr_b16 v[254:255], v13 offset:29696
  s_add_u32 s27, s27, 17408
  buffer_load_dwordx4 v15, s[4:7], s27 offen offset:1024 lds
  s_sub_u32 s34, s23, 3
  s_and_b32 s34, s34, 7
  s_lshl_b32 s34, s34, 4
  s_lshl_b32 s29, s23, 7
  s_waitcnt lgkmcnt(6)
  v_mfma_f32_32x32x16_bf16 v[156:171], v[192:195], v[68:71], v[156:171]
  ds_read_b64_tr_b16 v[188:189], v14 offset:24576
  ds_read_b64_tr_b16 v[190:191], v14 offset:27648
  s_add_u32 s34, s34, s29
  s_add_u32 s34, s34, s39
  buffer_load_dword v11, v6, s[12:15], s34 offen sc1
  s_waitcnt lgkmcnt(6)
  v_mfma_f32_32x32x16_bf16 v[156:171], v[196:199], v[224:227], v[156:171]
  ds_read_b64_tr_b16 v[192:193], v14 offset:25600
  ds_read_b64_tr_b16 v[194:195], v14 offset:28672
  s_add_u32 s27, s27, 54272
  buffer_load_dwordx4 v15, s[4:7], s27 offen offset:2048 lds
  v_lshrrev_b32 v18, 3, v1
  v_lshrrev_b32 v19, 2, v18
  s_waitcnt lgkmcnt(6)
  v_mfma_f32_32x32x16_bf16 v[156:171], v[200:203], v[228:231], v[156:171]
  ds_read_b64_tr_b16 v[196:197], v14 offset:26624
  ds_read_b64_tr_b16 v[198:199], v14 offset:29696
  v_mul_u32_u24 v19, 68, v19
  v_add_u32 v19, v19, v18
  s_waitcnt lgkmcnt(6)
  v_mfma_f32_32x32x16_bf16 v[156:171], v[252:255], v[232:235], v[156:171]
  s_waitcnt vmcnt(9)
  s_barrier
  ds_read_b64_tr_b16 v[200:201], v13 offset:36864
  ds_read_b64_tr_b16 v[202:203], v13 offset:39936
  s_add_u32 m0, s28, 12288
  s_add_u32 s27, s27, 20480
  buffer_load_dwordx4 v15, s[4:7], s27 offen offset:0 lds
  v_and_b32 v18, 2, v18
  v_lshl_add_u32 v19, v18, 3, v19
  s_waitcnt lgkmcnt(6)
  v_mfma_f32_32x32x16_bf16 v[156:171], v[188:191], v[72:75], v[156:171]
  ds_read_b64_tr_b16 v[252:253], v13 offset:37888
  ds_read_b64_tr_b16 v[254:255], v13 offset:40960
  v_mul_u32_u24 v19, 1152, v19
  v_lshlrev_b32 v18, 1, v18
  s_waitcnt lgkmcnt(6)
  v_mfma_f32_32x32x16_bf16 v[156:171], v[192:195], v[76:79], v[156:171]
  ds_read_b64_tr_b16 v[188:189], v13 offset:38912
  ds_read_b64_tr_b16 v[190:191], v13 offset:41984
  s_add_u32 s27, s27, 54272
  buffer_load_dwordx4 v15, s[4:7], s27 offen offset:1024 lds
  v_xor_b32 v18, v18, v1
  v_and_b32 v18, 7, v18
  s_waitcnt lgkmcnt(6)
  v_mfma_f32_32x32x16_bf16 v[156:171], v[196:199], v[80:83], v[156:171]
  ds_read_b64_tr_b16 v[192:193], v14 offset:36864
  ds_read_b64_tr_b16 v[194:195], v14 offset:39936
  v_lshl_add_u32 v19, v18, 4, v19
  v_mov_b32 v18, s22
  s_waitcnt lgkmcnt(6)
  v_mfma_f32_32x32x16_bf16 v[156:171], v[200:203], v[236:239], v[156:171]
  ds_read_b64_tr_b16 v[196:197], v14 offset:37888
  ds_read_b64_tr_b16 v[198:199], v14 offset:40960
  s_add_u32 s27, s27, 17408
  buffer_load_dwordx4 v15, s[4:7], s27 offen offset:2048 lds
  v_cmp_eq_u32 vcc, 1, v18
  s_nop 1
  v_cndmask_b32 v2, v15, v19, vcc
  s_mul_i32 s36, s21, 41472
  s_waitcnt lgkmcnt(6)
  v_mfma_f32_32x32x16_bf16 v[156:171], v[252:255], v[240:243], v[156:171]
  ds_read_b64_tr_b16 v[200:201], v14 offset:38912
  ds_read_b64_tr_b16 v[202:203], v14 offset:41984
  s_add_u32 s36, s36, 18432
  s_cmp_eq_u32 s22, 1
  s_cselect_b32 s36, s36, 290304
  s_mov_b32 s37, 19712
  s_cselect_b32 s37, 164864, s37
  s_waitcnt lgkmcnt(6)
  v_mfma_f32_32x32x16_bf16 v[156:171], v[188:191], v[244:247], v[156:171]
  s_waitcnt vmcnt(9)
  s_barrier
  ds_read_b64_tr_b16 v[252:253], v13 offset:49152
  ds_read_b64_tr_b16 v[254:255], v13 offset:52224
  s_add_u32 m0, s28, 24576
  s_add_u32 s27, s27, 57344
  buffer_load_dwordx4 v15, s[4:7], s27 offen offset:0 lds
  s_lshl_b32 s25, s23, 7
  s_add_u32 s36, s36, s25
  s_waitcnt lgkmcnt(6)
  v_mfma_f32_32x32x16_bf16 v[156:171], v[192:195], v[84:87], v[156:171]
  ds_read_b64_tr_b16 v[188:189], v13 offset:50176
  ds_read_b64_tr_b16 v[190:191], v13 offset:53248
  s_sub_u32 s36, s36, 2048
  s_mov_b32 s8, s48
  s_waitcnt lgkmcnt(6)
  v_mfma_f32_32x32x16_bf16 v[156:171], v[196:199], v[88:91], v[156:171]
  ds_read_b64_tr_b16 v[192:193], v13 offset:51200
  ds_read_b64_tr_b16 v[194:195], v13 offset:54272
  s_add_u32 s27, s27, 17408
  buffer_load_dwordx4 v15, s[4:7], s27 offen offset:1024 lds
  s_mov_b32 s9, s49
  s_mov_b32 s10, 663552
  s_waitcnt lgkmcnt(6)
  v_mfma_f32_32x32x16_bf16 v[156:171], v[200:203], v[92:95], v[156:171]
  ds_read_b64_tr_b16 v[196:197], v14 offset:49152
  ds_read_b64_tr_b16 v[198:199], v14 offset:52224
  s_waitcnt lgkmcnt(6)
  v_mfma_f32_32x32x16_bf16 v[156:171], v[252:255], v[248:251], v[156:171]
  ds_read_b64_tr_b16 v[200:201], v14 offset:50176
  ds_read_b64_tr_b16 v[202:203], v14 offset:53248
  s_add_u32 s27, s27, 54272
  buffer_load_dwordx4 v15, s[4:7], s27 offen offset:2048 lds
  s_waitcnt vmcnt(7)
  v_lshrrev_b32 v18, 30, v6
  v_or_b32 v19, v18, v11
  v_cmp_ne_u32 vcc, 1, v19
  s_cbranch_vccz Lfok_49
  s_mov_b32 s26, 0
Lfwait_50:
  s_sleep 2
  buffer_load_dword v11, v6, s[12:15], s34 offen sc1
  s_add_u32 s26, s26, 1
  s_waitcnt vmcnt(0)
  v_or_b32 v19, v18, v11
  v_cmp_ne_u32 vcc, 1, v19
  s_cbranch_vccz Lfok_49
  s_cmp_lt_u32 s26, 0x40000
  s_cbranch_scc1 Lfwait_50
Lfok_49:
  s_sub_u32 s29, s23, 3
  s_and_b32 s29, s29, 7
  s_mul_i32 s29, s29, 2359296
  s_lshl_b32 s35, s23, 18
  s_add_u32 s35, s35, s46
  s_add_u32 s35, s35, s29
  buffer_load_dwordx4 v[116:119], v4, s[12:15], s35 offen sc1
  s_add_u32 s35, s35, 65536
  buffer_load_dwordx4 v[120:123], v4, s[12:15], s35 offen sc1
  s_waitcnt lgkmcnt(6)
  v_mfma_f32_32x32x16_bf16 v[156:171], v[188:191], v[100:103], v[156:171]
  ds_read_b64_tr_b16 v[252:253], v14 offset:51200
  ds_read_b64_tr_b16 v[254:255], v14 offset:54272
  s_add_u32 s25, s23, 4
  s_and_b32 s25, s25, 7
  s_waitcnt lgkmcnt(6)
  v_mfma_f32_32x32x16_bf16 v[156:171], v[192:195], v[104:107], v[156:171]
  s_waitcnt vmcnt(8)
  s_barrier
  ds_read_b64_tr_b16 v[188:189], v13 offset:0
  ds_read_b64_tr_b16 v[190:191], v13 offset:3072
  s_add_u32 m0, s28, 36864
  s_add_u32 s27, s27, 20480
  buffer_load_dwordx4 v15, s[4:7], s27 offen offset:0 lds
  s_lshl_b32 s25, s25, 7
  s_add_u32 s25, s25, s33
  buffer_store_dword v16, v17, s[12:15], s25 offen sc1
  s_waitcnt lgkmcnt(6)
  v_mfma_f32_32x32x16_bf16 v[156:171], v[196:199], v[96:99], v[156:171]
  ds_read_b64_tr_b16 v[192:193], v13 offset:1024
  ds_read_b64_tr_b16 v[194:195], v13 offset:4096
  s_waitcnt lgkmcnt(6)
  v_mfma_f32_32x32x16_bf16 v[156:171], v[200:203], v[108:111], v[156:171]
  ds_read_b64_tr_b16 v[196:197], v13 offset:2048
  ds_read_b64_tr_b16 v[198:199], v13 offset:5120
  s_add_u32 s27, s27, 54272
  buffer_load_dwordx4 v15, s[4:7], s27 offen offset:1024 lds
  s_waitcnt lgkmcnt(6)
  v_mfma_f32_32x32x16_bf16 v[156:171], v[252:255], v[112:115], v[156:171]
  ds_read_b64_tr_b16 v[200:201], v14 offset:0
  ds_read_b64_tr_b16 v[202:203], v14 offset:3072
  s_waitcnt lgkmcnt(6)
  v_mfma_f32_32x32x16_bf16 v[172:187], v[188:191], v[20:23], 0
  ds_read_b64_tr_b16 v[252:253], v14 offset:1024
  ds_read_b64_tr_b16 v[254:255], v14 offset:4096
  s_add_u32 s27, s27, 17408
  buffer_load_dwordx4 v15, s[4:7], s27 offen offset:2048 lds
  s_waitcnt lgkmcnt(6)
  v_mfma_f32_32x32x16_bf16 v[172:187], v[192:195], v[24:27], v[172:187]
  ds_read_b64_tr_b16 v[188:189], v14 offset:2048
  ds_read_b64_tr_b16 v[190:191], v14 offset:5120
  s_waitcnt lgkmcnt(6)
  v_mfma_f32_32x32x16_bf16 v[172:187], v[196:199], v[28:31], v[172:187]
  s_waitcnt vmcnt(9)
  s_barrier
  ds_read_b64_tr_b16 v[192:193], v13 offset:12288
  ds_read_b64_tr_b16 v[194:195], v13 offset:15360
  s_add_u32 m0, s28, 49152
  s_add_u32 s27, s27, 57344
  buffer_load_dwordx4 v15, s[4:7], s27 offen offset:0 lds
  s_waitcnt lgkmcnt(6)
  v_mfma_f32_32x32x16_bf16 v[172:187], v[200:203], v[36:39], v[172:187]
  ds_read_b64_tr_b16 v[196:197], v13 offset:13312
  ds_read_b64_tr_b16 v[198:199], v13 offset:16384
  s_waitcnt lgkmcnt(6)
  v_mfma_f32_32x32x16_bf16 v[172:187], v[252:255], v[40:43], v[172:187]
  ds_read_b64_tr_b16 v[200:201], v13 offset:14336
  ds_read_b64_tr_b16 v[202:203], v13 offset:17408
  s_add_u32 s32, s23, 5
  s_and_b32 s32, s32, 7
  s_add_u32 s27, s27, 17408
  buffer_load_dwordx4 v15, s[4:7], s27 offen offset:1024 lds
  s_waitcnt lgkmcnt(6)
  v_mfma_f32_32x32x16_bf16 v[172:187], v[188:191], v[44:47], v[172:187]
  ds_read_b64_tr_b16 v[252:253], v14 offset:12288
  ds_read_b64_tr_b16 v[254:255], v14 offset:15360
  s_lshl_b32 s32, s32, 18
  s_add_u32 s32, s32, s46
  s_waitcnt lgkmcnt(6)
  v_mfma_f32_32x32x16_bf16 v[172:187], v[192:195], v[32:35], v[172:187]
  ds_read_b64_tr_b16 v[188:189], v14 offset:13312
  ds_read_b64_tr_b16 v[190:191], v14 offset:16384
  s_mul_i32 s26, s23, 2359296
  s_add_u32 s32, s32, s26
  s_add_u32 s27, s27, 54272
  buffer_load_dwordx4 v15, s[4:7], s27 offen offset:2048 lds
  s_waitcnt lgkmcnt(6)
  v_mfma_f32_32x32x16_bf16 v[172:187], v[196:199], v[204:207], v[172:187]
  ds_read_b64_tr_b16 v[192:193], v14 offset:14336
  ds_read_b64_tr_b16 v[194:195], v14 offset:17408
  v_cvt_pk_bf16_f32 v156, v156, v157
  s_waitcnt lgkmcnt(6)
  v_mfma_f32_32x32x16_bf16 v[172:187], v[200:203], v[208:211], v[172:187]
  s_waitcnt vmcnt(9)
  s_barrier
  ds_read_b64_tr_b16 v[196:197], v13 offset:24576
  ds_read_b64_tr_b16 v[198:199], v13 offset:27648
  v_cvt_pk_bf16_f32 v157, v158, v159
  v_cvt_pk_bf16_f32 v158, v160, v161
  s_add_u32 m0, s28, 0
  s_add_u32 s27, s27, 20480
  buffer_load_dwordx4 v15, s[4:7], s27 offen offset:0 lds
  s_waitcnt lgkmcnt(6)
  v_mfma_f32_32x32x16_bf16 v[172:187], v[252:255], v[48:51], v[172:187]
  ds_read_b64_tr_b16 v[200:201], v13 offset:25600
  ds_read_b64_tr_b16 v[202:203], v13 offset:28672
  v_cvt_pk_bf16_f32 v159, v162, v163
  v_cvt_pk_bf16_f32 v160, v164, v165
  s_add_u32 s31, s23, 7
  s_and_b32 s31, s31, 7
  s_lshl_b32 s31, s31, 7
  s_waitcnt lgkmcnt(6)
  v_mfma_f32_32x32x16_bf16 v[172:187], v[188:191], v[52:55], v[172:187]
  ds_read_b64_tr_b16 v[252:253], v13 offset:26624
  ds_read_b64_tr_b16 v[254:255], v13 offset:29696
  v_cvt_pk_bf16_f32 v161, v166, v167
  v_cvt_pk_bf16_f32 v162, v168, v169
  s_add_u32 s27, s27, 54272
  buffer_load_dwordx4 v15, s[4:7], s27 offen offset:1024 lds
  s_mul_i32 s25, s23, 663552
  s_add_u32 s31, s31, s25
  s_waitcnt lgkmcnt(6)
  v_mfma_f32_32x32x16_bf16 v[172:187], v[192:195], v[56:59], v[172:187]
  ds_read_b64_tr_b16 v[188:189], v14 offset:24576
  ds_read_b64_tr_b16 v[190:191], v14 offset:27648
  v_cvt_pk_bf16_f32 v163, v170, v171
  s_waitcnt lgkmcnt(6)
  v_mfma_f32_32x32x16_bf16 v[172:187], v[196:199], v[212:215], v[172:187]
  ds_read_b64_tr_b16 v[192:193], v14 offset:25600
  ds_read_b64_tr_b16 v[194:195], v14 offset:28672
  v_permlane32_swap_b32 v156, v158
  v_permlane32_swap_b32 v157, v159
  s_add_u32 s27, s27, 17408
  buffer_load_dwordx4 v15, s[4:7], s27 offen offset:2048 lds
  s_waitcnt vmcnt(10)
  v_mfma_f32_32x32x16_bf16 v[140:155], v[128:131], v[116:119], v[140:155]
  v_mfma_f32_32x32x16_bf16 v[140:155], v[132:135], v[120:123], v[140:155]
  s_waitcnt lgkmcnt(6)
  v_mfma_f32_32x32x16_bf16 v[172:187], v[200:203], v[216:219], v[172:187]
  ds_read_b64_tr_b16 v[196:197], v14 offset:26624
  ds_read_b64_tr_b16 v[198:199], v14 offset:29696
  buffer_store_dwordx4 v[156:159], v4, s[12:15], s32 offen sc1
  s_add_u32 s32, s32, 65536
  s_waitcnt lgkmcnt(6)
  v_mfma_f32_32x32x16_bf16 v[172:187], v[252:255], v[220:223], v[172:187]
  s_waitcnt vmcnt(7)
  s_barrier
  ds_read_b64_tr_b16 v[200:201], v13 offset:36864
  ds_read_b64_tr_b16 v[202:203], v13 offset:39936
  v_permlane32_swap_b32 v160, v162
  v_permlane32_swap_b32 v161, v163
  s_add_u32 m0, s28, 12288
  s_mov_b32 s27, s31
  buffer_load_dwordx4 v15, s[4:7], s27 offen offset:0 lds
  s_waitcnt lgkmcnt(6)
  v_mfma_f32_32x32x16_bf16 v[172:187], v[188:191], v[60:63], v[172:187]
  ds_read_b64_tr_b16 v[252:253], v13 offset:37888
  ds_read_b64_tr_b16 v[254:255], v13 offset:40960
  buffer_store_dwordx4 v[160:163], v4, s[12:15], s32 offen sc1
  s_waitcnt lgkmcnt(6)
  v_mfma_f32_32x32x16_bf16 v[172:187], v[192:195], v[64:67], v[172:187]
  ds_read_b64_tr_b16 v[188:189], v13 offset:38912
  ds_read_b64_tr_b16 v[190:191], v13 offset:41984
  s_add_u32 s27, s27, 17408
  buffer_load_dwordx4 v15, s[4:7], s27 offen offset:1024 lds
  s_sub_u32 s34, s23, 4
  s_and_b32 s34, s34, 7
  s_lshl_b32 s34, s34, 4
  s_lshl_b32 s29, s23, 7
  s_waitcnt lgkmcnt(6)
  v_mfma_f32_32x32x16_bf16 v[172:187], v[196:199], v[68:71], v[172:187]
  ds_read_b64_tr_b16 v[192:193], v14 offset:36864
  ds_read_b64_tr_b16 v[194:195], v14 offset:39936
  s_add_u32 s34, s34, s29
  s_add_u32 s34, s34, s39
  buffer_load_dword v11, v6, s[12:15], s34 offen sc1
  s_waitcnt lgkmcnt(6)
  v_mfma_f32_32x32x16_bf16 v[172:187], v[200:203], v[224:227], v[172:187]
  ds_read_b64_tr_b16 v[196:197], v14 offset:37888
  ds_read_b64_tr_b16 v[198:199], v14 offset:40960
  s_add_u32 s27, s27, 54272
  buffer_load_dwordx4 v15, s[4:7], s27 offen offset:2048 lds
  s_waitcnt lgkmcnt(6)
  v_mfma_f32_32x32x16_bf16 v[172:187], v[252:255], v[228:231], v[172:187]
  ds_read_b64_tr_b16 v[200:201], v14 offset:38912
  ds_read_b64_tr_b16 v[202:203], v14 offset:41984
  s_waitcnt lgkmcnt(6)
  v_mfma_f32_32x32x16_bf16 v[172:187], v[188:191], v[232:235], v[172:187]
  s_waitcnt vmcnt(9)
  s_barrier
  ds_read_b64_tr_b16 v[252:253], v13 offset:49152
  ds_read_b64_tr_b16 v[254:255], v13 offset:52224
  s_add_u32 m0, s28, 24576
  s_add_u32 s27, s27, 20480
  buffer_load_dwordx4 v15, s[4:7], s27 offen offset:0 lds
  s_waitcnt lgkmcnt(6)
  v_mfma_f32_32x32x16_bf16 v[172:187], v[192:195], v[72:75], v[172:187]
  ds_read_b64_tr_b16 v[188:189], v13 offset:50176
  ds_read_b64_tr_b16 v[190:191], v13 offset:53248
  s_waitcnt lgkmcnt(6)
  v_mfma_f32_32x32x16_bf16 v[172:187], v[196:199], v[76:79], v[172:187]
  ds_read_b64_tr_b16 v[192:193], v13 offset:51200
  ds_read_b64_tr_b16 v[194:195], v13 offset:54272
  s_add_u32 s27, s27, 54272
  buffer_load_dwordx4 v15, s[4:7], s27 offen offset:1024 lds
  s_waitcnt lgkmcnt(6)
  v_mfma_f32_32x32x16_bf16 v[172:187], v[200:203], v[80:83], v[172:187]
  ds_read_b64_tr_b16 v[196:197], v14 offset:49152
  ds_read_b64_tr_b16 v[198:199], v14 offset:52224
  s_waitcnt lgkmcnt(6)
  v_mfma_f32_32x32x16_bf16 v[172:187], v[252:255], v[236:239], v[172:187]
  ds_read_b64_tr_b16 v[200:201], v14 offset:50176
  ds_read_b64_tr_b16 v[202:203], v14 offset:53248
  s_add_u32 s27, s27, 17408
  buffer_load_dwordx4 v15, s[4:7], s27 offen offset:2048 lds
  s_waitcnt lgkmcnt(6)
  v_mfma_f32_32x32x16_bf16 v[172:187], v[188:191], v[240:243], v[172:187]
  ds_read_b64_tr_b16 v[252:253], v14 offset:51200
  ds_read_b64_tr_b16 v[254:255], v14 offset:54272
  s_waitcnt lgkmcnt(6)
  v_mfma_f32_32x32x16_bf16 v[172:187], v[192:195], v[244:247], v[172:187]
  s_waitcnt vmcnt(9)
  s_barrier
  ds_read_b64_tr_b16 v[188:189], v13 offset:0
  ds_read_b64_tr_b16 v[190:191], v13 offset:3072
  s_add_u32 m0, s28, 36864
  s_add_u32 s27, s27, 57344
  buffer_load_dwordx4 v15, s[4:7], s27 offen offset:0 lds
  s_waitcnt lgkmcnt(6)
  v_mfma_f32_32x32x16_bf16 v[172:187], v[196:199], v[84:87], v[172:187]
  ds_read_b64_tr_b16 v[192:193], v13 offset:1024
  ds_read_b64_tr_b16 v[194:195], v13 offset:4096
  s_waitcnt lgkmcnt(6)
  v_mfma_f32_32x32x16_bf16 v[172:187], v[200:203], v[88:91], v[172:187]
  ds_read_b64_tr_b16 v[196:197], v13 offset:2048
  ds_read_b64_tr_b16 v[198:199], v13 offset:5120
  s_add_u32 s27, s27, 17408
  buffer_load_dwordx4 v15, s[4:7], s27 offen offset:1024 lds
  s_waitcnt lgkmcnt(6)
  v_mfma_f32_32x32x16_bf16 v[172:187], v[252:255], v[92:95], v[172:187]
  ds_read_b64_tr_b16 v[200:201], v14 offset:0
  ds_read_b64_tr_b16 v[202:203], v14 offset:3072
  s_waitcnt lgkmcnt(6)
  v_mfma_f32_32x32x16_bf16 v[172:187], v[188:191], v[248:251], v[172:187]
  ds_read_b64_tr_b16 v[252:253], v14 offset:1024
  ds_read_b64_tr_b16 v[254:255], v14 offset:4096
  s_add_u32 s27, s27, 54272
  buffer_load_dwordx4 v15, s[4:7], s27 offen offset:2048 lds
  s_waitcnt vmcnt(7)
  v_lshrrev_b32 v18, 30, v6
  v_or_b32 v19, v18, v11
  v_cmp_ne_u32 vcc, 1, v19
  s_cbranch_vccz Lfok_51
  s_mov_b32 s26, 0
Lfwait_52:
  s_sleep 2
  buffer_load_dword v11, v6, s[12:15], s34 offen sc1
  s_add_u32 s26, s26, 1
  s_waitcnt vmcnt(0)
  v_or_b32 v19, v18, v11
  v_cmp_ne_u32 vcc, 1, v19
  s_cbranch_vccz Lfok_51
  s_cmp_lt_u32 s26, 0x40000
  s_cbranch_scc1 Lfwait_52
Lfok_51:
  s_sub_u32 s29, s23, 4
  s_and_b32 s29, s29, 7
  s_mul_i32 s29, s29, 2359296
  s_lshl_b32 s35, s23, 18
  s_add_u32 s35, s35, s46
  s_add_u32 s35, s35, s29
  buffer_load_dwordx4 v[116:119], v4, s[12:15], s35 offen sc1
  s_add_u32 s35, s35, 65536
  buffer_load_dwordx4 v[120:123], v4, s[12:15], s35 offen sc1
  s_waitcnt lgkmcnt(6)
  v_mfma_f32_32x32x16_bf16 v[172:187], v[192:195], v[100:103], v[172:187]
  ds_read_b64_tr_b16 v[188:189], v14 offset:2048
  ds_read_b64_tr_b16 v[190:191], v14 offset:5120
  s_add_u32 s25, s23, 5
  s_and_b32 s25, s25, 7
  s_waitcnt lgkmcnt(6)
  v_mfma_f32_32x32x16_bf16 v[172:187], v[196:199], v[104:107], v[172:187]
  s_waitcnt vmcnt(8)
  s_barrier
  ds_read_b64_tr_b16 v[192:193], v13 offset:12288
  ds_read_b64_tr_b16 v[194:195], v13 offset:15360
  s_add_u32 m0, s28, 49152
  s_add_u32 s27, s27, 20480
  buffer_load_dwordx4 v15, s[4:7], s27 offen offset:0 lds
  s_lshl_b32 s25, s25, 7
  s_add_u32 s25, s25, s33
  buffer_store_dword v16, v17, s[12:15], s25 offen sc1
  s_waitcnt lgkmcnt(6)
  v_mfma_f32_32x32x16_bf16 v[172:187], v[200:203], v[96:99], v[172:187]
  ds_read_b64_tr_b16 v[196:197], v13 offset:13312
  ds_read_b64_tr_b16 v[198:199], v13 offset:16384
  s_waitcnt lgkmcnt(6)
  v_mfma_f32_32x32x16_bf16 v[172:187], v[252:255], v[108:111], v[172:187]
  ds_read_b64_tr_b16 v[200:201], v13 offset:14336
  ds_read_b64_tr_b16 v[202:203], v13 offset:17408
  s_add_u32 s27, s27, 54272
  buffer_load_dwordx4 v15, s[4:7], s27 offen offset:1024 lds
  s_waitcnt lgkmcnt(6)
  v_mfma_f32_32x32x16_bf16 v[172:187], v[188:191], v[112:115], v[172:187]
  ds_read_b64_tr_b16 v[252:253], v14 offset:12288
  ds_read_b64_tr_b16 v[254:255], v14 offset:15360
  s_waitcnt lgkmcnt(6)
  v_mfma_f32_32x32x16_bf16 v[156:171], v[192:195], v[20:23], 0
  ds_read_b64_tr_b16 v[188:189], v14 offset:13312
  ds_read_b64_tr_b16 v[190:191], v14 offset:16384
  s_add_u32 s27, s27, 17408
  buffer_load_dwordx4 v15, s[4:7], s27 offen offset:2048 lds
  s_waitcnt lgkmcnt(6)
  v_mfma_f32_32x32x16_bf16 v[156:171], v[196:199], v[24:27], v[156:171]
  ds_read_b64_tr_b16 v[192:193], v14 offset:14336
  ds_read_b64_tr_b16 v[194:195], v14 offset:17408
  s_waitcnt lgkmcnt(6)
  v_mfma_f32_32x32x16_bf16 v[156:171], v[200:203], v[28:31], v[156:171]
  s_waitcnt vmcnt(9)
  s_barrier
  ds_read_b64_tr_b16 v[196:197], v13 offset:24576
  ds_read_b64_tr_b16 v[198:199], v13 offset:27648
  s_add_u32 m0, s28, 0
  s_add_u32 s27, s27, 57344
  buffer_load_dwordx4 v15, s[4:7], s27 offen offset:0 lds
  s_add_u32 s47, s39, 1024
  buffer_load_dword v124, v5, s[12:15], s47 offen sc1
  s_waitcnt lgkmcnt(6)
  v_mfma_f32_32x32x16_bf16 v[156:171], v[252:255], v[36:39], v[156:171]
  ds_read_b64_tr_b16 v[200:201], v13 offset:25600
  ds_read_b64_tr_b16 v[202:203], v13 offset:28672
  s_waitcnt lgkmcnt(6)
  v_mfma_f32_32x32x16_bf16 v[156:171], v[188:191], v[40:43], v[156:171]
  ds_read_b64_tr_b16 v[252:253], v13 offset:26624
  ds_read_b64_tr_b16 v[254:255], v13 offset:29696
  s_add_u32 s32, s23, 6
  s_and_b32 s32, s32, 7
  s_add_u32 s27, s27, 17408
  buffer_load_dwordx4 v15, s[4:7], s27 offen offset:1024 lds
  s_waitcnt lgkmcnt(6)
  v_mfma_f32_32x32x16_bf16 v[156:171], v[192:195], v[44:47], v[156:171]
  ds_read_b64_tr_b16 v[188:189], v14 offset:24576
  ds_read_b64_tr_b16 v[190:191], v14 offset:27648
  s_lshl_b32 s32, s32, 18
  s_add_u32 s32, s32, s46
  s_waitcnt lgkmcnt(6)
  v_mfma_f32_32x32x16_bf16 v[156:171], v[196:199], v[32:35], v[156:171]
  ds_read_b64_tr_b16 v[192:193], v14 offset:25600
  ds_read_b64_tr_b16 v[194:195], v14 offset:28672
  s_mul_i32 s26, s23, 2359296
  s_add_u32 s32, s32, s26
  s_add_u32 s27, s27, 54272
  buffer_load_dwordx4 v15, s[4:7], s27 offen offset:2048 lds
  s_waitcnt lgkmcnt(6)
  v_mfma_f32_32x32x16_bf16 v[156:171], v[200:203], v[204:207], v[156:171]
  ds_read_b64_tr_b16 v[196:197], v14 offset:26624
  ds_read_b64_tr_b16 v[198:199], v14 offset:29696
  v_cvt_pk_bf16_f32 v172, v172, v173
  s_waitcnt lgkmcnt(6)
  v_mfma_f32_32x32x16_bf16 v[156:171], v[252:255], v[208:211], v[156:171]
  s_waitcnt vmcnt(10)
  s_barrier
  ds_read_b64_tr_b16 v[200:201], v13 offset:36864
  ds_read_b64_tr_b16 v[202:203], v13 offset:39936
  v_cvt_pk_bf16_f32 v173, v174, v175
  v_cvt_pk_bf16_f32 v174, v176, v177
  s_add_u32 m0, s28, 12288
  s_add_u32 s27, s27, 20480
  buffer_load_dwordx4 v15, s[4:7], s27 offen offset:0 lds
  s_waitcnt lgkmcnt(6)
  v_mfma_f32_32x32x16_bf16 v[156:171], v[188:191], v[48:51], v[156:171]
  ds_read_b64_tr_b16 v[252:253], v13 offset:37888
  ds_read_b64_tr_b16 v[254:255], v13 offset:40960
  v_cvt_pk_bf16_f32 v175, v178, v179
  v_cvt_pk_bf16_f32 v176, v180, v181
  s_add_u32 s31, s23, 0
  s_and_b32 s31, s31, 7
  s_lshl_b32 s31, s31, 7
  s_waitcnt lgkmcnt(6)
  v_mfma_f32_32x32x16_bf16 v[156:171], v[192:195], v[52:55], v[156:171]
  ds_read_b64_tr_b16 v[188:189], v13 offset:38912
  ds_read_b64_tr_b16 v[190:191], v13 offset:41984
  v_cvt_pk_bf16_f32 v177, v182, v183
  v_cvt_pk_bf16_f32 v178, v184, v185
  s_add_u32 s27, s27, 54272
  buffer_load_dwordx4 v15, s[4:7], s27 offen offset:1024 lds
  s_mul_i32 s25, s23, 663552
  s_add_u32 s31, s31, s25
  s_waitcnt lgkmcnt(6)
  v_mfma_f32_32x32x16_bf16 v[156:171], v[196:199], v[56:59], v[156:171]
  ds_read_b64_tr_b16 v[192:193], v14 offset:36864
  ds_read_b64_tr_b16 v[194:195], v14 offset:39936
  v_cvt_pk_bf16_f32 v179, v186, v187
  s_waitcnt lgkmcnt(6)
  v_mfma_f32_32x32x16_bf16 v[156:171], v[200:203], v[212:215], v[156:171]
  ds_read_b64_tr_b16 v[196:197], v14 offset:37888
  ds_read_b64_tr_b16 v[198:199], v14 offset:40960
  v_permlane32_swap_b32 v172, v174
  v_permlane32_swap_b32 v173, v175
  s_add_u32 s27, s27, 17408
  buffer_load_dwordx4 v15, s[4:7], s27 offen offset:2048 lds
  s_waitcnt vmcnt(11)
  v_mfma_f32_32x32x16_bf16 v[140:155], v[128:131], v[116:119], v[140:155]
  v_mfma_f32_32x32x16_bf16 v[140:155], v[132:135], v[120:123], v[140:155]
  s_waitcnt lgkmcnt(6)
  v_mfma_f32_32x32x16_bf16 v[156:171], v[252:255], v[216:219], v[156:171]
  ds_read_b64_tr_b16 v[200:201], v14 offset:38912
  ds_read_b64_tr_b16 v[202:203], v14 offset:41984
  buffer_store_dwordx4 v[172:175], v4, s[12:15], s32 offen sc1
  s_add_u32 s32, s32, 65536
  s_waitcnt lgkmcnt(6)
  v_mfma_f32_32x32x16_bf16 v[156:171], v[188:191], v[220:223], v[156:171]
  s_waitcnt vmcnt(8)
  s_barrier
  ds_read_b64_tr_b16 v[252:253], v13 offset:49152
  ds_read_b64_tr_b16 v[254:255], v13 offset:52224
  v_permlane32_swap_b32 v176, v178
  v_permlane32_swap_b32 v177, v179
  s_add_u32 m0, s28, 24576
  s_mov_b32 s27, s31
  buffer_load_dwordx4 v15, s[4:7], s27 offen offset:0 lds
  s_waitcnt lgkmcnt(6)
  v_mfma_f32_32x32x16_bf16 v[156:171], v[192:195], v[60:63], v[156:171]
  ds_read_b64_tr_b16 v[188:189], v13 offset:50176
  ds_read_b64_tr_b16 v[190:191], v13 offset:53248
  buffer_store_dwordx4 v[176:179], v4, s[12:15], s32 offen sc1
  s_waitcnt lgkmcnt(6)
  v_mfma_f32_32x32x16_bf16 v[156:171], v[196:199], v[64:67], v[156:171]
  ds_read_b64_tr_b16 v[192:193], v13 offset:51200
  ds_read_b64_tr_b16 v[194:195], v13 offset:54272
  s_add_u32 s27, s27, 17408
  buffer_load_dwordx4 v15, s[4:7], s27 offen offset:1024 lds
  s_sub_u32 s34, s23, 5
  s_and_b32 s34, s34, 7
  s_lshl_b32 s34, s34, 4
  s_lshl_b32 s29, s23, 7
  s_waitcnt lgkmcnt(6)
  v_mfma_f32_32x32x16_bf16 v[156:171], v[200:203], v[68:71], v[156:171]
  ds_read_b64_tr_b16 v[196:197], v14 offset:49152
  ds_read_b64_tr_b16 v[198:199], v14 offset:52224
  s_add_u32 s34, s34, s29
  s_add_u32 s34, s34, s39
  buffer_load_dword v11, v6, s[12:15], s34 offen sc1
  s_waitcnt lgkmcnt(6)
  v_mfma_f32_32x32x16_bf16 v[156:171], v[252:255], v[224:227], v[156:171]
  ds_read_b64_tr_b16 v[200:201], v14 offset:50176
  ds_read_b64_tr_b16 v[202:203], v14 offset:53248
  s_add_u32 s27, s27, 54272
  buffer_load_dwordx4 v15, s[4:7], s27 offen offset:2048 lds
  s_waitcnt lgkmcnt(6)
  v_mfma_f32_32x32x16_bf16 v[156:171], v[188:191], v[228:231], v[156:171]
  ds_read_b64_tr_b16 v[252:253], v14 offset:51200
  ds_read_b64_tr_b16 v[254:255], v14 offset:54272
  s_waitcnt vmcnt(11)
  v_lshrrev_b32 v18, 30, v5
  v_or_b32 v19, v18, v124
  v_cmp_ne_u32 vcc, 1, v19
  s_cbranch_vccz Lfok_55
  s_mov_b32 s26, 0
Lfwait_56:
  s_sleep 2
  buffer_load_dword v124, v5, s[12:15], s47 offen sc1
  s_add_u32 s26, s26, 1
  s_waitcnt vmcnt(0)
  v_or_b32 v19, v18, v124
  v_cmp_ne_u32 vcc, 1, v19
  s_cbranch_vccz Lfok_55
  s_cmp_lt_u32 s26, 0x40000
  s_cbranch_scc1 Lfwait_56
Lfok_55:
  s_waitcnt lgkmcnt(6)
  v_mfma_f32_32x32x16_bf16 v[156:171], v[192:195], v[232:235], v[156:171]
  s_waitcnt vmcnt(9)
  s_barrier
  ds_read_b64_tr_b16 v[188:189], v13 offset:0
  ds_read_b64_tr_b16 v[190:191], v13 offset:3072
  s_add_u32 m0, s28, 36864
  s_add_u32 s27, s27, 20480
  buffer_load_dwordx4 v15, s[4:7], s27 offen offset:0 lds
  s_waitcnt lgkmcnt(6)
  v_mfma_f32_32x32x16_bf16 v[156:171], v[196:199], v[72:75], v[156:171]
  ds_read_b64_tr_b16 v[192:193], v13 offset:1024
  ds_read_b64_tr_b16 v[194:195], v13 offset:4096
  s_waitcnt lgkmcnt(6)
  v_mfma_f32_32x32x16_bf16 v[156:171], v[200:203], v[76:79], v[156:171]
  ds_read_b64_tr_b16 v[196:197], v13 offset:2048
  ds_read_b64_tr_b16 v[198:199], v13 offset:5120
  s_add_u32 s27, s27, 54272
  buffer_load_dwordx4 v15, s[4:7], s27 offen offset:1024 lds
  s_waitcnt lgkmcnt(6)
  v_mfma_f32_32x32x16_bf16 v[156:171], v[252:255], v[80:83], v[156:171]
  ds_read_b64_tr_b16 v[200:201], v14 offset:0
  ds_read_b64_tr_b16 v[202:203], v14 offset:3072
  s_waitcnt lgkmcnt(6)
  v_mfma_f32_32x32x16_bf16 v[156:171], v[188:191], v[236:239], v[156:171]
  ds_read_b64_tr_b16 v[252:253], v14 offset:1024
  ds_read_b64_tr_b16 v[254:255], v14 offset:4096
  s_add_u32 s27, s27, 17408
  buffer_load_dwordx4 v15, s[4:7], s27 offen offset:2048 lds
  s_waitcnt lgkmcnt(6)
  v_mfma_f32_32x32x16_bf16 v[156:171], v[192:195], v[240:243], v[156:171]
  ds_read_b64_tr_b16 v[188:189], v14 offset:2048
  ds_read_b64_tr_b16 v[190:191], v14 offset:5120
  s_waitcnt lgkmcnt(6)
  v_mfma_f32_32x32x16_bf16 v[156:171], v[196:199], v[244:247], v[156:171]
  s_waitcnt vmcnt(9)
  s_barrier
  ds_read_b64_tr_b16 v[192:193], v13 offset:12288
  ds_read_b64_tr_b16 v[194:195], v13 offset:15360
  s_add_u32 m0, s28, 49152
  s_add_u32 s27, s27, 57344
  buffer_load_dwordx4 v15, s[4:7], s27 offen offset:0 lds
  s_waitcnt lgkmcnt(6)
  v_mfma_f32_32x32x16_bf16 v[156:171], v[200:203], v[84:87], v[156:171]
  ds_read_b64_tr_b16 v[196:197], v13 offset:13312
  ds_read_b64_tr_b16 v[198:199], v13 offset:16384
  s_waitcnt lgkmcnt(6)
  v_mfma_f32_32x32x16_bf16 v[156:171], v[252:255], v[88:91], v[156:171]
  ds_read_b64_tr_b16 v[200:201], v13 offset:14336
  ds_read_b64_tr_b16 v[202:203], v13 offset:17408
  s_add_u32 s27, s27, 17408
  buffer_load_dwordx4 v15, s[4:7], s27 offen offset:1024 lds
  s_waitcnt lgkmcnt(6)
  v_mfma_f32_32x32x16_bf16 v[156:171], v[188:191], v[92:95], v[156:171]
  ds_read_b64_tr_b16 v[252:253], v14 offset:12288
  ds_read_b64_tr_b16 v[254:255], v14 offset:15360
  s_waitcnt lgkmcnt(6)
  v_mfma_f32_32x32x16_bf16 v[156:171], v[192:195], v[248:251], v[156:171]
  ds_read_b64_tr_b16 v[188:189], v14 offset:13312
  ds_read_b64_tr_b16 v[190:191], v14 offset:16384
  s_add_u32 s27, s27, 54272
  buffer_load_dwordx4 v15, s[4:7], s27 offen offset:2048 lds
  s_waitcnt vmcnt(7)
  v_lshrrev_b32 v18, 30, v6
  v_or_b32 v19, v18, v11
  v_cmp_ne_u32 vcc, 1, v19
  s_cbranch_vccz Lfok_53
  s_mov_b32 s26, 0
Lfwait_54:
  s_sleep 2
  buffer_load_dword v11, v6, s[12:15], s34 offen sc1
  s_add_u32 s26, s26, 1
  s_waitcnt vmcnt(0)
  v_or_b32 v19, v18, v11
  v_cmp_ne_u32 vcc, 1, v19
  s_cbranch_vccz Lfok_53
  s_cmp_lt_u32 s26, 0x40000
  s_cbranch_scc1 Lfwait_54
Lfok_53:
  s_sub_u32 s29, s23, 5
  s_and_b32 s29, s29, 7
  s_mul_i32 s29, s29, 2359296
  s_lshl_b32 s35, s23, 18
  s_add_u32 s35, s35, s46
  s_add_u32 s35, s35, s29
  buffer_load_dwordx4 v[116:119], v4, s[12:15], s35 offen sc1
  s_add_u32 s35, s35, 65536
  buffer_load_dwordx4 v[120:123], v4, s[12:15], s35 offen sc1
  s_waitcnt lgkmcnt(6)
  v_mfma_f32_32x32x16_bf16 v[156:171], v[196:199], v[100:103], v[156:171]
  ds_read_b64_tr_b16 v[192:193], v14 offset:14336
  ds_read_b64_tr_b16 v[194:195], v14 offset:17408
  s_add_u32 s25, s23, 6
  s_and_b32 s25, s25, 7
  s_waitcnt lgkmcnt(6)
  v_mfma_f32_32x32x16_bf16 v[156:171], v[200:203], v[104:107], v[156:171]
  s_waitcnt vmcnt(8)
  s_barrier
  ds_read_b64_tr_b16 v[196:197], v13 offset:24576
  ds_read_b64_tr_b16 v[198:199], v13 offset:27648
  s_add_u32 m0, s28, 0
  s_add_u32 s27, s27, 20480
  buffer_load_dwordx4 v15, s[4:7], s27 offen offset:0 lds
  s_lshl_b32 s25, s25, 7
  s_add_u32 s25, s25, s33
  buffer_store_dword v16, v17, s[12:15], s25 offen sc1
  s_waitcnt lgkmcnt(6)
  v_mfma_f32_32x32x16_bf16 v[156:171], v[252:255], v[96:99], v[156:171]
  ds_read_b64_tr_b16 v[200:201], v13 offset:25600
  ds_read_b64_tr_b16 v[202:203], v13 offset:28672
  s_waitcnt lgkmcnt(6)
  v_mfma_f32_32x32x16_bf16 v[156:171], v[188:191], v[108:111], v[156:171]
  ds_read_b64_tr_b16 v[252:253], v13 offset:26624
  ds_read_b64_tr_b16 v[254:255], v13 offset:29696
  s_add_u32 s27, s27, 54272
  buffer_load_dwordx4 v15, s[4:7], s27 offen offset:1024 lds
  s_waitcnt lgkmcnt(6)
  v_mfma_f32_32x32x16_bf16 v[156:171], v[192:195], v[112:115], v[156:171]
  ds_read_b64_tr_b16 v[188:189], v14 offset:24576
  ds_read_b64_tr_b16 v[190:191], v14 offset:27648
  s_waitcnt lgkmcnt(6)
  v_mfma_f32_32x32x16_bf16 v[172:187], v[196:199], v[20:23], v[140:155]
  ds_read_b64_tr_b16 v[192:193], v14 offset:25600
  ds_read_b64_tr_b16 v[194:195], v14 offset:28672
  s_add_u32 s27, s27, 17408
  buffer_load_dwordx4 v15, s[4:7], s27 offen offset:2048 lds
  s_waitcnt lgkmcnt(6)
  v_mfma_f32_32x32x16_bf16 v[172:187], v[200:203], v[24:27], v[172:187]
  ds_read_b64_tr_b16 v[196:197], v14 offset:26624
  ds_read_b64_tr_b16 v[198:199], v14 offset:29696
  s_waitcnt lgkmcnt(6)
  v_mfma_f32_32x32x16_bf16 v[172:187], v[252:255], v[28:31], v[172:187]
  s_waitcnt vmcnt(9)
  s_barrier
  ds_read_b64_tr_b16 v[200:201], v13 offset:36864
  ds_read_b64_tr_b16 v[202:203], v13 offset:39936
  s_add_u32 m0, s28, 12288
  s_add_u32 s27, s27, 57344
  buffer_load_dwordx4 v15, s[4:7], s27 offen offset:0 lds
  s_waitcnt lgkmcnt(6)
  v_mfma_f32_32x32x16_bf16 v[172:187], v[188:191], v[36:39], v[172:187]
  ds_read_b64_tr_b16 v[252:253], v13 offset:37888
  ds_read_b64_tr_b16 v[254:255], v13 offset:40960
  buffer_load_dword v124, v5, s[12:15], s38 offen sc1
  s_waitcnt lgkmcnt(6)
  v_mfma_f32_32x32x16_bf16 v[172:187], v[192:195], v[40:43], v[172:187]
  ds_read_b64_tr_b16 v[188:189], v13 offset:38912
  ds_read_b64_tr_b16 v[190:191], v13 offset:41984
  s_add_u32 s32, s23, 7
  s_and_b32 s32, s32, 7
  s_add_u32 s27, s27, 17408
  buffer_load_dwordx4 v15, s[4:7], s27 offen offset:1024 lds
  s_waitcnt lgkmcnt(6)
  v_mfma_f32_32x32x16_bf16 v[172:187], v[196:199], v[44:47], v[172:187]
  ds_read_b64_tr_b16 v[192:193], v14 offset:36864
  ds_read_b64_tr_b16 v[194:195], v14 offset:39936
  s_lshl_b32 s32, s32, 18
  s_add_u32 s32, s32, s46
  s_waitcnt lgkmcnt(6)
  v_mfma_f32_32x32x16_bf16 v[172:187], v[200:203], v[32:35], v[172:187]
  ds_read_b64_tr_b16 v[196:197], v14 offset:37888
  ds_read_b64_tr_b16 v[198:199], v14 offset:40960
  s_mul_i32 s26, s23, 2359296
  s_add_u32 s32, s32, s26
  s_add_u32 s27, s27, 54272
  buffer_load_dwordx4 v15, s[4:7], s27 offen offset:2048 lds
  s_waitcnt lgkmcnt(6)
  v_mfma_f32_32x32x16_bf16 v[172:187], v[252:255], v[204:207], v[172:187]
  ds_read_b64_tr_b16 v[200:201], v14 offset:38912
  ds_read_b64_tr_b16 v[202:203], v14 offset:41984
  v_cvt_pk_bf16_f32 v156, v156, v157
  s_waitcnt lgkmcnt(6)
  v_mfma_f32_32x32x16_bf16 v[172:187], v[188:191], v[208:211], v[172:187]
  s_waitcnt vmcnt(10)
  s_barrier
  ds_read_b64_tr_b16 v[252:253], v13 offset:49152
  ds_read_b64_tr_b16 v[254:255], v13 offset:52224
  v_cvt_pk_bf16_f32 v157, v158, v159
  v_cvt_pk_bf16_f32 v158, v160, v161
  s_add_u32 m0, s28, 24576
  s_add_u32 s27, s27, 20480
  buffer_load_dwordx4 v15, s[4:7], s27 offen offset:0 lds
  s_waitcnt lgkmcnt(6)
  v_mfma_f32_32x32x16_bf16 v[172:187], v[192:195], v[48:51], v[172:187]
  ds_read_b64_tr_b16 v[188:189], v13 offset:50176
  ds_read_b64_tr_b16 v[190:191], v13 offset:53248
  v_cvt_pk_bf16_f32 v159, v162, v163
  v_cvt_pk_bf16_f32 v160, v164, v165
  s_mul_i32 s31, s22, 336384
  s_lshl_b32 s25, s23, 7
  s_waitcnt lgkmcnt(6)
  v_mfma_f32_32x32x16_bf16 v[172:187], v[196:199], v[52:55], v[172:187]
  ds_read_b64_tr_b16 v[192:193], v13 offset:51200
  ds_read_b64_tr_b16 v[194:195], v13 offset:54272
  v_cvt_pk_bf16_f32 v161, v166, v167
  v_cvt_pk_bf16_f32 v162, v168, v169
  s_add_u32 s27, s27, 54272
  buffer_load_dwordx4 v15, s[4:7], s27 offen offset:1024 lds
  s_add_u32 s31, s31, s25
  s_waitcnt lgkmcnt(6)
  v_mfma_f32_32x32x16_bf16 v[172:187], v[200:203], v[56:59], v[172:187]
  ds_read_b64_tr_b16 v[196:197], v14 offset:49152
  ds_read_b64_tr_b16 v[198:199], v14 offset:52224
  v_cvt_pk_bf16_f32 v163, v170, v171
  s_waitcnt lgkmcnt(6)
  v_mfma_f32_32x32x16_bf16 v[172:187], v[252:255], v[212:215], v[172:187]
  ds_read_b64_tr_b16 v[200:201], v14 offset:50176
  ds_read_b64_tr_b16 v[202:203], v14 offset:53248
  v_permlane32_swap_b32 v156, v158
  v_permlane32_swap_b32 v157, v159
  s_add_u32 s27, s27, 17408
  buffer_load_dwordx4 v15, s[4:7], s27 offen offset:2048 lds
  s_waitcnt vmcnt(11)
  v_mfma_f32_32x32x16_bf16 v[172:187], v[128:131], v[116:119], v[172:187]
  v_mfma_f32_32x32x16_bf16 v[172:187], v[132:135], v[120:123], v[172:187]
  s_waitcnt lgkmcnt(6)
  v_mfma_f32_32x32x16_bf16 v[172:187], v[188:191], v[216:219], v[172:187]
  ds_read_b64_tr_b16 v[252:253], v14 offset:51200
  ds_read_b64_tr_b16 v[254:255], v14 offset:54272
  buffer_store_dwordx4 v[156:159], v4, s[12:15], s32 offen sc1
  s_add_u32 s32, s32, 65536
  s_waitcnt lgkmcnt(6)
  v_mfma_f32_32x32x16_bf16 v[172:187], v[192:195], v[220:223], v[172:187]
  s_waitcnt vmcnt(8)
  s_barrier
  ds_read_b64_tr_b16 v[188:189], v13 offset:0
  ds_read_b64_tr_b16 v[190:191], v13 offset:3072
  v_permlane32_swap_b32 v160, v162
  v_permlane32_swap_b32 v161, v163
  s_add_u32 m0, s28, 36864
  s_mov_b32 s27, s31
  buffer_load_dwordx4 v15, s[8:11], s27 offen offset:0 lds
  s_waitcnt lgkmcnt(6)
  v_mfma_f32_32x32x16_bf16 v[172:187], v[196:199], v[60:63], v[172:187]
  ds_read_b64_tr_b16 v[192:193], v13 offset:1024
  ds_read_b64_tr_b16 v[194:195], v13 offset:4096
  buffer_store_dwordx4 v[160:163], v4, s[12:15], s32 offen sc1
  s_waitcnt lgkmcnt(6)
  v_mfma_f32_32x32x16_bf16 v[172:187], v[200:203], v[64:67], v[172:187]
  ds_read_b64_tr_b16 v[196:197], v13 offset:2048
  ds_read_b64_tr_b16 v[198:199], v13 offset:5120
  s_add_u32 s27, s27, 19712
  buffer_load_dwordx4 v15, s[8:11], s27 offen offset:1024 lds
  s_sub_u32 s34, s23, 6
  s_and_b32 s34, s34, 7
  s_lshl_b32 s34, s34, 4
  s_lshl_b32 s29, s23, 7
  s_waitcnt lgkmcnt(6)
  v_mfma_f32_32x32x16_bf16 v[172:187], v[252:255], v[68:71], v[172:187]
  ds_read_b64_tr_b16 v[200:201], v14 offset:0
  ds_read_b64_tr_b16 v[202:203], v14 offset:3072
  s_add_u32 s34, s34, s29
  s_add_u32 s34, s34, s39
  buffer_load_dword v11, v6, s[12:15], s34 offen sc1
  s_waitcnt lgkmcnt(6)
  v_mfma_f32_32x32x16_bf16 v[172:187], v[188:191], v[224:227], v[172:187]
  ds_read_b64_tr_b16 v[252:253], v14 offset:1024
  ds_read_b64_tr_b16 v[254:255], v14 offset:4096
  s_add_u32 s27, s27, 19712
  buffer_load_dwordx4 v15, s[8:11], s27 offen offset:2048 lds
  s_waitcnt lgkmcnt(6)
  v_mfma_f32_32x32x16_bf16 v[172:187], v[192:195], v[228:231], v[172:187]
  ds_read_b64_tr_b16 v[188:189], v14 offset:2048
  ds_read_b64_tr_b16 v[190:191], v14 offset:5120
  s_waitcnt vmcnt(11)
  v_lshrrev_b32 v18, 30, v5
  v_or_b32 v19, v18, v124
  v_cmp_ne_u32 vcc, 1, v19
  s_cbranch_vccz Lfok_59
  s_mov_b32 s26, 0
Lfwait_60:
  s_sleep 2
  buffer_load_dword v124, v5, s[12:15], s38 offen sc1
  s_add_u32 s26, s26, 1
  s_waitcnt vmcnt(0)
  v_or_b32 v19, v18, v124
  v_cmp_ne_u32 vcc, 1, v19
  s_cbranch_vccz Lfok_59
  s_cmp_lt_u32 s26, 0x40000
  s_cbranch_scc1 Lfwait_60
Lfok_59:
  s_mul_i32 s47, s22, 1179648
  s_add_u32 s47, s47, 9437184
  s_waitcnt lgkmcnt(6)
  v_mfma_f32_32x32x16_bf16 v[172:187], v[196:199], v[232:235], v[172:187]
  s_waitcnt vmcnt(9)
  s_barrier
  ds_read_b64_tr_b16 v[192:193], v13 offset:12288
  ds_read_b64_tr_b16 v[194:195], v13 offset:15360
  s_add_u32 m0, s28, 49152
  s_add_u32 s27, s27, 22784
  buffer_load_dwordx4 v15, s[8:11], s27 offen offset:0 lds
  buffer_load_dwordx4 v[20:23], v4, s[12:15], s47 offen sc1
  s_add_u32 s47, s47, 65536
  s_waitcnt lgkmcnt(6)
  v_mfma_f32_32x32x16_bf16 v[172:187], v[200:203], v[72:75], v[172:187]
  ds_read_b64_tr_b16 v[196:197], v13 offset:13312
  ds_read_b64_tr_b16 v[198:199], v13 offset:16384
  s_waitcnt lgkmcnt(6)
  v_mfma_f32_32x32x16_bf16 v[172:187], v[252:255], v[76:79], v[172:187]
  ds_read_b64_tr_b16 v[200:201], v13 offset:14336
  ds_read_b64_tr_b16 v[202:203], v13 offset:17408
  s_add_u32 s27, s27, 19712
  buffer_load_dwordx4 v15, s[8:11], s27 offen offset:1024 lds
  buffer_load_dwordx4 v[24:27], v4, s[12:15], s47 offen sc1
  s_add_u32 s47, s47, 65536
  s_waitcnt lgkmcnt(6)
  v_mfma_f32_32x32x16_bf16 v[172:187], v[188:191], v[80:83], v[172:187]
  ds_read_b64_tr_b16 v[252:253], v14 offset:12288
  ds_read_b64_tr_b16 v[254:255], v14 offset:15360
  s_waitcnt lgkmcnt(6)
  v_mfma_f32_32x32x16_bf16 v[172:187], v[192:195], v[236:239], v[172:187]
  ds_read_b64_tr_b16 v[188:189], v14 offset:13312
  ds_read_b64_tr_b16 v[190:191], v14 offset:16384
  s_add_u32 s27, s27, 19712
  buffer_load_dwordx4 v15, s[8:11], s27 offen offset:2048 lds
  buffer_load_dwordx4 v[28:31], v4, s[12:15], s47 offen sc1
  s_add_u32 s47, s47, 65536
  s_waitcnt lgkmcnt(6)
  v_mfma_f32_32x32x16_bf16 v[172:187], v[196:199], v[240:243], v[172:187]
  ds_read_b64_tr_b16 v[192:193], v14 offset:14336
  ds_read_b64_tr_b16 v[194:195], v14 offset:17408
  s_waitcnt lgkmcnt(6)
  v_mfma_f32_32x32x16_bf16 v[172:187], v[200:203], v[244:247], v[172:187]
  s_waitcnt vmcnt(12)
  s_barrier
  ds_read_b64_tr_b16 v[196:197], v13 offset:24576
  ds_read_b64_tr_b16 v[198:199], v13 offset:27648
  s_add_u32 m0, s28, 0
  s_add_u32 s27, s27, 22784
  buffer_load_dwordx4 v15, s[8:11], s27 offen offset:0 lds
  buffer_load_dwordx4 v[32:35], v4, s[12:15], s47 offen sc1
  s_add_u32 s47, s47, 65536
  s_waitcnt lgkmcnt(6)
  v_mfma_f32_32x32x16_bf16 v[172:187], v[252:255], v[84:87], v[172:187]
  ds_read_b64_tr_b16 v[200:201], v13 offset:25600
  ds_read_b64_tr_b16 v[202:203], v13 offset:28672
  s_waitcnt lgkmcnt(6)
  v_mfma_f32_32x32x16_bf16 v[172:187], v[188:191], v[88:91], v[172:187]
  ds_read_b64_tr_b16 v[252:253], v13 offset:26624
  ds_read_b64_tr_b16 v[254:255], v13 offset:29696
  s_add_u32 s27, s27, 19712
  buffer_load_dwordx4 v15, s[8:11], s27 offen offset:1024 lds
  buffer_load_dwordx4 v[204:207], v4, s[12:15], s47 offen sc1
  s_add_u32 s47, s47, 65536
  s_waitcnt lgkmcnt(6)
  v_mfma_f32_32x32x16_bf16 v[172:187], v[192:195], v[92:95], v[172:187]
  ds_read_b64_tr_b16 v[188:189], v14 offset:24576
  ds_read_b64_tr_b16 v[190:191], v14 offset:27648
  s_waitcnt lgkmcnt(6)
  v_mfma_f32_32x32x16_bf16 v[172:187], v[196:199], v[248:251], v[172:187]
  ds_read_b64_tr_b16 v[192:193], v14 offset:25600
  ds_read_b64_tr_b16 v[194:195], v14 offset:28672
  s_add_u32 s27, s27, 19712
  buffer_load_dwordx4 v15, s[8:11], s27 offen offset:2048 lds
  s_waitcnt vmcnt(12)
  v_lshrrev_b32 v18, 30, v6
  v_or_b32 v19, v18, v11
  v_cmp_ne_u32 vcc, 1, v19
  s_cbranch_vccz Lfok_57
  s_mov_b32 s26, 0
Lfwait_58:
  s_sleep 2
  buffer_load_dword v11, v6, s[12:15], s34 offen sc1
  s_add_u32 s26, s26, 1
  s_waitcnt vmcnt(0)
  v_or_b32 v19, v18, v11
  v_cmp_ne_u32 vcc, 1, v19
  s_cbranch_vccz Lfok_57
  s_cmp_lt_u32 s26, 0x40000
  s_cbranch_scc1 Lfwait_58
Lfok_57:
  s_sub_u32 s29, s23, 6
  s_and_b32 s29, s29, 7
  s_mul_i32 s29, s29, 2359296
  s_lshl_b32 s35, s23, 18
  s_add_u32 s35, s35, s46
  s_add_u32 s35, s35, s29
  buffer_load_dwordx4 v[36:39], v4, s[12:15], s35 offen sc1
  s_add_u32 s35, s35, 65536
  buffer_load_dwordx4 v[40:43], v4, s[12:15], s35 offen sc1
  buffer_load_dwordx4 v[208:211], v4, s[12:15], s47 offen sc1
  s_add_u32 s47, s47, 65536
  s_waitcnt lgkmcnt(6)
  v_mfma_f32_32x32x16_bf16 v[172:187], v[200:203], v[100:103], v[172:187]
  ds_read_b64_tr_b16 v[196:197], v14 offset:26624
  ds_read_b64_tr_b16 v[198:199], v14 offset:29696
  s_add_u32 s25, s23, 7
  s_and_b32 s25, s25, 7
  s_waitcnt lgkmcnt(6)
  v_mfma_f32_32x32x16_bf16 v[172:187], v[252:255], v[104:107], v[172:187]
  s_waitcnt vmcnt(14)
  s_barrier
  ds_read_b64_tr_b16 v[200:201], v13 offset:36864
  ds_read_b64_tr_b16 v[202:203], v13 offset:39936
  s_add_u32 m0, s28, 12288
  s_add_u32 s27, s27, 22784
  buffer_load_dwordx4 v15, s[8:11], s27 offen offset:0 lds
  s_lshl_b32 s25, s25, 7
  s_add_u32 s25, s25, s33
  buffer_store_dword v16, v17, s[12:15], s25 offen sc1
  buffer_load_dwordx4 v[212:215], v4, s[12:15], s47 offen sc1
  s_add_u32 s47, s47, 65536
  v_xor_b32 v14, 64, v13
  s_waitcnt lgkmcnt(6)
  v_mfma_f32_32x32x16_bf16 v[172:187], v[188:191], v[96:99], v[172:187]
  ds_read_b64_tr_b16 v[252:253], v14 offset:36864
  ds_read_b64_tr_b16 v[254:255], v14 offset:39936
  s_waitcnt lgkmcnt(6)
  v_mfma_f32_32x32x16_bf16 v[172:187], v[192:195], v[108:111], v[172:187]
  ds_read_b64_tr_b16 v[116:117], v3 offset:0
  ds_read_b64_tr_b16 v[118:119], v3 offset:64
  ds_read_b64_tr_b16 v[188:189], v13 offset:37888
  ds_read_b64_tr_b16 v[190:191], v13 offset:40960
  s_add_u32 s27, s27, 19712
  buffer_load_dwordx4 v15, s[8:11], s27 offen offset:1024 lds
  buffer_load_dwordx4 v[216:219], v4, s[12:15], s47 offen sc1
  s_add_u32 s47, s47, 65536
  s_waitcnt lgkmcnt(6)
  v_mfma_f32_32x32x16_bf16 v[172:187], v[196:199], v[112:115], v[172:187]
  ds_read_b64_tr_b16 v[120:121], v3 offset:256
  ds_read_b64_tr_b16 v[122:123], v3 offset:320
  ds_read_b64_tr_b16 v[192:193], v14 offset:37888
  ds_read_b64_tr_b16 v[194:195], v14 offset:40960
  s_waitcnt vmcnt(17)
  s_waitcnt lgkmcnt(6)
  v_mfma_f32_32x32x16_bf16 v[172:187], v[200:203], v[20:23], v[172:187]
  ds_read_b64_tr_b16 v[196:197], v13 offset:38912
  ds_read_b64_tr_b16 v[198:199], v13 offset:41984
  s_add_u32 s27, s27, 19712
  buffer_load_dwordx4 v15, s[8:11], s27 offen offset:2048 lds
  buffer_load_dwordx4 v[220:223], v4, s[12:15], s47 offen sc1
  s_add_u32 s47, s47, 65536
  s_waitcnt lgkmcnt(6)
  v_mfma_f32_32x32x16_bf16 v[140:155], v[252:255], v[20:23], 0
  v_mfma_f32_32x32x16_bf16 v[156:171], v[116:119], v[20:23], 0
  ds_read_b64_tr_b16 v[124:125], v3 offset:512
  ds_read_b64_tr_b16 v[126:127], v3 offset:576
  ds_read_b64_tr_b16 v[200:201], v14 offset:38912
  ds_read_b64_tr_b16 v[202:203], v14 offset:41984
  s_waitcnt vmcnt(17)
  s_waitcnt lgkmcnt(6)
  v_mfma_f32_32x32x16_bf16 v[172:187], v[188:191], v[24:27], v[172:187]
  s_waitcnt vmcnt(16)
  s_barrier
  ds_read_b64_tr_b16 v[252:253], v13 offset:49152
  ds_read_b64_tr_b16 v[254:255], v13 offset:52224
  s_add_u32 m0, s28, 24576
  s_add_u32 s27, s27, 22784
  buffer_load_dwordx4 v15, s[8:11], s27 offen offset:0 lds
  buffer_load_dwordx4 v[224:227], v4, s[12:15], s47 offen sc1
  s_add_u32 s47, s47, 65536
  s_waitcnt lgkmcnt(6)
  v_mfma_f32_32x32x16_bf16 v[140:155], v[192:195], v[24:27], v[140:155]
  v_mfma_f32_32x32x16_bf16 v[156:171], v[120:123], v[24:27], v[156:171]
  ds_read_b64_tr_b16 v[116:117], v3 offset:768
  ds_read_b64_tr_b16 v[118:119], v3 offset:832
  ds_read_b64_tr_b16 v[188:189], v14 offset:49152
  ds_read_b64_tr_b16 v[190:191], v14 offset:52224
  s_waitcnt vmcnt(17)
  s_waitcnt lgkmcnt(6)
  v_mfma_f32_32x32x16_bf16 v[172:187], v[196:199], v[28:31], v[172:187]
  ds_read_b64_tr_b16 v[192:193], v13 offset:50176
  ds_read_b64_tr_b16 v[194:195], v13 offset:53248
  s_add_u32 s27, s27, 19712
  buffer_load_dwordx4 v15, s[8:11], s27 offen offset:1024 lds
  buffer_load_dwordx4 v[228:231], v4, s[12:15], s47 offen sc1
  s_add_u32 s47, s47, 65536
  s_lshl_b32 s35, s23, 15
  s_add_u32 s35, s35, 19255296
  s_waitcnt lgkmcnt(6)
  v_mfma_f32_32x32x16_bf16 v[140:155], v[200:203], v[28:31], v[140:155]
  v_mfma_f32_32x32x16_bf16 v[156:171], v[124:127], v[28:31], v[156:171]
  ds_read_b64_tr_b16 v[120:121], v3 offset:1024
  ds_read_b64_tr_b16 v[122:123], v3 offset:1088
  ds_read_b64_tr_b16 v[196:197], v14 offset:50176
  ds_read_b64_tr_b16 v[198:199], v14 offset:53248
  buffer_load_dwordx4 v[52:55], v7, s[12:15], s35 offen sc1
  s_waitcnt vmcnt(18)
  s_waitcnt lgkmcnt(6)
  v_mfma_f32_32x32x16_bf16 v[172:187], v[252:255], v[32:35], v[172:187]
  ds_read_b64_tr_b16 v[200:201], v13 offset:51200
  ds_read_b64_tr_b16 v[202:203], v13 offset:54272
  s_mov_b32 s27, s36
  buffer_load_dwordx4 v2, s[8:11], s27 offen offset:2048 lds
  buffer_load_dwordx4 v[232:235], v4, s[12:15], s47 offen sc1
  s_add_u32 s47, s47, 65536
  s_lshl_b32 s35, s23, 15
  s_add_u32 s35, s35, 23973888
  s_waitcnt lgkmcnt(6)
  v_mfma_f32_32x32x16_bf16 v[140:155], v[188:191], v[32:35], v[140:155]
  v_mfma_f32_32x32x16_bf16 v[156:171], v[116:119], v[32:35], v[156:171]
  ds_read_b64_tr_b16 v[124:125], v3 offset:1280
  ds_read_b64_tr_b16 v[126:127], v3 offset:1344
  ds_read_b64_tr_b16 v[252:253], v14 offset:51200
  ds_read_b64_tr_b16 v[254:255], v14 offset:54272
  buffer_load_dwordx4 v[60:63], v7, s[12:15], s35 offen sc1
  s_waitcnt vmcnt(19)
  s_waitcnt lgkmcnt(6)
  v_mfma_f32_32x32x16_bf16 v[172:187], v[192:195], v[204:207], v[172:187]
  s_waitcnt vmcnt(18)
  s_barrier
  ds_read_b64_tr_b16 v[188:189], v13 offset:0
  ds_read_b64_tr_b16 v[190:191], v13 offset:3072
  s_add_u32 m0, s28, 36864
  s_add_u32 s27, s27, s37
  s_add_u32 s27, s27, 3072
  buffer_load_dwordx4 v2, s[8:11], s27 offen offset:0 lds
  buffer_load_dwordx4 v[236:239], v4, s[12:15], s47 offen sc1
  s_add_u32 s47, s47, 65536
  s_lshl_b32 s35, s23, 15
  s_add_u32 s35, s35, 28692480
  s_waitcnt lgkmcnt(6)
  v_mfma_f32_32x32x16_bf16 v[140:155], v[196:199], v[204:207], v[140:155]
  v_mfma_f32_32x32x16_bf16 v[156:171], v[120:123], v[204:207], v[156:171]
  ds_read_b64_tr_b16 v[116:117], v3 offset:1536
  ds_read_b64_tr_b16 v[118:119], v3 offset:1600
  ds_read_b64_tr_b16 v[192:193], v14 offset:0
  ds_read_b64_tr_b16 v[194:195], v14 offset:3072
  buffer_load_dwordx4 v[68:71], v7, s[12:15], s35 offen sc1
  s_waitcnt vmcnt(18)
  s_waitcnt lgkmcnt(6)
  v_mfma_f32_32x32x16_bf16 v[172:187], v[200:203], v[208:211], v[172:187]
  ds_read_b64_tr_b16 v[196:197], v13 offset:1024
  ds_read_b64_tr_b16 v[198:199], v13 offset:4096
  s_add_u32 s27, s27, s37
  buffer_load_dwordx4 v2, s[8:11], s27 offen offset:1024 lds
  buffer_load_dwordx4 v[240:243], v4, s[12:15], s47 offen sc1
  s_add_u32 s47, s47, 65536
  s_lshl_b32 s35, s23, 15
  s_add_u32 s35, s35, 33411072
  s_waitcnt lgkmcnt(6)
  v_mfma_f32_32x32x16_bf16 v[140:155], v[252:255], v[208:211], v[140:155]
  v_mfma_f32_32x32x16_bf16 v[156:171], v[124:127], v[208:211], v[156:171]
  ds_read_b64_tr_b16 v[120:121], v3 offset:1792
  ds_read_b64_tr_b16 v[122:123], v3 offset:1856
  ds_read_b64_tr_b16 v[200:201], v14 offset:1024
  ds_read_b64_tr_b16 v[202:203], v14 offset:4096
  buffer_load_dwordx4 v[76:79], v7, s[12:15], s35 offen sc1
  s_waitcnt vmcnt(18)
  s_waitcnt lgkmcnt(6)
  v_mfma_f32_32x32x16_bf16 v[172:187], v[188:191], v[212:215], v[172:187]
  ds_read_b64_tr_b16 v[252:253], v13 offset:2048
  ds_read_b64_tr_b16 v[254:255], v13 offset:5120
  s_add_u32 s27, s27, s37
  buffer_load_dwordx4 v2, s[8:11], s27 offen offset:2048 lds
  v_mfma_f32_32x32x16_bf16 v[172:187], v[128:131], v[36:39], v[172:187]
  v_mfma_f32_32x32x16_bf16 v[172:187], v[132:135], v[40:43], v[172:187]
  buffer_load_dwordx4 v[244:247], v4, s[12:15], s47 offen sc1
  s_add_u32 s47, s47, 65536
  s_lshl_b32 s35, s23, 15
  s_add_u32 s35, s35, 9175040
  s_waitcnt lgkmcnt(6)
  v_mfma_f32_32x32x16_bf16 v[140:155], v[192:195], v[212:215], v[140:155]
  v_mfma_f32_32x32x16_bf16 v[156:171], v[116:119], v[212:215], v[156:171]
  ds_read_b64_tr_b16 v[124:125], v3 offset:2048
  ds_read_b64_tr_b16 v[126:127], v3 offset:2112
  ds_read_b64_tr_b16 v[188:189], v14 offset:2048
  ds_read_b64_tr_b16 v[190:191], v14 offset:5120
  buffer_load_dwordx4 v[84:87], v8, s[12:15], s35 offen sc1
  s_waitcnt vmcnt(19)
  s_waitcnt lgkmcnt(6)
  v_mfma_f32_32x32x16_bf16 v[172:187], v[196:199], v[216:219], v[172:187]
  s_waitcnt vmcnt(18)
  s_barrier
  ds_read_b64_tr_b16 v[192:193], v13 offset:12288
  ds_read_b64_tr_b16 v[194:195], v13 offset:15360
  buffer_load_dwordx4 v[248:251], v4, s[12:15], s47 offen sc1
  s_add_u32 s47, s47, 65536
  s_waitcnt lgkmcnt(6)
  v_mfma_f32_32x32x16_bf16 v[140:155], v[200:203], v[216:219], v[140:155]
  v_mfma_f32_32x32x16_bf16 v[156:171], v[120:123], v[216:219], v[156:171]
  ds_read_b64_tr_b16 v[116:117], v3 offset:2304
  ds_read_b64_tr_b16 v[118:119], v3 offset:2368
  ds_read_b64_tr_b16 v[196:197], v14 offset:12288
  ds_read_b64_tr_b16 v[198:199], v14 offset:15360
  s_waitcnt vmcnt(18)
  s_waitcnt lgkmcnt(6)
  v_mfma_f32_32x32x16_bf16 v[172:187], v[252:255], v[220:223], v[172:187]
  ds_read_b64_tr_b16 v[200:201], v13 offset:13312
  ds_read_b64_tr_b16 v[202:203], v13 offset:16384
  s_sub_u32 s34, s23, 7
  s_and_b32 s34, s34, 7
  s_lshl_b32 s34, s34, 4
  s_lshl_b32 s29, s23, 7
  buffer_load_dwordx4 v[100:103], v4, s[12:15], s47 offen sc1
  s_add_u32 s47, s47, 65536
  s_waitcnt lgkmcnt(6)
  v_mfma_f32_32x32x16_bf16 v[140:155], v[188:191], v[220:223], v[140:155]
  v_mfma_f32_32x32x16_bf16 v[156:171], v[124:127], v[220:223], v[156:171]
  ds_read_b64_tr_b16 v[120:121], v3 offset:2560
  ds_read_b64_tr_b16 v[122:123], v3 offset:2624
  ds_read_b64_tr_b16 v[252:253], v14 offset:13312
  ds_read_b64_tr_b16 v[254:255], v14 offset:16384
  s_add_u32 s34, s34, s29
  s_add_u32 s34, s34, s39
  buffer_load_dword v11, v6, s[12:15], s34 offen sc1
  s_waitcnt vmcnt(18)
  s_waitcnt lgkmcnt(6)
  v_mfma_f32_32x32x16_bf16 v[172:187], v[192:195], v[224:227], v[172:187]
  ds_read_b64_tr_b16 v[188:189], v13 offset:14336
  ds_read_b64_tr_b16 v[190:191], v13 offset:17408
  buffer_load_dwordx4 v[104:107], v4, s[12:15], s47 offen sc1
  s_add_u32 s47, s47, 65536
  s_waitcnt lgkmcnt(6)
  v_mfma_f32_32x32x16_bf16 v[140:155], v[196:199], v[224:227], v[140:155]
  v_mfma_f32_32x32x16_bf16 v[156:171], v[116:119], v[224:227], v[156:171]
  ds_read_b64_tr_b16 v[124:125], v3 offset:2816
  ds_read_b64_tr_b16 v[126:127], v3 offset:2880
  ds_read_b64_tr_b16 v[192:193], v14 offset:14336
  ds_read_b64_tr_b16 v[194:195], v14 offset:17408
  s_waitcnt vmcnt(17)
  s_waitcnt lgkmcnt(6)
  v_mfma_f32_32x32x16_bf16 v[172:187], v[200:203], v[228:231], v[172:187]
  s_waitcnt vmcnt(15)
  s_barrier
  ds_read_b64_tr_b16 v[196:197], v13 offset:24576
  ds_read_b64_tr_b16 v[198:199], v13 offset:27648
  s_waitcnt lgkmcnt(6)
  v_mfma_f32_32x32x16_bf16 v[140:155], v[252:255], v[228:231], v[140:155]
  v_mfma_f32_32x32x16_bf16 v[156:171], v[120:123], v[228:231], v[156:171]
  ds_read_b64_tr_b16 v[116:117], v3 offset:3072
  ds_read_b64_tr_b16 v[118:119], v3 offset:3136
  ds_read_b64_tr_b16 v[200:201], v14 offset:24576
  ds_read_b64_tr_b16 v[202:203], v14 offset:27648
  s_waitcnt vmcnt(14)
  s_waitcnt lgkmcnt(6)
  v_mfma_f32_32x32x16_bf16 v[172:187], v[188:191], v[232:235], v[172:187]
  ds_read_b64_tr_b16 v[252:253], v13 offset:25600
  ds_read_b64_tr_b16 v[254:255], v13 offset:28672
  s_waitcnt lgkmcnt(6)
  v_mfma_f32_32x32x16_bf16 v[140:155], v[192:195], v[232:235], v[140:155]
  v_mfma_f32_32x32x16_bf16 v[156:171], v[124:127], v[232:235], v[156:171]
  ds_read_b64_tr_b16 v[120:121], v3 offset:3328
  ds_read_b64_tr_b16 v[122:123], v3 offset:3392
  ds_read_b64_tr_b16 v[188:189], v14 offset:25600
  ds_read_b64_tr_b16 v[190:191], v14 offset:28672
  s_waitcnt vmcnt(11)
  s_waitcnt lgkmcnt(6)
  v_mfma_f32_32x32x16_bf16 v[172:187], v[196:199], v[236:239], v[172:187]
  ds_read_b64_tr_b16 v[192:193], v13 offset:26624
  ds_read_b64_tr_b16 v[194:195], v13 offset:29696
  s_waitcnt lgkmcnt(6)
  v_mfma_f32_32x32x16_bf16 v[140:155], v[200:203], v[236:239], v[140:155]
  v_mfma_f32_32x32x16_bf16 v[156:171], v[116:119], v[236:239], v[156:171]
  ds_read_b64_tr_b16 v[124:125], v3 offset:3584
  ds_read_b64_tr_b16 v[126:127], v3 offset:3648
  ds_read_b64_tr_b16 v[196:197], v14 offset:26624
  ds_read_b64_tr_b16 v[198:199], v14 offset:29696
  s_waitcnt vmcnt(8)
  s_waitcnt lgkmcnt(6)
  v_mfma_f32_32x32x16_bf16 v[172:187], v[252:255], v[240:243], v[172:187]
  s_waitcnt vmcnt(6)
  s_barrier
  ds_read_b64_tr_b16 v[200:201], v13 offset:36864
  ds_read_b64_tr_b16 v[202:203], v13 offset:39936
  s_waitcnt lgkmcnt(6)
  v_mfma_f32_32x32x16_bf16 v[140:155], v[188:191], v[240:243], v[140:155]
  v_mfma_f32_32x32x16_bf16 v[156:171], v[120:123], v[240:243], v[156:171]
  ds_read_b64_tr_b16 v[116:117], v3 offset:3840
  ds_read_b64_tr_b16 v[118:119], v3 offset:3904
  ds_read_b64_tr_b16 v[252:253], v14 offset:36864
  ds_read_b64_tr_b16 v[254:255], v14 offset:39936
  s_waitcnt vmcnt(5)
  s_waitcnt lgkmcnt(6)
  v_mfma_f32_32x32x16_bf16 v[172:187], v[192:195], v[244:247], v[172:187]
  ds_read_b64_tr_b16 v[188:189], v13 offset:37888
  ds_read_b64_tr_b16 v[190:191], v13 offset:40960
  s_waitcnt lgkmcnt(6)
  v_mfma_f32_32x32x16_bf16 v[140:155], v[196:199], v[244:247], v[140:155]
  v_mfma_f32_32x32x16_bf16 v[156:171], v[124:127], v[244:247], v[156:171]
  ds_read_b64_tr_b16 v[120:121], v3 offset:4096
  ds_read_b64_tr_b16 v[122:123], v3 offset:4160
  ds_read_b64_tr_b16 v[192:193], v14 offset:37888
  ds_read_b64_tr_b16 v[194:195], v14 offset:40960
  s_waitcnt vmcnt(3)
  s_waitcnt lgkmcnt(6)
  v_mfma_f32_32x32x16_bf16 v[172:187], v[200:203], v[248:251], v[172:187]
  ds_read_b64_tr_b16 v[196:197], v13 offset:38912
  ds_read_b64_tr_b16 v[198:199], v13 offset:41984
  s_waitcnt vmcnt(1)
  v_lshrrev_b32 v18, 30, v6
  v_or_b32 v19, v18, v11
  v_cmp_ne_u32 vcc, 1, v19
  s_cbranch_vccz Lfok_61
  s_mov_b32 s26, 0
Lfwait_62:
  s_sleep 2
  buffer_load_dword v11, v6, s[12:15], s34 offen sc1
  s_add_u32 s26, s26, 1
  s_waitcnt vmcnt(0)
  v_or_b32 v19, v18, v11
  v_cmp_ne_u32 vcc, 1, v19
  s_cbranch_vccz Lfok_61
  s_cmp_lt_u32 s26, 0x40000
  s_cbranch_scc1 Lfwait_62
Lfok_61:
  s_sub_u32 s29, s23, 7
  s_and_b32 s29, s29, 7
  s_mul_i32 s29, s29, 2359296
  s_lshl_b32 s35, s23, 18
  s_add_u32 s35, s35, s46
  s_add_u32 s35, s35, s29
  buffer_load_dwordx4 v[44:47], v4, s[12:15], s35 offen sc1
  s_add_u32 s35, s35, 65536
  buffer_load_dwordx4 v[48:51], v4, s[12:15], s35 offen sc1
  s_waitcnt lgkmcnt(6)
  v_mfma_f32_32x32x16_bf16 v[140:155], v[252:255], v[248:251], v[140:155]
  v_mfma_f32_32x32x16_bf16 v[156:171], v[116:119], v[248:251], v[156:171]
  ds_read_b64_tr_b16 v[124:125], v3 offset:4352
  ds_read_b64_tr_b16 v[126:127], v3 offset:4416
  ds_read_b64_tr_b16 v[200:201], v14 offset:38912
  ds_read_b64_tr_b16 v[202:203], v14 offset:41984
  s_waitcnt lgkmcnt(6)
  v_mfma_f32_32x32x16_bf16 v[172:187], v[188:191], v[100:103], v[172:187]
  s_waitcnt lgkmcnt(4)
  v_mfma_f32_32x32x16_bf16 v[140:155], v[192:195], v[100:103], v[140:155]
  v_mfma_f32_32x32x16_bf16 v[156:171], v[120:123], v[100:103], v[156:171]
  s_waitcnt vmcnt(2)
  s_waitcnt lgkmcnt(2)
  v_mfma_f32_32x32x16_bf16 v[172:187], v[196:199], v[104:107], v[172:187]
  s_waitcnt lgkmcnt(0)
  v_mfma_f32_32x32x16_bf16 v[140:155], v[200:203], v[104:107], v[140:155]
  v_mfma_f32_32x32x16_bf16 v[156:171], v[124:127], v[104:107], v[156:171]
  v_mfma_f32_32x32x16_bf16 v[156:171], v[136:139], v[52:55], v[156:171]
  v_mfma_f32_32x32x16_bf16 v[156:171], v[136:139], v[60:63], v[156:171]
  v_mfma_f32_32x32x16_bf16 v[156:171], v[136:139], v[68:71], v[156:171]
  v_mfma_f32_32x32x16_bf16 v[156:171], v[136:139], v[76:79], v[156:171]
  v_mfma_f32_32x32x16_bf16 v[156:171], v[136:139], v[84:87], v[156:171]
  s_mov_b32 s8, s50
  s_mov_b32 s9, s51
  s_mov_b32 s10, 2359296
  v_lshrrev_b32 v18, 5, v1
  v_lshl_add_u32 v4, v18, 4, v10
  v_lshl_add_u32 v10, v18, 3, v10
  s_lshl_b32 s32, s23, 1
  s_add_u32 s32, s32, s22
  s_lshl_b32 s32, s32, 6
  s_lshl_b32 s25, s23, 4
  s_lshl_b32 s26, s22, 30
  s_add_u32 s25, s25, s26
  v_subrev_u32 v18, 61440, v0
  v_subrev_u32 v19, 61440, v12
  s_barrier
  ds_write_b128 v0, v[140:143] offset:0
  ds_write_b128 v0, v[144:147] offset:1024
  ds_write_b128 v0, v[148:151] offset:2048
  ds_write_b128 v0, v[152:155] offset:3072
  ds_write_b128 v18, v[156:159]
  s_waitcnt lgkmcnt(0)
  s_barrier
  ds_read_b128 v[140:143], v12 offset:0
  ds_read_b128 v[144:147], v12 offset:1024
  ds_read_b128 v[148:151], v12 offset:2048
  ds_read_b128 v[152:155], v12 offset:3072
  ds_read_b128 v[116:119], v19
  s_waitcnt vmcnt(0)
  v_mfma_f32_32x32x16_bf16 v[172:187], v[128:131], v[44:47], v[172:187]
  v_mfma_f32_32x32x16_bf16 v[172:187], v[132:135], v[48:51], v[172:187]
  s_waitcnt lgkmcnt(0)
  v_add_f32 v156, v156, v116
  v_add_f32 v156, v156, v9
  v_add_f32 v157, v157, v117
  v_add_f32 v157, v157, v9
  v_add_f32 v158, v158, v118
  v_add_f32 v158, v158, v9
  v_add_f32 v159, v159, v119
  v_add_f32 v159, v159, v9
  v_cvt_pk_bf16_f32 v156, v156, v157
  v_cvt_pk_bf16_f32 v157, v158, v159
  buffer_store_dwordx2 v[156:157], v10, s[8:11], s25 offen offset:1024 sc1
  v_add_f32 v172, v172, v140
  v_add_f32 v173, v173, v141
  v_add_f32 v174, v174, v142
  v_add_f32 v175, v175, v143
  v_add_f32 v176, v176, v144
  v_add_f32 v177, v177, v145
  v_add_f32 v178, v178, v146
  v_add_f32 v179, v179, v147
  v_add_f32 v180, v180, v148
  v_add_f32 v181, v181, v149
  v_add_f32 v182, v182, v150
  v_add_f32 v183, v183, v151
  v_add_f32 v184, v184, v152
  v_add_f32 v185, v185, v153
  v_add_f32 v186, v186, v154
  v_add_f32 v187, v187, v155
  v_add_f32 v172, v172, v9
  v_add_f32 v173, v173, v9
  v_add_f32 v174, v174, v9
  v_add_f32 v175, v175, v9
  v_add_f32 v176, v176, v9
  v_add_f32 v177, v177, v9
  v_add_f32 v178, v178, v9
  v_add_f32 v179, v179, v9
  v_add_f32 v180, v180, v9
  v_add_f32 v181, v181, v9
  v_add_f32 v182, v182, v9
  v_add_f32 v183, v183, v9
  v_add_f32 v184, v184, v9
  v_add_f32 v185, v185, v9
  v_add_f32 v186, v186, v9
  v_add_f32 v187, v187, v9
  v_cvt_pk_bf16_f32 v172, v172, v173
  v_cvt_pk_bf16_f32 v173, v174, v175
  v_cvt_pk_bf16_f32 v174, v176, v177
  v_cvt_pk_bf16_f32 v175, v178, v179
  v_cvt_pk_bf16_f32 v176, v180, v181
  v_cvt_pk_bf16_f32 v177, v182, v183
  v_cvt_pk_bf16_f32 v178, v184, v185
  v_cvt_pk_bf16_f32 v179, v186, v187
  v_permlane32_swap_b32 v172, v174
  v_permlane32_swap_b32 v173, v175
  buffer_store_dwordx4 v[172:175], v4, s[8:11], s32 offen offset:0 sc1
  v_permlane32_swap_b32 v176, v178
  v_permlane32_swap_b32 v177, v179
  buffer_store_dwordx4 v[176:179], v4, s[8:11], s32 offen offset:32 sc1
  s_endpgm
.text
code_end:
.fill 64, 4, 0xbf800000
.section .rodata,"a"
.p2align 6
.amdhsa_kernel proj_kernel
  .amdhsa_next_free_vgpr 220
  .amdhsa_next_free_sgpr 96
  .amdhsa_accum_offset 220
  .amdhsa_group_segment_fixed_size 0
  .amdhsa_kernarg_size 88
  .amdhsa_user_sgpr_count 2
  .amdhsa_user_sgpr_kernarg_segment_ptr 1
  .amdhsa_system_sgpr_workgroup_id_x 1
  .amdhsa_float_denorm_mode_32 3
.end_amdhsa_kernel
.section .rodata,"a"
.p2align 6
.amdhsa_kernel main_kernel
  .amdhsa_next_free_vgpr 256
  .amdhsa_next_free_sgpr 96
  .amdhsa_accum_offset 256
  .amdhsa_group_segment_fixed_size 0
  .amdhsa_kernarg_size 88
  .amdhsa_user_sgpr_count 2
  .amdhsa_user_sgpr_kernarg_segment_ptr 1
  .amdhsa_system_sgpr_workgroup_id_x 1
  .amdhsa_float_denorm_mode_32 3
.end_amdhsa_kernel
```
